```python
import torch

def _softmax(x, axis=-1):
    return torch.softmax(x, dim=axis)
def _gelu(x):
    return torch.nn.functional.gelu(x, approximate="tanh")
def _silu(x):
    return torch.nn.functional.silu(x)
def _sigmoid(x):
    return torch.sigmoid(x)
def _layernorm(x, axis=-1, eps=1e-5):
    m = x.mean(dim=axis, keepdim=True)
    v = x.var(dim=axis, keepdim=True, unbiased=False)
    return (x - m) / torch.sqrt(v + eps)
def _scatter_add(tgt, idx, src, axis=0):
    return tgt.clone().index_add_(axis, idx, src)
def _segment_sum(src, seg, n):
    out = torch.zeros((n,) + src.shape[1:], dtype=src.dtype)
    return out.index_add_(0, seg, src)
def _pad(x, pw):
    flat = tuple(v for pair in reversed(pw) for v in pair)
    return torch.nn.functional.pad(x, flat)

kernel_name = 'gated_mix__compressed_kv_cla__geglu_ffn__prompt'

def setup_inputs():

    _w = (lambda a: (lambda t: t.to(torch.bfloat16) if t.is_floating_point() else t)(torch.as_tensor(a)))
    def _A_setup():
        B, H, Sq, Sk, D, M = 1, 16, 2048, 2048, 256, 448
        Dc = 4 * D
        return {
            "x": _w((lambda *s: torch.randn(*s, dtype=torch.bfloat16) * 0.05)(B, Sq, M)),
            "c_kv": _w((lambda *s: torch.randn(*s, dtype=torch.bfloat16) * 0.8)(B, Sk, Dc)),
            "w_q": _w((lambda *s: torch.randn(*s, dtype=torch.bfloat16) * 6.4)(M, H, D) * (M ** -0.5)),
            "w_uk": _w((lambda *s: torch.randn(*s, dtype=torch.bfloat16) * 6.4)(Dc, H, D) * (Dc ** -0.5)),
            "w_uv": _w((lambda *s: torch.randn(*s, dtype=torch.bfloat16) * 0.8)(Dc, H, D) * (Dc ** -0.5)),
            "w_o": _w((lambda *s: torch.randn(*s, dtype=torch.bfloat16) * 0.8)(H, D, M) * ((H * D) ** -0.5)),
        }
    _A_in = _A_setup()

    def _B_setup():
        B, S, D, F = 1, 2048, 448, 1792
        return {
            "x": _w((lambda *s: torch.randn(*s, dtype=torch.bfloat16) * 0.05)(B, S, D)),
            "w_gate": _w((lambda *s: torch.randn(*s, dtype=torch.bfloat16) * 0.2)(D, F)),
            "w_up": _w((lambda *s: torch.randn(*s, dtype=torch.bfloat16) * 0.2)(D, F)),
            "w_down": _w((lambda *s: torch.randn(*s, dtype=torch.bfloat16) * 0.2)(F, D)),
        }
    _B_in = _B_setup()

    return {
        "A_x": _A_in["x"],
        "A_c_kv": _A_in["c_kv"],
        "A_w_q": _A_in["w_q"],
        "A_w_uk": _A_in["w_uk"],
        "A_w_uv": _A_in["w_uv"],
        "A_w_o": _A_in["w_o"],
        "B_x": _B_in["x"],
        "B_w_gate": _B_in["w_gate"],
        "B_w_up": _B_in["w_up"],
        "B_w_down": _B_in["w_down"],
        "gate_w": _w((lambda *s: torch.randn(*s, dtype=torch.bfloat16) * 0.05)(448) * 16.0),
    }

def reference(A_x, A_c_kv, A_w_q, A_w_uk, A_w_uv, A_w_o, B_x, B_w_gate, B_w_up, B_w_down, gate_w):
    def _A_ref(x, c_kv, w_q, w_uk, w_uv, w_o):
        B, Sq, M = x.shape[0], x.shape[1], x.shape[2]
        Sk = c_kv.shape[1]
        H, D = w_q.shape[1], w_q.shape[2]
        q = torch.einsum("bqm,mhd->bhqd", x, w_q)
        k = torch.einsum("bkc,chd->bhkd", c_kv, w_uk)
        v = torch.einsum("bkc,chd->bhkd", c_kv, w_uv)
        scores = torch.einsum("bhqd,bhkd->bhqk", q, k) * (D ** -0.5)
        off = Sk - Sq
        qi = torch.arange(Sq)[:, None]
        kj = torch.arange(Sk)[None, :]
        cmask = kj <= (qi + off)
        scores = torch.where(cmask[None, None], scores, -1e9)
        p = _softmax(scores, axis=-1)
        ctx = torch.einsum("bhqk,bhkd->bhqd", p, v)
        return torch.einsum("bhqd,hdm->bqm", ctx, w_o)

    def _B_ref(x, w_gate, w_up, w_down):
        return (_gelu(x @ w_gate) * (x @ w_up)) @ w_down

    x = A_x
    g = _sigmoid((x * gate_w).sum(-1, keepdims=True))
    a = _A_ref(x, A_c_kv, A_w_q, A_w_uk, A_w_uv, A_w_o)
    b = _B_ref(x, B_w_gate, B_w_up, B_w_down)
    return g * a + (1 - g) * b
```

```asm
; @launch kernel=k1_proj_kernel grid=(256,1,1) block=(256,1,1) lds=131072
; @launch kernel=k2_attn_kernel grid=(256,1,1) block=(256,1,1) lds=131072
; @launch kernel=k4_red_kernel grid=(224,1,1) block=(512,1,1) lds=0
.amdgcn_target "amdgcn-amd-amdhsa--gfx950"
.text
.globl k1_proj_kernel
.p2align 8
.type k1_proj_kernel,@function
k1_proj_kernel:
    s_cmp_ge_u32 s2, 256
    s_cbranch_scc1 K1_END
    s_load_dwordx2 s[72:73], s[0:1], 0
    s_load_dwordx2 s[74:75], s[0:1], 8
    s_load_dwordx2 s[76:77], s[0:1], 16
    s_load_dwordx2 s[78:79], s[0:1], 24
    s_load_dwordx2 s[80:81], s[0:1], 32
    s_load_dwordx2 s[84:85], s[0:1], 56
    s_load_dwordx2 s[86:87], s[0:1], 64
    s_load_dwordx2 s[88:89], s[0:1], 80
    s_load_dwordx2 s[90:91], s[0:1], 104
    s_load_dwordx2 s[98:99], s[0:1], 40
    s_load_dwordx2 s[100:101], s[0:1], 72
    v_lshrrev_b32 v3, 6, v0
    v_and_b32 v1, 63, v0
    s_nop 0
    v_readfirstlane_b32 s3, v3
    s_getpc_b64 s[92:93]
CPF_1:
    v_lshlrev_b32 v32, 7, v0
    v_min_u32 v33, K4_END-CPF_1-4, v32
    global_load_dword v3, v33, s[92:93]
    v_add_u32 v32, 32768, v32
    v_min_u32 v33, K4_END-CPF_1-4, v32
    global_load_dword v3, v33, s[92:93]
    v_add_u32 v32, 32768, v32
    v_min_u32 v33, K4_END-CPF_1-4, v32
    global_load_dword v3, v33, s[92:93]
    v_add_u32 v32, 32768, v32
    v_min_u32 v33, K4_END-CPF_1-4, v32
    global_load_dword v3, v33, s[92:93]
    s_and_b32 s4, s2, 7
    s_lshr_b32 s5, s2, 3
    s_and_b32 s6, s5, 3
    s_lshl_b32 s7, s4, 2
    s_add_u32 s6, s6, s7
    s_and_b32 s68, s6, 1
    s_lshr_b32 s6, s6, 1
    s_lshr_b32 s7, s5, 2
    s_lshl_b32 s64, s3, 13
    v_lshrrev_b32 v32, 3, v1
    v_lshrrev_b32 v33, 4, v1
    v_and_b32 v34, 7, v1
    v_xor_b32 v34, v34, v33
    v_lshlrev_b32 v34, 4, v34
    s_lshl_b32 s92, s3, 6
    s_lshl_b32 s93, s7, 8
    s_add_u32 s93, s93, s92
    v_add_u32 v35, s93, v32
    v_lshlrev_b32 v35, 11, v35
    v_add_u32 v4, v35, v34
    v_xor_b32 v5, 64, v4
    v_bfe_u32 v36, v1, 1, 3
    v_xor_b32 v36, v36, v33
    v_lshlrev_b32 v36, 5, v36
    v_and_b32 v37, 1, v1
    v_lshl_add_u32 v36, v37, 4, v36
    v_xor_b32 v38, 128, v36
    s_and_b32 s92, s3, 1
    s_lshl_b32 s92, s92, 5
    v_add_u32 v37, s92, v33
    s_lshr_b32 s92, s3, 1
    s_lshl_b32 s93, s6, 9
    s_lshl_b32 s31, s92, 8
    s_add_u32 s93, s93, s31
    v_lshlrev_b32 v39, 13, v37
    v_add3_u32 v6, v39, v36, s93
    v_add3_u32 v7, v39, v38, s93
    s_mov_b32 s32, 0
    s_mov_b32 s40, 0
    s_mov_b32 s33, 15360
    s_mov_b32 s41, 31744
    s_mov_b32 s34, 30720
    s_mov_b32 s42, 63488
    s_mov_b32 s35, 46080
    s_mov_b32 s43, 95232
    s_mov_b32 s36, 65536
    s_mov_b32 s44, 131072
    s_mov_b32 s37, 80896
    s_mov_b32 s45, 162816
    s_mov_b32 s38, 96256
    s_mov_b32 s46, 194560
    s_mov_b32 s39, 111616
    s_mov_b32 s47, 226304
    s_mov_b32 s65, 524288
    s_mov_b32 s10, 4194304
    s_mov_b32 s11, 0x20000
    s_mov_b32 s14, 8388608
    s_mov_b32 s15, 0x20000
    s_cmp_eq_u32 s68, 0
    s_waitcnt lgkmcnt(0)
    s_mov_b32 s8, s74
    s_mov_b32 s9, s75
    s_cselect_b32 s12, s78, s80
    s_cselect_b32 s13, s79, s81
    s_add_u32 m0, s64, 0
    s_nop 0
    buffer_load_dwordx4 v4, s[8:11], s32 offen offset:0  lds
    s_mov_b32 s16, s72
    s_mov_b32 s17, s73
    s_mov_b32 s18, 1835008
    s_mov_b32 s19, 0x20000
    s_mov_b32 s24, s90
    s_mov_b32 s25, s91
    s_mov_b32 s26, 268435456
    s_mov_b32 s27, 0x20000
    buffer_load_dwordx4 v5, s[8:11], s33 offen offset:1024  lds
    s_cmp_ge_u32 s5, 16
    s_cselect_b32 s69, 1, 0
    s_cmp_ge_u32 s5, 30
    s_cselect_b32 s69, 2, s69
    s_cmp_ge_u32 s3, 2
    s_cselect_b32 s20, s86, s84
    s_cselect_b32 s21, s87, s85
    s_cmp_eq_u32 s69, 1
    s_cselect_b32 s20, s20, s76
    s_cselect_b32 s21, s21, s77
    s_movk_i32 s83, 8192
    s_cselect_b32 s83, 3584, s83
    buffer_load_dwordx4 v4, s[8:11], s34 offen offset:2048  lds
    s_mul_i32 s22, s83, 448
    s_mov_b32 s23, 0x20000
    s_mov_b32 s48, 0
    s_mul_i32 s56, s83, 0
    s_mov_b32 s49, 6144
    s_mul_i32 s57, s83, 4
    s_sub_u32 s57, s57, 1024
    s_mov_b32 s50, 12288
    buffer_load_dwordx4 v5, s[8:11], s35 offen offset:3072  lds
    s_mul_i32 s58, s83, 8
    s_sub_u32 s58, s58, 2048
    s_mov_b32 s51, 18432
    s_mul_i32 s59, s83, 12
    s_sub_u32 s59, s59, 3072
    s_mov_b32 s52, 28672
    s_mul_i32 s60, s83, 16
    s_mov_b32 s53, 34816
    s_add_u32 m0, s64, 4096
    s_nop 0
    buffer_load_dwordx4 v4, s[8:11], s36 offen offset:0  lds
    s_mul_i32 s61, s83, 20
    s_sub_u32 s61, s61, 1024
    s_mov_b32 s54, 40960
    s_mul_i32 s62, s83, 24
    s_sub_u32 s62, s62, 2048
    s_mov_b32 s55, 47104
    s_mul_i32 s63, s83, 28
    s_sub_u32 s63, s63, 3072
    buffer_load_dwordx4 v5, s[8:11], s37 offen offset:1024  lds
    s_lshl_b32 s66, s83, 6
    s_and_b32 s28, s5, 1
    s_lshl_b32 s29, s4, 1
    s_add_u32 s28, s28, s29
    s_lshr_b32 s29, s5, 1
    s_and_b32 s29, s29, 7
    s_sub_u32 s30, s5, 16
    s_cmp_ge_u32 s30, 7
    s_cselect_b32 s31, 1, 0
    buffer_load_dwordx4 v4, s[8:11], s38 offen offset:2048  lds
    s_mul_i32 s92, s31, 7
    s_sub_u32 s30, s30, s92
    s_and_b32 s92, s4, 1
    s_mul_i32 s92, s92, 7
    s_add_u32 s30, s30, s92
    s_and_b32 s92, s4, 6
    s_add_u32 s31, s31, s92
    s_cmp_eq_u32 s69, 1
    s_cselect_b32 s29, s31, s29
    buffer_load_dwordx4 v5, s[8:11], s39 offen offset:3072  lds
    s_lshl_b32 s92, s3, 6
    s_lshl_b32 s93, s29, 8
    s_add_u32 s93, s93, s92
    v_add_u32 v35, s93, v32
    s_movk_i32 s93, 896
    v_mul_lo_u32 v35, v35, s93
    v_add_u32 v8, v35, v34
    v_xor_b32 v9, 64, v8
    s_add_u32 m0, s64, 65536
    s_nop 0
    buffer_load_dwordx4 v6, s[12:15], s40 offen offset:0  lds
    s_lshr_b32 s92, s3, 1
    s_lshl_b32 s31, s92, 8
    s_lshl_b32 s93, s28, 9
    s_add_u32 s93, s93, s31
    s_lshl_b32 s31, s30, 8
    s_cmp_eq_u32 s69, 1
    s_cselect_b32 s93, s31, s93
    v_mul_lo_u32 v39, v37, s83
    buffer_load_dwordx4 v6, s[12:15], s41 offen offset:1024  lds
    v_add3_u32 v10, v39, v36, s93
    v_add3_u32 v11, v39, v38, s93
    v_and_b32 v32, 15, v1
    v_lshrrev_b32 v34, 1, v32
    v_xor_b32 v34, v34, v33
    s_and_b32 s92, s3, 1
    s_lshl_b32 s92, s92, 7
    v_add_u32 v35, s92, v32
    buffer_load_dwordx4 v7, s[12:15], s42 offen offset:2048  lds
    v_lshlrev_b32 v35, 7, v35
    v_xor_b32 v36, 0, v34
    v_lshl_add_u32 v12, v36, 4, v35
    v_xor_b32 v36, 4, v34
    v_lshl_add_u32 v13, v36, 4, v35
    v_bfe_u32 v34, v1, 2, 2
    v_lshlrev_b32 v35, 11, v33
    v_lshl_add_u32 v35, v34, 8, v35
    buffer_load_dwordx4 v7, s[12:15], s43 offen offset:3072  lds
    v_and_b32 v36, 3, v1
    v_lshl_add_u32 v35, v36, 3, v35
    v_add_u32 v35, 0x10000, v35
    v_and_b32 v36, 1, v33
    v_lshl_or_b32 v34, v36, 2, v34
    s_lshr_b32 s92, s3, 1
    s_lshl_b32 s93, s92, 14
    s_lshl_b32 s31, s92, 2
    s_add_u32 m0, s64, 69632
    s_nop 0
    buffer_load_dwordx4 v6, s[12:15], s44 offen offset:0  lds
    s_cmp_eq_u32 s69, 1
    s_cselect_b64 vcc, -1, 0
    v_xor_b32 v36, 0, v34
    v_lshl_add_u32 v36, v36, 5, v35
    v_add_u32 v16, s93, v36
    s_add_u32 s94, s31, 0
    v_xor_b32 v36, s94, v34
    v_lshl_add_u32 v36, v36, 5, v35
    buffer_load_dwordx4 v6, s[12:15], s45 offen offset:1024  lds
    v_add_u32 v36, 0, v36
    v_cndmask_b32 v24, v16, v36, vcc
    v_xor_b32 v36, 1, v34
    v_lshl_add_u32 v36, v36, 5, v35
    v_add_u32 v17, s93, v36
    s_add_u32 s94, s31, 1
    v_xor_b32 v36, s94, v34
    v_lshl_add_u32 v36, v36, 5, v35
    buffer_load_dwordx4 v7, s[12:15], s46 offen offset:2048  lds
    v_add_u32 v36, 0, v36
    v_cndmask_b32 v25, v17, v36, vcc
    v_xor_b32 v36, 2, v34
    v_lshl_add_u32 v36, v36, 5, v35
    v_add_u32 v18, s93, v36
    s_add_u32 s94, s31, 2
    v_xor_b32 v36, s94, v34
    v_lshl_add_u32 v36, v36, 5, v35
    buffer_load_dwordx4 v7, s[12:15], s47 offen offset:3072  lds
    v_add_u32 v36, 0, v36
    v_cndmask_b32 v26, v18, v36, vcc
    v_xor_b32 v36, 3, v34
    v_lshl_add_u32 v36, v36, 5, v35
    v_add_u32 v19, s93, v36
    s_add_u32 s94, s31, 3
    v_xor_b32 v36, s94, v34
    v_lshl_add_u32 v36, v36, 5, v35
    v_add_u32 v4, 128, v4
    v_add_u32 v5, 128, v5
    v_add_u32 v6, s65, v6
    v_add_u32 v7, s65, v7
    s_add_u32 m0, s64, 32768
    s_nop 0
    buffer_load_dwordx4 v4, s[8:11], s32 offen offset:0  lds
    v_add_u32 v36, 0, v36
    v_cndmask_b32 v27, v19, v36, vcc
    v_xor_b32 v36, 4, v34
    v_lshl_add_u32 v36, v36, 5, v35
    v_add_u32 v20, s93, v36
    s_add_u32 s94, s31, 0
    v_xor_b32 v36, s94, v34
    v_lshl_add_u32 v36, v36, 5, v35
    buffer_load_dwordx4 v5, s[8:11], s33 offen offset:1024  lds
    v_add_u32 v36, 16384, v36
    v_cndmask_b32 v28, v20, v36, vcc
    v_xor_b32 v36, 5, v34
    v_lshl_add_u32 v36, v36, 5, v35
    v_add_u32 v21, s93, v36
    s_add_u32 s94, s31, 1
    v_xor_b32 v36, s94, v34
    v_lshl_add_u32 v36, v36, 5, v35
    buffer_load_dwordx4 v4, s[8:11], s34 offen offset:2048  lds
    v_add_u32 v36, 16384, v36
    v_cndmask_b32 v29, v21, v36, vcc
    v_xor_b32 v36, 6, v34
    v_lshl_add_u32 v36, v36, 5, v35
    v_add_u32 v22, s93, v36
    s_add_u32 s94, s31, 2
    v_xor_b32 v36, s94, v34
    v_lshl_add_u32 v36, v36, 5, v35
    buffer_load_dwordx4 v5, s[8:11], s35 offen offset:3072  lds
    v_add_u32 v36, 16384, v36
    v_cndmask_b32 v30, v22, v36, vcc
    v_xor_b32 v36, 7, v34
    v_lshl_add_u32 v36, v36, 5, v35
    v_add_u32 v23, s93, v36
    s_add_u32 s94, s31, 3
    v_xor_b32 v36, s94, v34
    v_lshl_add_u32 v36, v36, 5, v35
    s_add_u32 m0, s64, 36864
    s_nop 0
    buffer_load_dwordx4 v4, s[8:11], s36 offen offset:0  lds
    v_add_u32 v36, 16384, v36
    v_cndmask_b32 v31, v23, v36, vcc
    v_lshlrev_b32 v2, 4, v1
    s_and_b32 s92, s3, 1
    s_lshr_b32 s93, s3, 1
    s_lshl_b32 s4, s6, 7
    s_lshl_b32 s5, s7, 4
    s_add_u32 s4, s4, s5
    buffer_load_dwordx4 v5, s[8:11], s37 offen offset:1024  lds
    s_lshl_b32 s5, s92, 3
    s_add_u32 s4, s4, s5
    s_lshl_b32 s4, s4, 13
    s_lshl_b32 s5, s93, 12
    s_add_u32 s5, s4, s5
    s_add_u32 s5, s5, 16777216
    s_lshl_b32 s31, s93, 13
    s_add_u32 s4, s4, s31
    buffer_load_dwordx4 v4, s[8:11], s38 offen offset:2048  lds
    s_add_u32 s4, s4, 33554432
    s_cmp_eq_u32 s68, 0
    s_cselect_b32 s70, s5, s4
    s_lshl_b32 s4, s28, 7
    s_lshl_b32 s5, s29, 4
    s_lshl_b32 s31, s92, 3
    s_add_u32 s5, s5, s31
    s_add_u32 s4, s4, s5
    buffer_load_dwordx4 v5, s[8:11], s39 offen offset:3072  lds
    s_lshl_b32 s4, s4, 13
    s_lshl_b32 s6, s93, 12
    s_add_u32 s4, s4, s6
    s_add_u32 s4, s4, 0
    s_mul_i32 s5, s5, 184
    s_lshl_b32 s6, s30, 2
    s_add_u32 s5, s5, s6
    s_lshl_b32 s6, s93, 1
    s_add_u32 m0, s64, 98304
    s_nop 0
    buffer_load_dwordx4 v6, s[12:15], s40 offen offset:0  lds
    s_add_u32 s5, s5, s6
    s_add_u32 s5, s5, 128
    s_lshl_b32 s5, s5, 10
    s_add_u32 s5, s5, 50331648
    s_cmp_eq_u32 s69, 1
    s_cselect_b32 s71, s5, s4
    s_and_b32 s4, s2, 7
    s_lshr_b32 s5, s2, 3
    buffer_load_dwordx4 v6, s[12:15], s41 offen offset:1024  lds
    s_lshl_b32 s4, s4, 1
    s_add_u32 s4, s4, s5
    s_sub_u32 s82, s4, 30
    s_lshr_b32 s4, s2, 3
    s_and_b32 s5, s4, 3
    s_lshr_b32 s6, s4, 2
    s_lshl_b32 s7, s6, 8
    s_lshl_b32 s5, s5, 6
    buffer_load_dwordx4 v7, s[12:15], s42 offen offset:2048  lds
    s_add_u32 s7, s7, s5
    s_lshl_b32 s5, s3, 4
    s_add_u32 s7, s7, s5
    v_add_u32 v32, s7, v1
    v_lshlrev_b32 v32, 11, v32
    v_add_u32 v32, 256, v32
    v_mov_b32 v33, 0x7f000000
    v_cmp_gt_u32 vcc, 16, v1
    buffer_load_dwordx4 v7, s[12:15], s43 offen offset:3072  lds
    s_nop 1
    v_cndmask_b32 v14, v33, v32, vcc
    s_lshl_b32 s6, s6, 3
    s_lshl_b32 s5, s3, 1
    s_add_u32 s6, s6, s5
    s_add_u32 s6, s6, 128
    v_lshrrev_b32 v32, 2, v1
    v_add_u32 v32, s6, v32
    s_add_u32 m0, s64, 102400
    s_nop 0
    buffer_load_dwordx4 v6, s[12:15], s44 offen offset:0  lds
    v_lshlrev_b32 v32, 13, v32
    v_and_b32 v34, 3, v1
    v_lshl_add_u32 v32, v34, 7, v32
    s_and_b32 s4, s2, 7
    s_lshr_b32 s5, s2, 3
    s_and_b32 s5, s5, 3
    s_lshl_b32 s4, s4, 2
    s_add_u32 s4, s4, s5
    buffer_load_dwordx4 v6, s[12:15], s45 offen offset:1024  lds
    s_lshr_b32 s4, s4, 1
    s_lshl_b32 s4, s4, 9
    v_add_u32 v32, s4, v32
    v_cmp_gt_u32 vcc, 8, v1
    s_nop 1
    v_cndmask_b32 v15, v33, v32, vcc
    s_cmp_eq_u32 s68, 0
    s_movk_i32 s75, 4096
    s_cselect_b32 s75, 8192, s75
    buffer_load_dwordx4 v7, s[12:15], s46 offen offset:2048  lds
    s_lshr_b32 s4, s2, 3
    s_and_b32 s4, s4, 1
    s_lshl_b32 s4, s4, 7
    s_lshl_b32 s5, s29, 8
    s_add_u32 s4, s4, s5
    s_lshl_b32 s5, s3, 5
    s_add_u32 s4, s4, s5
    v_add_u32 v32, s4, v1
    buffer_load_dwordx4 v7, s[12:15], s47 offen offset:3072  lds
    v_add_u32 v4, 128, v4
    v_add_u32 v5, 128, v5
    v_add_u32 v6, s65, v6
    v_add_u32 v7, s65, v7
    s_movk_i32 s4, 896
    v_mul_lo_u32 v32, v32, s4
    v_cmp_gt_u32 vcc, 32, v1
    s_nop 1
    v_cndmask_b32 v124, v33, v32, vcc
    s_lshl_b32 s4, s29, 3
    s_lshl_b32 s5, s3, 1
    s_add_u32 s4, s4, s5
    v_lshrrev_b32 v32, 2, v1
    v_add_u32 v32, s4, v32
    v_lshlrev_b32 v32, 13, v32
    v_and_b32 v34, 3, v1
    v_lshl_add_u32 v32, v34, 7, v32
    s_lshl_b32 s4, s28, 9
    v_add_u32 v32, s4, v32
    v_cmp_gt_u32 vcc, 8, v1
    s_nop 1
    v_cndmask_b32 v32, v33, v32, vcc
    s_and_b32 s4, s3, 1
    s_lshl_b32 s4, s4, 5
    v_lshrrev_b32 v34, 1, v1
    v_add_u32 v34, s4, v34
    v_mul_u32_u24 v34, 3584, v34
    v_and_b32 v35, 1, v1
    v_lshl_add_u32 v34, v35, 7, v34
    s_lshl_b32 s4, s30, 8
    v_add_u32 v34, s4, v34
    s_cmp_eq_u32 s69, 1
    s_cselect_b64 vcc, -1, 0
    v_cndmask_b32 v125, v32, v34, vcc
    s_cmp_eq_u32 s69, 2
    s_cbranch_scc0 K1_NOGPF
    s_lshl_b32 s92, s82, 2
    s_add_u32 s92, s92, s3
    s_mov_b32 s31, 0x20000
    v_lshlrev_b32 v33, 7, v1
    s_mov_b32 s28, s84
    s_mov_b32 s29, s85
    s_mov_b32 s30, 1605632
    s_mul_i32 s93, s92, 25088
    v_add_u32 v32, s93, v33
    buffer_load_dword v3, v32, s[28:31], 0 offen
    v_add_u32 v32, 8192, v32
    s_waitcnt vmcnt(12)
    buffer_load_dword v3, v32, s[28:31], 0 offen
    v_add_u32 v32, 8192, v32
    s_waitcnt vmcnt(12)
    buffer_load_dword v3, v32, s[28:31], 0 offen
    v_add_u32 v32, 8192, v32
    s_waitcnt vmcnt(12)
    buffer_load_dword v3, v32, s[28:31], 0 offen
    s_waitcnt vmcnt(12)
    s_mov_b32 s28, s86
    s_mov_b32 s29, s87
    s_mov_b32 s30, 1605632
    s_mul_i32 s93, s92, 25088
    v_add_u32 v32, s93, v33
    buffer_load_dword v3, v32, s[28:31], 0 offen
    v_add_u32 v32, 8192, v32
    s_waitcnt vmcnt(12)
    buffer_load_dword v3, v32, s[28:31], 0 offen
    v_add_u32 v32, 8192, v32
    s_waitcnt vmcnt(12)
    buffer_load_dword v3, v32, s[28:31], 0 offen
    v_add_u32 v32, 8192, v32
    s_waitcnt vmcnt(12)
    buffer_load_dword v3, v32, s[28:31], 0 offen
    s_waitcnt vmcnt(12)
K1_NOGPF:
    buffer_load_dword v3, v14, s[8:11], 0 offen
    buffer_load_dword v3, v15, s[12:15], 0 offen
    v_add_u32 v14, 128, v14
    v_add_u32 v15, s65, v15
    buffer_load_dword v3, v14, s[8:11], 0 offen
    buffer_load_dword v3, v15, s[12:15], 0 offen
    v_add_u32 v14, 128, v14
    v_add_u32 v15, s65, v15
    s_waitcnt vmcnt(20)
    s_barrier
    ds_read_b128 v[128:131], v12 offset:0
    ds_read_b64_tr_b16 v[160:161], v16 offset:0
    ds_read_b64_tr_b16 v[162:163], v16 offset:1024
    ds_read_b128 v[132:135], v12 offset:2048
    ds_read_b64_tr_b16 v[164:165], v17 offset:0
    ds_read_b64_tr_b16 v[166:167], v17 offset:1024
    ds_read_b128 v[136:139], v12 offset:4096
    ds_read_b64_tr_b16 v[168:169], v18 offset:0
    ds_read_b64_tr_b16 v[170:171], v18 offset:1024
    ds_read_b128 v[140:143], v12 offset:6144
    ds_read_b64_tr_b16 v[172:173], v19 offset:0
    ds_read_b64_tr_b16 v[174:175], v19 offset:1024
    ds_read_b128 v[144:147], v12 offset:8192
    ds_read_b64_tr_b16 v[176:177], v20 offset:0
    ds_read_b64_tr_b16 v[178:179], v20 offset:1024
    ds_read_b128 v[148:151], v12 offset:10240
    ds_read_b64_tr_b16 v[180:181], v21 offset:0
    ds_read_b64_tr_b16 v[182:183], v21 offset:1024
    ds_read_b128 v[152:155], v12 offset:12288
    ds_read_b64_tr_b16 v[184:185], v22 offset:0
    ds_read_b64_tr_b16 v[186:187], v22 offset:1024
    ds_read_b128 v[156:159], v12 offset:14336
    ds_read_b64_tr_b16 v[188:189], v23 offset:0
    ds_read_b64_tr_b16 v[190:191], v23 offset:1024
    s_cmp_eq_u32 s68, 1
    s_cbranch_scc1 K1_V
    s_waitcnt lgkmcnt(0)
    v_mfma_f32_16x16x32_bf16 a[0:3], v[160:163], v[128:131], 0
    v_mfma_f32_16x16x32_bf16 a[4:7], v[160:163], v[132:135], 0
    ds_read_b128 v[192:195], v13 offset:0
    v_mfma_f32_16x16x32_bf16 a[8:11], v[160:163], v[136:139], 0
    v_mfma_f32_16x16x32_bf16 a[12:15], v[160:163], v[140:143], 0
    ds_read_b64_tr_b16 v[224:225], v16 offset:8192
    v_mfma_f32_16x16x32_bf16 a[16:19], v[160:163], v[144:147], 0
    v_mfma_f32_16x16x32_bf16 a[20:23], v[160:163], v[148:151], 0
    ds_read_b64_tr_b16 v[226:227], v16 offset:9216
    v_mfma_f32_16x16x32_bf16 a[24:27], v[160:163], v[152:155], 0
    v_mfma_f32_16x16x32_bf16 a[28:31], v[160:163], v[156:159], 0
    ds_read_b128 v[196:199], v13 offset:2048
    v_mfma_f32_16x16x32_bf16 a[60:63], v[164:167], v[156:159], 0
    v_mfma_f32_16x16x32_bf16 a[56:59], v[164:167], v[152:155], 0
    ds_read_b64_tr_b16 v[228:229], v17 offset:8192
    v_mfma_f32_16x16x32_bf16 a[52:55], v[164:167], v[148:151], 0
    v_mfma_f32_16x16x32_bf16 a[48:51], v[164:167], v[144:147], 0
    ds_read_b64_tr_b16 v[230:231], v17 offset:9216
    v_mfma_f32_16x16x32_bf16 a[44:47], v[164:167], v[140:143], 0
    v_mfma_f32_16x16x32_bf16 a[40:43], v[164:167], v[136:139], 0
    ds_read_b128 v[200:203], v13 offset:4096
    v_mfma_f32_16x16x32_bf16 a[36:39], v[164:167], v[132:135], 0
    v_mfma_f32_16x16x32_bf16 a[32:35], v[164:167], v[128:131], 0
    ds_read_b64_tr_b16 v[232:233], v18 offset:8192
    v_mfma_f32_16x16x32_bf16 a[64:67], v[168:171], v[128:131], 0
    v_mfma_f32_16x16x32_bf16 a[68:71], v[168:171], v[132:135], 0
    ds_read_b64_tr_b16 v[234:235], v18 offset:9216
    v_mfma_f32_16x16x32_bf16 a[72:75], v[168:171], v[136:139], 0
    v_mfma_f32_16x16x32_bf16 a[76:79], v[168:171], v[140:143], 0
    ds_read_b128 v[204:207], v13 offset:6144
    v_mfma_f32_16x16x32_bf16 a[80:83], v[168:171], v[144:147], 0
    v_mfma_f32_16x16x32_bf16 a[84:87], v[168:171], v[148:151], 0
    ds_read_b64_tr_b16 v[236:237], v19 offset:8192
    v_mfma_f32_16x16x32_bf16 a[88:91], v[168:171], v[152:155], 0
    v_mfma_f32_16x16x32_bf16 a[92:95], v[168:171], v[156:159], 0
    ds_read_b64_tr_b16 v[238:239], v19 offset:9216
    v_mfma_f32_16x16x32_bf16 a[124:127], v[172:175], v[156:159], 0
    v_mfma_f32_16x16x32_bf16 a[120:123], v[172:175], v[152:155], 0
    ds_read_b128 v[208:211], v13 offset:8192
    v_mfma_f32_16x16x32_bf16 a[116:119], v[172:175], v[148:151], 0
    v_mfma_f32_16x16x32_bf16 a[112:115], v[172:175], v[144:147], 0
    ds_read_b64_tr_b16 v[240:241], v20 offset:8192
    v_mfma_f32_16x16x32_bf16 a[108:111], v[172:175], v[140:143], 0
    v_mfma_f32_16x16x32_bf16 a[104:107], v[172:175], v[136:139], 0
    ds_read_b64_tr_b16 v[242:243], v20 offset:9216
    v_mfma_f32_16x16x32_bf16 a[100:103], v[172:175], v[132:135], 0
    v_mfma_f32_16x16x32_bf16 a[96:99], v[172:175], v[128:131], 0
    ds_read_b128 v[212:215], v13 offset:10240
    v_mfma_f32_16x16x32_bf16 a[128:131], v[176:179], v[128:131], 0
    v_mfma_f32_16x16x32_bf16 a[132:135], v[176:179], v[132:135], 0
    ds_read_b64_tr_b16 v[244:245], v21 offset:8192
    v_mfma_f32_16x16x32_bf16 a[136:139], v[176:179], v[136:139], 0
    v_mfma_f32_16x16x32_bf16 a[140:143], v[176:179], v[140:143], 0
    ds_read_b64_tr_b16 v[246:247], v21 offset:9216
    v_mfma_f32_16x16x32_bf16 a[144:147], v[176:179], v[144:147], 0
    v_mfma_f32_16x16x32_bf16 a[148:151], v[176:179], v[148:151], 0
    ds_read_b128 v[216:219], v13 offset:12288
    v_mfma_f32_16x16x32_bf16 a[152:155], v[176:179], v[152:155], 0
    v_mfma_f32_16x16x32_bf16 a[156:159], v[176:179], v[156:159], 0
    ds_read_b64_tr_b16 v[248:249], v22 offset:8192
    v_mfma_f32_16x16x32_bf16 a[188:191], v[180:183], v[156:159], 0
    v_mfma_f32_16x16x32_bf16 a[184:187], v[180:183], v[152:155], 0
    ds_read_b64_tr_b16 v[250:251], v22 offset:9216
    v_mfma_f32_16x16x32_bf16 a[180:183], v[180:183], v[148:151], 0
    v_mfma_f32_16x16x32_bf16 a[176:179], v[180:183], v[144:147], 0
    ds_read_b128 v[220:223], v13 offset:14336
    v_mfma_f32_16x16x32_bf16 a[172:175], v[180:183], v[140:143], 0
    v_mfma_f32_16x16x32_bf16 a[168:171], v[180:183], v[136:139], 0
    ds_read_b64_tr_b16 v[252:253], v23 offset:8192
    v_mfma_f32_16x16x32_bf16 a[164:167], v[180:183], v[132:135], 0
    v_mfma_f32_16x16x32_bf16 a[160:163], v[180:183], v[128:131], 0
    ds_read_b64_tr_b16 v[254:255], v23 offset:9216
    v_mfma_f32_16x16x32_bf16 a[192:195], v[184:187], v[128:131], 0
    v_mfma_f32_16x16x32_bf16 a[196:199], v[184:187], v[132:135], 0
    v_mfma_f32_16x16x32_bf16 a[200:203], v[184:187], v[136:139], 0
    v_mfma_f32_16x16x32_bf16 a[204:207], v[184:187], v[140:143], 0
    v_mfma_f32_16x16x32_bf16 a[208:211], v[184:187], v[144:147], 0
    v_mfma_f32_16x16x32_bf16 a[212:215], v[184:187], v[148:151], 0
    v_mfma_f32_16x16x32_bf16 a[216:219], v[184:187], v[152:155], 0
    v_mfma_f32_16x16x32_bf16 a[220:223], v[184:187], v[156:159], 0
    v_mfma_f32_16x16x32_bf16 a[252:255], v[188:191], v[156:159], 0
    v_mfma_f32_16x16x32_bf16 a[248:251], v[188:191], v[152:155], 0
    v_mfma_f32_16x16x32_bf16 a[244:247], v[188:191], v[148:151], 0
    v_mfma_f32_16x16x32_bf16 a[240:243], v[188:191], v[144:147], 0
    v_mfma_f32_16x16x32_bf16 a[236:239], v[188:191], v[140:143], 0
    v_mfma_f32_16x16x32_bf16 a[232:235], v[188:191], v[136:139], 0
    v_mfma_f32_16x16x32_bf16 a[228:231], v[188:191], v[132:135], 0
    v_mfma_f32_16x16x32_bf16 a[224:227], v[188:191], v[128:131], 0
    s_waitcnt vmcnt(4) lgkmcnt(0)
    s_barrier
    s_mov_b32 s67, 6
K1_LOOP_K:
    s_waitcnt lgkmcnt(0)
    v_mfma_f32_16x16x32_bf16 a[0:3], v[224:227], v[192:195], a[0:3]
    v_mfma_f32_16x16x32_bf16 a[4:7], v[224:227], v[196:199], a[4:7]
    ds_read_b128 v[128:131], v12 offset:32768
    s_add_u32 m0, s64, 0
    v_mfma_f32_16x16x32_bf16 a[8:11], v[224:227], v[200:203], a[8:11]
    buffer_load_dwordx4 v4, s[8:11], s32 offen offset:0  lds
    v_mfma_f32_16x16x32_bf16 a[12:15], v[224:227], v[204:207], a[12:15]
    ds_read_b64_tr_b16 v[160:161], v16 offset:32768
    v_mfma_f32_16x16x32_bf16 a[16:19], v[224:227], v[208:211], a[16:19]
    v_mfma_f32_16x16x32_bf16 a[20:23], v[224:227], v[212:215], a[20:23]
    ds_read_b64_tr_b16 v[162:163], v16 offset:33792
    v_mfma_f32_16x16x32_bf16 a[24:27], v[224:227], v[216:219], a[24:27]
    buffer_load_dwordx4 v5, s[8:11], s33 offen offset:1024  lds
    v_mfma_f32_16x16x32_bf16 a[28:31], v[224:227], v[220:223], a[28:31]
    ds_read_b128 v[132:135], v12 offset:34816
    v_mfma_f32_16x16x32_bf16 a[60:63], v[228:231], v[220:223], a[60:63]
    v_mfma_f32_16x16x32_bf16 a[56:59], v[228:231], v[216:219], a[56:59]
    ds_read_b64_tr_b16 v[164:165], v17 offset:32768
    v_mfma_f32_16x16x32_bf16 a[52:55], v[228:231], v[212:215], a[52:55]
    buffer_load_dwordx4 v4, s[8:11], s34 offen offset:2048  lds
    v_mfma_f32_16x16x32_bf16 a[48:51], v[228:231], v[208:211], a[48:51]
    ds_read_b64_tr_b16 v[166:167], v17 offset:33792
    v_mfma_f32_16x16x32_bf16 a[44:47], v[228:231], v[204:207], a[44:47]
    v_mfma_f32_16x16x32_bf16 a[40:43], v[228:231], v[200:203], a[40:43]
    ds_read_b128 v[136:139], v12 offset:36864
    v_mfma_f32_16x16x32_bf16 a[36:39], v[228:231], v[196:199], a[36:39]
    buffer_load_dwordx4 v5, s[8:11], s35 offen offset:3072  lds
    v_mfma_f32_16x16x32_bf16 a[32:35], v[228:231], v[192:195], a[32:35]
    ds_read_b64_tr_b16 v[168:169], v18 offset:32768
    v_mfma_f32_16x16x32_bf16 a[64:67], v[232:235], v[192:195], a[64:67]
    v_mfma_f32_16x16x32_bf16 a[68:71], v[232:235], v[196:199], a[68:71]
    ds_read_b64_tr_b16 v[170:171], v18 offset:33792
    s_add_u32 m0, s64, 4096
    v_mfma_f32_16x16x32_bf16 a[72:75], v[232:235], v[200:203], a[72:75]
    buffer_load_dwordx4 v4, s[8:11], s36 offen offset:0  lds
    v_mfma_f32_16x16x32_bf16 a[76:79], v[232:235], v[204:207], a[76:79]
    ds_read_b128 v[140:143], v12 offset:38912
    v_mfma_f32_16x16x32_bf16 a[80:83], v[232:235], v[208:211], a[80:83]
    v_mfma_f32_16x16x32_bf16 a[84:87], v[232:235], v[212:215], a[84:87]
    ds_read_b64_tr_b16 v[172:173], v19 offset:32768
    v_mfma_f32_16x16x32_bf16 a[88:91], v[232:235], v[216:219], a[88:91]
    buffer_load_dwordx4 v5, s[8:11], s37 offen offset:1024  lds
    v_mfma_f32_16x16x32_bf16 a[92:95], v[232:235], v[220:223], a[92:95]
    ds_read_b64_tr_b16 v[174:175], v19 offset:33792
    v_mfma_f32_16x16x32_bf16 a[124:127], v[236:239], v[220:223], a[124:127]
    v_mfma_f32_16x16x32_bf16 a[120:123], v[236:239], v[216:219], a[120:123]
    ds_read_b128 v[144:147], v12 offset:40960
    v_mfma_f32_16x16x32_bf16 a[116:119], v[236:239], v[212:215], a[116:119]
    buffer_load_dwordx4 v4, s[8:11], s38 offen offset:2048  lds
    v_mfma_f32_16x16x32_bf16 a[112:115], v[236:239], v[208:211], a[112:115]
    ds_read_b64_tr_b16 v[176:177], v20 offset:32768
    v_mfma_f32_16x16x32_bf16 a[108:111], v[236:239], v[204:207], a[108:111]
    v_mfma_f32_16x16x32_bf16 a[104:107], v[236:239], v[200:203], a[104:107]
    ds_read_b64_tr_b16 v[178:179], v20 offset:33792
    v_mfma_f32_16x16x32_bf16 a[100:103], v[236:239], v[196:199], a[100:103]
    buffer_load_dwordx4 v5, s[8:11], s39 offen offset:3072  lds
    v_mfma_f32_16x16x32_bf16 a[96:99], v[236:239], v[192:195], a[96:99]
    ds_read_b128 v[148:151], v12 offset:43008
    v_mfma_f32_16x16x32_bf16 a[128:131], v[240:243], v[192:195], a[128:131]
    v_mfma_f32_16x16x32_bf16 a[132:135], v[240:243], v[196:199], a[132:135]
    ds_read_b64_tr_b16 v[180:181], v21 offset:32768
    s_add_u32 m0, s64, 65536
    v_mfma_f32_16x16x32_bf16 a[136:139], v[240:243], v[200:203], a[136:139]
    buffer_load_dwordx4 v6, s[12:15], s40 offen offset:0  lds
    v_mfma_f32_16x16x32_bf16 a[140:143], v[240:243], v[204:207], a[140:143]
    ds_read_b64_tr_b16 v[182:183], v21 offset:33792
    v_mfma_f32_16x16x32_bf16 a[144:147], v[240:243], v[208:211], a[144:147]
    v_mfma_f32_16x16x32_bf16 a[148:151], v[240:243], v[212:215], a[148:151]
    ds_read_b128 v[152:155], v12 offset:45056
    v_mfma_f32_16x16x32_bf16 a[152:155], v[240:243], v[216:219], a[152:155]
    buffer_load_dwordx4 v6, s[12:15], s41 offen offset:1024  lds
    v_mfma_f32_16x16x32_bf16 a[156:159], v[240:243], v[220:223], a[156:159]
    ds_read_b64_tr_b16 v[184:185], v22 offset:32768
    v_mfma_f32_16x16x32_bf16 a[188:191], v[244:247], v[220:223], a[188:191]
    v_mfma_f32_16x16x32_bf16 a[184:187], v[244:247], v[216:219], a[184:187]
    ds_read_b64_tr_b16 v[186:187], v22 offset:33792
    v_mfma_f32_16x16x32_bf16 a[180:183], v[244:247], v[212:215], a[180:183]
    buffer_load_dwordx4 v7, s[12:15], s42 offen offset:2048  lds
    v_mfma_f32_16x16x32_bf16 a[176:179], v[244:247], v[208:211], a[176:179]
    ds_read_b128 v[156:159], v12 offset:47104
    v_mfma_f32_16x16x32_bf16 a[172:175], v[244:247], v[204:207], a[172:175]
    v_mfma_f32_16x16x32_bf16 a[168:171], v[244:247], v[200:203], a[168:171]
    ds_read_b64_tr_b16 v[188:189], v23 offset:32768
    v_mfma_f32_16x16x32_bf16 a[164:167], v[244:247], v[196:199], a[164:167]
    buffer_load_dwordx4 v7, s[12:15], s43 offen offset:3072  lds
    v_mfma_f32_16x16x32_bf16 a[160:163], v[244:247], v[192:195], a[160:163]
    ds_read_b64_tr_b16 v[190:191], v23 offset:33792
    v_mfma_f32_16x16x32_bf16 a[192:195], v[248:251], v[192:195], a[192:195]
    v_mfma_f32_16x16x32_bf16 a[196:199], v[248:251], v[196:199], a[196:199]
    s_add_u32 m0, s64, 69632
    v_mfma_f32_16x16x32_bf16 a[200:203], v[248:251], v[200:203], a[200:203]
    buffer_load_dwordx4 v6, s[12:15], s44 offen offset:0  lds
    v_mfma_f32_16x16x32_bf16 a[204:207], v[248:251], v[204:207], a[204:207]
    v_mfma_f32_16x16x32_bf16 a[208:211], v[248:251], v[208:211], a[208:211]
    v_mfma_f32_16x16x32_bf16 a[212:215], v[248:251], v[212:215], a[212:215]
    v_mfma_f32_16x16x32_bf16 a[216:219], v[248:251], v[216:219], a[216:219]
    buffer_load_dwordx4 v6, s[12:15], s45 offen offset:1024  lds
    v_mfma_f32_16x16x32_bf16 a[220:223], v[248:251], v[220:223], a[220:223]
    v_mfma_f32_16x16x32_bf16 a[252:255], v[252:255], v[220:223], a[252:255]
    v_mfma_f32_16x16x32_bf16 a[248:251], v[252:255], v[216:219], a[248:251]
    v_mfma_f32_16x16x32_bf16 a[244:247], v[252:255], v[212:215], a[244:247]
    buffer_load_dwordx4 v7, s[12:15], s46 offen offset:2048  lds
    v_mfma_f32_16x16x32_bf16 a[240:243], v[252:255], v[208:211], a[240:243]
    v_mfma_f32_16x16x32_bf16 a[236:239], v[252:255], v[204:207], a[236:239]
    v_mfma_f32_16x16x32_bf16 a[232:235], v[252:255], v[200:203], a[232:235]
    v_mfma_f32_16x16x32_bf16 a[228:231], v[252:255], v[196:199], a[228:231]
    buffer_load_dwordx4 v7, s[12:15], s47 offen offset:3072  lds
    v_mfma_f32_16x16x32_bf16 a[224:227], v[252:255], v[192:195], a[224:227]
    s_waitcnt lgkmcnt(0)
    v_add_u32 v4, 128, v4
    v_mfma_f32_16x16x32_bf16 a[0:3], v[160:163], v[128:131], a[0:3]
    v_add_u32 v5, 128, v5
    v_mfma_f32_16x16x32_bf16 a[4:7], v[160:163], v[132:135], a[4:7]
    ds_read_b128 v[192:195], v13 offset:32768
    v_add_u32 v6, s65, v6
    v_mfma_f32_16x16x32_bf16 a[8:11], v[160:163], v[136:139], a[8:11]
    v_add_u32 v7, s65, v7
    v_mfma_f32_16x16x32_bf16 a[12:15], v[160:163], v[140:143], a[12:15]
    ds_read_b64_tr_b16 v[224:225], v16 offset:40960
    v_mfma_f32_16x16x32_bf16 a[16:19], v[160:163], v[144:147], a[16:19]
    buffer_load_dword v3, v14, s[8:11], 0 offen
    v_mfma_f32_16x16x32_bf16 a[20:23], v[160:163], v[148:151], a[20:23]
    ds_read_b64_tr_b16 v[226:227], v16 offset:41984
    v_mfma_f32_16x16x32_bf16 a[24:27], v[160:163], v[152:155], a[24:27]
    buffer_load_dword v3, v15, s[12:15], 0 offen
    v_mfma_f32_16x16x32_bf16 a[28:31], v[160:163], v[156:159], a[28:31]
    ds_read_b128 v[196:199], v13 offset:34816
    v_mfma_f32_16x16x32_bf16 a[60:63], v[164:167], v[156:159], a[60:63]
    v_add_u32 v14, 128, v14
    v_mfma_f32_16x16x32_bf16 a[56:59], v[164:167], v[152:155], a[56:59]
    ds_read_b64_tr_b16 v[228:229], v17 offset:40960
    v_mfma_f32_16x16x32_bf16 a[52:55], v[164:167], v[148:151], a[52:55]
    v_add_u32 v15, s65, v15
    v_mfma_f32_16x16x32_bf16 a[48:51], v[164:167], v[144:147], a[48:51]
    ds_read_b64_tr_b16 v[230:231], v17 offset:41984
    v_mfma_f32_16x16x32_bf16 a[44:47], v[164:167], v[140:143], a[44:47]
    v_mfma_f32_16x16x32_bf16 a[40:43], v[164:167], v[136:139], a[40:43]
    ds_read_b128 v[200:203], v13 offset:36864
    v_mfma_f32_16x16x32_bf16 a[36:39], v[164:167], v[132:135], a[36:39]
    v_mfma_f32_16x16x32_bf16 a[32:35], v[164:167], v[128:131], a[32:35]
    ds_read_b64_tr_b16 v[232:233], v18 offset:40960
    v_mfma_f32_16x16x32_bf16 a[64:67], v[168:171], v[128:131], a[64:67]
    v_mfma_f32_16x16x32_bf16 a[68:71], v[168:171], v[132:135], a[68:71]
    ds_read_b64_tr_b16 v[234:235], v18 offset:41984
    v_mfma_f32_16x16x32_bf16 a[72:75], v[168:171], v[136:139], a[72:75]
    v_mfma_f32_16x16x32_bf16 a[76:79], v[168:171], v[140:143], a[76:79]
    ds_read_b128 v[204:207], v13 offset:38912
    v_mfma_f32_16x16x32_bf16 a[80:83], v[168:171], v[144:147], a[80:83]
    v_mfma_f32_16x16x32_bf16 a[84:87], v[168:171], v[148:151], a[84:87]
    ds_read_b64_tr_b16 v[236:237], v19 offset:40960
    v_mfma_f32_16x16x32_bf16 a[88:91], v[168:171], v[152:155], a[88:91]
    v_mfma_f32_16x16x32_bf16 a[92:95], v[168:171], v[156:159], a[92:95]
    ds_read_b64_tr_b16 v[238:239], v19 offset:41984
    v_mfma_f32_16x16x32_bf16 a[124:127], v[172:175], v[156:159], a[124:127]
    v_mfma_f32_16x16x32_bf16 a[120:123], v[172:175], v[152:155], a[120:123]
    ds_read_b128 v[208:211], v13 offset:40960
    v_mfma_f32_16x16x32_bf16 a[116:119], v[172:175], v[148:151], a[116:119]
    v_mfma_f32_16x16x32_bf16 a[112:115], v[172:175], v[144:147], a[112:115]
    ds_read_b64_tr_b16 v[240:241], v20 offset:40960
    v_mfma_f32_16x16x32_bf16 a[108:111], v[172:175], v[140:143], a[108:111]
    v_mfma_f32_16x16x32_bf16 a[104:107], v[172:175], v[136:139], a[104:107]
    ds_read_b64_tr_b16 v[242:243], v20 offset:41984
    v_mfma_f32_16x16x32_bf16 a[100:103], v[172:175], v[132:135], a[100:103]
    v_mfma_f32_16x16x32_bf16 a[96:99], v[172:175], v[128:131], a[96:99]
    ds_read_b128 v[212:215], v13 offset:43008
    v_mfma_f32_16x16x32_bf16 a[128:131], v[176:179], v[128:131], a[128:131]
    v_mfma_f32_16x16x32_bf16 a[132:135], v[176:179], v[132:135], a[132:135]
    ds_read_b64_tr_b16 v[244:245], v21 offset:40960
    v_mfma_f32_16x16x32_bf16 a[136:139], v[176:179], v[136:139], a[136:139]
    v_mfma_f32_16x16x32_bf16 a[140:143], v[176:179], v[140:143], a[140:143]
    ds_read_b64_tr_b16 v[246:247], v21 offset:41984
    v_mfma_f32_16x16x32_bf16 a[144:147], v[176:179], v[144:147], a[144:147]
    v_mfma_f32_16x16x32_bf16 a[148:151], v[176:179], v[148:151], a[148:151]
    ds_read_b128 v[216:219], v13 offset:45056
    v_mfma_f32_16x16x32_bf16 a[152:155], v[176:179], v[152:155], a[152:155]
    v_mfma_f32_16x16x32_bf16 a[156:159], v[176:179], v[156:159], a[156:159]
    ds_read_b64_tr_b16 v[248:249], v22 offset:40960
    v_mfma_f32_16x16x32_bf16 a[188:191], v[180:183], v[156:159], a[188:191]
    v_mfma_f32_16x16x32_bf16 a[184:187], v[180:183], v[152:155], a[184:187]
    ds_read_b64_tr_b16 v[250:251], v22 offset:41984
    v_mfma_f32_16x16x32_bf16 a[180:183], v[180:183], v[148:151], a[180:183]
    v_mfma_f32_16x16x32_bf16 a[176:179], v[180:183], v[144:147], a[176:179]
    ds_read_b128 v[220:223], v13 offset:47104
    v_mfma_f32_16x16x32_bf16 a[172:175], v[180:183], v[140:143], a[172:175]
    v_mfma_f32_16x16x32_bf16 a[168:171], v[180:183], v[136:139], a[168:171]
    ds_read_b64_tr_b16 v[252:253], v23 offset:40960
    v_mfma_f32_16x16x32_bf16 a[164:167], v[180:183], v[132:135], a[164:167]
    v_mfma_f32_16x16x32_bf16 a[160:163], v[180:183], v[128:131], a[160:163]
    ds_read_b64_tr_b16 v[254:255], v23 offset:41984
    v_mfma_f32_16x16x32_bf16 a[192:195], v[184:187], v[128:131], a[192:195]
    v_mfma_f32_16x16x32_bf16 a[196:199], v[184:187], v[132:135], a[196:199]
    v_mfma_f32_16x16x32_bf16 a[200:203], v[184:187], v[136:139], a[200:203]
    v_mfma_f32_16x16x32_bf16 a[204:207], v[184:187], v[140:143], a[204:207]
    v_mfma_f32_16x16x32_bf16 a[208:211], v[184:187], v[144:147], a[208:211]
    v_mfma_f32_16x16x32_bf16 a[212:215], v[184:187], v[148:151], a[212:215]
    v_mfma_f32_16x16x32_bf16 a[216:219], v[184:187], v[152:155], a[216:219]
    v_mfma_f32_16x16x32_bf16 a[220:223], v[184:187], v[156:159], a[220:223]
    v_mfma_f32_16x16x32_bf16 a[252:255], v[188:191], v[156:159], a[252:255]
    v_mfma_f32_16x16x32_bf16 a[248:251], v[188:191], v[152:155], a[248:251]
    v_mfma_f32_16x16x32_bf16 a[244:247], v[188:191], v[148:151], a[244:247]
    v_mfma_f32_16x16x32_bf16 a[240:243], v[188:191], v[144:147], a[240:243]
    v_mfma_f32_16x16x32_bf16 a[236:239], v[188:191], v[140:143], a[236:239]
    v_mfma_f32_16x16x32_bf16 a[232:235], v[188:191], v[136:139], a[232:235]
    v_mfma_f32_16x16x32_bf16 a[228:231], v[188:191], v[132:135], a[228:231]
    v_mfma_f32_16x16x32_bf16 a[224:227], v[188:191], v[128:131], a[224:227]
    s_waitcnt vmcnt(2) lgkmcnt(0)
    s_barrier
    s_waitcnt lgkmcnt(0)
    v_mfma_f32_16x16x32_bf16 a[0:3], v[224:227], v[192:195], a[0:3]
    v_mfma_f32_16x16x32_bf16 a[4:7], v[224:227], v[196:199], a[4:7]
    ds_read_b128 v[128:131], v12 offset:0
    s_add_u32 m0, s64, 32768
    v_mfma_f32_16x16x32_bf16 a[8:11], v[224:227], v[200:203], a[8:11]
    buffer_load_dwordx4 v4, s[8:11], s32 offen offset:0  lds
    v_mfma_f32_16x16x32_bf16 a[12:15], v[224:227], v[204:207], a[12:15]
    ds_read_b64_tr_b16 v[160:161], v16 offset:0
    v_mfma_f32_16x16x32_bf16 a[16:19], v[224:227], v[208:211], a[16:19]
    v_mfma_f32_16x16x32_bf16 a[20:23], v[224:227], v[212:215], a[20:23]
    ds_read_b64_tr_b16 v[162:163], v16 offset:1024
    v_mfma_f32_16x16x32_bf16 a[24:27], v[224:227], v[216:219], a[24:27]
    buffer_load_dwordx4 v5, s[8:11], s33 offen offset:1024  lds
    v_mfma_f32_16x16x32_bf16 a[28:31], v[224:227], v[220:223], a[28:31]
    ds_read_b128 v[132:135], v12 offset:2048
    v_mfma_f32_16x16x32_bf16 a[60:63], v[228:231], v[220:223], a[60:63]
    v_mfma_f32_16x16x32_bf16 a[56:59], v[228:231], v[216:219], a[56:59]
    ds_read_b64_tr_b16 v[164:165], v17 offset:0
    v_mfma_f32_16x16x32_bf16 a[52:55], v[228:231], v[212:215], a[52:55]
    buffer_load_dwordx4 v4, s[8:11], s34 offen offset:2048  lds
    v_mfma_f32_16x16x32_bf16 a[48:51], v[228:231], v[208:211], a[48:51]
    ds_read_b64_tr_b16 v[166:167], v17 offset:1024
    v_mfma_f32_16x16x32_bf16 a[44:47], v[228:231], v[204:207], a[44:47]
    v_mfma_f32_16x16x32_bf16 a[40:43], v[228:231], v[200:203], a[40:43]
    ds_read_b128 v[136:139], v12 offset:4096
    v_mfma_f32_16x16x32_bf16 a[36:39], v[228:231], v[196:199], a[36:39]
    buffer_load_dwordx4 v5, s[8:11], s35 offen offset:3072  lds
    v_mfma_f32_16x16x32_bf16 a[32:35], v[228:231], v[192:195], a[32:35]
    ds_read_b64_tr_b16 v[168:169], v18 offset:0
    v_mfma_f32_16x16x32_bf16 a[64:67], v[232:235], v[192:195], a[64:67]
    v_mfma_f32_16x16x32_bf16 a[68:71], v[232:235], v[196:199], a[68:71]
    ds_read_b64_tr_b16 v[170:171], v18 offset:1024
    s_add_u32 m0, s64, 36864
    v_mfma_f32_16x16x32_bf16 a[72:75], v[232:235], v[200:203], a[72:75]
    buffer_load_dwordx4 v4, s[8:11], s36 offen offset:0  lds
    v_mfma_f32_16x16x32_bf16 a[76:79], v[232:235], v[204:207], a[76:79]
    ds_read_b128 v[140:143], v12 offset:6144
    v_mfma_f32_16x16x32_bf16 a[80:83], v[232:235], v[208:211], a[80:83]
    v_mfma_f32_16x16x32_bf16 a[84:87], v[232:235], v[212:215], a[84:87]
    ds_read_b64_tr_b16 v[172:173], v19 offset:0
    v_mfma_f32_16x16x32_bf16 a[88:91], v[232:235], v[216:219], a[88:91]
    buffer_load_dwordx4 v5, s[8:11], s37 offen offset:1024  lds
    v_mfma_f32_16x16x32_bf16 a[92:95], v[232:235], v[220:223], a[92:95]
    ds_read_b64_tr_b16 v[174:175], v19 offset:1024
    v_mfma_f32_16x16x32_bf16 a[124:127], v[236:239], v[220:223], a[124:127]
    v_mfma_f32_16x16x32_bf16 a[120:123], v[236:239], v[216:219], a[120:123]
    ds_read_b128 v[144:147], v12 offset:8192
    v_mfma_f32_16x16x32_bf16 a[116:119], v[236:239], v[212:215], a[116:119]
    buffer_load_dwordx4 v4, s[8:11], s38 offen offset:2048  lds
    v_mfma_f32_16x16x32_bf16 a[112:115], v[236:239], v[208:211], a[112:115]
    ds_read_b64_tr_b16 v[176:177], v20 offset:0
    v_mfma_f32_16x16x32_bf16 a[108:111], v[236:239], v[204:207], a[108:111]
    v_mfma_f32_16x16x32_bf16 a[104:107], v[236:239], v[200:203], a[104:107]
    ds_read_b64_tr_b16 v[178:179], v20 offset:1024
    v_mfma_f32_16x16x32_bf16 a[100:103], v[236:239], v[196:199], a[100:103]
    buffer_load_dwordx4 v5, s[8:11], s39 offen offset:3072  lds
    v_mfma_f32_16x16x32_bf16 a[96:99], v[236:239], v[192:195], a[96:99]
    ds_read_b128 v[148:151], v12 offset:10240
    v_mfma_f32_16x16x32_bf16 a[128:131], v[240:243], v[192:195], a[128:131]
    v_mfma_f32_16x16x32_bf16 a[132:135], v[240:243], v[196:199], a[132:135]
    ds_read_b64_tr_b16 v[180:181], v21 offset:0
    s_add_u32 m0, s64, 98304
    v_mfma_f32_16x16x32_bf16 a[136:139], v[240:243], v[200:203], a[136:139]
    buffer_load_dwordx4 v6, s[12:15], s40 offen offset:0  lds
    v_mfma_f32_16x16x32_bf16 a[140:143], v[240:243], v[204:207], a[140:143]
    ds_read_b64_tr_b16 v[182:183], v21 offset:1024
    v_mfma_f32_16x16x32_bf16 a[144:147], v[240:243], v[208:211], a[144:147]
    v_mfma_f32_16x16x32_bf16 a[148:151], v[240:243], v[212:215], a[148:151]
    ds_read_b128 v[152:155], v12 offset:12288
    v_mfma_f32_16x16x32_bf16 a[152:155], v[240:243], v[216:219], a[152:155]
    buffer_load_dwordx4 v6, s[12:15], s41 offen offset:1024  lds
    v_mfma_f32_16x16x32_bf16 a[156:159], v[240:243], v[220:223], a[156:159]
    ds_read_b64_tr_b16 v[184:185], v22 offset:0
    v_mfma_f32_16x16x32_bf16 a[188:191], v[244:247], v[220:223], a[188:191]
    v_mfma_f32_16x16x32_bf16 a[184:187], v[244:247], v[216:219], a[184:187]
    ds_read_b64_tr_b16 v[186:187], v22 offset:1024
    v_mfma_f32_16x16x32_bf16 a[180:183], v[244:247], v[212:215], a[180:183]
    buffer_load_dwordx4 v7, s[12:15], s42 offen offset:2048  lds
    v_mfma_f32_16x16x32_bf16 a[176:179], v[244:247], v[208:211], a[176:179]
    ds_read_b128 v[156:159], v12 offset:14336
    v_mfma_f32_16x16x32_bf16 a[172:175], v[244:247], v[204:207], a[172:175]
    v_mfma_f32_16x16x32_bf16 a[168:171], v[244:247], v[200:203], a[168:171]
    ds_read_b64_tr_b16 v[188:189], v23 offset:0
    v_mfma_f32_16x16x32_bf16 a[164:167], v[244:247], v[196:199], a[164:167]
    buffer_load_dwordx4 v7, s[12:15], s43 offen offset:3072  lds
    v_mfma_f32_16x16x32_bf16 a[160:163], v[244:247], v[192:195], a[160:163]
    ds_read_b64_tr_b16 v[190:191], v23 offset:1024
    v_mfma_f32_16x16x32_bf16 a[192:195], v[248:251], v[192:195], a[192:195]
    v_mfma_f32_16x16x32_bf16 a[196:199], v[248:251], v[196:199], a[196:199]
    s_add_u32 m0, s64, 102400
    v_mfma_f32_16x16x32_bf16 a[200:203], v[248:251], v[200:203], a[200:203]
    buffer_load_dwordx4 v6, s[12:15], s44 offen offset:0  lds
    v_mfma_f32_16x16x32_bf16 a[204:207], v[248:251], v[204:207], a[204:207]
    v_mfma_f32_16x16x32_bf16 a[208:211], v[248:251], v[208:211], a[208:211]
    v_mfma_f32_16x16x32_bf16 a[212:215], v[248:251], v[212:215], a[212:215]
    v_mfma_f32_16x16x32_bf16 a[216:219], v[248:251], v[216:219], a[216:219]
    buffer_load_dwordx4 v6, s[12:15], s45 offen offset:1024  lds
    v_mfma_f32_16x16x32_bf16 a[220:223], v[248:251], v[220:223], a[220:223]
    v_mfma_f32_16x16x32_bf16 a[252:255], v[252:255], v[220:223], a[252:255]
    v_mfma_f32_16x16x32_bf16 a[248:251], v[252:255], v[216:219], a[248:251]
    v_mfma_f32_16x16x32_bf16 a[244:247], v[252:255], v[212:215], a[244:247]
    buffer_load_dwordx4 v7, s[12:15], s46 offen offset:2048  lds
    v_mfma_f32_16x16x32_bf16 a[240:243], v[252:255], v[208:211], a[240:243]
    v_mfma_f32_16x16x32_bf16 a[236:239], v[252:255], v[204:207], a[236:239]
    v_mfma_f32_16x16x32_bf16 a[232:235], v[252:255], v[200:203], a[232:235]
    v_mfma_f32_16x16x32_bf16 a[228:231], v[252:255], v[196:199], a[228:231]
    buffer_load_dwordx4 v7, s[12:15], s47 offen offset:3072  lds
    v_mfma_f32_16x16x32_bf16 a[224:227], v[252:255], v[192:195], a[224:227]
    s_waitcnt lgkmcnt(0)
    v_add_u32 v4, 128, v4
    v_mfma_f32_16x16x32_bf16 a[0:3], v[160:163], v[128:131], a[0:3]
    v_add_u32 v5, 128, v5
    v_mfma_f32_16x16x32_bf16 a[4:7], v[160:163], v[132:135], a[4:7]
    ds_read_b128 v[192:195], v13 offset:0
    v_add_u32 v6, s65, v6
    v_mfma_f32_16x16x32_bf16 a[8:11], v[160:163], v[136:139], a[8:11]
    v_add_u32 v7, s65, v7
    v_mfma_f32_16x16x32_bf16 a[12:15], v[160:163], v[140:143], a[12:15]
    ds_read_b64_tr_b16 v[224:225], v16 offset:8192
    v_mfma_f32_16x16x32_bf16 a[16:19], v[160:163], v[144:147], a[16:19]
    buffer_load_dword v3, v14, s[8:11], 0 offen
    v_mfma_f32_16x16x32_bf16 a[20:23], v[160:163], v[148:151], a[20:23]
    ds_read_b64_tr_b16 v[226:227], v16 offset:9216
    v_mfma_f32_16x16x32_bf16 a[24:27], v[160:163], v[152:155], a[24:27]
    buffer_load_dword v3, v15, s[12:15], 0 offen
    v_mfma_f32_16x16x32_bf16 a[28:31], v[160:163], v[156:159], a[28:31]
    ds_read_b128 v[196:199], v13 offset:2048
    v_mfma_f32_16x16x32_bf16 a[60:63], v[164:167], v[156:159], a[60:63]
    v_add_u32 v14, 128, v14
    v_mfma_f32_16x16x32_bf16 a[56:59], v[164:167], v[152:155], a[56:59]
    ds_read_b64_tr_b16 v[228:229], v17 offset:8192
    v_mfma_f32_16x16x32_bf16 a[52:55], v[164:167], v[148:151], a[52:55]
    v_add_u32 v15, s65, v15
    v_mfma_f32_16x16x32_bf16 a[48:51], v[164:167], v[144:147], a[48:51]
    ds_read_b64_tr_b16 v[230:231], v17 offset:9216
    v_mfma_f32_16x16x32_bf16 a[44:47], v[164:167], v[140:143], a[44:47]
    v_mfma_f32_16x16x32_bf16 a[40:43], v[164:167], v[136:139], a[40:43]
    ds_read_b128 v[200:203], v13 offset:4096
    v_mfma_f32_16x16x32_bf16 a[36:39], v[164:167], v[132:135], a[36:39]
    v_mfma_f32_16x16x32_bf16 a[32:35], v[164:167], v[128:131], a[32:35]
    ds_read_b64_tr_b16 v[232:233], v18 offset:8192
    v_mfma_f32_16x16x32_bf16 a[64:67], v[168:171], v[128:131], a[64:67]
    v_mfma_f32_16x16x32_bf16 a[68:71], v[168:171], v[132:135], a[68:71]
    ds_read_b64_tr_b16 v[234:235], v18 offset:9216
    v_mfma_f32_16x16x32_bf16 a[72:75], v[168:171], v[136:139], a[72:75]
    v_mfma_f32_16x16x32_bf16 a[76:79], v[168:171], v[140:143], a[76:79]
    ds_read_b128 v[204:207], v13 offset:6144
    v_mfma_f32_16x16x32_bf16 a[80:83], v[168:171], v[144:147], a[80:83]
    v_mfma_f32_16x16x32_bf16 a[84:87], v[168:171], v[148:151], a[84:87]
    ds_read_b64_tr_b16 v[236:237], v19 offset:8192
    v_mfma_f32_16x16x32_bf16 a[88:91], v[168:171], v[152:155], a[88:91]
    v_mfma_f32_16x16x32_bf16 a[92:95], v[168:171], v[156:159], a[92:95]
    ds_read_b64_tr_b16 v[238:239], v19 offset:9216
    v_mfma_f32_16x16x32_bf16 a[124:127], v[172:175], v[156:159], a[124:127]
    v_mfma_f32_16x16x32_bf16 a[120:123], v[172:175], v[152:155], a[120:123]
    ds_read_b128 v[208:211], v13 offset:8192
    v_mfma_f32_16x16x32_bf16 a[116:119], v[172:175], v[148:151], a[116:119]
    v_mfma_f32_16x16x32_bf16 a[112:115], v[172:175], v[144:147], a[112:115]
    ds_read_b64_tr_b16 v[240:241], v20 offset:8192
    v_mfma_f32_16x16x32_bf16 a[108:111], v[172:175], v[140:143], a[108:111]
    v_mfma_f32_16x16x32_bf16 a[104:107], v[172:175], v[136:139], a[104:107]
    ds_read_b64_tr_b16 v[242:243], v20 offset:9216
    v_mfma_f32_16x16x32_bf16 a[100:103], v[172:175], v[132:135], a[100:103]
    v_mfma_f32_16x16x32_bf16 a[96:99], v[172:175], v[128:131], a[96:99]
    ds_read_b128 v[212:215], v13 offset:10240
    v_mfma_f32_16x16x32_bf16 a[128:131], v[176:179], v[128:131], a[128:131]
    v_mfma_f32_16x16x32_bf16 a[132:135], v[176:179], v[132:135], a[132:135]
    ds_read_b64_tr_b16 v[244:245], v21 offset:8192
    v_mfma_f32_16x16x32_bf16 a[136:139], v[176:179], v[136:139], a[136:139]
    v_mfma_f32_16x16x32_bf16 a[140:143], v[176:179], v[140:143], a[140:143]
    ds_read_b64_tr_b16 v[246:247], v21 offset:9216
    v_mfma_f32_16x16x32_bf16 a[144:147], v[176:179], v[144:147], a[144:147]
    v_mfma_f32_16x16x32_bf16 a[148:151], v[176:179], v[148:151], a[148:151]
    ds_read_b128 v[216:219], v13 offset:12288
    v_mfma_f32_16x16x32_bf16 a[152:155], v[176:179], v[152:155], a[152:155]
    v_mfma_f32_16x16x32_bf16 a[156:159], v[176:179], v[156:159], a[156:159]
    ds_read_b64_tr_b16 v[248:249], v22 offset:8192
    v_mfma_f32_16x16x32_bf16 a[188:191], v[180:183], v[156:159], a[188:191]
    v_mfma_f32_16x16x32_bf16 a[184:187], v[180:183], v[152:155], a[184:187]
    ds_read_b64_tr_b16 v[250:251], v22 offset:9216
    v_mfma_f32_16x16x32_bf16 a[180:183], v[180:183], v[148:151], a[180:183]
    v_mfma_f32_16x16x32_bf16 a[176:179], v[180:183], v[144:147], a[176:179]
    ds_read_b128 v[220:223], v13 offset:14336
    v_mfma_f32_16x16x32_bf16 a[172:175], v[180:183], v[140:143], a[172:175]
    v_mfma_f32_16x16x32_bf16 a[168:171], v[180:183], v[136:139], a[168:171]
    ds_read_b64_tr_b16 v[252:253], v23 offset:8192
    v_mfma_f32_16x16x32_bf16 a[164:167], v[180:183], v[132:135], a[164:167]
    v_mfma_f32_16x16x32_bf16 a[160:163], v[180:183], v[128:131], a[160:163]
    ds_read_b64_tr_b16 v[254:255], v23 offset:9216
    v_mfma_f32_16x16x32_bf16 a[192:195], v[184:187], v[128:131], a[192:195]
    v_mfma_f32_16x16x32_bf16 a[196:199], v[184:187], v[132:135], a[196:199]
    v_mfma_f32_16x16x32_bf16 a[200:203], v[184:187], v[136:139], a[200:203]
    v_mfma_f32_16x16x32_bf16 a[204:207], v[184:187], v[140:143], a[204:207]
    v_mfma_f32_16x16x32_bf16 a[208:211], v[184:187], v[144:147], a[208:211]
    v_mfma_f32_16x16x32_bf16 a[212:215], v[184:187], v[148:151], a[212:215]
    v_mfma_f32_16x16x32_bf16 a[216:219], v[184:187], v[152:155], a[216:219]
    v_mfma_f32_16x16x32_bf16 a[220:223], v[184:187], v[156:159], a[220:223]
    v_mfma_f32_16x16x32_bf16 a[252:255], v[188:191], v[156:159], a[252:255]
    v_mfma_f32_16x16x32_bf16 a[248:251], v[188:191], v[152:155], a[248:251]
    v_mfma_f32_16x16x32_bf16 a[244:247], v[188:191], v[148:151], a[244:247]
    v_mfma_f32_16x16x32_bf16 a[240:243], v[188:191], v[144:147], a[240:243]
    v_mfma_f32_16x16x32_bf16 a[236:239], v[188:191], v[140:143], a[236:239]
    v_mfma_f32_16x16x32_bf16 a[232:235], v[188:191], v[136:139], a[232:235]
    v_mfma_f32_16x16x32_bf16 a[228:231], v[188:191], v[132:135], a[228:231]
    v_mfma_f32_16x16x32_bf16 a[224:227], v[188:191], v[128:131], a[224:227]
    s_waitcnt vmcnt(2) lgkmcnt(0)
    s_barrier
    s_sub_u32 s67, s67, 1
    s_cmp_lg_u32 s67, 0
    s_cbranch_scc1 K1_LOOP_K
    v_mov_b32 v14, v124
    v_mov_b32 v15, v125
    s_waitcnt lgkmcnt(0)
    v_mfma_f32_16x16x32_bf16 a[0:3], v[224:227], v[192:195], a[0:3]
    v_mfma_f32_16x16x32_bf16 a[4:7], v[224:227], v[196:199], a[4:7]
    ds_read_b128 v[128:131], v12 offset:32768
    s_add_u32 m0, s64, 0
    v_mfma_f32_16x16x32_bf16 a[8:11], v[224:227], v[200:203], a[8:11]
    buffer_load_dwordx4 v4, s[8:11], s32 offen offset:0  lds
    v_mfma_f32_16x16x32_bf16 a[12:15], v[224:227], v[204:207], a[12:15]
    ds_read_b64_tr_b16 v[160:161], v16 offset:32768
    v_mfma_f32_16x16x32_bf16 a[16:19], v[224:227], v[208:211], a[16:19]
    v_mfma_f32_16x16x32_bf16 a[20:23], v[224:227], v[212:215], a[20:23]
    ds_read_b64_tr_b16 v[162:163], v16 offset:33792
    v_mfma_f32_16x16x32_bf16 a[24:27], v[224:227], v[216:219], a[24:27]
    buffer_load_dwordx4 v5, s[8:11], s33 offen offset:1024  lds
    v_mfma_f32_16x16x32_bf16 a[28:31], v[224:227], v[220:223], a[28:31]
    ds_read_b128 v[132:135], v12 offset:34816
    v_mfma_f32_16x16x32_bf16 a[60:63], v[228:231], v[220:223], a[60:63]
    v_mfma_f32_16x16x32_bf16 a[56:59], v[228:231], v[216:219], a[56:59]
    ds_read_b64_tr_b16 v[164:165], v17 offset:32768
    v_mfma_f32_16x16x32_bf16 a[52:55], v[228:231], v[212:215], a[52:55]
    buffer_load_dwordx4 v4, s[8:11], s34 offen offset:2048  lds
    v_mfma_f32_16x16x32_bf16 a[48:51], v[228:231], v[208:211], a[48:51]
    ds_read_b64_tr_b16 v[166:167], v17 offset:33792
    v_mfma_f32_16x16x32_bf16 a[44:47], v[228:231], v[204:207], a[44:47]
    v_mfma_f32_16x16x32_bf16 a[40:43], v[228:231], v[200:203], a[40:43]
    ds_read_b128 v[136:139], v12 offset:36864
    v_mfma_f32_16x16x32_bf16 a[36:39], v[228:231], v[196:199], a[36:39]
    buffer_load_dwordx4 v5, s[8:11], s35 offen offset:3072  lds
    v_mfma_f32_16x16x32_bf16 a[32:35], v[228:231], v[192:195], a[32:35]
    ds_read_b64_tr_b16 v[168:169], v18 offset:32768
    v_mfma_f32_16x16x32_bf16 a[64:67], v[232:235], v[192:195], a[64:67]
    v_mfma_f32_16x16x32_bf16 a[68:71], v[232:235], v[196:199], a[68:71]
    ds_read_b64_tr_b16 v[170:171], v18 offset:33792
    s_add_u32 m0, s64, 4096
    v_mfma_f32_16x16x32_bf16 a[72:75], v[232:235], v[200:203], a[72:75]
    buffer_load_dwordx4 v4, s[8:11], s36 offen offset:0  lds
    v_mfma_f32_16x16x32_bf16 a[76:79], v[232:235], v[204:207], a[76:79]
    ds_read_b128 v[140:143], v12 offset:38912
    v_mfma_f32_16x16x32_bf16 a[80:83], v[232:235], v[208:211], a[80:83]
    v_mfma_f32_16x16x32_bf16 a[84:87], v[232:235], v[212:215], a[84:87]
    ds_read_b64_tr_b16 v[172:173], v19 offset:32768
    v_mfma_f32_16x16x32_bf16 a[88:91], v[232:235], v[216:219], a[88:91]
    buffer_load_dwordx4 v5, s[8:11], s37 offen offset:1024  lds
    v_mfma_f32_16x16x32_bf16 a[92:95], v[232:235], v[220:223], a[92:95]
    ds_read_b64_tr_b16 v[174:175], v19 offset:33792
    v_mfma_f32_16x16x32_bf16 a[124:127], v[236:239], v[220:223], a[124:127]
    v_mfma_f32_16x16x32_bf16 a[120:123], v[236:239], v[216:219], a[120:123]
    ds_read_b128 v[144:147], v12 offset:40960
    v_mfma_f32_16x16x32_bf16 a[116:119], v[236:239], v[212:215], a[116:119]
    buffer_load_dwordx4 v4, s[8:11], s38 offen offset:2048  lds
    v_mfma_f32_16x16x32_bf16 a[112:115], v[236:239], v[208:211], a[112:115]
    ds_read_b64_tr_b16 v[176:177], v20 offset:32768
    v_mfma_f32_16x16x32_bf16 a[108:111], v[236:239], v[204:207], a[108:111]
    v_mfma_f32_16x16x32_bf16 a[104:107], v[236:239], v[200:203], a[104:107]
    ds_read_b64_tr_b16 v[178:179], v20 offset:33792
    v_mfma_f32_16x16x32_bf16 a[100:103], v[236:239], v[196:199], a[100:103]
    buffer_load_dwordx4 v5, s[8:11], s39 offen offset:3072  lds
    v_mfma_f32_16x16x32_bf16 a[96:99], v[236:239], v[192:195], a[96:99]
    ds_read_b128 v[148:151], v12 offset:43008
    v_mfma_f32_16x16x32_bf16 a[128:131], v[240:243], v[192:195], a[128:131]
    v_mfma_f32_16x16x32_bf16 a[132:135], v[240:243], v[196:199], a[132:135]
    ds_read_b64_tr_b16 v[180:181], v21 offset:32768
    s_add_u32 m0, s64, 65536
    v_mfma_f32_16x16x32_bf16 a[136:139], v[240:243], v[200:203], a[136:139]
    buffer_load_dwordx4 v6, s[12:15], s40 offen offset:0  lds
    v_mfma_f32_16x16x32_bf16 a[140:143], v[240:243], v[204:207], a[140:143]
    ds_read_b64_tr_b16 v[182:183], v21 offset:33792
    v_mfma_f32_16x16x32_bf16 a[144:147], v[240:243], v[208:211], a[144:147]
    v_mfma_f32_16x16x32_bf16 a[148:151], v[240:243], v[212:215], a[148:151]
    ds_read_b128 v[152:155], v12 offset:45056
    v_mfma_f32_16x16x32_bf16 a[152:155], v[240:243], v[216:219], a[152:155]
    buffer_load_dwordx4 v6, s[12:15], s41 offen offset:1024  lds
    v_mfma_f32_16x16x32_bf16 a[156:159], v[240:243], v[220:223], a[156:159]
    ds_read_b64_tr_b16 v[184:185], v22 offset:32768
    v_mfma_f32_16x16x32_bf16 a[188:191], v[244:247], v[220:223], a[188:191]
    v_mfma_f32_16x16x32_bf16 a[184:187], v[244:247], v[216:219], a[184:187]
    ds_read_b64_tr_b16 v[186:187], v22 offset:33792
    v_mfma_f32_16x16x32_bf16 a[180:183], v[244:247], v[212:215], a[180:183]
    buffer_load_dwordx4 v7, s[12:15], s42 offen offset:2048  lds
    v_mfma_f32_16x16x32_bf16 a[176:179], v[244:247], v[208:211], a[176:179]
    ds_read_b128 v[156:159], v12 offset:47104
    v_mfma_f32_16x16x32_bf16 a[172:175], v[244:247], v[204:207], a[172:175]
    v_mfma_f32_16x16x32_bf16 a[168:171], v[244:247], v[200:203], a[168:171]
    ds_read_b64_tr_b16 v[188:189], v23 offset:32768
    v_mfma_f32_16x16x32_bf16 a[164:167], v[244:247], v[196:199], a[164:167]
    buffer_load_dwordx4 v7, s[12:15], s43 offen offset:3072  lds
    v_mfma_f32_16x16x32_bf16 a[160:163], v[244:247], v[192:195], a[160:163]
    ds_read_b64_tr_b16 v[190:191], v23 offset:33792
    v_mfma_f32_16x16x32_bf16 a[192:195], v[248:251], v[192:195], a[192:195]
    v_mfma_f32_16x16x32_bf16 a[196:199], v[248:251], v[196:199], a[196:199]
    s_add_u32 m0, s64, 69632
    v_mfma_f32_16x16x32_bf16 a[200:203], v[248:251], v[200:203], a[200:203]
    buffer_load_dwordx4 v6, s[12:15], s44 offen offset:0  lds
    v_mfma_f32_16x16x32_bf16 a[204:207], v[248:251], v[204:207], a[204:207]
    v_mfma_f32_16x16x32_bf16 a[208:211], v[248:251], v[208:211], a[208:211]
    v_mfma_f32_16x16x32_bf16 a[212:215], v[248:251], v[212:215], a[212:215]
    v_mfma_f32_16x16x32_bf16 a[216:219], v[248:251], v[216:219], a[216:219]
    buffer_load_dwordx4 v6, s[12:15], s45 offen offset:1024  lds
    v_mfma_f32_16x16x32_bf16 a[220:223], v[248:251], v[220:223], a[220:223]
    v_mfma_f32_16x16x32_bf16 a[252:255], v[252:255], v[220:223], a[252:255]
    v_mfma_f32_16x16x32_bf16 a[248:251], v[252:255], v[216:219], a[248:251]
    v_mfma_f32_16x16x32_bf16 a[244:247], v[252:255], v[212:215], a[244:247]
    buffer_load_dwordx4 v7, s[12:15], s46 offen offset:2048  lds
    v_mfma_f32_16x16x32_bf16 a[240:243], v[252:255], v[208:211], a[240:243]
    v_mfma_f32_16x16x32_bf16 a[236:239], v[252:255], v[204:207], a[236:239]
    v_mfma_f32_16x16x32_bf16 a[232:235], v[252:255], v[200:203], a[232:235]
    v_mfma_f32_16x16x32_bf16 a[228:231], v[252:255], v[196:199], a[228:231]
    buffer_load_dwordx4 v7, s[12:15], s47 offen offset:3072  lds
    v_mfma_f32_16x16x32_bf16 a[224:227], v[252:255], v[192:195], a[224:227]
    s_waitcnt lgkmcnt(0)
    v_add_u32 v4, 128, v4
    v_mfma_f32_16x16x32_bf16 a[0:3], v[160:163], v[128:131], a[0:3]
    v_add_u32 v5, 128, v5
    v_mfma_f32_16x16x32_bf16 a[4:7], v[160:163], v[132:135], a[4:7]
    ds_read_b128 v[192:195], v13 offset:32768
    v_add_u32 v6, s65, v6
    v_mfma_f32_16x16x32_bf16 a[8:11], v[160:163], v[136:139], a[8:11]
    v_add_u32 v7, s65, v7
    v_mfma_f32_16x16x32_bf16 a[12:15], v[160:163], v[140:143], a[12:15]
    ds_read_b64_tr_b16 v[224:225], v16 offset:40960
    v_mfma_f32_16x16x32_bf16 a[16:19], v[160:163], v[144:147], a[16:19]
    buffer_load_dword v3, v14, s[16:19], 0 offen
    v_mfma_f32_16x16x32_bf16 a[20:23], v[160:163], v[148:151], a[20:23]
    ds_read_b64_tr_b16 v[226:227], v16 offset:41984
    v_mfma_f32_16x16x32_bf16 a[24:27], v[160:163], v[152:155], a[24:27]
    buffer_load_dword v3, v15, s[20:23], 0 offen
    v_mfma_f32_16x16x32_bf16 a[28:31], v[160:163], v[156:159], a[28:31]
    ds_read_b128 v[196:199], v13 offset:34816
    v_mfma_f32_16x16x32_bf16 a[60:63], v[164:167], v[156:159], a[60:63]
    v_add_u32 v14, 128, v14
    v_mfma_f32_16x16x32_bf16 a[56:59], v[164:167], v[152:155], a[56:59]
    ds_read_b64_tr_b16 v[228:229], v17 offset:40960
    v_mfma_f32_16x16x32_bf16 a[52:55], v[164:167], v[148:151], a[52:55]
    v_add_u32 v15, s66, v15
    v_mfma_f32_16x16x32_bf16 a[48:51], v[164:167], v[144:147], a[48:51]
    ds_read_b64_tr_b16 v[230:231], v17 offset:41984
    v_mfma_f32_16x16x32_bf16 a[44:47], v[164:167], v[140:143], a[44:47]
    v_mfma_f32_16x16x32_bf16 a[40:43], v[164:167], v[136:139], a[40:43]
    ds_read_b128 v[200:203], v13 offset:36864
    v_mfma_f32_16x16x32_bf16 a[36:39], v[164:167], v[132:135], a[36:39]
    v_mfma_f32_16x16x32_bf16 a[32:35], v[164:167], v[128:131], a[32:35]
    ds_read_b64_tr_b16 v[232:233], v18 offset:40960
    v_mfma_f32_16x16x32_bf16 a[64:67], v[168:171], v[128:131], a[64:67]
    v_mfma_f32_16x16x32_bf16 a[68:71], v[168:171], v[132:135], a[68:71]
    ds_read_b64_tr_b16 v[234:235], v18 offset:41984
    v_mfma_f32_16x16x32_bf16 a[72:75], v[168:171], v[136:139], a[72:75]
    v_mfma_f32_16x16x32_bf16 a[76:79], v[168:171], v[140:143], a[76:79]
    ds_read_b128 v[204:207], v13 offset:38912
    v_mfma_f32_16x16x32_bf16 a[80:83], v[168:171], v[144:147], a[80:83]
    v_mfma_f32_16x16x32_bf16 a[84:87], v[168:171], v[148:151], a[84:87]
    ds_read_b64_tr_b16 v[236:237], v19 offset:40960
    v_mfma_f32_16x16x32_bf16 a[88:91], v[168:171], v[152:155], a[88:91]
    v_mfma_f32_16x16x32_bf16 a[92:95], v[168:171], v[156:159], a[92:95]
    ds_read_b64_tr_b16 v[238:239], v19 offset:41984
    v_mfma_f32_16x16x32_bf16 a[124:127], v[172:175], v[156:159], a[124:127]
    v_mfma_f32_16x16x32_bf16 a[120:123], v[172:175], v[152:155], a[120:123]
    ds_read_b128 v[208:211], v13 offset:40960
    v_mfma_f32_16x16x32_bf16 a[116:119], v[172:175], v[148:151], a[116:119]
    v_mfma_f32_16x16x32_bf16 a[112:115], v[172:175], v[144:147], a[112:115]
    ds_read_b64_tr_b16 v[240:241], v20 offset:40960
    v_mfma_f32_16x16x32_bf16 a[108:111], v[172:175], v[140:143], a[108:111]
    v_mfma_f32_16x16x32_bf16 a[104:107], v[172:175], v[136:139], a[104:107]
    ds_read_b64_tr_b16 v[242:243], v20 offset:41984
    v_mfma_f32_16x16x32_bf16 a[100:103], v[172:175], v[132:135], a[100:103]
    v_mfma_f32_16x16x32_bf16 a[96:99], v[172:175], v[128:131], a[96:99]
    ds_read_b128 v[212:215], v13 offset:43008
    v_mfma_f32_16x16x32_bf16 a[128:131], v[176:179], v[128:131], a[128:131]
    v_mfma_f32_16x16x32_bf16 a[132:135], v[176:179], v[132:135], a[132:135]
    ds_read_b64_tr_b16 v[244:245], v21 offset:40960
    v_mfma_f32_16x16x32_bf16 a[136:139], v[176:179], v[136:139], a[136:139]
    v_mfma_f32_16x16x32_bf16 a[140:143], v[176:179], v[140:143], a[140:143]
    ds_read_b64_tr_b16 v[246:247], v21 offset:41984
    v_mfma_f32_16x16x32_bf16 a[144:147], v[176:179], v[144:147], a[144:147]
    v_mfma_f32_16x16x32_bf16 a[148:151], v[176:179], v[148:151], a[148:151]
    ds_read_b128 v[216:219], v13 offset:45056
    v_mfma_f32_16x16x32_bf16 a[152:155], v[176:179], v[152:155], a[152:155]
    v_mfma_f32_16x16x32_bf16 a[156:159], v[176:179], v[156:159], a[156:159]
    ds_read_b64_tr_b16 v[248:249], v22 offset:40960
    v_mfma_f32_16x16x32_bf16 a[188:191], v[180:183], v[156:159], a[188:191]
    v_mfma_f32_16x16x32_bf16 a[184:187], v[180:183], v[152:155], a[184:187]
    ds_read_b64_tr_b16 v[250:251], v22 offset:41984
    v_mfma_f32_16x16x32_bf16 a[180:183], v[180:183], v[148:151], a[180:183]
    v_mfma_f32_16x16x32_bf16 a[176:179], v[180:183], v[144:147], a[176:179]
    ds_read_b128 v[220:223], v13 offset:47104
    v_mfma_f32_16x16x32_bf16 a[172:175], v[180:183], v[140:143], a[172:175]
    v_mfma_f32_16x16x32_bf16 a[168:171], v[180:183], v[136:139], a[168:171]
    ds_read_b64_tr_b16 v[252:253], v23 offset:40960
    v_mfma_f32_16x16x32_bf16 a[164:167], v[180:183], v[132:135], a[164:167]
    v_mfma_f32_16x16x32_bf16 a[160:163], v[180:183], v[128:131], a[160:163]
    ds_read_b64_tr_b16 v[254:255], v23 offset:41984
    v_mfma_f32_16x16x32_bf16 a[192:195], v[184:187], v[128:131], a[192:195]
    v_mfma_f32_16x16x32_bf16 a[196:199], v[184:187], v[132:135], a[196:199]
    v_mfma_f32_16x16x32_bf16 a[200:203], v[184:187], v[136:139], a[200:203]
    v_mfma_f32_16x16x32_bf16 a[204:207], v[184:187], v[140:143], a[204:207]
    v_mfma_f32_16x16x32_bf16 a[208:211], v[184:187], v[144:147], a[208:211]
    v_mfma_f32_16x16x32_bf16 a[212:215], v[184:187], v[148:151], a[212:215]
    v_mfma_f32_16x16x32_bf16 a[216:219], v[184:187], v[152:155], a[216:219]
    v_mfma_f32_16x16x32_bf16 a[220:223], v[184:187], v[156:159], a[220:223]
    v_mfma_f32_16x16x32_bf16 a[252:255], v[188:191], v[156:159], a[252:255]
    v_mfma_f32_16x16x32_bf16 a[248:251], v[188:191], v[152:155], a[248:251]
    v_mfma_f32_16x16x32_bf16 a[244:247], v[188:191], v[148:151], a[244:247]
    v_mfma_f32_16x16x32_bf16 a[240:243], v[188:191], v[144:147], a[240:243]
    v_mfma_f32_16x16x32_bf16 a[236:239], v[188:191], v[140:143], a[236:239]
    v_mfma_f32_16x16x32_bf16 a[232:235], v[188:191], v[136:139], a[232:235]
    v_mfma_f32_16x16x32_bf16 a[228:231], v[188:191], v[132:135], a[228:231]
    v_mfma_f32_16x16x32_bf16 a[224:227], v[188:191], v[128:131], a[224:227]
    s_waitcnt vmcnt(2) lgkmcnt(0)
    s_barrier
    s_waitcnt lgkmcnt(0)
    v_mfma_f32_16x16x32_bf16 a[0:3], v[224:227], v[192:195], a[0:3]
    v_mfma_f32_16x16x32_bf16 a[4:7], v[224:227], v[196:199], a[4:7]
    ds_read_b128 v[128:131], v12 offset:0
    s_add_u32 m0, s64, 32768
    v_mfma_f32_16x16x32_bf16 a[8:11], v[224:227], v[200:203], a[8:11]
    buffer_load_dwordx4 v4, s[8:11], s32 offen offset:0  lds
    v_mfma_f32_16x16x32_bf16 a[12:15], v[224:227], v[204:207], a[12:15]
    ds_read_b64_tr_b16 v[160:161], v16 offset:0
    v_mfma_f32_16x16x32_bf16 a[16:19], v[224:227], v[208:211], a[16:19]
    v_mfma_f32_16x16x32_bf16 a[20:23], v[224:227], v[212:215], a[20:23]
    ds_read_b64_tr_b16 v[162:163], v16 offset:1024
    v_mfma_f32_16x16x32_bf16 a[24:27], v[224:227], v[216:219], a[24:27]
    buffer_load_dwordx4 v5, s[8:11], s33 offen offset:1024  lds
    v_mfma_f32_16x16x32_bf16 a[28:31], v[224:227], v[220:223], a[28:31]
    ds_read_b128 v[132:135], v12 offset:2048
    v_mfma_f32_16x16x32_bf16 a[60:63], v[228:231], v[220:223], a[60:63]
    v_mfma_f32_16x16x32_bf16 a[56:59], v[228:231], v[216:219], a[56:59]
    ds_read_b64_tr_b16 v[164:165], v17 offset:0
    v_mfma_f32_16x16x32_bf16 a[52:55], v[228:231], v[212:215], a[52:55]
    buffer_load_dwordx4 v4, s[8:11], s34 offen offset:2048  lds
    v_mfma_f32_16x16x32_bf16 a[48:51], v[228:231], v[208:211], a[48:51]
    ds_read_b64_tr_b16 v[166:167], v17 offset:1024
    v_mfma_f32_16x16x32_bf16 a[44:47], v[228:231], v[204:207], a[44:47]
    v_mfma_f32_16x16x32_bf16 a[40:43], v[228:231], v[200:203], a[40:43]
    ds_read_b128 v[136:139], v12 offset:4096
    v_mfma_f32_16x16x32_bf16 a[36:39], v[228:231], v[196:199], a[36:39]
    buffer_load_dwordx4 v5, s[8:11], s35 offen offset:3072  lds
    v_mfma_f32_16x16x32_bf16 a[32:35], v[228:231], v[192:195], a[32:35]
    ds_read_b64_tr_b16 v[168:169], v18 offset:0
    v_mfma_f32_16x16x32_bf16 a[64:67], v[232:235], v[192:195], a[64:67]
    v_mfma_f32_16x16x32_bf16 a[68:71], v[232:235], v[196:199], a[68:71]
    ds_read_b64_tr_b16 v[170:171], v18 offset:1024
    s_add_u32 m0, s64, 36864
    v_mfma_f32_16x16x32_bf16 a[72:75], v[232:235], v[200:203], a[72:75]
    buffer_load_dwordx4 v4, s[8:11], s36 offen offset:0  lds
    v_mfma_f32_16x16x32_bf16 a[76:79], v[232:235], v[204:207], a[76:79]
    ds_read_b128 v[140:143], v12 offset:6144
    v_mfma_f32_16x16x32_bf16 a[80:83], v[232:235], v[208:211], a[80:83]
    v_mfma_f32_16x16x32_bf16 a[84:87], v[232:235], v[212:215], a[84:87]
    ds_read_b64_tr_b16 v[172:173], v19 offset:0
    v_mfma_f32_16x16x32_bf16 a[88:91], v[232:235], v[216:219], a[88:91]
    buffer_load_dwordx4 v5, s[8:11], s37 offen offset:1024  lds
    v_mfma_f32_16x16x32_bf16 a[92:95], v[232:235], v[220:223], a[92:95]
    ds_read_b64_tr_b16 v[174:175], v19 offset:1024
    v_mfma_f32_16x16x32_bf16 a[124:127], v[236:239], v[220:223], a[124:127]
    v_mfma_f32_16x16x32_bf16 a[120:123], v[236:239], v[216:219], a[120:123]
    ds_read_b128 v[144:147], v12 offset:8192
    v_mfma_f32_16x16x32_bf16 a[116:119], v[236:239], v[212:215], a[116:119]
    buffer_load_dwordx4 v4, s[8:11], s38 offen offset:2048  lds
    v_mfma_f32_16x16x32_bf16 a[112:115], v[236:239], v[208:211], a[112:115]
    ds_read_b64_tr_b16 v[176:177], v20 offset:0
    v_mfma_f32_16x16x32_bf16 a[108:111], v[236:239], v[204:207], a[108:111]
    v_mfma_f32_16x16x32_bf16 a[104:107], v[236:239], v[200:203], a[104:107]
    ds_read_b64_tr_b16 v[178:179], v20 offset:1024
    v_mfma_f32_16x16x32_bf16 a[100:103], v[236:239], v[196:199], a[100:103]
    buffer_load_dwordx4 v5, s[8:11], s39 offen offset:3072  lds
    v_mfma_f32_16x16x32_bf16 a[96:99], v[236:239], v[192:195], a[96:99]
    ds_read_b128 v[148:151], v12 offset:10240
    v_mfma_f32_16x16x32_bf16 a[128:131], v[240:243], v[192:195], a[128:131]
    v_mfma_f32_16x16x32_bf16 a[132:135], v[240:243], v[196:199], a[132:135]
    ds_read_b64_tr_b16 v[180:181], v21 offset:0
    s_add_u32 m0, s64, 98304
    v_mfma_f32_16x16x32_bf16 a[136:139], v[240:243], v[200:203], a[136:139]
    buffer_load_dwordx4 v6, s[12:15], s40 offen offset:0  lds
    v_mfma_f32_16x16x32_bf16 a[140:143], v[240:243], v[204:207], a[140:143]
    ds_read_b64_tr_b16 v[182:183], v21 offset:1024
    v_mfma_f32_16x16x32_bf16 a[144:147], v[240:243], v[208:211], a[144:147]
    v_mfma_f32_16x16x32_bf16 a[148:151], v[240:243], v[212:215], a[148:151]
    ds_read_b128 v[152:155], v12 offset:12288
    v_mfma_f32_16x16x32_bf16 a[152:155], v[240:243], v[216:219], a[152:155]
    buffer_load_dwordx4 v6, s[12:15], s41 offen offset:1024  lds
    v_mfma_f32_16x16x32_bf16 a[156:159], v[240:243], v[220:223], a[156:159]
    ds_read_b64_tr_b16 v[184:185], v22 offset:0
    v_mfma_f32_16x16x32_bf16 a[188:191], v[244:247], v[220:223], a[188:191]
    v_mfma_f32_16x16x32_bf16 a[184:187], v[244:247], v[216:219], a[184:187]
    ds_read_b64_tr_b16 v[186:187], v22 offset:1024
    v_mfma_f32_16x16x32_bf16 a[180:183], v[244:247], v[212:215], a[180:183]
    buffer_load_dwordx4 v7, s[12:15], s42 offen offset:2048  lds
    v_mfma_f32_16x16x32_bf16 a[176:179], v[244:247], v[208:211], a[176:179]
    ds_read_b128 v[156:159], v12 offset:14336
    v_mfma_f32_16x16x32_bf16 a[172:175], v[244:247], v[204:207], a[172:175]
    v_mfma_f32_16x16x32_bf16 a[168:171], v[244:247], v[200:203], a[168:171]
    ds_read_b64_tr_b16 v[188:189], v23 offset:0
    v_mfma_f32_16x16x32_bf16 a[164:167], v[244:247], v[196:199], a[164:167]
    buffer_load_dwordx4 v7, s[12:15], s43 offen offset:3072  lds
    v_mfma_f32_16x16x32_bf16 a[160:163], v[244:247], v[192:195], a[160:163]
    ds_read_b64_tr_b16 v[190:191], v23 offset:1024
    v_mfma_f32_16x16x32_bf16 a[192:195], v[248:251], v[192:195], a[192:195]
    v_mfma_f32_16x16x32_bf16 a[196:199], v[248:251], v[196:199], a[196:199]
    s_add_u32 m0, s64, 102400
    v_mfma_f32_16x16x32_bf16 a[200:203], v[248:251], v[200:203], a[200:203]
    buffer_load_dwordx4 v6, s[12:15], s44 offen offset:0  lds
    v_mfma_f32_16x16x32_bf16 a[204:207], v[248:251], v[204:207], a[204:207]
    v_mfma_f32_16x16x32_bf16 a[208:211], v[248:251], v[208:211], a[208:211]
    v_mfma_f32_16x16x32_bf16 a[212:215], v[248:251], v[212:215], a[212:215]
    v_mfma_f32_16x16x32_bf16 a[216:219], v[248:251], v[216:219], a[216:219]
    buffer_load_dwordx4 v6, s[12:15], s45 offen offset:1024  lds
    v_mfma_f32_16x16x32_bf16 a[220:223], v[248:251], v[220:223], a[220:223]
    v_mfma_f32_16x16x32_bf16 a[252:255], v[252:255], v[220:223], a[252:255]
    v_mfma_f32_16x16x32_bf16 a[248:251], v[252:255], v[216:219], a[248:251]
    v_mfma_f32_16x16x32_bf16 a[244:247], v[252:255], v[212:215], a[244:247]
    buffer_load_dwordx4 v7, s[12:15], s46 offen offset:2048  lds
    v_mfma_f32_16x16x32_bf16 a[240:243], v[252:255], v[208:211], a[240:243]
    v_mfma_f32_16x16x32_bf16 a[236:239], v[252:255], v[204:207], a[236:239]
    v_mfma_f32_16x16x32_bf16 a[232:235], v[252:255], v[200:203], a[232:235]
    v_mfma_f32_16x16x32_bf16 a[228:231], v[252:255], v[196:199], a[228:231]
    buffer_load_dwordx4 v7, s[12:15], s47 offen offset:3072  lds
    v_mfma_f32_16x16x32_bf16 a[224:227], v[252:255], v[192:195], a[224:227]
    s_waitcnt lgkmcnt(0)
    v_add_u32 v4, 128, v4
    v_mfma_f32_16x16x32_bf16 a[0:3], v[160:163], v[128:131], a[0:3]
    v_add_u32 v5, 128, v5
    v_mfma_f32_16x16x32_bf16 a[4:7], v[160:163], v[132:135], a[4:7]
    ds_read_b128 v[192:195], v13 offset:0
    v_add_u32 v6, s65, v6
    v_mfma_f32_16x16x32_bf16 a[8:11], v[160:163], v[136:139], a[8:11]
    v_add_u32 v7, s65, v7
    v_mfma_f32_16x16x32_bf16 a[12:15], v[160:163], v[140:143], a[12:15]
    ds_read_b64_tr_b16 v[224:225], v16 offset:8192
    v_mfma_f32_16x16x32_bf16 a[16:19], v[160:163], v[144:147], a[16:19]
    buffer_load_dword v3, v14, s[16:19], 0 offen
    v_mfma_f32_16x16x32_bf16 a[20:23], v[160:163], v[148:151], a[20:23]
    ds_read_b64_tr_b16 v[226:227], v16 offset:9216
    v_mfma_f32_16x16x32_bf16 a[24:27], v[160:163], v[152:155], a[24:27]
    buffer_load_dword v3, v15, s[20:23], 0 offen
    v_mfma_f32_16x16x32_bf16 a[28:31], v[160:163], v[156:159], a[28:31]
    ds_read_b128 v[196:199], v13 offset:2048
    v_mfma_f32_16x16x32_bf16 a[60:63], v[164:167], v[156:159], a[60:63]
    v_add_u32 v14, 128, v14
    v_mfma_f32_16x16x32_bf16 a[56:59], v[164:167], v[152:155], a[56:59]
    ds_read_b64_tr_b16 v[228:229], v17 offset:8192
    v_mfma_f32_16x16x32_bf16 a[52:55], v[164:167], v[148:151], a[52:55]
    v_add_u32 v15, s66, v15
    v_mfma_f32_16x16x32_bf16 a[48:51], v[164:167], v[144:147], a[48:51]
    ds_read_b64_tr_b16 v[230:231], v17 offset:9216
    v_mfma_f32_16x16x32_bf16 a[44:47], v[164:167], v[140:143], a[44:47]
    v_mfma_f32_16x16x32_bf16 a[40:43], v[164:167], v[136:139], a[40:43]
    ds_read_b128 v[200:203], v13 offset:4096
    v_mfma_f32_16x16x32_bf16 a[36:39], v[164:167], v[132:135], a[36:39]
    v_mfma_f32_16x16x32_bf16 a[32:35], v[164:167], v[128:131], a[32:35]
    ds_read_b64_tr_b16 v[232:233], v18 offset:8192
    v_mfma_f32_16x16x32_bf16 a[64:67], v[168:171], v[128:131], a[64:67]
    v_mfma_f32_16x16x32_bf16 a[68:71], v[168:171], v[132:135], a[68:71]
    ds_read_b64_tr_b16 v[234:235], v18 offset:9216
    v_mfma_f32_16x16x32_bf16 a[72:75], v[168:171], v[136:139], a[72:75]
    v_mfma_f32_16x16x32_bf16 a[76:79], v[168:171], v[140:143], a[76:79]
    ds_read_b128 v[204:207], v13 offset:6144
    v_mfma_f32_16x16x32_bf16 a[80:83], v[168:171], v[144:147], a[80:83]
    v_mfma_f32_16x16x32_bf16 a[84:87], v[168:171], v[148:151], a[84:87]
    ds_read_b64_tr_b16 v[236:237], v19 offset:8192
    v_mfma_f32_16x16x32_bf16 a[88:91], v[168:171], v[152:155], a[88:91]
    v_mfma_f32_16x16x32_bf16 a[92:95], v[168:171], v[156:159], a[92:95]
    ds_read_b64_tr_b16 v[238:239], v19 offset:9216
    v_mfma_f32_16x16x32_bf16 a[124:127], v[172:175], v[156:159], a[124:127]
    v_mfma_f32_16x16x32_bf16 a[120:123], v[172:175], v[152:155], a[120:123]
    ds_read_b128 v[208:211], v13 offset:8192
    v_mfma_f32_16x16x32_bf16 a[116:119], v[172:175], v[148:151], a[116:119]
    v_mfma_f32_16x16x32_bf16 a[112:115], v[172:175], v[144:147], a[112:115]
    ds_read_b64_tr_b16 v[240:241], v20 offset:8192
    v_mfma_f32_16x16x32_bf16 a[108:111], v[172:175], v[140:143], a[108:111]
    v_mfma_f32_16x16x32_bf16 a[104:107], v[172:175], v[136:139], a[104:107]
    ds_read_b64_tr_b16 v[242:243], v20 offset:9216
    v_mfma_f32_16x16x32_bf16 a[100:103], v[172:175], v[132:135], a[100:103]
    v_mfma_f32_16x16x32_bf16 a[96:99], v[172:175], v[128:131], a[96:99]
    ds_read_b128 v[212:215], v13 offset:10240
    v_mfma_f32_16x16x32_bf16 a[128:131], v[176:179], v[128:131], a[128:131]
    v_mfma_f32_16x16x32_bf16 a[132:135], v[176:179], v[132:135], a[132:135]
    ds_read_b64_tr_b16 v[244:245], v21 offset:8192
    v_mfma_f32_16x16x32_bf16 a[136:139], v[176:179], v[136:139], a[136:139]
    v_mfma_f32_16x16x32_bf16 a[140:143], v[176:179], v[140:143], a[140:143]
    ds_read_b64_tr_b16 v[246:247], v21 offset:9216
    v_mfma_f32_16x16x32_bf16 a[144:147], v[176:179], v[144:147], a[144:147]
    v_mfma_f32_16x16x32_bf16 a[148:151], v[176:179], v[148:151], a[148:151]
    ds_read_b128 v[216:219], v13 offset:12288
    v_mfma_f32_16x16x32_bf16 a[152:155], v[176:179], v[152:155], a[152:155]
    v_mfma_f32_16x16x32_bf16 a[156:159], v[176:179], v[156:159], a[156:159]
    ds_read_b64_tr_b16 v[248:249], v22 offset:8192
    v_mfma_f32_16x16x32_bf16 a[188:191], v[180:183], v[156:159], a[188:191]
    v_mfma_f32_16x16x32_bf16 a[184:187], v[180:183], v[152:155], a[184:187]
    ds_read_b64_tr_b16 v[250:251], v22 offset:9216
    v_mfma_f32_16x16x32_bf16 a[180:183], v[180:183], v[148:151], a[180:183]
    v_mfma_f32_16x16x32_bf16 a[176:179], v[180:183], v[144:147], a[176:179]
    ds_read_b128 v[220:223], v13 offset:14336
    v_mfma_f32_16x16x32_bf16 a[172:175], v[180:183], v[140:143], a[172:175]
    v_mfma_f32_16x16x32_bf16 a[168:171], v[180:183], v[136:139], a[168:171]
    ds_read_b64_tr_b16 v[252:253], v23 offset:8192
    v_mfma_f32_16x16x32_bf16 a[164:167], v[180:183], v[132:135], a[164:167]
    v_mfma_f32_16x16x32_bf16 a[160:163], v[180:183], v[128:131], a[160:163]
    ds_read_b64_tr_b16 v[254:255], v23 offset:9216
    v_mfma_f32_16x16x32_bf16 a[192:195], v[184:187], v[128:131], a[192:195]
    v_mfma_f32_16x16x32_bf16 a[196:199], v[184:187], v[132:135], a[196:199]
    v_mfma_f32_16x16x32_bf16 a[200:203], v[184:187], v[136:139], a[200:203]
    v_mfma_f32_16x16x32_bf16 a[204:207], v[184:187], v[140:143], a[204:207]
    v_mfma_f32_16x16x32_bf16 a[208:211], v[184:187], v[144:147], a[208:211]
    v_mfma_f32_16x16x32_bf16 a[212:215], v[184:187], v[148:151], a[212:215]
    v_mfma_f32_16x16x32_bf16 a[216:219], v[184:187], v[152:155], a[216:219]
    v_mfma_f32_16x16x32_bf16 a[220:223], v[184:187], v[156:159], a[220:223]
    v_mfma_f32_16x16x32_bf16 a[252:255], v[188:191], v[156:159], a[252:255]
    v_mfma_f32_16x16x32_bf16 a[248:251], v[188:191], v[152:155], a[248:251]
    v_mfma_f32_16x16x32_bf16 a[244:247], v[188:191], v[148:151], a[244:247]
    v_mfma_f32_16x16x32_bf16 a[240:243], v[188:191], v[144:147], a[240:243]
    v_mfma_f32_16x16x32_bf16 a[236:239], v[188:191], v[140:143], a[236:239]
    v_mfma_f32_16x16x32_bf16 a[232:235], v[188:191], v[136:139], a[232:235]
    v_mfma_f32_16x16x32_bf16 a[228:231], v[188:191], v[132:135], a[228:231]
    v_mfma_f32_16x16x32_bf16 a[224:227], v[188:191], v[128:131], a[224:227]
    s_waitcnt vmcnt(2) lgkmcnt(0)
    s_barrier
    s_waitcnt lgkmcnt(0)
    v_mfma_f32_16x16x32_bf16 a[0:3], v[224:227], v[192:195], a[0:3]
    v_mfma_f32_16x16x32_bf16 a[4:7], v[224:227], v[196:199], a[4:7]
    ds_read_b128 v[128:131], v12 offset:32768
    s_add_u32 m0, s64, 0
    v_mfma_f32_16x16x32_bf16 a[8:11], v[224:227], v[200:203], a[8:11]
    buffer_load_dwordx4 v8, s[16:19], s48 offen offset:0  lds
    v_mfma_f32_16x16x32_bf16 a[12:15], v[224:227], v[204:207], a[12:15]
    ds_read_b64_tr_b16 v[160:161], v16 offset:32768
    v_mfma_f32_16x16x32_bf16 a[16:19], v[224:227], v[208:211], a[16:19]
    v_mfma_f32_16x16x32_bf16 a[20:23], v[224:227], v[212:215], a[20:23]
    ds_read_b64_tr_b16 v[162:163], v16 offset:33792
    v_mfma_f32_16x16x32_bf16 a[24:27], v[224:227], v[216:219], a[24:27]
    buffer_load_dwordx4 v9, s[16:19], s49 offen offset:1024  lds
    v_mfma_f32_16x16x32_bf16 a[28:31], v[224:227], v[220:223], a[28:31]
    ds_read_b128 v[132:135], v12 offset:34816
    v_mfma_f32_16x16x32_bf16 a[60:63], v[228:231], v[220:223], a[60:63]
    v_mfma_f32_16x16x32_bf16 a[56:59], v[228:231], v[216:219], a[56:59]
    ds_read_b64_tr_b16 v[164:165], v17 offset:32768
    v_mfma_f32_16x16x32_bf16 a[52:55], v[228:231], v[212:215], a[52:55]
    buffer_load_dwordx4 v8, s[16:19], s50 offen offset:2048  lds
    v_mfma_f32_16x16x32_bf16 a[48:51], v[228:231], v[208:211], a[48:51]
    ds_read_b64_tr_b16 v[166:167], v17 offset:33792
    v_mfma_f32_16x16x32_bf16 a[44:47], v[228:231], v[204:207], a[44:47]
    v_mfma_f32_16x16x32_bf16 a[40:43], v[228:231], v[200:203], a[40:43]
    ds_read_b128 v[136:139], v12 offset:36864
    v_mfma_f32_16x16x32_bf16 a[36:39], v[228:231], v[196:199], a[36:39]
    buffer_load_dwordx4 v9, s[16:19], s51 offen offset:3072  lds
    v_mfma_f32_16x16x32_bf16 a[32:35], v[228:231], v[192:195], a[32:35]
    ds_read_b64_tr_b16 v[168:169], v18 offset:32768
    v_mfma_f32_16x16x32_bf16 a[64:67], v[232:235], v[192:195], a[64:67]
    v_mfma_f32_16x16x32_bf16 a[68:71], v[232:235], v[196:199], a[68:71]
    ds_read_b64_tr_b16 v[170:171], v18 offset:33792
    s_add_u32 m0, s64, 4096
    v_mfma_f32_16x16x32_bf16 a[72:75], v[232:235], v[200:203], a[72:75]
    buffer_load_dwordx4 v8, s[16:19], s52 offen offset:0  lds
    v_mfma_f32_16x16x32_bf16 a[76:79], v[232:235], v[204:207], a[76:79]
    ds_read_b128 v[140:143], v12 offset:38912
    v_mfma_f32_16x16x32_bf16 a[80:83], v[232:235], v[208:211], a[80:83]
    v_mfma_f32_16x16x32_bf16 a[84:87], v[232:235], v[212:215], a[84:87]
    ds_read_b64_tr_b16 v[172:173], v19 offset:32768
    v_mfma_f32_16x16x32_bf16 a[88:91], v[232:235], v[216:219], a[88:91]
    buffer_load_dwordx4 v9, s[16:19], s53 offen offset:1024  lds
    v_mfma_f32_16x16x32_bf16 a[92:95], v[232:235], v[220:223], a[92:95]
    ds_read_b64_tr_b16 v[174:175], v19 offset:33792
    v_mfma_f32_16x16x32_bf16 a[124:127], v[236:239], v[220:223], a[124:127]
    v_mfma_f32_16x16x32_bf16 a[120:123], v[236:239], v[216:219], a[120:123]
    ds_read_b128 v[144:147], v12 offset:40960
    v_mfma_f32_16x16x32_bf16 a[116:119], v[236:239], v[212:215], a[116:119]
    buffer_load_dwordx4 v8, s[16:19], s54 offen offset:2048  lds
    v_mfma_f32_16x16x32_bf16 a[112:115], v[236:239], v[208:211], a[112:115]
    ds_read_b64_tr_b16 v[176:177], v20 offset:32768
    v_mfma_f32_16x16x32_bf16 a[108:111], v[236:239], v[204:207], a[108:111]
    v_mfma_f32_16x16x32_bf16 a[104:107], v[236:239], v[200:203], a[104:107]
    ds_read_b64_tr_b16 v[178:179], v20 offset:33792
    v_mfma_f32_16x16x32_bf16 a[100:103], v[236:239], v[196:199], a[100:103]
    buffer_load_dwordx4 v9, s[16:19], s55 offen offset:3072  lds
    v_mfma_f32_16x16x32_bf16 a[96:99], v[236:239], v[192:195], a[96:99]
    ds_read_b128 v[148:151], v12 offset:43008
    v_mfma_f32_16x16x32_bf16 a[128:131], v[240:243], v[192:195], a[128:131]
    v_mfma_f32_16x16x32_bf16 a[132:135], v[240:243], v[196:199], a[132:135]
    ds_read_b64_tr_b16 v[180:181], v21 offset:32768
    s_add_u32 m0, s64, 65536
    v_mfma_f32_16x16x32_bf16 a[136:139], v[240:243], v[200:203], a[136:139]
    buffer_load_dwordx4 v10, s[20:23], s56 offen offset:0  lds
    v_mfma_f32_16x16x32_bf16 a[140:143], v[240:243], v[204:207], a[140:143]
    ds_read_b64_tr_b16 v[182:183], v21 offset:33792
    v_mfma_f32_16x16x32_bf16 a[144:147], v[240:243], v[208:211], a[144:147]
    v_mfma_f32_16x16x32_bf16 a[148:151], v[240:243], v[212:215], a[148:151]
    ds_read_b128 v[152:155], v12 offset:45056
    v_mfma_f32_16x16x32_bf16 a[152:155], v[240:243], v[216:219], a[152:155]
    buffer_load_dwordx4 v10, s[20:23], s57 offen offset:1024  lds
    v_mfma_f32_16x16x32_bf16 a[156:159], v[240:243], v[220:223], a[156:159]
    ds_read_b64_tr_b16 v[184:185], v22 offset:32768
    v_mfma_f32_16x16x32_bf16 a[188:191], v[244:247], v[220:223], a[188:191]
    v_mfma_f32_16x16x32_bf16 a[184:187], v[244:247], v[216:219], a[184:187]
    ds_read_b64_tr_b16 v[186:187], v22 offset:33792
    v_mfma_f32_16x16x32_bf16 a[180:183], v[244:247], v[212:215], a[180:183]
    buffer_load_dwordx4 v11, s[20:23], s58 offen offset:2048  lds
    v_mfma_f32_16x16x32_bf16 a[176:179], v[244:247], v[208:211], a[176:179]
    ds_read_b128 v[156:159], v12 offset:47104
    v_mfma_f32_16x16x32_bf16 a[172:175], v[244:247], v[204:207], a[172:175]
    v_mfma_f32_16x16x32_bf16 a[168:171], v[244:247], v[200:203], a[168:171]
    ds_read_b64_tr_b16 v[188:189], v23 offset:32768
    v_mfma_f32_16x16x32_bf16 a[164:167], v[244:247], v[196:199], a[164:167]
    buffer_load_dwordx4 v11, s[20:23], s59 offen offset:3072  lds
    v_mfma_f32_16x16x32_bf16 a[160:163], v[244:247], v[192:195], a[160:163]
    ds_read_b64_tr_b16 v[190:191], v23 offset:33792
    v_mfma_f32_16x16x32_bf16 a[192:195], v[248:251], v[192:195], a[192:195]
    v_mfma_f32_16x16x32_bf16 a[196:199], v[248:251], v[196:199], a[196:199]
    s_add_u32 m0, s64, 69632
    v_mfma_f32_16x16x32_bf16 a[200:203], v[248:251], v[200:203], a[200:203]
    buffer_load_dwordx4 v10, s[20:23], s60 offen offset:0  lds
    v_mfma_f32_16x16x32_bf16 a[204:207], v[248:251], v[204:207], a[204:207]
    v_mfma_f32_16x16x32_bf16 a[208:211], v[248:251], v[208:211], a[208:211]
    v_mfma_f32_16x16x32_bf16 a[212:215], v[248:251], v[212:215], a[212:215]
    v_mfma_f32_16x16x32_bf16 a[216:219], v[248:251], v[216:219], a[216:219]
    buffer_load_dwordx4 v10, s[20:23], s61 offen offset:1024  lds
    v_mfma_f32_16x16x32_bf16 a[220:223], v[248:251], v[220:223], a[220:223]
    v_mfma_f32_16x16x32_bf16 a[252:255], v[252:255], v[220:223], a[252:255]
    v_mfma_f32_16x16x32_bf16 a[248:251], v[252:255], v[216:219], a[248:251]
    v_mfma_f32_16x16x32_bf16 a[244:247], v[252:255], v[212:215], a[244:247]
    buffer_load_dwordx4 v11, s[20:23], s62 offen offset:2048  lds
    v_mfma_f32_16x16x32_bf16 a[240:243], v[252:255], v[208:211], a[240:243]
    v_mfma_f32_16x16x32_bf16 a[236:239], v[252:255], v[204:207], a[236:239]
    v_mfma_f32_16x16x32_bf16 a[232:235], v[252:255], v[200:203], a[232:235]
    v_mfma_f32_16x16x32_bf16 a[228:231], v[252:255], v[196:199], a[228:231]
    buffer_load_dwordx4 v11, s[20:23], s63 offen offset:3072  lds
    v_mfma_f32_16x16x32_bf16 a[224:227], v[252:255], v[192:195], a[224:227]
    s_waitcnt lgkmcnt(0)
    v_add_u32 v8, 128, v8
    v_mfma_f32_16x16x32_bf16 a[0:3], v[160:163], v[128:131], a[0:3]
    v_add_u32 v9, 128, v9
    v_mfma_f32_16x16x32_bf16 a[4:7], v[160:163], v[132:135], a[4:7]
    ds_read_b128 v[192:195], v13 offset:32768
    v_add_u32 v10, s66, v10
    v_mfma_f32_16x16x32_bf16 a[8:11], v[160:163], v[136:139], a[8:11]
    v_add_u32 v11, s66, v11
    v_mfma_f32_16x16x32_bf16 a[12:15], v[160:163], v[140:143], a[12:15]
    ds_read_b64_tr_b16 v[224:225], v16 offset:40960
    v_mfma_f32_16x16x32_bf16 a[16:19], v[160:163], v[144:147], a[16:19]
    buffer_load_dword v3, v14, s[16:19], 0 offen
    v_mfma_f32_16x16x32_bf16 a[20:23], v[160:163], v[148:151], a[20:23]
    ds_read_b64_tr_b16 v[226:227], v16 offset:41984
    v_mfma_f32_16x16x32_bf16 a[24:27], v[160:163], v[152:155], a[24:27]
    buffer_load_dword v3, v15, s[20:23], 0 offen
    v_mfma_f32_16x16x32_bf16 a[28:31], v[160:163], v[156:159], a[28:31]
    ds_read_b128 v[196:199], v13 offset:34816
    v_mfma_f32_16x16x32_bf16 a[60:63], v[164:167], v[156:159], a[60:63]
    v_add_u32 v14, 128, v14
    v_mfma_f32_16x16x32_bf16 a[56:59], v[164:167], v[152:155], a[56:59]
    ds_read_b64_tr_b16 v[228:229], v17 offset:40960
    v_mfma_f32_16x16x32_bf16 a[52:55], v[164:167], v[148:151], a[52:55]
    v_add_u32 v15, s66, v15
    v_mfma_f32_16x16x32_bf16 a[48:51], v[164:167], v[144:147], a[48:51]
    ds_read_b64_tr_b16 v[230:231], v17 offset:41984
    v_mfma_f32_16x16x32_bf16 a[44:47], v[164:167], v[140:143], a[44:47]
    v_mfma_f32_16x16x32_bf16 a[40:43], v[164:167], v[136:139], a[40:43]
    ds_read_b128 v[200:203], v13 offset:36864
    v_mfma_f32_16x16x32_bf16 a[36:39], v[164:167], v[132:135], a[36:39]
    v_mfma_f32_16x16x32_bf16 a[32:35], v[164:167], v[128:131], a[32:35]
    ds_read_b64_tr_b16 v[232:233], v18 offset:40960
    v_mfma_f32_16x16x32_bf16 a[64:67], v[168:171], v[128:131], a[64:67]
    v_mfma_f32_16x16x32_bf16 a[68:71], v[168:171], v[132:135], a[68:71]
    ds_read_b64_tr_b16 v[234:235], v18 offset:41984
    v_mfma_f32_16x16x32_bf16 a[72:75], v[168:171], v[136:139], a[72:75]
    v_mfma_f32_16x16x32_bf16 a[76:79], v[168:171], v[140:143], a[76:79]
    ds_read_b128 v[204:207], v13 offset:38912
    v_mfma_f32_16x16x32_bf16 a[80:83], v[168:171], v[144:147], a[80:83]
    v_mfma_f32_16x16x32_bf16 a[84:87], v[168:171], v[148:151], a[84:87]
    ds_read_b64_tr_b16 v[236:237], v19 offset:40960
    v_mfma_f32_16x16x32_bf16 a[88:91], v[168:171], v[152:155], a[88:91]
    v_mfma_f32_16x16x32_bf16 a[92:95], v[168:171], v[156:159], a[92:95]
    ds_read_b64_tr_b16 v[238:239], v19 offset:41984
    v_mfma_f32_16x16x32_bf16 a[124:127], v[172:175], v[156:159], a[124:127]
    v_mfma_f32_16x16x32_bf16 a[120:123], v[172:175], v[152:155], a[120:123]
    ds_read_b128 v[208:211], v13 offset:40960
    v_mfma_f32_16x16x32_bf16 a[116:119], v[172:175], v[148:151], a[116:119]
    v_mfma_f32_16x16x32_bf16 a[112:115], v[172:175], v[144:147], a[112:115]
    ds_read_b64_tr_b16 v[240:241], v20 offset:40960
    v_mfma_f32_16x16x32_bf16 a[108:111], v[172:175], v[140:143], a[108:111]
    v_mfma_f32_16x16x32_bf16 a[104:107], v[172:175], v[136:139], a[104:107]
    ds_read_b64_tr_b16 v[242:243], v20 offset:41984
    v_mfma_f32_16x16x32_bf16 a[100:103], v[172:175], v[132:135], a[100:103]
    v_mfma_f32_16x16x32_bf16 a[96:99], v[172:175], v[128:131], a[96:99]
    ds_read_b128 v[212:215], v13 offset:43008
    v_mfma_f32_16x16x32_bf16 a[128:131], v[176:179], v[128:131], a[128:131]
    v_mfma_f32_16x16x32_bf16 a[132:135], v[176:179], v[132:135], a[132:135]
    ds_read_b64_tr_b16 v[244:245], v21 offset:40960
    v_mfma_f32_16x16x32_bf16 a[136:139], v[176:179], v[136:139], a[136:139]
    v_mfma_f32_16x16x32_bf16 a[140:143], v[176:179], v[140:143], a[140:143]
    ds_read_b64_tr_b16 v[246:247], v21 offset:41984
    v_mfma_f32_16x16x32_bf16 a[144:147], v[176:179], v[144:147], a[144:147]
    v_mfma_f32_16x16x32_bf16 a[148:151], v[176:179], v[148:151], a[148:151]
    ds_read_b128 v[216:219], v13 offset:45056
    v_mfma_f32_16x16x32_bf16 a[152:155], v[176:179], v[152:155], a[152:155]
    v_mfma_f32_16x16x32_bf16 a[156:159], v[176:179], v[156:159], a[156:159]
    ds_read_b64_tr_b16 v[248:249], v22 offset:40960
    v_mfma_f32_16x16x32_bf16 a[188:191], v[180:183], v[156:159], a[188:191]
    v_mfma_f32_16x16x32_bf16 a[184:187], v[180:183], v[152:155], a[184:187]
    ds_read_b64_tr_b16 v[250:251], v22 offset:41984
    v_mfma_f32_16x16x32_bf16 a[180:183], v[180:183], v[148:151], a[180:183]
    v_mfma_f32_16x16x32_bf16 a[176:179], v[180:183], v[144:147], a[176:179]
    ds_read_b128 v[220:223], v13 offset:47104
    v_mfma_f32_16x16x32_bf16 a[172:175], v[180:183], v[140:143], a[172:175]
    v_mfma_f32_16x16x32_bf16 a[168:171], v[180:183], v[136:139], a[168:171]
    ds_read_b64_tr_b16 v[252:253], v23 offset:40960
    v_mfma_f32_16x16x32_bf16 a[164:167], v[180:183], v[132:135], a[164:167]
    v_mfma_f32_16x16x32_bf16 a[160:163], v[180:183], v[128:131], a[160:163]
    ds_read_b64_tr_b16 v[254:255], v23 offset:41984
    v_mfma_f32_16x16x32_bf16 a[192:195], v[184:187], v[128:131], a[192:195]
    v_mfma_f32_16x16x32_bf16 a[196:199], v[184:187], v[132:135], a[196:199]
    v_mfma_f32_16x16x32_bf16 a[200:203], v[184:187], v[136:139], a[200:203]
    v_mfma_f32_16x16x32_bf16 a[204:207], v[184:187], v[140:143], a[204:207]
    v_mfma_f32_16x16x32_bf16 a[208:211], v[184:187], v[144:147], a[208:211]
    v_mfma_f32_16x16x32_bf16 a[212:215], v[184:187], v[148:151], a[212:215]
    v_mfma_f32_16x16x32_bf16 a[216:219], v[184:187], v[152:155], a[216:219]
    v_mfma_f32_16x16x32_bf16 a[220:223], v[184:187], v[156:159], a[220:223]
    v_mfma_f32_16x16x32_bf16 a[252:255], v[188:191], v[156:159], a[252:255]
    v_mfma_f32_16x16x32_bf16 a[248:251], v[188:191], v[152:155], a[248:251]
    v_mfma_f32_16x16x32_bf16 a[244:247], v[188:191], v[148:151], a[244:247]
    v_mfma_f32_16x16x32_bf16 a[240:243], v[188:191], v[144:147], a[240:243]
    v_mfma_f32_16x16x32_bf16 a[236:239], v[188:191], v[140:143], a[236:239]
    v_mfma_f32_16x16x32_bf16 a[232:235], v[188:191], v[136:139], a[232:235]
    v_mfma_f32_16x16x32_bf16 a[228:231], v[188:191], v[132:135], a[228:231]
    v_mfma_f32_16x16x32_bf16 a[224:227], v[188:191], v[128:131], a[224:227]
    s_waitcnt vmcnt(2) lgkmcnt(0)
    s_barrier
    s_waitcnt lgkmcnt(0)
    v_mfma_f32_16x16x32_bf16 a[0:3], v[224:227], v[192:195], a[0:3]
    v_mfma_f32_16x16x32_bf16 a[4:7], v[224:227], v[196:199], a[4:7]
    ds_read_b128 v[128:131], v12 offset:0
    s_add_u32 m0, s64, 32768
    v_mfma_f32_16x16x32_bf16 a[8:11], v[224:227], v[200:203], a[8:11]
    buffer_load_dwordx4 v8, s[16:19], s48 offen offset:0  lds
    v_mfma_f32_16x16x32_bf16 a[12:15], v[224:227], v[204:207], a[12:15]
    ds_read_b64_tr_b16 v[160:161], v24 offset:0
    v_mfma_f32_16x16x32_bf16 a[16:19], v[224:227], v[208:211], a[16:19]
    v_mfma_f32_16x16x32_bf16 a[20:23], v[224:227], v[212:215], a[20:23]
    ds_read_b64_tr_b16 v[162:163], v24 offset:1024
    buffer_load_dwordx4 v9, s[16:19], s49 offen offset:1024  lds
    v_mfma_f32_16x16x32_bf16 a[24:27], v[224:227], v[216:219], a[24:27]
    v_mfma_f32_16x16x32_bf16 a[28:31], v[224:227], v[220:223], a[28:31]
    ds_read_b128 v[132:135], v12 offset:2048
    v_mfma_f32_16x16x32_bf16 a[60:63], v[228:231], v[220:223], a[60:63]
    buffer_load_dwordx4 v8, s[16:19], s50 offen offset:2048  lds
    v_mfma_f32_16x16x32_bf16 a[56:59], v[228:231], v[216:219], a[56:59]
    ds_read_b64_tr_b16 v[164:165], v25 offset:0
    v_mfma_f32_16x16x32_bf16 a[52:55], v[228:231], v[212:215], a[52:55]
    v_mfma_f32_16x16x32_bf16 a[48:51], v[228:231], v[208:211], a[48:51]
    ds_read_b64_tr_b16 v[166:167], v25 offset:1024
    buffer_load_dwordx4 v9, s[16:19], s51 offen offset:3072  lds
    v_mfma_f32_16x16x32_bf16 a[44:47], v[228:231], v[204:207], a[44:47]
    v_mfma_f32_16x16x32_bf16 a[40:43], v[228:231], v[200:203], a[40:43]
    ds_read_b128 v[136:139], v12 offset:4096
    s_add_u32 m0, s64, 36864
    v_mfma_f32_16x16x32_bf16 a[36:39], v[228:231], v[196:199], a[36:39]
    buffer_load_dwordx4 v8, s[16:19], s52 offen offset:0  lds
    v_mfma_f32_16x16x32_bf16 a[32:35], v[228:231], v[192:195], a[32:35]
    ds_read_b64_tr_b16 v[168:169], v26 offset:0
    v_mfma_f32_16x16x32_bf16 a[64:67], v[232:235], v[192:195], a[64:67]
    v_mfma_f32_16x16x32_bf16 a[68:71], v[232:235], v[196:199], a[68:71]
    ds_read_b64_tr_b16 v[170:171], v26 offset:1024
    buffer_load_dwordx4 v9, s[16:19], s53 offen offset:1024  lds
    v_mfma_f32_16x16x32_bf16 a[72:75], v[232:235], v[200:203], a[72:75]
    v_mfma_f32_16x16x32_bf16 a[76:79], v[232:235], v[204:207], a[76:79]
    ds_read_b128 v[140:143], v12 offset:6144
    v_mfma_f32_16x16x32_bf16 a[80:83], v[232:235], v[208:211], a[80:83]
    buffer_load_dwordx4 v8, s[16:19], s54 offen offset:2048  lds
    v_mfma_f32_16x16x32_bf16 a[84:87], v[232:235], v[212:215], a[84:87]
    ds_read_b64_tr_b16 v[172:173], v27 offset:0
    v_mfma_f32_16x16x32_bf16 a[88:91], v[232:235], v[216:219], a[88:91]
    v_mfma_f32_16x16x32_bf16 a[92:95], v[232:235], v[220:223], a[92:95]
    ds_read_b64_tr_b16 v[174:175], v27 offset:1024
    buffer_load_dwordx4 v9, s[16:19], s55 offen offset:3072  lds
    v_mfma_f32_16x16x32_bf16 a[124:127], v[236:239], v[220:223], a[124:127]
    v_mfma_f32_16x16x32_bf16 a[120:123], v[236:239], v[216:219], a[120:123]
    ds_read_b128 v[144:147], v12 offset:8192
    s_add_u32 m0, s64, 98304
    v_mfma_f32_16x16x32_bf16 a[116:119], v[236:239], v[212:215], a[116:119]
    buffer_load_dwordx4 v10, s[20:23], s56 offen offset:0  lds
    v_mfma_f32_16x16x32_bf16 a[112:115], v[236:239], v[208:211], a[112:115]
    ds_read_b64_tr_b16 v[176:177], v28 offset:0
    v_mfma_f32_16x16x32_bf16 a[108:111], v[236:239], v[204:207], a[108:111]
    v_mfma_f32_16x16x32_bf16 a[104:107], v[236:239], v[200:203], a[104:107]
    ds_read_b64_tr_b16 v[178:179], v28 offset:1024
    buffer_load_dwordx4 v10, s[20:23], s57 offen offset:1024  lds
    v_mfma_f32_16x16x32_bf16 a[100:103], v[236:239], v[196:199], a[100:103]
    v_mfma_f32_16x16x32_bf16 a[96:99], v[236:239], v[192:195], a[96:99]
    ds_read_b128 v[148:151], v12 offset:10240
    v_mfma_f32_16x16x32_bf16 a[128:131], v[240:243], v[192:195], a[128:131]
    buffer_load_dwordx4 v11, s[20:23], s58 offen offset:2048  lds
    v_mfma_f32_16x16x32_bf16 a[132:135], v[240:243], v[196:199], a[132:135]
    ds_read_b64_tr_b16 v[180:181], v29 offset:0
    v_mfma_f32_16x16x32_bf16 a[136:139], v[240:243], v[200:203], a[136:139]
    v_mfma_f32_16x16x32_bf16 a[140:143], v[240:243], v[204:207], a[140:143]
    ds_read_b64_tr_b16 v[182:183], v29 offset:1024
    buffer_load_dwordx4 v11, s[20:23], s59 offen offset:3072  lds
    v_mfma_f32_16x16x32_bf16 a[144:147], v[240:243], v[208:211], a[144:147]
    v_mfma_f32_16x16x32_bf16 a[148:151], v[240:243], v[212:215], a[148:151]
    ds_read_b128 v[152:155], v12 offset:12288
    s_add_u32 m0, s64, 102400
    v_mfma_f32_16x16x32_bf16 a[152:155], v[240:243], v[216:219], a[152:155]
    buffer_load_dwordx4 v10, s[20:23], s60 offen offset:0  lds
    v_mfma_f32_16x16x32_bf16 a[156:159], v[240:243], v[220:223], a[156:159]
    ds_read_b64_tr_b16 v[184:185], v30 offset:0
    v_mfma_f32_16x16x32_bf16 a[188:191], v[244:247], v[220:223], a[188:191]
    v_mfma_f32_16x16x32_bf16 a[184:187], v[244:247], v[216:219], a[184:187]
    ds_read_b64_tr_b16 v[186:187], v30 offset:1024
    buffer_load_dwordx4 v10, s[20:23], s61 offen offset:1024  lds
    v_mfma_f32_16x16x32_bf16 a[180:183], v[244:247], v[212:215], a[180:183]
    v_mfma_f32_16x16x32_bf16 a[176:179], v[244:247], v[208:211], a[176:179]
    ds_read_b128 v[156:159], v12 offset:14336
    v_mfma_f32_16x16x32_bf16 a[172:175], v[244:247], v[204:207], a[172:175]
    buffer_load_dwordx4 v11, s[20:23], s62 offen offset:2048  lds
    v_mfma_f32_16x16x32_bf16 a[168:171], v[244:247], v[200:203], a[168:171]
    ds_read_b64_tr_b16 v[188:189], v31 offset:0
    v_mfma_f32_16x16x32_bf16 a[164:167], v[244:247], v[196:199], a[164:167]
    v_mfma_f32_16x16x32_bf16 a[160:163], v[244:247], v[192:195], a[160:163]
    ds_read_b64_tr_b16 v[190:191], v31 offset:1024
    buffer_load_dwordx4 v11, s[20:23], s63 offen offset:3072  lds
    v_mfma_f32_16x16x32_bf16 a[192:195], v[248:251], v[192:195], a[192:195]
    v_add_u32 v8, 128, v8
    v_mfma_f32_16x16x32_bf16 a[196:199], v[248:251], v[196:199], a[196:199]
    v_add_u32 v9, 128, v9
    v_mfma_f32_16x16x32_bf16 a[200:203], v[248:251], v[200:203], a[200:203]
    v_add_u32 v10, s66, v10
    v_mfma_f32_16x16x32_bf16 a[204:207], v[248:251], v[204:207], a[204:207]
    v_add_u32 v11, s66, v11
    v_mfma_f32_16x16x32_bf16 a[208:211], v[248:251], v[208:211], a[208:211]
    v_mfma_f32_16x16x32_bf16 a[212:215], v[248:251], v[212:215], a[212:215]
    v_mfma_f32_16x16x32_bf16 a[216:219], v[248:251], v[216:219], a[216:219]
    buffer_load_dword v3, v14, s[16:19], 0 offen
    v_mfma_f32_16x16x32_bf16 a[220:223], v[248:251], v[220:223], a[220:223]
    v_mfma_f32_16x16x32_bf16 a[252:255], v[252:255], v[220:223], a[252:255]
    buffer_load_dword v3, v15, s[20:23], 0 offen
    v_mfma_f32_16x16x32_bf16 a[248:251], v[252:255], v[216:219], a[248:251]
    v_mfma_f32_16x16x32_bf16 a[244:247], v[252:255], v[212:215], a[244:247]
    v_add_u32 v14, 128, v14
    v_mfma_f32_16x16x32_bf16 a[240:243], v[252:255], v[208:211], a[240:243]
    v_mfma_f32_16x16x32_bf16 a[236:239], v[252:255], v[204:207], a[236:239]
    v_add_u32 v15, s66, v15
    v_mfma_f32_16x16x32_bf16 a[232:235], v[252:255], v[200:203], a[232:235]
    v_mfma_f32_16x16x32_bf16 a[228:231], v[252:255], v[196:199], a[228:231]
    v_mfma_f32_16x16x32_bf16 a[224:227], v[252:255], v[192:195], a[224:227]
    s_nop 7
    v_accvgpr_read_b32 v232, a0
    v_accvgpr_read_b32 v233, a1
    v_accvgpr_read_b32 v234, a2
    v_accvgpr_read_b32 v235, a3
    v_accvgpr_read_b32 v236, a32
    v_accvgpr_read_b32 v237, a33
    v_accvgpr_read_b32 v238, a34
    v_accvgpr_read_b32 v239, a35
    v_cvt_pk_bf16_f32 v32, v232, v233
    v_cvt_pk_bf16_f32 v33, v234, v235
    v_cvt_pk_bf16_f32 v34, v236, v237
    v_cvt_pk_bf16_f32 v35, v238, v239
    v_accvgpr_read_b32 v240, a64
    v_accvgpr_read_b32 v241, a65
    v_accvgpr_read_b32 v242, a66
    v_accvgpr_read_b32 v243, a67
    v_accvgpr_read_b32 v244, a96
    v_accvgpr_read_b32 v245, a97
    v_accvgpr_read_b32 v246, a98
    v_accvgpr_read_b32 v247, a99
    v_cvt_pk_bf16_f32 v36, v240, v241
    v_cvt_pk_bf16_f32 v37, v242, v243
    v_cvt_pk_bf16_f32 v38, v244, v245
    v_cvt_pk_bf16_f32 v39, v246, v247
    v_accvgpr_read_b32 v248, a128
    v_accvgpr_read_b32 v249, a129
    v_accvgpr_read_b32 v250, a130
    v_accvgpr_read_b32 v251, a131
    v_accvgpr_read_b32 v252, a160
    v_accvgpr_read_b32 v253, a161
    v_accvgpr_read_b32 v254, a162
    v_accvgpr_read_b32 v255, a163
    v_cvt_pk_bf16_f32 v40, v248, v249
    v_cvt_pk_bf16_f32 v41, v250, v251
    v_cvt_pk_bf16_f32 v42, v252, v253
    v_cvt_pk_bf16_f32 v43, v254, v255
    v_accvgpr_read_b32 v232, a192
    v_accvgpr_read_b32 v233, a193
    v_accvgpr_read_b32 v234, a194
    v_accvgpr_read_b32 v235, a195
    v_accvgpr_read_b32 v236, a224
    v_accvgpr_read_b32 v237, a225
    v_accvgpr_read_b32 v238, a226
    v_accvgpr_read_b32 v239, a227
    v_cvt_pk_bf16_f32 v44, v232, v233
    v_cvt_pk_bf16_f32 v45, v234, v235
    v_cvt_pk_bf16_f32 v46, v236, v237
    v_cvt_pk_bf16_f32 v47, v238, v239
    v_accvgpr_read_b32 v240, a4
    v_accvgpr_read_b32 v241, a5
    v_accvgpr_read_b32 v242, a6
    v_accvgpr_read_b32 v243, a7
    v_accvgpr_read_b32 v244, a36
    v_accvgpr_read_b32 v245, a37
    v_accvgpr_read_b32 v246, a38
    v_accvgpr_read_b32 v247, a39
    v_cvt_pk_bf16_f32 v48, v240, v241
    v_cvt_pk_bf16_f32 v49, v242, v243
    v_cvt_pk_bf16_f32 v50, v244, v245
    v_cvt_pk_bf16_f32 v51, v246, v247
    v_accvgpr_read_b32 v248, a68
    v_accvgpr_read_b32 v249, a69
    v_accvgpr_read_b32 v250, a70
    v_accvgpr_read_b32 v251, a71
    v_accvgpr_read_b32 v252, a100
    v_accvgpr_read_b32 v253, a101
    v_accvgpr_read_b32 v254, a102
    v_accvgpr_read_b32 v255, a103
    v_cvt_pk_bf16_f32 v52, v248, v249
    v_cvt_pk_bf16_f32 v53, v250, v251
    v_cvt_pk_bf16_f32 v54, v252, v253
    v_cvt_pk_bf16_f32 v55, v254, v255
    v_accvgpr_read_b32 v232, a132
    v_accvgpr_read_b32 v233, a133
    v_accvgpr_read_b32 v234, a134
    v_accvgpr_read_b32 v235, a135
    v_accvgpr_read_b32 v236, a164
    v_accvgpr_read_b32 v237, a165
    v_accvgpr_read_b32 v238, a166
    v_accvgpr_read_b32 v239, a167
    v_cvt_pk_bf16_f32 v56, v232, v233
    v_cvt_pk_bf16_f32 v57, v234, v235
    v_cvt_pk_bf16_f32 v58, v236, v237
    v_cvt_pk_bf16_f32 v59, v238, v239
    v_accvgpr_read_b32 v240, a196
    v_accvgpr_read_b32 v241, a197
    v_accvgpr_read_b32 v242, a198
    v_accvgpr_read_b32 v243, a199
    v_accvgpr_read_b32 v244, a228
    v_accvgpr_read_b32 v245, a229
    v_accvgpr_read_b32 v246, a230
    v_accvgpr_read_b32 v247, a231
    v_cvt_pk_bf16_f32 v60, v240, v241
    v_cvt_pk_bf16_f32 v61, v242, v243
    v_cvt_pk_bf16_f32 v62, v244, v245
    v_cvt_pk_bf16_f32 v63, v246, v247
    v_accvgpr_read_b32 v248, a8
    v_accvgpr_read_b32 v249, a9
    v_accvgpr_read_b32 v250, a10
    v_accvgpr_read_b32 v251, a11
    v_accvgpr_read_b32 v252, a40
    v_accvgpr_read_b32 v253, a41
    v_accvgpr_read_b32 v254, a42
    v_accvgpr_read_b32 v255, a43
    v_cvt_pk_bf16_f32 v64, v248, v249
    v_cvt_pk_bf16_f32 v65, v250, v251
    v_cvt_pk_bf16_f32 v66, v252, v253
    v_cvt_pk_bf16_f32 v67, v254, v255
    v_accvgpr_read_b32 v232, a72
    v_accvgpr_read_b32 v233, a73
    v_accvgpr_read_b32 v234, a74
    v_accvgpr_read_b32 v235, a75
    v_accvgpr_read_b32 v236, a104
    v_accvgpr_read_b32 v237, a105
    v_accvgpr_read_b32 v238, a106
    v_accvgpr_read_b32 v239, a107
    v_cvt_pk_bf16_f32 v68, v232, v233
    v_cvt_pk_bf16_f32 v69, v234, v235
    v_cvt_pk_bf16_f32 v70, v236, v237
    v_cvt_pk_bf16_f32 v71, v238, v239
    v_accvgpr_read_b32 v240, a136
    v_accvgpr_read_b32 v241, a137
    v_accvgpr_read_b32 v242, a138
    v_accvgpr_read_b32 v243, a139
    v_accvgpr_read_b32 v244, a168
    v_accvgpr_read_b32 v245, a169
    v_accvgpr_read_b32 v246, a170
    v_accvgpr_read_b32 v247, a171
    v_cvt_pk_bf16_f32 v72, v240, v241
    v_cvt_pk_bf16_f32 v73, v242, v243
    v_cvt_pk_bf16_f32 v74, v244, v245
    v_cvt_pk_bf16_f32 v75, v246, v247
    v_accvgpr_read_b32 v248, a200
    v_accvgpr_read_b32 v249, a201
    v_accvgpr_read_b32 v250, a202
    v_accvgpr_read_b32 v251, a203
    v_accvgpr_read_b32 v252, a232
    v_accvgpr_read_b32 v253, a233
    v_accvgpr_read_b32 v254, a234
    v_accvgpr_read_b32 v255, a235
    v_cvt_pk_bf16_f32 v76, v248, v249
    v_cvt_pk_bf16_f32 v77, v250, v251
    v_cvt_pk_bf16_f32 v78, v252, v253
    v_cvt_pk_bf16_f32 v79, v254, v255
    v_accvgpr_read_b32 v232, a12
    v_accvgpr_read_b32 v233, a13
    v_accvgpr_read_b32 v234, a14
    v_accvgpr_read_b32 v235, a15
    v_accvgpr_read_b32 v236, a44
    v_accvgpr_read_b32 v237, a45
    v_accvgpr_read_b32 v238, a46
    v_accvgpr_read_b32 v239, a47
    v_cvt_pk_bf16_f32 v80, v232, v233
    v_cvt_pk_bf16_f32 v81, v234, v235
    v_cvt_pk_bf16_f32 v82, v236, v237
    v_cvt_pk_bf16_f32 v83, v238, v239
    v_accvgpr_read_b32 v240, a76
    v_accvgpr_read_b32 v241, a77
    v_accvgpr_read_b32 v242, a78
    v_accvgpr_read_b32 v243, a79
    v_accvgpr_read_b32 v244, a108
    v_accvgpr_read_b32 v245, a109
    v_accvgpr_read_b32 v246, a110
    v_accvgpr_read_b32 v247, a111
    v_cvt_pk_bf16_f32 v84, v240, v241
    v_cvt_pk_bf16_f32 v85, v242, v243
    v_cvt_pk_bf16_f32 v86, v244, v245
    v_cvt_pk_bf16_f32 v87, v246, v247
    v_accvgpr_read_b32 v248, a140
    v_accvgpr_read_b32 v249, a141
    v_accvgpr_read_b32 v250, a142
    v_accvgpr_read_b32 v251, a143
    v_accvgpr_read_b32 v252, a172
    v_accvgpr_read_b32 v253, a173
    v_accvgpr_read_b32 v254, a174
    v_accvgpr_read_b32 v255, a175
    v_cvt_pk_bf16_f32 v88, v248, v249
    v_cvt_pk_bf16_f32 v89, v250, v251
    v_cvt_pk_bf16_f32 v90, v252, v253
    v_cvt_pk_bf16_f32 v91, v254, v255
    v_accvgpr_read_b32 v232, a204
    v_accvgpr_read_b32 v233, a205
    v_accvgpr_read_b32 v234, a206
    v_accvgpr_read_b32 v235, a207
    v_accvgpr_read_b32 v236, a236
    v_accvgpr_read_b32 v237, a237
    v_accvgpr_read_b32 v238, a238
    v_accvgpr_read_b32 v239, a239
    v_cvt_pk_bf16_f32 v92, v232, v233
    v_cvt_pk_bf16_f32 v93, v234, v235
    v_cvt_pk_bf16_f32 v94, v236, v237
    v_cvt_pk_bf16_f32 v95, v238, v239
    v_accvgpr_read_b32 v240, a16
    v_accvgpr_read_b32 v241, a17
    v_accvgpr_read_b32 v242, a18
    v_accvgpr_read_b32 v243, a19
    v_accvgpr_read_b32 v244, a48
    v_accvgpr_read_b32 v245, a49
    v_accvgpr_read_b32 v246, a50
    v_accvgpr_read_b32 v247, a51
    v_cvt_pk_bf16_f32 v96, v240, v241
    v_cvt_pk_bf16_f32 v97, v242, v243
    v_cvt_pk_bf16_f32 v98, v244, v245
    v_cvt_pk_bf16_f32 v99, v246, v247
    v_accvgpr_read_b32 v248, a80
    v_accvgpr_read_b32 v249, a81
    v_accvgpr_read_b32 v250, a82
    v_accvgpr_read_b32 v251, a83
    v_accvgpr_read_b32 v252, a112
    v_accvgpr_read_b32 v253, a113
    v_accvgpr_read_b32 v254, a114
    v_accvgpr_read_b32 v255, a115
    v_cvt_pk_bf16_f32 v100, v248, v249
    v_cvt_pk_bf16_f32 v101, v250, v251
    v_cvt_pk_bf16_f32 v102, v252, v253
    v_cvt_pk_bf16_f32 v103, v254, v255
    v_accvgpr_read_b32 v232, a144
    v_accvgpr_read_b32 v233, a145
    v_accvgpr_read_b32 v234, a146
    v_accvgpr_read_b32 v235, a147
    v_accvgpr_read_b32 v236, a176
    v_accvgpr_read_b32 v237, a177
    v_accvgpr_read_b32 v238, a178
    v_accvgpr_read_b32 v239, a179
    v_cvt_pk_bf16_f32 v104, v232, v233
    v_cvt_pk_bf16_f32 v105, v234, v235
    v_cvt_pk_bf16_f32 v106, v236, v237
    v_cvt_pk_bf16_f32 v107, v238, v239
    v_accvgpr_read_b32 v240, a208
    v_accvgpr_read_b32 v241, a209
    v_accvgpr_read_b32 v242, a210
    v_accvgpr_read_b32 v243, a211
    v_accvgpr_read_b32 v244, a240
    v_accvgpr_read_b32 v245, a241
    v_accvgpr_read_b32 v246, a242
    v_accvgpr_read_b32 v247, a243
    v_cvt_pk_bf16_f32 v108, v240, v241
    v_cvt_pk_bf16_f32 v109, v242, v243
    v_cvt_pk_bf16_f32 v110, v244, v245
    v_cvt_pk_bf16_f32 v111, v246, v247
    v_accvgpr_read_b32 v248, a20
    v_accvgpr_read_b32 v249, a21
    v_accvgpr_read_b32 v250, a22
    v_accvgpr_read_b32 v251, a23
    v_accvgpr_read_b32 v252, a52
    v_accvgpr_read_b32 v253, a53
    v_accvgpr_read_b32 v254, a54
    v_accvgpr_read_b32 v255, a55
    v_cvt_pk_bf16_f32 v112, v248, v249
    v_cvt_pk_bf16_f32 v113, v250, v251
    v_cvt_pk_bf16_f32 v114, v252, v253
    v_cvt_pk_bf16_f32 v115, v254, v255
    v_accvgpr_read_b32 v232, a84
    v_accvgpr_read_b32 v233, a85
    v_accvgpr_read_b32 v234, a86
    v_accvgpr_read_b32 v235, a87
    v_accvgpr_read_b32 v236, a116
    v_accvgpr_read_b32 v237, a117
    v_accvgpr_read_b32 v238, a118
    v_accvgpr_read_b32 v239, a119
    v_cvt_pk_bf16_f32 v116, v232, v233
    v_cvt_pk_bf16_f32 v117, v234, v235
    v_cvt_pk_bf16_f32 v118, v236, v237
    v_cvt_pk_bf16_f32 v119, v238, v239
    v_accvgpr_read_b32 v240, a148
    v_accvgpr_read_b32 v241, a149
    v_accvgpr_read_b32 v242, a150
    v_accvgpr_read_b32 v243, a151
    v_accvgpr_read_b32 v244, a180
    v_accvgpr_read_b32 v245, a181
    v_accvgpr_read_b32 v246, a182
    v_accvgpr_read_b32 v247, a183
    v_cvt_pk_bf16_f32 v120, v240, v241
    v_cvt_pk_bf16_f32 v121, v242, v243
    v_cvt_pk_bf16_f32 v122, v244, v245
    v_cvt_pk_bf16_f32 v123, v246, v247
    v_accvgpr_read_b32 v248, a212
    v_accvgpr_read_b32 v249, a213
    v_accvgpr_read_b32 v250, a214
    v_accvgpr_read_b32 v251, a215
    v_accvgpr_read_b32 v252, a244
    v_accvgpr_read_b32 v253, a245
    v_accvgpr_read_b32 v254, a246
    v_accvgpr_read_b32 v255, a247
    v_cvt_pk_bf16_f32 v192, v248, v249
    v_cvt_pk_bf16_f32 v193, v250, v251
    v_cvt_pk_bf16_f32 v194, v252, v253
    v_cvt_pk_bf16_f32 v195, v254, v255
    v_accvgpr_read_b32 v232, a24
    v_accvgpr_read_b32 v233, a25
    v_accvgpr_read_b32 v234, a26
    v_accvgpr_read_b32 v235, a27
    v_accvgpr_read_b32 v236, a56
    v_accvgpr_read_b32 v237, a57
    v_accvgpr_read_b32 v238, a58
    v_accvgpr_read_b32 v239, a59
    v_cvt_pk_bf16_f32 v196, v232, v233
    v_cvt_pk_bf16_f32 v197, v234, v235
    v_cvt_pk_bf16_f32 v198, v236, v237
    v_cvt_pk_bf16_f32 v199, v238, v239
    v_accvgpr_read_b32 v240, a88
    v_accvgpr_read_b32 v241, a89
    v_accvgpr_read_b32 v242, a90
    v_accvgpr_read_b32 v243, a91
    v_accvgpr_read_b32 v244, a120
    v_accvgpr_read_b32 v245, a121
    v_accvgpr_read_b32 v246, a122
    v_accvgpr_read_b32 v247, a123
    v_cvt_pk_bf16_f32 v200, v240, v241
    v_cvt_pk_bf16_f32 v201, v242, v243
    v_cvt_pk_bf16_f32 v202, v244, v245
    v_cvt_pk_bf16_f32 v203, v246, v247
    v_accvgpr_read_b32 v248, a152
    v_accvgpr_read_b32 v249, a153
    v_accvgpr_read_b32 v250, a154
    v_accvgpr_read_b32 v251, a155
    v_accvgpr_read_b32 v252, a184
    v_accvgpr_read_b32 v253, a185
    v_accvgpr_read_b32 v254, a186
    v_accvgpr_read_b32 v255, a187
    v_cvt_pk_bf16_f32 v204, v248, v249
    v_cvt_pk_bf16_f32 v205, v250, v251
    v_cvt_pk_bf16_f32 v206, v252, v253
    v_cvt_pk_bf16_f32 v207, v254, v255
    v_accvgpr_read_b32 v232, a216
    v_accvgpr_read_b32 v233, a217
    v_accvgpr_read_b32 v234, a218
    v_accvgpr_read_b32 v235, a219
    v_accvgpr_read_b32 v236, a248
    v_accvgpr_read_b32 v237, a249
    v_accvgpr_read_b32 v238, a250
    v_accvgpr_read_b32 v239, a251
    v_cvt_pk_bf16_f32 v208, v232, v233
    v_cvt_pk_bf16_f32 v209, v234, v235
    v_cvt_pk_bf16_f32 v210, v236, v237
    v_cvt_pk_bf16_f32 v211, v238, v239
    v_accvgpr_read_b32 v240, a28
    v_accvgpr_read_b32 v241, a29
    v_accvgpr_read_b32 v242, a30
    v_accvgpr_read_b32 v243, a31
    v_accvgpr_read_b32 v244, a60
    v_accvgpr_read_b32 v245, a61
    v_accvgpr_read_b32 v246, a62
    v_accvgpr_read_b32 v247, a63
    v_cvt_pk_bf16_f32 v212, v240, v241
    v_cvt_pk_bf16_f32 v213, v242, v243
    v_cvt_pk_bf16_f32 v214, v244, v245
    v_cvt_pk_bf16_f32 v215, v246, v247
    v_accvgpr_read_b32 v248, a92
    v_accvgpr_read_b32 v249, a93
    v_accvgpr_read_b32 v250, a94
    v_accvgpr_read_b32 v251, a95
    v_accvgpr_read_b32 v252, a124
    v_accvgpr_read_b32 v253, a125
    v_accvgpr_read_b32 v254, a126
    v_accvgpr_read_b32 v255, a127
    v_cvt_pk_bf16_f32 v216, v248, v249
    v_cvt_pk_bf16_f32 v217, v250, v251
    v_cvt_pk_bf16_f32 v218, v252, v253
    v_cvt_pk_bf16_f32 v219, v254, v255
    v_accvgpr_read_b32 v232, a156
    v_accvgpr_read_b32 v233, a157
    v_accvgpr_read_b32 v234, a158
    v_accvgpr_read_b32 v235, a159
    v_accvgpr_read_b32 v236, a188
    v_accvgpr_read_b32 v237, a189
    v_accvgpr_read_b32 v238, a190
    v_accvgpr_read_b32 v239, a191
    v_cvt_pk_bf16_f32 v220, v232, v233
    v_cvt_pk_bf16_f32 v221, v234, v235
    v_cvt_pk_bf16_f32 v222, v236, v237
    v_cvt_pk_bf16_f32 v223, v238, v239
    v_accvgpr_read_b32 v240, a220
    v_accvgpr_read_b32 v241, a221
    v_accvgpr_read_b32 v242, a222
    v_accvgpr_read_b32 v243, a223
    v_accvgpr_read_b32 v244, a252
    v_accvgpr_read_b32 v245, a253
    v_accvgpr_read_b32 v246, a254
    v_accvgpr_read_b32 v247, a255
    v_cvt_pk_bf16_f32 v224, v240, v241
    v_cvt_pk_bf16_f32 v225, v242, v243
    v_cvt_pk_bf16_f32 v226, v244, v245
    v_cvt_pk_bf16_f32 v227, v246, v247
    s_branch K1_T2
K1_V:
    s_waitcnt lgkmcnt(0)
    v_mfma_f32_16x16x32_bf16 a[0:3], v[128:131], v[160:163], 0
    v_mfma_f32_16x16x32_bf16 a[4:7], v[132:135], v[160:163], 0
    ds_read_b128 v[192:195], v13 offset:0
    v_mfma_f32_16x16x32_bf16 a[8:11], v[136:139], v[160:163], 0
    v_mfma_f32_16x16x32_bf16 a[12:15], v[140:143], v[160:163], 0
    ds_read_b64_tr_b16 v[224:225], v16 offset:8192
    v_mfma_f32_16x16x32_bf16 a[16:19], v[144:147], v[160:163], 0
    v_mfma_f32_16x16x32_bf16 a[20:23], v[148:151], v[160:163], 0
    ds_read_b64_tr_b16 v[226:227], v16 offset:9216
    v_mfma_f32_16x16x32_bf16 a[24:27], v[152:155], v[160:163], 0
    v_mfma_f32_16x16x32_bf16 a[28:31], v[156:159], v[160:163], 0
    ds_read_b128 v[196:199], v13 offset:2048
    v_mfma_f32_16x16x32_bf16 a[60:63], v[156:159], v[164:167], 0
    v_mfma_f32_16x16x32_bf16 a[56:59], v[152:155], v[164:167], 0
    ds_read_b64_tr_b16 v[228:229], v17 offset:8192
    v_mfma_f32_16x16x32_bf16 a[52:55], v[148:151], v[164:167], 0
    v_mfma_f32_16x16x32_bf16 a[48:51], v[144:147], v[164:167], 0
    ds_read_b64_tr_b16 v[230:231], v17 offset:9216
    v_mfma_f32_16x16x32_bf16 a[44:47], v[140:143], v[164:167], 0
    v_mfma_f32_16x16x32_bf16 a[40:43], v[136:139], v[164:167], 0
    ds_read_b128 v[200:203], v13 offset:4096
    v_mfma_f32_16x16x32_bf16 a[36:39], v[132:135], v[164:167], 0
    v_mfma_f32_16x16x32_bf16 a[32:35], v[128:131], v[164:167], 0
    ds_read_b64_tr_b16 v[232:233], v18 offset:8192
    v_mfma_f32_16x16x32_bf16 a[64:67], v[128:131], v[168:171], 0
    v_mfma_f32_16x16x32_bf16 a[68:71], v[132:135], v[168:171], 0
    ds_read_b64_tr_b16 v[234:235], v18 offset:9216
    v_mfma_f32_16x16x32_bf16 a[72:75], v[136:139], v[168:171], 0
    v_mfma_f32_16x16x32_bf16 a[76:79], v[140:143], v[168:171], 0
    ds_read_b128 v[204:207], v13 offset:6144
    v_mfma_f32_16x16x32_bf16 a[80:83], v[144:147], v[168:171], 0
    v_mfma_f32_16x16x32_bf16 a[84:87], v[148:151], v[168:171], 0
    ds_read_b64_tr_b16 v[236:237], v19 offset:8192
    v_mfma_f32_16x16x32_bf16 a[88:91], v[152:155], v[168:171], 0
    v_mfma_f32_16x16x32_bf16 a[92:95], v[156:159], v[168:171], 0
    ds_read_b64_tr_b16 v[238:239], v19 offset:9216
    v_mfma_f32_16x16x32_bf16 a[124:127], v[156:159], v[172:175], 0
    v_mfma_f32_16x16x32_bf16 a[120:123], v[152:155], v[172:175], 0
    ds_read_b128 v[208:211], v13 offset:8192
    v_mfma_f32_16x16x32_bf16 a[116:119], v[148:151], v[172:175], 0
    v_mfma_f32_16x16x32_bf16 a[112:115], v[144:147], v[172:175], 0
    ds_read_b64_tr_b16 v[240:241], v20 offset:8192
    v_mfma_f32_16x16x32_bf16 a[108:111], v[140:143], v[172:175], 0
    v_mfma_f32_16x16x32_bf16 a[104:107], v[136:139], v[172:175], 0
    ds_read_b64_tr_b16 v[242:243], v20 offset:9216
    v_mfma_f32_16x16x32_bf16 a[100:103], v[132:135], v[172:175], 0
    v_mfma_f32_16x16x32_bf16 a[96:99], v[128:131], v[172:175], 0
    ds_read_b128 v[212:215], v13 offset:10240
    v_mfma_f32_16x16x32_bf16 a[128:131], v[128:131], v[176:179], 0
    v_mfma_f32_16x16x32_bf16 a[132:135], v[132:135], v[176:179], 0
    ds_read_b64_tr_b16 v[244:245], v21 offset:8192
    v_mfma_f32_16x16x32_bf16 a[136:139], v[136:139], v[176:179], 0
    v_mfma_f32_16x16x32_bf16 a[140:143], v[140:143], v[176:179], 0
    ds_read_b64_tr_b16 v[246:247], v21 offset:9216
    v_mfma_f32_16x16x32_bf16 a[144:147], v[144:147], v[176:179], 0
    v_mfma_f32_16x16x32_bf16 a[148:151], v[148:151], v[176:179], 0
    ds_read_b128 v[216:219], v13 offset:12288
    v_mfma_f32_16x16x32_bf16 a[152:155], v[152:155], v[176:179], 0
    v_mfma_f32_16x16x32_bf16 a[156:159], v[156:159], v[176:179], 0
    ds_read_b64_tr_b16 v[248:249], v22 offset:8192
    v_mfma_f32_16x16x32_bf16 a[188:191], v[156:159], v[180:183], 0
    v_mfma_f32_16x16x32_bf16 a[184:187], v[152:155], v[180:183], 0
    ds_read_b64_tr_b16 v[250:251], v22 offset:9216
    v_mfma_f32_16x16x32_bf16 a[180:183], v[148:151], v[180:183], 0
    v_mfma_f32_16x16x32_bf16 a[176:179], v[144:147], v[180:183], 0
    ds_read_b128 v[220:223], v13 offset:14336
    v_mfma_f32_16x16x32_bf16 a[172:175], v[140:143], v[180:183], 0
    v_mfma_f32_16x16x32_bf16 a[168:171], v[136:139], v[180:183], 0
    ds_read_b64_tr_b16 v[252:253], v23 offset:8192
    v_mfma_f32_16x16x32_bf16 a[164:167], v[132:135], v[180:183], 0
    v_mfma_f32_16x16x32_bf16 a[160:163], v[128:131], v[180:183], 0
    ds_read_b64_tr_b16 v[254:255], v23 offset:9216
    v_mfma_f32_16x16x32_bf16 a[192:195], v[128:131], v[184:187], 0
    v_mfma_f32_16x16x32_bf16 a[196:199], v[132:135], v[184:187], 0
    v_mfma_f32_16x16x32_bf16 a[200:203], v[136:139], v[184:187], 0
    v_mfma_f32_16x16x32_bf16 a[204:207], v[140:143], v[184:187], 0
    v_mfma_f32_16x16x32_bf16 a[208:211], v[144:147], v[184:187], 0
    v_mfma_f32_16x16x32_bf16 a[212:215], v[148:151], v[184:187], 0
    v_mfma_f32_16x16x32_bf16 a[216:219], v[152:155], v[184:187], 0
    v_mfma_f32_16x16x32_bf16 a[220:223], v[156:159], v[184:187], 0
    v_mfma_f32_16x16x32_bf16 a[252:255], v[156:159], v[188:191], 0
    v_mfma_f32_16x16x32_bf16 a[248:251], v[152:155], v[188:191], 0
    v_mfma_f32_16x16x32_bf16 a[244:247], v[148:151], v[188:191], 0
    v_mfma_f32_16x16x32_bf16 a[240:243], v[144:147], v[188:191], 0
    v_mfma_f32_16x16x32_bf16 a[236:239], v[140:143], v[188:191], 0
    v_mfma_f32_16x16x32_bf16 a[232:235], v[136:139], v[188:191], 0
    v_mfma_f32_16x16x32_bf16 a[228:231], v[132:135], v[188:191], 0
    v_mfma_f32_16x16x32_bf16 a[224:227], v[128:131], v[188:191], 0
    s_waitcnt vmcnt(4) lgkmcnt(0)
    s_barrier
    s_mov_b32 s67, 6
K1_LOOP_V:
    s_waitcnt lgkmcnt(0)
    v_mfma_f32_16x16x32_bf16 a[0:3], v[192:195], v[224:227], a[0:3]
    v_mfma_f32_16x16x32_bf16 a[4:7], v[196:199], v[224:227], a[4:7]
    ds_read_b128 v[128:131], v12 offset:32768
    s_add_u32 m0, s64, 0
    v_mfma_f32_16x16x32_bf16 a[8:11], v[200:203], v[224:227], a[8:11]
    buffer_load_dwordx4 v4, s[8:11], s32 offen offset:0  lds
    v_mfma_f32_16x16x32_bf16 a[12:15], v[204:207], v[224:227], a[12:15]
    ds_read_b64_tr_b16 v[160:161], v16 offset:32768
    v_mfma_f32_16x16x32_bf16 a[16:19], v[208:211], v[224:227], a[16:19]
    v_mfma_f32_16x16x32_bf16 a[20:23], v[212:215], v[224:227], a[20:23]
    ds_read_b64_tr_b16 v[162:163], v16 offset:33792
    v_mfma_f32_16x16x32_bf16 a[24:27], v[216:219], v[224:227], a[24:27]
    buffer_load_dwordx4 v5, s[8:11], s33 offen offset:1024  lds
    v_mfma_f32_16x16x32_bf16 a[28:31], v[220:223], v[224:227], a[28:31]
    ds_read_b128 v[132:135], v12 offset:34816
    v_mfma_f32_16x16x32_bf16 a[60:63], v[220:223], v[228:231], a[60:63]
    v_mfma_f32_16x16x32_bf16 a[56:59], v[216:219], v[228:231], a[56:59]
    ds_read_b64_tr_b16 v[164:165], v17 offset:32768
    v_mfma_f32_16x16x32_bf16 a[52:55], v[212:215], v[228:231], a[52:55]
    buffer_load_dwordx4 v4, s[8:11], s34 offen offset:2048  lds
    v_mfma_f32_16x16x32_bf16 a[48:51], v[208:211], v[228:231], a[48:51]
    ds_read_b64_tr_b16 v[166:167], v17 offset:33792
    v_mfma_f32_16x16x32_bf16 a[44:47], v[204:207], v[228:231], a[44:47]
    v_mfma_f32_16x16x32_bf16 a[40:43], v[200:203], v[228:231], a[40:43]
    ds_read_b128 v[136:139], v12 offset:36864
    v_mfma_f32_16x16x32_bf16 a[36:39], v[196:199], v[228:231], a[36:39]
    buffer_load_dwordx4 v5, s[8:11], s35 offen offset:3072  lds
    v_mfma_f32_16x16x32_bf16 a[32:35], v[192:195], v[228:231], a[32:35]
    ds_read_b64_tr_b16 v[168:169], v18 offset:32768
    v_mfma_f32_16x16x32_bf16 a[64:67], v[192:195], v[232:235], a[64:67]
    v_mfma_f32_16x16x32_bf16 a[68:71], v[196:199], v[232:235], a[68:71]
    ds_read_b64_tr_b16 v[170:171], v18 offset:33792
    s_add_u32 m0, s64, 4096
    v_mfma_f32_16x16x32_bf16 a[72:75], v[200:203], v[232:235], a[72:75]
    buffer_load_dwordx4 v4, s[8:11], s36 offen offset:0  lds
    v_mfma_f32_16x16x32_bf16 a[76:79], v[204:207], v[232:235], a[76:79]
    ds_read_b128 v[140:143], v12 offset:38912
    v_mfma_f32_16x16x32_bf16 a[80:83], v[208:211], v[232:235], a[80:83]
    v_mfma_f32_16x16x32_bf16 a[84:87], v[212:215], v[232:235], a[84:87]
    ds_read_b64_tr_b16 v[172:173], v19 offset:32768
    v_mfma_f32_16x16x32_bf16 a[88:91], v[216:219], v[232:235], a[88:91]
    buffer_load_dwordx4 v5, s[8:11], s37 offen offset:1024  lds
    v_mfma_f32_16x16x32_bf16 a[92:95], v[220:223], v[232:235], a[92:95]
    ds_read_b64_tr_b16 v[174:175], v19 offset:33792
    v_mfma_f32_16x16x32_bf16 a[124:127], v[220:223], v[236:239], a[124:127]
    v_mfma_f32_16x16x32_bf16 a[120:123], v[216:219], v[236:239], a[120:123]
    ds_read_b128 v[144:147], v12 offset:40960
    v_mfma_f32_16x16x32_bf16 a[116:119], v[212:215], v[236:239], a[116:119]
    buffer_load_dwordx4 v4, s[8:11], s38 offen offset:2048  lds
    v_mfma_f32_16x16x32_bf16 a[112:115], v[208:211], v[236:239], a[112:115]
    ds_read_b64_tr_b16 v[176:177], v20 offset:32768
    v_mfma_f32_16x16x32_bf16 a[108:111], v[204:207], v[236:239], a[108:111]
    v_mfma_f32_16x16x32_bf16 a[104:107], v[200:203], v[236:239], a[104:107]
    ds_read_b64_tr_b16 v[178:179], v20 offset:33792
    v_mfma_f32_16x16x32_bf16 a[100:103], v[196:199], v[236:239], a[100:103]
    buffer_load_dwordx4 v5, s[8:11], s39 offen offset:3072  lds
    v_mfma_f32_16x16x32_bf16 a[96:99], v[192:195], v[236:239], a[96:99]
    ds_read_b128 v[148:151], v12 offset:43008
    v_mfma_f32_16x16x32_bf16 a[128:131], v[192:195], v[240:243], a[128:131]
    v_mfma_f32_16x16x32_bf16 a[132:135], v[196:199], v[240:243], a[132:135]
    ds_read_b64_tr_b16 v[180:181], v21 offset:32768
    s_add_u32 m0, s64, 65536
    v_mfma_f32_16x16x32_bf16 a[136:139], v[200:203], v[240:243], a[136:139]
    buffer_load_dwordx4 v6, s[12:15], s40 offen offset:0  lds
    v_mfma_f32_16x16x32_bf16 a[140:143], v[204:207], v[240:243], a[140:143]
    ds_read_b64_tr_b16 v[182:183], v21 offset:33792
    v_mfma_f32_16x16x32_bf16 a[144:147], v[208:211], v[240:243], a[144:147]
    v_mfma_f32_16x16x32_bf16 a[148:151], v[212:215], v[240:243], a[148:151]
    ds_read_b128 v[152:155], v12 offset:45056
    v_mfma_f32_16x16x32_bf16 a[152:155], v[216:219], v[240:243], a[152:155]
    buffer_load_dwordx4 v6, s[12:15], s41 offen offset:1024  lds
    v_mfma_f32_16x16x32_bf16 a[156:159], v[220:223], v[240:243], a[156:159]
    ds_read_b64_tr_b16 v[184:185], v22 offset:32768
    v_mfma_f32_16x16x32_bf16 a[188:191], v[220:223], v[244:247], a[188:191]
    v_mfma_f32_16x16x32_bf16 a[184:187], v[216:219], v[244:247], a[184:187]
    ds_read_b64_tr_b16 v[186:187], v22 offset:33792
    v_mfma_f32_16x16x32_bf16 a[180:183], v[212:215], v[244:247], a[180:183]
    buffer_load_dwordx4 v7, s[12:15], s42 offen offset:2048  lds
    v_mfma_f32_16x16x32_bf16 a[176:179], v[208:211], v[244:247], a[176:179]
    ds_read_b128 v[156:159], v12 offset:47104
    v_mfma_f32_16x16x32_bf16 a[172:175], v[204:207], v[244:247], a[172:175]
    v_mfma_f32_16x16x32_bf16 a[168:171], v[200:203], v[244:247], a[168:171]
    ds_read_b64_tr_b16 v[188:189], v23 offset:32768
    v_mfma_f32_16x16x32_bf16 a[164:167], v[196:199], v[244:247], a[164:167]
    buffer_load_dwordx4 v7, s[12:15], s43 offen offset:3072  lds
    v_mfma_f32_16x16x32_bf16 a[160:163], v[192:195], v[244:247], a[160:163]
    ds_read_b64_tr_b16 v[190:191], v23 offset:33792
    v_mfma_f32_16x16x32_bf16 a[192:195], v[192:195], v[248:251], a[192:195]
    v_mfma_f32_16x16x32_bf16 a[196:199], v[196:199], v[248:251], a[196:199]
    s_add_u32 m0, s64, 69632
    v_mfma_f32_16x16x32_bf16 a[200:203], v[200:203], v[248:251], a[200:203]
    buffer_load_dwordx4 v6, s[12:15], s44 offen offset:0  lds
    v_mfma_f32_16x16x32_bf16 a[204:207], v[204:207], v[248:251], a[204:207]
    v_mfma_f32_16x16x32_bf16 a[208:211], v[208:211], v[248:251], a[208:211]
    v_mfma_f32_16x16x32_bf16 a[212:215], v[212:215], v[248:251], a[212:215]
    v_mfma_f32_16x16x32_bf16 a[216:219], v[216:219], v[248:251], a[216:219]
    buffer_load_dwordx4 v6, s[12:15], s45 offen offset:1024  lds
    v_mfma_f32_16x16x32_bf16 a[220:223], v[220:223], v[248:251], a[220:223]
    v_mfma_f32_16x16x32_bf16 a[252:255], v[220:223], v[252:255], a[252:255]
    v_mfma_f32_16x16x32_bf16 a[248:251], v[216:219], v[252:255], a[248:251]
    v_mfma_f32_16x16x32_bf16 a[244:247], v[212:215], v[252:255], a[244:247]
    buffer_load_dwordx4 v7, s[12:15], s46 offen offset:2048  lds
    v_mfma_f32_16x16x32_bf16 a[240:243], v[208:211], v[252:255], a[240:243]
    v_mfma_f32_16x16x32_bf16 a[236:239], v[204:207], v[252:255], a[236:239]
    v_mfma_f32_16x16x32_bf16 a[232:235], v[200:203], v[252:255], a[232:235]
    v_mfma_f32_16x16x32_bf16 a[228:231], v[196:199], v[252:255], a[228:231]
    buffer_load_dwordx4 v7, s[12:15], s47 offen offset:3072  lds
    v_mfma_f32_16x16x32_bf16 a[224:227], v[192:195], v[252:255], a[224:227]
    s_waitcnt lgkmcnt(0)
    v_add_u32 v4, 128, v4
    v_mfma_f32_16x16x32_bf16 a[0:3], v[128:131], v[160:163], a[0:3]
    v_add_u32 v5, 128, v5
    v_mfma_f32_16x16x32_bf16 a[4:7], v[132:135], v[160:163], a[4:7]
    ds_read_b128 v[192:195], v13 offset:32768
    v_add_u32 v6, s65, v6
    v_mfma_f32_16x16x32_bf16 a[8:11], v[136:139], v[160:163], a[8:11]
    v_add_u32 v7, s65, v7
    v_mfma_f32_16x16x32_bf16 a[12:15], v[140:143], v[160:163], a[12:15]
    ds_read_b64_tr_b16 v[224:225], v16 offset:40960
    v_mfma_f32_16x16x32_bf16 a[16:19], v[144:147], v[160:163], a[16:19]
    buffer_load_dword v3, v14, s[8:11], 0 offen
    v_mfma_f32_16x16x32_bf16 a[20:23], v[148:151], v[160:163], a[20:23]
    ds_read_b64_tr_b16 v[226:227], v16 offset:41984
    v_mfma_f32_16x16x32_bf16 a[24:27], v[152:155], v[160:163], a[24:27]
    buffer_load_dword v3, v15, s[12:15], 0 offen
    v_mfma_f32_16x16x32_bf16 a[28:31], v[156:159], v[160:163], a[28:31]
    ds_read_b128 v[196:199], v13 offset:34816
    v_mfma_f32_16x16x32_bf16 a[60:63], v[156:159], v[164:167], a[60:63]
    v_add_u32 v14, 128, v14
    v_mfma_f32_16x16x32_bf16 a[56:59], v[152:155], v[164:167], a[56:59]
    ds_read_b64_tr_b16 v[228:229], v17 offset:40960
    v_mfma_f32_16x16x32_bf16 a[52:55], v[148:151], v[164:167], a[52:55]
    v_add_u32 v15, s65, v15
    v_mfma_f32_16x16x32_bf16 a[48:51], v[144:147], v[164:167], a[48:51]
    ds_read_b64_tr_b16 v[230:231], v17 offset:41984
    v_mfma_f32_16x16x32_bf16 a[44:47], v[140:143], v[164:167], a[44:47]
    v_mfma_f32_16x16x32_bf16 a[40:43], v[136:139], v[164:167], a[40:43]
    ds_read_b128 v[200:203], v13 offset:36864
    v_mfma_f32_16x16x32_bf16 a[36:39], v[132:135], v[164:167], a[36:39]
    v_mfma_f32_16x16x32_bf16 a[32:35], v[128:131], v[164:167], a[32:35]
    ds_read_b64_tr_b16 v[232:233], v18 offset:40960
    v_mfma_f32_16x16x32_bf16 a[64:67], v[128:131], v[168:171], a[64:67]
    v_mfma_f32_16x16x32_bf16 a[68:71], v[132:135], v[168:171], a[68:71]
    ds_read_b64_tr_b16 v[234:235], v18 offset:41984
    v_mfma_f32_16x16x32_bf16 a[72:75], v[136:139], v[168:171], a[72:75]
    v_mfma_f32_16x16x32_bf16 a[76:79], v[140:143], v[168:171], a[76:79]
    ds_read_b128 v[204:207], v13 offset:38912
    v_mfma_f32_16x16x32_bf16 a[80:83], v[144:147], v[168:171], a[80:83]
    v_mfma_f32_16x16x32_bf16 a[84:87], v[148:151], v[168:171], a[84:87]
    ds_read_b64_tr_b16 v[236:237], v19 offset:40960
    v_mfma_f32_16x16x32_bf16 a[88:91], v[152:155], v[168:171], a[88:91]
    v_mfma_f32_16x16x32_bf16 a[92:95], v[156:159], v[168:171], a[92:95]
    ds_read_b64_tr_b16 v[238:239], v19 offset:41984
    v_mfma_f32_16x16x32_bf16 a[124:127], v[156:159], v[172:175], a[124:127]
    v_mfma_f32_16x16x32_bf16 a[120:123], v[152:155], v[172:175], a[120:123]
    ds_read_b128 v[208:211], v13 offset:40960
    v_mfma_f32_16x16x32_bf16 a[116:119], v[148:151], v[172:175], a[116:119]
    v_mfma_f32_16x16x32_bf16 a[112:115], v[144:147], v[172:175], a[112:115]
    ds_read_b64_tr_b16 v[240:241], v20 offset:40960
    v_mfma_f32_16x16x32_bf16 a[108:111], v[140:143], v[172:175], a[108:111]
    v_mfma_f32_16x16x32_bf16 a[104:107], v[136:139], v[172:175], a[104:107]
    ds_read_b64_tr_b16 v[242:243], v20 offset:41984
    v_mfma_f32_16x16x32_bf16 a[100:103], v[132:135], v[172:175], a[100:103]
    v_mfma_f32_16x16x32_bf16 a[96:99], v[128:131], v[172:175], a[96:99]
    ds_read_b128 v[212:215], v13 offset:43008
    v_mfma_f32_16x16x32_bf16 a[128:131], v[128:131], v[176:179], a[128:131]
    v_mfma_f32_16x16x32_bf16 a[132:135], v[132:135], v[176:179], a[132:135]
    ds_read_b64_tr_b16 v[244:245], v21 offset:40960
    v_mfma_f32_16x16x32_bf16 a[136:139], v[136:139], v[176:179], a[136:139]
    v_mfma_f32_16x16x32_bf16 a[140:143], v[140:143], v[176:179], a[140:143]
    ds_read_b64_tr_b16 v[246:247], v21 offset:41984
    v_mfma_f32_16x16x32_bf16 a[144:147], v[144:147], v[176:179], a[144:147]
    v_mfma_f32_16x16x32_bf16 a[148:151], v[148:151], v[176:179], a[148:151]
    ds_read_b128 v[216:219], v13 offset:45056
    v_mfma_f32_16x16x32_bf16 a[152:155], v[152:155], v[176:179], a[152:155]
    v_mfma_f32_16x16x32_bf16 a[156:159], v[156:159], v[176:179], a[156:159]
    ds_read_b64_tr_b16 v[248:249], v22 offset:40960
    v_mfma_f32_16x16x32_bf16 a[188:191], v[156:159], v[180:183], a[188:191]
    v_mfma_f32_16x16x32_bf16 a[184:187], v[152:155], v[180:183], a[184:187]
    ds_read_b64_tr_b16 v[250:251], v22 offset:41984
    v_mfma_f32_16x16x32_bf16 a[180:183], v[148:151], v[180:183], a[180:183]
    v_mfma_f32_16x16x32_bf16 a[176:179], v[144:147], v[180:183], a[176:179]
    ds_read_b128 v[220:223], v13 offset:47104
    v_mfma_f32_16x16x32_bf16 a[172:175], v[140:143], v[180:183], a[172:175]
    v_mfma_f32_16x16x32_bf16 a[168:171], v[136:139], v[180:183], a[168:171]
    ds_read_b64_tr_b16 v[252:253], v23 offset:40960
    v_mfma_f32_16x16x32_bf16 a[164:167], v[132:135], v[180:183], a[164:167]
    v_mfma_f32_16x16x32_bf16 a[160:163], v[128:131], v[180:183], a[160:163]
    ds_read_b64_tr_b16 v[254:255], v23 offset:41984
    v_mfma_f32_16x16x32_bf16 a[192:195], v[128:131], v[184:187], a[192:195]
    v_mfma_f32_16x16x32_bf16 a[196:199], v[132:135], v[184:187], a[196:199]
    v_mfma_f32_16x16x32_bf16 a[200:203], v[136:139], v[184:187], a[200:203]
    v_mfma_f32_16x16x32_bf16 a[204:207], v[140:143], v[184:187], a[204:207]
    v_mfma_f32_16x16x32_bf16 a[208:211], v[144:147], v[184:187], a[208:211]
    v_mfma_f32_16x16x32_bf16 a[212:215], v[148:151], v[184:187], a[212:215]
    v_mfma_f32_16x16x32_bf16 a[216:219], v[152:155], v[184:187], a[216:219]
    v_mfma_f32_16x16x32_bf16 a[220:223], v[156:159], v[184:187], a[220:223]
    v_mfma_f32_16x16x32_bf16 a[252:255], v[156:159], v[188:191], a[252:255]
    v_mfma_f32_16x16x32_bf16 a[248:251], v[152:155], v[188:191], a[248:251]
    v_mfma_f32_16x16x32_bf16 a[244:247], v[148:151], v[188:191], a[244:247]
    v_mfma_f32_16x16x32_bf16 a[240:243], v[144:147], v[188:191], a[240:243]
    v_mfma_f32_16x16x32_bf16 a[236:239], v[140:143], v[188:191], a[236:239]
    v_mfma_f32_16x16x32_bf16 a[232:235], v[136:139], v[188:191], a[232:235]
    v_mfma_f32_16x16x32_bf16 a[228:231], v[132:135], v[188:191], a[228:231]
    v_mfma_f32_16x16x32_bf16 a[224:227], v[128:131], v[188:191], a[224:227]
    s_waitcnt vmcnt(2) lgkmcnt(0)
    s_barrier
    s_waitcnt lgkmcnt(0)
    v_mfma_f32_16x16x32_bf16 a[0:3], v[192:195], v[224:227], a[0:3]
    v_mfma_f32_16x16x32_bf16 a[4:7], v[196:199], v[224:227], a[4:7]
    ds_read_b128 v[128:131], v12 offset:0
    s_add_u32 m0, s64, 32768
    v_mfma_f32_16x16x32_bf16 a[8:11], v[200:203], v[224:227], a[8:11]
    buffer_load_dwordx4 v4, s[8:11], s32 offen offset:0  lds
    v_mfma_f32_16x16x32_bf16 a[12:15], v[204:207], v[224:227], a[12:15]
    ds_read_b64_tr_b16 v[160:161], v16 offset:0
    v_mfma_f32_16x16x32_bf16 a[16:19], v[208:211], v[224:227], a[16:19]
    v_mfma_f32_16x16x32_bf16 a[20:23], v[212:215], v[224:227], a[20:23]
    ds_read_b64_tr_b16 v[162:163], v16 offset:1024
    v_mfma_f32_16x16x32_bf16 a[24:27], v[216:219], v[224:227], a[24:27]
    buffer_load_dwordx4 v5, s[8:11], s33 offen offset:1024  lds
    v_mfma_f32_16x16x32_bf16 a[28:31], v[220:223], v[224:227], a[28:31]
    ds_read_b128 v[132:135], v12 offset:2048
    v_mfma_f32_16x16x32_bf16 a[60:63], v[220:223], v[228:231], a[60:63]
    v_mfma_f32_16x16x32_bf16 a[56:59], v[216:219], v[228:231], a[56:59]
    ds_read_b64_tr_b16 v[164:165], v17 offset:0
    v_mfma_f32_16x16x32_bf16 a[52:55], v[212:215], v[228:231], a[52:55]
    buffer_load_dwordx4 v4, s[8:11], s34 offen offset:2048  lds
    v_mfma_f32_16x16x32_bf16 a[48:51], v[208:211], v[228:231], a[48:51]
    ds_read_b64_tr_b16 v[166:167], v17 offset:1024
    v_mfma_f32_16x16x32_bf16 a[44:47], v[204:207], v[228:231], a[44:47]
    v_mfma_f32_16x16x32_bf16 a[40:43], v[200:203], v[228:231], a[40:43]
    ds_read_b128 v[136:139], v12 offset:4096
    v_mfma_f32_16x16x32_bf16 a[36:39], v[196:199], v[228:231], a[36:39]
    buffer_load_dwordx4 v5, s[8:11], s35 offen offset:3072  lds
    v_mfma_f32_16x16x32_bf16 a[32:35], v[192:195], v[228:231], a[32:35]
    ds_read_b64_tr_b16 v[168:169], v18 offset:0
    v_mfma_f32_16x16x32_bf16 a[64:67], v[192:195], v[232:235], a[64:67]
    v_mfma_f32_16x16x32_bf16 a[68:71], v[196:199], v[232:235], a[68:71]
    ds_read_b64_tr_b16 v[170:171], v18 offset:1024
    s_add_u32 m0, s64, 36864
    v_mfma_f32_16x16x32_bf16 a[72:75], v[200:203], v[232:235], a[72:75]
    buffer_load_dwordx4 v4, s[8:11], s36 offen offset:0  lds
    v_mfma_f32_16x16x32_bf16 a[76:79], v[204:207], v[232:235], a[76:79]
    ds_read_b128 v[140:143], v12 offset:6144
    v_mfma_f32_16x16x32_bf16 a[80:83], v[208:211], v[232:235], a[80:83]
    v_mfma_f32_16x16x32_bf16 a[84:87], v[212:215], v[232:235], a[84:87]
    ds_read_b64_tr_b16 v[172:173], v19 offset:0
    v_mfma_f32_16x16x32_bf16 a[88:91], v[216:219], v[232:235], a[88:91]
    buffer_load_dwordx4 v5, s[8:11], s37 offen offset:1024  lds
    v_mfma_f32_16x16x32_bf16 a[92:95], v[220:223], v[232:235], a[92:95]
    ds_read_b64_tr_b16 v[174:175], v19 offset:1024
    v_mfma_f32_16x16x32_bf16 a[124:127], v[220:223], v[236:239], a[124:127]
    v_mfma_f32_16x16x32_bf16 a[120:123], v[216:219], v[236:239], a[120:123]
    ds_read_b128 v[144:147], v12 offset:8192
    v_mfma_f32_16x16x32_bf16 a[116:119], v[212:215], v[236:239], a[116:119]
    buffer_load_dwordx4 v4, s[8:11], s38 offen offset:2048  lds
    v_mfma_f32_16x16x32_bf16 a[112:115], v[208:211], v[236:239], a[112:115]
    ds_read_b64_tr_b16 v[176:177], v20 offset:0
    v_mfma_f32_16x16x32_bf16 a[108:111], v[204:207], v[236:239], a[108:111]
    v_mfma_f32_16x16x32_bf16 a[104:107], v[200:203], v[236:239], a[104:107]
    ds_read_b64_tr_b16 v[178:179], v20 offset:1024
    v_mfma_f32_16x16x32_bf16 a[100:103], v[196:199], v[236:239], a[100:103]
    buffer_load_dwordx4 v5, s[8:11], s39 offen offset:3072  lds
    v_mfma_f32_16x16x32_bf16 a[96:99], v[192:195], v[236:239], a[96:99]
    ds_read_b128 v[148:151], v12 offset:10240
    v_mfma_f32_16x16x32_bf16 a[128:131], v[192:195], v[240:243], a[128:131]
    v_mfma_f32_16x16x32_bf16 a[132:135], v[196:199], v[240:243], a[132:135]
    ds_read_b64_tr_b16 v[180:181], v21 offset:0
    s_add_u32 m0, s64, 98304
    v_mfma_f32_16x16x32_bf16 a[136:139], v[200:203], v[240:243], a[136:139]
    buffer_load_dwordx4 v6, s[12:15], s40 offen offset:0  lds
    v_mfma_f32_16x16x32_bf16 a[140:143], v[204:207], v[240:243], a[140:143]
    ds_read_b64_tr_b16 v[182:183], v21 offset:1024
    v_mfma_f32_16x16x32_bf16 a[144:147], v[208:211], v[240:243], a[144:147]
    v_mfma_f32_16x16x32_bf16 a[148:151], v[212:215], v[240:243], a[148:151]
    ds_read_b128 v[152:155], v12 offset:12288
    v_mfma_f32_16x16x32_bf16 a[152:155], v[216:219], v[240:243], a[152:155]
    buffer_load_dwordx4 v6, s[12:15], s41 offen offset:1024  lds
    v_mfma_f32_16x16x32_bf16 a[156:159], v[220:223], v[240:243], a[156:159]
    ds_read_b64_tr_b16 v[184:185], v22 offset:0
    v_mfma_f32_16x16x32_bf16 a[188:191], v[220:223], v[244:247], a[188:191]
    v_mfma_f32_16x16x32_bf16 a[184:187], v[216:219], v[244:247], a[184:187]
    ds_read_b64_tr_b16 v[186:187], v22 offset:1024
    v_mfma_f32_16x16x32_bf16 a[180:183], v[212:215], v[244:247], a[180:183]
    buffer_load_dwordx4 v7, s[12:15], s42 offen offset:2048  lds
    v_mfma_f32_16x16x32_bf16 a[176:179], v[208:211], v[244:247], a[176:179]
    ds_read_b128 v[156:159], v12 offset:14336
    v_mfma_f32_16x16x32_bf16 a[172:175], v[204:207], v[244:247], a[172:175]
    v_mfma_f32_16x16x32_bf16 a[168:171], v[200:203], v[244:247], a[168:171]
    ds_read_b64_tr_b16 v[188:189], v23 offset:0
    v_mfma_f32_16x16x32_bf16 a[164:167], v[196:199], v[244:247], a[164:167]
    buffer_load_dwordx4 v7, s[12:15], s43 offen offset:3072  lds
    v_mfma_f32_16x16x32_bf16 a[160:163], v[192:195], v[244:247], a[160:163]
    ds_read_b64_tr_b16 v[190:191], v23 offset:1024
    v_mfma_f32_16x16x32_bf16 a[192:195], v[192:195], v[248:251], a[192:195]
    v_mfma_f32_16x16x32_bf16 a[196:199], v[196:199], v[248:251], a[196:199]
    s_add_u32 m0, s64, 102400
    v_mfma_f32_16x16x32_bf16 a[200:203], v[200:203], v[248:251], a[200:203]
    buffer_load_dwordx4 v6, s[12:15], s44 offen offset:0  lds
    v_mfma_f32_16x16x32_bf16 a[204:207], v[204:207], v[248:251], a[204:207]
    v_mfma_f32_16x16x32_bf16 a[208:211], v[208:211], v[248:251], a[208:211]
    v_mfma_f32_16x16x32_bf16 a[212:215], v[212:215], v[248:251], a[212:215]
    v_mfma_f32_16x16x32_bf16 a[216:219], v[216:219], v[248:251], a[216:219]
    buffer_load_dwordx4 v6, s[12:15], s45 offen offset:1024  lds
    v_mfma_f32_16x16x32_bf16 a[220:223], v[220:223], v[248:251], a[220:223]
    v_mfma_f32_16x16x32_bf16 a[252:255], v[220:223], v[252:255], a[252:255]
    v_mfma_f32_16x16x32_bf16 a[248:251], v[216:219], v[252:255], a[248:251]
    v_mfma_f32_16x16x32_bf16 a[244:247], v[212:215], v[252:255], a[244:247]
    buffer_load_dwordx4 v7, s[12:15], s46 offen offset:2048  lds
    v_mfma_f32_16x16x32_bf16 a[240:243], v[208:211], v[252:255], a[240:243]
    v_mfma_f32_16x16x32_bf16 a[236:239], v[204:207], v[252:255], a[236:239]
    v_mfma_f32_16x16x32_bf16 a[232:235], v[200:203], v[252:255], a[232:235]
    v_mfma_f32_16x16x32_bf16 a[228:231], v[196:199], v[252:255], a[228:231]
    buffer_load_dwordx4 v7, s[12:15], s47 offen offset:3072  lds
    v_mfma_f32_16x16x32_bf16 a[224:227], v[192:195], v[252:255], a[224:227]
    s_waitcnt lgkmcnt(0)
    v_add_u32 v4, 128, v4
    v_mfma_f32_16x16x32_bf16 a[0:3], v[128:131], v[160:163], a[0:3]
    v_add_u32 v5, 128, v5
    v_mfma_f32_16x16x32_bf16 a[4:7], v[132:135], v[160:163], a[4:7]
    ds_read_b128 v[192:195], v13 offset:0
    v_add_u32 v6, s65, v6
    v_mfma_f32_16x16x32_bf16 a[8:11], v[136:139], v[160:163], a[8:11]
    v_add_u32 v7, s65, v7
    v_mfma_f32_16x16x32_bf16 a[12:15], v[140:143], v[160:163], a[12:15]
    ds_read_b64_tr_b16 v[224:225], v16 offset:8192
    v_mfma_f32_16x16x32_bf16 a[16:19], v[144:147], v[160:163], a[16:19]
    buffer_load_dword v3, v14, s[8:11], 0 offen
    v_mfma_f32_16x16x32_bf16 a[20:23], v[148:151], v[160:163], a[20:23]
    ds_read_b64_tr_b16 v[226:227], v16 offset:9216
    v_mfma_f32_16x16x32_bf16 a[24:27], v[152:155], v[160:163], a[24:27]
    buffer_load_dword v3, v15, s[12:15], 0 offen
    v_mfma_f32_16x16x32_bf16 a[28:31], v[156:159], v[160:163], a[28:31]
    ds_read_b128 v[196:199], v13 offset:2048
    v_mfma_f32_16x16x32_bf16 a[60:63], v[156:159], v[164:167], a[60:63]
    v_add_u32 v14, 128, v14
    v_mfma_f32_16x16x32_bf16 a[56:59], v[152:155], v[164:167], a[56:59]
    ds_read_b64_tr_b16 v[228:229], v17 offset:8192
    v_mfma_f32_16x16x32_bf16 a[52:55], v[148:151], v[164:167], a[52:55]
    v_add_u32 v15, s65, v15
    v_mfma_f32_16x16x32_bf16 a[48:51], v[144:147], v[164:167], a[48:51]
    ds_read_b64_tr_b16 v[230:231], v17 offset:9216
    v_mfma_f32_16x16x32_bf16 a[44:47], v[140:143], v[164:167], a[44:47]
    v_mfma_f32_16x16x32_bf16 a[40:43], v[136:139], v[164:167], a[40:43]
    ds_read_b128 v[200:203], v13 offset:4096
    v_mfma_f32_16x16x32_bf16 a[36:39], v[132:135], v[164:167], a[36:39]
    v_mfma_f32_16x16x32_bf16 a[32:35], v[128:131], v[164:167], a[32:35]
    ds_read_b64_tr_b16 v[232:233], v18 offset:8192
    v_mfma_f32_16x16x32_bf16 a[64:67], v[128:131], v[168:171], a[64:67]
    v_mfma_f32_16x16x32_bf16 a[68:71], v[132:135], v[168:171], a[68:71]
    ds_read_b64_tr_b16 v[234:235], v18 offset:9216
    v_mfma_f32_16x16x32_bf16 a[72:75], v[136:139], v[168:171], a[72:75]
    v_mfma_f32_16x16x32_bf16 a[76:79], v[140:143], v[168:171], a[76:79]
    ds_read_b128 v[204:207], v13 offset:6144
    v_mfma_f32_16x16x32_bf16 a[80:83], v[144:147], v[168:171], a[80:83]
    v_mfma_f32_16x16x32_bf16 a[84:87], v[148:151], v[168:171], a[84:87]
    ds_read_b64_tr_b16 v[236:237], v19 offset:8192
    v_mfma_f32_16x16x32_bf16 a[88:91], v[152:155], v[168:171], a[88:91]
    v_mfma_f32_16x16x32_bf16 a[92:95], v[156:159], v[168:171], a[92:95]
    ds_read_b64_tr_b16 v[238:239], v19 offset:9216
    v_mfma_f32_16x16x32_bf16 a[124:127], v[156:159], v[172:175], a[124:127]
    v_mfma_f32_16x16x32_bf16 a[120:123], v[152:155], v[172:175], a[120:123]
    ds_read_b128 v[208:211], v13 offset:8192
    v_mfma_f32_16x16x32_bf16 a[116:119], v[148:151], v[172:175], a[116:119]
    v_mfma_f32_16x16x32_bf16 a[112:115], v[144:147], v[172:175], a[112:115]
    ds_read_b64_tr_b16 v[240:241], v20 offset:8192
    v_mfma_f32_16x16x32_bf16 a[108:111], v[140:143], v[172:175], a[108:111]
    v_mfma_f32_16x16x32_bf16 a[104:107], v[136:139], v[172:175], a[104:107]
    ds_read_b64_tr_b16 v[242:243], v20 offset:9216
    v_mfma_f32_16x16x32_bf16 a[100:103], v[132:135], v[172:175], a[100:103]
    v_mfma_f32_16x16x32_bf16 a[96:99], v[128:131], v[172:175], a[96:99]
    ds_read_b128 v[212:215], v13 offset:10240
    v_mfma_f32_16x16x32_bf16 a[128:131], v[128:131], v[176:179], a[128:131]
    v_mfma_f32_16x16x32_bf16 a[132:135], v[132:135], v[176:179], a[132:135]
    ds_read_b64_tr_b16 v[244:245], v21 offset:8192
    v_mfma_f32_16x16x32_bf16 a[136:139], v[136:139], v[176:179], a[136:139]
    v_mfma_f32_16x16x32_bf16 a[140:143], v[140:143], v[176:179], a[140:143]
    ds_read_b64_tr_b16 v[246:247], v21 offset:9216
    v_mfma_f32_16x16x32_bf16 a[144:147], v[144:147], v[176:179], a[144:147]
    v_mfma_f32_16x16x32_bf16 a[148:151], v[148:151], v[176:179], a[148:151]
    ds_read_b128 v[216:219], v13 offset:12288
    v_mfma_f32_16x16x32_bf16 a[152:155], v[152:155], v[176:179], a[152:155]
    v_mfma_f32_16x16x32_bf16 a[156:159], v[156:159], v[176:179], a[156:159]
    ds_read_b64_tr_b16 v[248:249], v22 offset:8192
    v_mfma_f32_16x16x32_bf16 a[188:191], v[156:159], v[180:183], a[188:191]
    v_mfma_f32_16x16x32_bf16 a[184:187], v[152:155], v[180:183], a[184:187]
    ds_read_b64_tr_b16 v[250:251], v22 offset:9216
    v_mfma_f32_16x16x32_bf16 a[180:183], v[148:151], v[180:183], a[180:183]
    v_mfma_f32_16x16x32_bf16 a[176:179], v[144:147], v[180:183], a[176:179]
    ds_read_b128 v[220:223], v13 offset:14336
    v_mfma_f32_16x16x32_bf16 a[172:175], v[140:143], v[180:183], a[172:175]
    v_mfma_f32_16x16x32_bf16 a[168:171], v[136:139], v[180:183], a[168:171]
    ds_read_b64_tr_b16 v[252:253], v23 offset:8192
    v_mfma_f32_16x16x32_bf16 a[164:167], v[132:135], v[180:183], a[164:167]
    v_mfma_f32_16x16x32_bf16 a[160:163], v[128:131], v[180:183], a[160:163]
    ds_read_b64_tr_b16 v[254:255], v23 offset:9216
    v_mfma_f32_16x16x32_bf16 a[192:195], v[128:131], v[184:187], a[192:195]
    v_mfma_f32_16x16x32_bf16 a[196:199], v[132:135], v[184:187], a[196:199]
    v_mfma_f32_16x16x32_bf16 a[200:203], v[136:139], v[184:187], a[200:203]
    v_mfma_f32_16x16x32_bf16 a[204:207], v[140:143], v[184:187], a[204:207]
    v_mfma_f32_16x16x32_bf16 a[208:211], v[144:147], v[184:187], a[208:211]
    v_mfma_f32_16x16x32_bf16 a[212:215], v[148:151], v[184:187], a[212:215]
    v_mfma_f32_16x16x32_bf16 a[216:219], v[152:155], v[184:187], a[216:219]
    v_mfma_f32_16x16x32_bf16 a[220:223], v[156:159], v[184:187], a[220:223]
    v_mfma_f32_16x16x32_bf16 a[252:255], v[156:159], v[188:191], a[252:255]
    v_mfma_f32_16x16x32_bf16 a[248:251], v[152:155], v[188:191], a[248:251]
    v_mfma_f32_16x16x32_bf16 a[244:247], v[148:151], v[188:191], a[244:247]
    v_mfma_f32_16x16x32_bf16 a[240:243], v[144:147], v[188:191], a[240:243]
    v_mfma_f32_16x16x32_bf16 a[236:239], v[140:143], v[188:191], a[236:239]
    v_mfma_f32_16x16x32_bf16 a[232:235], v[136:139], v[188:191], a[232:235]
    v_mfma_f32_16x16x32_bf16 a[228:231], v[132:135], v[188:191], a[228:231]
    v_mfma_f32_16x16x32_bf16 a[224:227], v[128:131], v[188:191], a[224:227]
    s_waitcnt vmcnt(2) lgkmcnt(0)
    s_barrier
    s_sub_u32 s67, s67, 1
    s_cmp_lg_u32 s67, 0
    s_cbranch_scc1 K1_LOOP_V
    v_mov_b32 v14, v124
    v_mov_b32 v15, v125
    s_waitcnt lgkmcnt(0)
    v_mfma_f32_16x16x32_bf16 a[0:3], v[192:195], v[224:227], a[0:3]
    v_mfma_f32_16x16x32_bf16 a[4:7], v[196:199], v[224:227], a[4:7]
    ds_read_b128 v[128:131], v12 offset:32768
    s_add_u32 m0, s64, 0
    v_mfma_f32_16x16x32_bf16 a[8:11], v[200:203], v[224:227], a[8:11]
    buffer_load_dwordx4 v4, s[8:11], s32 offen offset:0  lds
    v_mfma_f32_16x16x32_bf16 a[12:15], v[204:207], v[224:227], a[12:15]
    ds_read_b64_tr_b16 v[160:161], v16 offset:32768
    v_mfma_f32_16x16x32_bf16 a[16:19], v[208:211], v[224:227], a[16:19]
    v_mfma_f32_16x16x32_bf16 a[20:23], v[212:215], v[224:227], a[20:23]
    ds_read_b64_tr_b16 v[162:163], v16 offset:33792
    v_mfma_f32_16x16x32_bf16 a[24:27], v[216:219], v[224:227], a[24:27]
    buffer_load_dwordx4 v5, s[8:11], s33 offen offset:1024  lds
    v_mfma_f32_16x16x32_bf16 a[28:31], v[220:223], v[224:227], a[28:31]
    ds_read_b128 v[132:135], v12 offset:34816
    v_mfma_f32_16x16x32_bf16 a[60:63], v[220:223], v[228:231], a[60:63]
    v_mfma_f32_16x16x32_bf16 a[56:59], v[216:219], v[228:231], a[56:59]
    ds_read_b64_tr_b16 v[164:165], v17 offset:32768
    v_mfma_f32_16x16x32_bf16 a[52:55], v[212:215], v[228:231], a[52:55]
    buffer_load_dwordx4 v4, s[8:11], s34 offen offset:2048  lds
    v_mfma_f32_16x16x32_bf16 a[48:51], v[208:211], v[228:231], a[48:51]
    ds_read_b64_tr_b16 v[166:167], v17 offset:33792
    v_mfma_f32_16x16x32_bf16 a[44:47], v[204:207], v[228:231], a[44:47]
    v_mfma_f32_16x16x32_bf16 a[40:43], v[200:203], v[228:231], a[40:43]
    ds_read_b128 v[136:139], v12 offset:36864
    v_mfma_f32_16x16x32_bf16 a[36:39], v[196:199], v[228:231], a[36:39]
    buffer_load_dwordx4 v5, s[8:11], s35 offen offset:3072  lds
    v_mfma_f32_16x16x32_bf16 a[32:35], v[192:195], v[228:231], a[32:35]
    ds_read_b64_tr_b16 v[168:169], v18 offset:32768
    v_mfma_f32_16x16x32_bf16 a[64:67], v[192:195], v[232:235], a[64:67]
    v_mfma_f32_16x16x32_bf16 a[68:71], v[196:199], v[232:235], a[68:71]
    ds_read_b64_tr_b16 v[170:171], v18 offset:33792
    s_add_u32 m0, s64, 4096
    v_mfma_f32_16x16x32_bf16 a[72:75], v[200:203], v[232:235], a[72:75]
    buffer_load_dwordx4 v4, s[8:11], s36 offen offset:0  lds
    v_mfma_f32_16x16x32_bf16 a[76:79], v[204:207], v[232:235], a[76:79]
    ds_read_b128 v[140:143], v12 offset:38912
    v_mfma_f32_16x16x32_bf16 a[80:83], v[208:211], v[232:235], a[80:83]
    v_mfma_f32_16x16x32_bf16 a[84:87], v[212:215], v[232:235], a[84:87]
    ds_read_b64_tr_b16 v[172:173], v19 offset:32768
    v_mfma_f32_16x16x32_bf16 a[88:91], v[216:219], v[232:235], a[88:91]
    buffer_load_dwordx4 v5, s[8:11], s37 offen offset:1024  lds
    v_mfma_f32_16x16x32_bf16 a[92:95], v[220:223], v[232:235], a[92:95]
    ds_read_b64_tr_b16 v[174:175], v19 offset:33792
    v_mfma_f32_16x16x32_bf16 a[124:127], v[220:223], v[236:239], a[124:127]
    v_mfma_f32_16x16x32_bf16 a[120:123], v[216:219], v[236:239], a[120:123]
    ds_read_b128 v[144:147], v12 offset:40960
    v_mfma_f32_16x16x32_bf16 a[116:119], v[212:215], v[236:239], a[116:119]
    buffer_load_dwordx4 v4, s[8:11], s38 offen offset:2048  lds
    v_mfma_f32_16x16x32_bf16 a[112:115], v[208:211], v[236:239], a[112:115]
    ds_read_b64_tr_b16 v[176:177], v20 offset:32768
    v_mfma_f32_16x16x32_bf16 a[108:111], v[204:207], v[236:239], a[108:111]
    v_mfma_f32_16x16x32_bf16 a[104:107], v[200:203], v[236:239], a[104:107]
    ds_read_b64_tr_b16 v[178:179], v20 offset:33792
    v_mfma_f32_16x16x32_bf16 a[100:103], v[196:199], v[236:239], a[100:103]
    buffer_load_dwordx4 v5, s[8:11], s39 offen offset:3072  lds
    v_mfma_f32_16x16x32_bf16 a[96:99], v[192:195], v[236:239], a[96:99]
    ds_read_b128 v[148:151], v12 offset:43008
    v_mfma_f32_16x16x32_bf16 a[128:131], v[192:195], v[240:243], a[128:131]
    v_mfma_f32_16x16x32_bf16 a[132:135], v[196:199], v[240:243], a[132:135]
    ds_read_b64_tr_b16 v[180:181], v21 offset:32768
    s_add_u32 m0, s64, 65536
    v_mfma_f32_16x16x32_bf16 a[136:139], v[200:203], v[240:243], a[136:139]
    buffer_load_dwordx4 v6, s[12:15], s40 offen offset:0  lds
    v_mfma_f32_16x16x32_bf16 a[140:143], v[204:207], v[240:243], a[140:143]
    ds_read_b64_tr_b16 v[182:183], v21 offset:33792
    v_mfma_f32_16x16x32_bf16 a[144:147], v[208:211], v[240:243], a[144:147]
    v_mfma_f32_16x16x32_bf16 a[148:151], v[212:215], v[240:243], a[148:151]
    ds_read_b128 v[152:155], v12 offset:45056
    v_mfma_f32_16x16x32_bf16 a[152:155], v[216:219], v[240:243], a[152:155]
    buffer_load_dwordx4 v6, s[12:15], s41 offen offset:1024  lds
    v_mfma_f32_16x16x32_bf16 a[156:159], v[220:223], v[240:243], a[156:159]
    ds_read_b64_tr_b16 v[184:185], v22 offset:32768
    v_mfma_f32_16x16x32_bf16 a[188:191], v[220:223], v[244:247], a[188:191]
    v_mfma_f32_16x16x32_bf16 a[184:187], v[216:219], v[244:247], a[184:187]
    ds_read_b64_tr_b16 v[186:187], v22 offset:33792
    v_mfma_f32_16x16x32_bf16 a[180:183], v[212:215], v[244:247], a[180:183]
    buffer_load_dwordx4 v7, s[12:15], s42 offen offset:2048  lds
    v_mfma_f32_16x16x32_bf16 a[176:179], v[208:211], v[244:247], a[176:179]
    ds_read_b128 v[156:159], v12 offset:47104
    v_mfma_f32_16x16x32_bf16 a[172:175], v[204:207], v[244:247], a[172:175]
    v_mfma_f32_16x16x32_bf16 a[168:171], v[200:203], v[244:247], a[168:171]
    ds_read_b64_tr_b16 v[188:189], v23 offset:32768
    v_mfma_f32_16x16x32_bf16 a[164:167], v[196:199], v[244:247], a[164:167]
    buffer_load_dwordx4 v7, s[12:15], s43 offen offset:3072  lds
    v_mfma_f32_16x16x32_bf16 a[160:163], v[192:195], v[244:247], a[160:163]
    ds_read_b64_tr_b16 v[190:191], v23 offset:33792
    v_mfma_f32_16x16x32_bf16 a[192:195], v[192:195], v[248:251], a[192:195]
    v_mfma_f32_16x16x32_bf16 a[196:199], v[196:199], v[248:251], a[196:199]
    s_add_u32 m0, s64, 69632
    v_mfma_f32_16x16x32_bf16 a[200:203], v[200:203], v[248:251], a[200:203]
    buffer_load_dwordx4 v6, s[12:15], s44 offen offset:0  lds
    v_mfma_f32_16x16x32_bf16 a[204:207], v[204:207], v[248:251], a[204:207]
    v_mfma_f32_16x16x32_bf16 a[208:211], v[208:211], v[248:251], a[208:211]
    v_mfma_f32_16x16x32_bf16 a[212:215], v[212:215], v[248:251], a[212:215]
    v_mfma_f32_16x16x32_bf16 a[216:219], v[216:219], v[248:251], a[216:219]
    buffer_load_dwordx4 v6, s[12:15], s45 offen offset:1024  lds
    v_mfma_f32_16x16x32_bf16 a[220:223], v[220:223], v[248:251], a[220:223]
    v_mfma_f32_16x16x32_bf16 a[252:255], v[220:223], v[252:255], a[252:255]
    v_mfma_f32_16x16x32_bf16 a[248:251], v[216:219], v[252:255], a[248:251]
    v_mfma_f32_16x16x32_bf16 a[244:247], v[212:215], v[252:255], a[244:247]
    buffer_load_dwordx4 v7, s[12:15], s46 offen offset:2048  lds
    v_mfma_f32_16x16x32_bf16 a[240:243], v[208:211], v[252:255], a[240:243]
    v_mfma_f32_16x16x32_bf16 a[236:239], v[204:207], v[252:255], a[236:239]
    v_mfma_f32_16x16x32_bf16 a[232:235], v[200:203], v[252:255], a[232:235]
    v_mfma_f32_16x16x32_bf16 a[228:231], v[196:199], v[252:255], a[228:231]
    buffer_load_dwordx4 v7, s[12:15], s47 offen offset:3072  lds
    v_mfma_f32_16x16x32_bf16 a[224:227], v[192:195], v[252:255], a[224:227]
    s_waitcnt lgkmcnt(0)
    v_add_u32 v4, 128, v4
    v_mfma_f32_16x16x32_bf16 a[0:3], v[128:131], v[160:163], a[0:3]
    v_add_u32 v5, 128, v5
    v_mfma_f32_16x16x32_bf16 a[4:7], v[132:135], v[160:163], a[4:7]
    ds_read_b128 v[192:195], v13 offset:32768
    v_add_u32 v6, s65, v6
    v_mfma_f32_16x16x32_bf16 a[8:11], v[136:139], v[160:163], a[8:11]
    v_add_u32 v7, s65, v7
    v_mfma_f32_16x16x32_bf16 a[12:15], v[140:143], v[160:163], a[12:15]
    ds_read_b64_tr_b16 v[224:225], v16 offset:40960
    v_mfma_f32_16x16x32_bf16 a[16:19], v[144:147], v[160:163], a[16:19]
    buffer_load_dword v3, v14, s[16:19], 0 offen
    v_mfma_f32_16x16x32_bf16 a[20:23], v[148:151], v[160:163], a[20:23]
    ds_read_b64_tr_b16 v[226:227], v16 offset:41984
    v_mfma_f32_16x16x32_bf16 a[24:27], v[152:155], v[160:163], a[24:27]
    buffer_load_dword v3, v15, s[20:23], 0 offen
    v_mfma_f32_16x16x32_bf16 a[28:31], v[156:159], v[160:163], a[28:31]
    ds_read_b128 v[196:199], v13 offset:34816
    v_mfma_f32_16x16x32_bf16 a[60:63], v[156:159], v[164:167], a[60:63]
    v_add_u32 v14, 128, v14
    v_mfma_f32_16x16x32_bf16 a[56:59], v[152:155], v[164:167], a[56:59]
    ds_read_b64_tr_b16 v[228:229], v17 offset:40960
    v_mfma_f32_16x16x32_bf16 a[52:55], v[148:151], v[164:167], a[52:55]
    v_add_u32 v15, s66, v15
    v_mfma_f32_16x16x32_bf16 a[48:51], v[144:147], v[164:167], a[48:51]
    ds_read_b64_tr_b16 v[230:231], v17 offset:41984
    v_mfma_f32_16x16x32_bf16 a[44:47], v[140:143], v[164:167], a[44:47]
    v_mfma_f32_16x16x32_bf16 a[40:43], v[136:139], v[164:167], a[40:43]
    ds_read_b128 v[200:203], v13 offset:36864
    v_mfma_f32_16x16x32_bf16 a[36:39], v[132:135], v[164:167], a[36:39]
    v_mfma_f32_16x16x32_bf16 a[32:35], v[128:131], v[164:167], a[32:35]
    ds_read_b64_tr_b16 v[232:233], v18 offset:40960
    v_mfma_f32_16x16x32_bf16 a[64:67], v[128:131], v[168:171], a[64:67]
    v_mfma_f32_16x16x32_bf16 a[68:71], v[132:135], v[168:171], a[68:71]
    ds_read_b64_tr_b16 v[234:235], v18 offset:41984
    v_mfma_f32_16x16x32_bf16 a[72:75], v[136:139], v[168:171], a[72:75]
    v_mfma_f32_16x16x32_bf16 a[76:79], v[140:143], v[168:171], a[76:79]
    ds_read_b128 v[204:207], v13 offset:38912
    v_mfma_f32_16x16x32_bf16 a[80:83], v[144:147], v[168:171], a[80:83]
    v_mfma_f32_16x16x32_bf16 a[84:87], v[148:151], v[168:171], a[84:87]
    ds_read_b64_tr_b16 v[236:237], v19 offset:40960
    v_mfma_f32_16x16x32_bf16 a[88:91], v[152:155], v[168:171], a[88:91]
    v_mfma_f32_16x16x32_bf16 a[92:95], v[156:159], v[168:171], a[92:95]
    ds_read_b64_tr_b16 v[238:239], v19 offset:41984
    v_mfma_f32_16x16x32_bf16 a[124:127], v[156:159], v[172:175], a[124:127]
    v_mfma_f32_16x16x32_bf16 a[120:123], v[152:155], v[172:175], a[120:123]
    ds_read_b128 v[208:211], v13 offset:40960
    v_mfma_f32_16x16x32_bf16 a[116:119], v[148:151], v[172:175], a[116:119]
    v_mfma_f32_16x16x32_bf16 a[112:115], v[144:147], v[172:175], a[112:115]
    ds_read_b64_tr_b16 v[240:241], v20 offset:40960
    v_mfma_f32_16x16x32_bf16 a[108:111], v[140:143], v[172:175], a[108:111]
    v_mfma_f32_16x16x32_bf16 a[104:107], v[136:139], v[172:175], a[104:107]
    ds_read_b64_tr_b16 v[242:243], v20 offset:41984
    v_mfma_f32_16x16x32_bf16 a[100:103], v[132:135], v[172:175], a[100:103]
    v_mfma_f32_16x16x32_bf16 a[96:99], v[128:131], v[172:175], a[96:99]
    ds_read_b128 v[212:215], v13 offset:43008
    v_mfma_f32_16x16x32_bf16 a[128:131], v[128:131], v[176:179], a[128:131]
    v_mfma_f32_16x16x32_bf16 a[132:135], v[132:135], v[176:179], a[132:135]
    ds_read_b64_tr_b16 v[244:245], v21 offset:40960
    v_mfma_f32_16x16x32_bf16 a[136:139], v[136:139], v[176:179], a[136:139]
    v_mfma_f32_16x16x32_bf16 a[140:143], v[140:143], v[176:179], a[140:143]
    ds_read_b64_tr_b16 v[246:247], v21 offset:41984
    v_mfma_f32_16x16x32_bf16 a[144:147], v[144:147], v[176:179], a[144:147]
    v_mfma_f32_16x16x32_bf16 a[148:151], v[148:151], v[176:179], a[148:151]
    ds_read_b128 v[216:219], v13 offset:45056
    v_mfma_f32_16x16x32_bf16 a[152:155], v[152:155], v[176:179], a[152:155]
    v_mfma_f32_16x16x32_bf16 a[156:159], v[156:159], v[176:179], a[156:159]
    ds_read_b64_tr_b16 v[248:249], v22 offset:40960
    v_mfma_f32_16x16x32_bf16 a[188:191], v[156:159], v[180:183], a[188:191]
    v_mfma_f32_16x16x32_bf16 a[184:187], v[152:155], v[180:183], a[184:187]
    ds_read_b64_tr_b16 v[250:251], v22 offset:41984
    v_mfma_f32_16x16x32_bf16 a[180:183], v[148:151], v[180:183], a[180:183]
    v_mfma_f32_16x16x32_bf16 a[176:179], v[144:147], v[180:183], a[176:179]
    ds_read_b128 v[220:223], v13 offset:47104
    v_mfma_f32_16x16x32_bf16 a[172:175], v[140:143], v[180:183], a[172:175]
    v_mfma_f32_16x16x32_bf16 a[168:171], v[136:139], v[180:183], a[168:171]
    ds_read_b64_tr_b16 v[252:253], v23 offset:40960
    v_mfma_f32_16x16x32_bf16 a[164:167], v[132:135], v[180:183], a[164:167]
    v_mfma_f32_16x16x32_bf16 a[160:163], v[128:131], v[180:183], a[160:163]
    ds_read_b64_tr_b16 v[254:255], v23 offset:41984
    v_mfma_f32_16x16x32_bf16 a[192:195], v[128:131], v[184:187], a[192:195]
    v_mfma_f32_16x16x32_bf16 a[196:199], v[132:135], v[184:187], a[196:199]
    v_mfma_f32_16x16x32_bf16 a[200:203], v[136:139], v[184:187], a[200:203]
    v_mfma_f32_16x16x32_bf16 a[204:207], v[140:143], v[184:187], a[204:207]
    v_mfma_f32_16x16x32_bf16 a[208:211], v[144:147], v[184:187], a[208:211]
    v_mfma_f32_16x16x32_bf16 a[212:215], v[148:151], v[184:187], a[212:215]
    v_mfma_f32_16x16x32_bf16 a[216:219], v[152:155], v[184:187], a[216:219]
    v_mfma_f32_16x16x32_bf16 a[220:223], v[156:159], v[184:187], a[220:223]
    v_mfma_f32_16x16x32_bf16 a[252:255], v[156:159], v[188:191], a[252:255]
    v_mfma_f32_16x16x32_bf16 a[248:251], v[152:155], v[188:191], a[248:251]
    v_mfma_f32_16x16x32_bf16 a[244:247], v[148:151], v[188:191], a[244:247]
    v_mfma_f32_16x16x32_bf16 a[240:243], v[144:147], v[188:191], a[240:243]
    v_mfma_f32_16x16x32_bf16 a[236:239], v[140:143], v[188:191], a[236:239]
    v_mfma_f32_16x16x32_bf16 a[232:235], v[136:139], v[188:191], a[232:235]
    v_mfma_f32_16x16x32_bf16 a[228:231], v[132:135], v[188:191], a[228:231]
    v_mfma_f32_16x16x32_bf16 a[224:227], v[128:131], v[188:191], a[224:227]
    s_waitcnt vmcnt(2) lgkmcnt(0)
    s_barrier
    s_waitcnt lgkmcnt(0)
    v_mfma_f32_16x16x32_bf16 a[0:3], v[192:195], v[224:227], a[0:3]
    v_mfma_f32_16x16x32_bf16 a[4:7], v[196:199], v[224:227], a[4:7]
    ds_read_b128 v[128:131], v12 offset:0
    s_add_u32 m0, s64, 32768
    v_mfma_f32_16x16x32_bf16 a[8:11], v[200:203], v[224:227], a[8:11]
    buffer_load_dwordx4 v4, s[8:11], s32 offen offset:0  lds
    v_mfma_f32_16x16x32_bf16 a[12:15], v[204:207], v[224:227], a[12:15]
    ds_read_b64_tr_b16 v[160:161], v16 offset:0
    v_mfma_f32_16x16x32_bf16 a[16:19], v[208:211], v[224:227], a[16:19]
    v_mfma_f32_16x16x32_bf16 a[20:23], v[212:215], v[224:227], a[20:23]
    ds_read_b64_tr_b16 v[162:163], v16 offset:1024
    v_mfma_f32_16x16x32_bf16 a[24:27], v[216:219], v[224:227], a[24:27]
    buffer_load_dwordx4 v5, s[8:11], s33 offen offset:1024  lds
    v_mfma_f32_16x16x32_bf16 a[28:31], v[220:223], v[224:227], a[28:31]
    ds_read_b128 v[132:135], v12 offset:2048
    v_mfma_f32_16x16x32_bf16 a[60:63], v[220:223], v[228:231], a[60:63]
    v_mfma_f32_16x16x32_bf16 a[56:59], v[216:219], v[228:231], a[56:59]
    ds_read_b64_tr_b16 v[164:165], v17 offset:0
    v_mfma_f32_16x16x32_bf16 a[52:55], v[212:215], v[228:231], a[52:55]
    buffer_load_dwordx4 v4, s[8:11], s34 offen offset:2048  lds
    v_mfma_f32_16x16x32_bf16 a[48:51], v[208:211], v[228:231], a[48:51]
    ds_read_b64_tr_b16 v[166:167], v17 offset:1024
    v_mfma_f32_16x16x32_bf16 a[44:47], v[204:207], v[228:231], a[44:47]
    v_mfma_f32_16x16x32_bf16 a[40:43], v[200:203], v[228:231], a[40:43]
    ds_read_b128 v[136:139], v12 offset:4096
    v_mfma_f32_16x16x32_bf16 a[36:39], v[196:199], v[228:231], a[36:39]
    buffer_load_dwordx4 v5, s[8:11], s35 offen offset:3072  lds
    v_mfma_f32_16x16x32_bf16 a[32:35], v[192:195], v[228:231], a[32:35]
    ds_read_b64_tr_b16 v[168:169], v18 offset:0
    v_mfma_f32_16x16x32_bf16 a[64:67], v[192:195], v[232:235], a[64:67]
    v_mfma_f32_16x16x32_bf16 a[68:71], v[196:199], v[232:235], a[68:71]
    ds_read_b64_tr_b16 v[170:171], v18 offset:1024
    s_add_u32 m0, s64, 36864
    v_mfma_f32_16x16x32_bf16 a[72:75], v[200:203], v[232:235], a[72:75]
    buffer_load_dwordx4 v4, s[8:11], s36 offen offset:0  lds
    v_mfma_f32_16x16x32_bf16 a[76:79], v[204:207], v[232:235], a[76:79]
    ds_read_b128 v[140:143], v12 offset:6144
    v_mfma_f32_16x16x32_bf16 a[80:83], v[208:211], v[232:235], a[80:83]
    v_mfma_f32_16x16x32_bf16 a[84:87], v[212:215], v[232:235], a[84:87]
    ds_read_b64_tr_b16 v[172:173], v19 offset:0
    v_mfma_f32_16x16x32_bf16 a[88:91], v[216:219], v[232:235], a[88:91]
    buffer_load_dwordx4 v5, s[8:11], s37 offen offset:1024  lds
    v_mfma_f32_16x16x32_bf16 a[92:95], v[220:223], v[232:235], a[92:95]
    ds_read_b64_tr_b16 v[174:175], v19 offset:1024
    v_mfma_f32_16x16x32_bf16 a[124:127], v[220:223], v[236:239], a[124:127]
    v_mfma_f32_16x16x32_bf16 a[120:123], v[216:219], v[236:239], a[120:123]
    ds_read_b128 v[144:147], v12 offset:8192
    v_mfma_f32_16x16x32_bf16 a[116:119], v[212:215], v[236:239], a[116:119]
    buffer_load_dwordx4 v4, s[8:11], s38 offen offset:2048  lds
    v_mfma_f32_16x16x32_bf16 a[112:115], v[208:211], v[236:239], a[112:115]
    ds_read_b64_tr_b16 v[176:177], v20 offset:0
    v_mfma_f32_16x16x32_bf16 a[108:111], v[204:207], v[236:239], a[108:111]
    v_mfma_f32_16x16x32_bf16 a[104:107], v[200:203], v[236:239], a[104:107]
    ds_read_b64_tr_b16 v[178:179], v20 offset:1024
    v_mfma_f32_16x16x32_bf16 a[100:103], v[196:199], v[236:239], a[100:103]
    buffer_load_dwordx4 v5, s[8:11], s39 offen offset:3072  lds
    v_mfma_f32_16x16x32_bf16 a[96:99], v[192:195], v[236:239], a[96:99]
    ds_read_b128 v[148:151], v12 offset:10240
    v_mfma_f32_16x16x32_bf16 a[128:131], v[192:195], v[240:243], a[128:131]
    v_mfma_f32_16x16x32_bf16 a[132:135], v[196:199], v[240:243], a[132:135]
    ds_read_b64_tr_b16 v[180:181], v21 offset:0
    s_add_u32 m0, s64, 98304
    v_mfma_f32_16x16x32_bf16 a[136:139], v[200:203], v[240:243], a[136:139]
    buffer_load_dwordx4 v6, s[12:15], s40 offen offset:0  lds
    v_mfma_f32_16x16x32_bf16 a[140:143], v[204:207], v[240:243], a[140:143]
    ds_read_b64_tr_b16 v[182:183], v21 offset:1024
    v_mfma_f32_16x16x32_bf16 a[144:147], v[208:211], v[240:243], a[144:147]
    v_mfma_f32_16x16x32_bf16 a[148:151], v[212:215], v[240:243], a[148:151]
    ds_read_b128 v[152:155], v12 offset:12288
    v_mfma_f32_16x16x32_bf16 a[152:155], v[216:219], v[240:243], a[152:155]
    buffer_load_dwordx4 v6, s[12:15], s41 offen offset:1024  lds
    v_mfma_f32_16x16x32_bf16 a[156:159], v[220:223], v[240:243], a[156:159]
    ds_read_b64_tr_b16 v[184:185], v22 offset:0
    v_mfma_f32_16x16x32_bf16 a[188:191], v[220:223], v[244:247], a[188:191]
    v_mfma_f32_16x16x32_bf16 a[184:187], v[216:219], v[244:247], a[184:187]
    ds_read_b64_tr_b16 v[186:187], v22 offset:1024
    v_mfma_f32_16x16x32_bf16 a[180:183], v[212:215], v[244:247], a[180:183]
    buffer_load_dwordx4 v7, s[12:15], s42 offen offset:2048  lds
    v_mfma_f32_16x16x32_bf16 a[176:179], v[208:211], v[244:247], a[176:179]
    ds_read_b128 v[156:159], v12 offset:14336
    v_mfma_f32_16x16x32_bf16 a[172:175], v[204:207], v[244:247], a[172:175]
    v_mfma_f32_16x16x32_bf16 a[168:171], v[200:203], v[244:247], a[168:171]
    ds_read_b64_tr_b16 v[188:189], v23 offset:0
    v_mfma_f32_16x16x32_bf16 a[164:167], v[196:199], v[244:247], a[164:167]
    buffer_load_dwordx4 v7, s[12:15], s43 offen offset:3072  lds
    v_mfma_f32_16x16x32_bf16 a[160:163], v[192:195], v[244:247], a[160:163]
    ds_read_b64_tr_b16 v[190:191], v23 offset:1024
    v_mfma_f32_16x16x32_bf16 a[192:195], v[192:195], v[248:251], a[192:195]
    v_mfma_f32_16x16x32_bf16 a[196:199], v[196:199], v[248:251], a[196:199]
    s_add_u32 m0, s64, 102400
    v_mfma_f32_16x16x32_bf16 a[200:203], v[200:203], v[248:251], a[200:203]
    buffer_load_dwordx4 v6, s[12:15], s44 offen offset:0  lds
    v_mfma_f32_16x16x32_bf16 a[204:207], v[204:207], v[248:251], a[204:207]
    v_mfma_f32_16x16x32_bf16 a[208:211], v[208:211], v[248:251], a[208:211]
    v_mfma_f32_16x16x32_bf16 a[212:215], v[212:215], v[248:251], a[212:215]
    v_mfma_f32_16x16x32_bf16 a[216:219], v[216:219], v[248:251], a[216:219]
    buffer_load_dwordx4 v6, s[12:15], s45 offen offset:1024  lds
    v_mfma_f32_16x16x32_bf16 a[220:223], v[220:223], v[248:251], a[220:223]
    v_mfma_f32_16x16x32_bf16 a[252:255], v[220:223], v[252:255], a[252:255]
    v_mfma_f32_16x16x32_bf16 a[248:251], v[216:219], v[252:255], a[248:251]
    v_mfma_f32_16x16x32_bf16 a[244:247], v[212:215], v[252:255], a[244:247]
    buffer_load_dwordx4 v7, s[12:15], s46 offen offset:2048  lds
    v_mfma_f32_16x16x32_bf16 a[240:243], v[208:211], v[252:255], a[240:243]
    v_mfma_f32_16x16x32_bf16 a[236:239], v[204:207], v[252:255], a[236:239]
    v_mfma_f32_16x16x32_bf16 a[232:235], v[200:203], v[252:255], a[232:235]
    v_mfma_f32_16x16x32_bf16 a[228:231], v[196:199], v[252:255], a[228:231]
    buffer_load_dwordx4 v7, s[12:15], s47 offen offset:3072  lds
    v_mfma_f32_16x16x32_bf16 a[224:227], v[192:195], v[252:255], a[224:227]
    s_waitcnt lgkmcnt(0)
    v_add_u32 v4, 128, v4
    v_mfma_f32_16x16x32_bf16 a[0:3], v[128:131], v[160:163], a[0:3]
    v_add_u32 v5, 128, v5
    v_mfma_f32_16x16x32_bf16 a[4:7], v[132:135], v[160:163], a[4:7]
    ds_read_b128 v[192:195], v13 offset:0
    v_add_u32 v6, s65, v6
    v_mfma_f32_16x16x32_bf16 a[8:11], v[136:139], v[160:163], a[8:11]
    v_add_u32 v7, s65, v7
    v_mfma_f32_16x16x32_bf16 a[12:15], v[140:143], v[160:163], a[12:15]
    ds_read_b64_tr_b16 v[224:225], v16 offset:8192
    v_mfma_f32_16x16x32_bf16 a[16:19], v[144:147], v[160:163], a[16:19]
    buffer_load_dword v3, v14, s[16:19], 0 offen
    v_mfma_f32_16x16x32_bf16 a[20:23], v[148:151], v[160:163], a[20:23]
    ds_read_b64_tr_b16 v[226:227], v16 offset:9216
    v_mfma_f32_16x16x32_bf16 a[24:27], v[152:155], v[160:163], a[24:27]
    buffer_load_dword v3, v15, s[20:23], 0 offen
    v_mfma_f32_16x16x32_bf16 a[28:31], v[156:159], v[160:163], a[28:31]
    ds_read_b128 v[196:199], v13 offset:2048
    v_mfma_f32_16x16x32_bf16 a[60:63], v[156:159], v[164:167], a[60:63]
    v_add_u32 v14, 128, v14
    v_mfma_f32_16x16x32_bf16 a[56:59], v[152:155], v[164:167], a[56:59]
    ds_read_b64_tr_b16 v[228:229], v17 offset:8192
    v_mfma_f32_16x16x32_bf16 a[52:55], v[148:151], v[164:167], a[52:55]
    v_add_u32 v15, s66, v15
    v_mfma_f32_16x16x32_bf16 a[48:51], v[144:147], v[164:167], a[48:51]
    ds_read_b64_tr_b16 v[230:231], v17 offset:9216
    v_mfma_f32_16x16x32_bf16 a[44:47], v[140:143], v[164:167], a[44:47]
    v_mfma_f32_16x16x32_bf16 a[40:43], v[136:139], v[164:167], a[40:43]
    ds_read_b128 v[200:203], v13 offset:4096
    v_mfma_f32_16x16x32_bf16 a[36:39], v[132:135], v[164:167], a[36:39]
    v_mfma_f32_16x16x32_bf16 a[32:35], v[128:131], v[164:167], a[32:35]
    ds_read_b64_tr_b16 v[232:233], v18 offset:8192
    v_mfma_f32_16x16x32_bf16 a[64:67], v[128:131], v[168:171], a[64:67]
    v_mfma_f32_16x16x32_bf16 a[68:71], v[132:135], v[168:171], a[68:71]
    ds_read_b64_tr_b16 v[234:235], v18 offset:9216
    v_mfma_f32_16x16x32_bf16 a[72:75], v[136:139], v[168:171], a[72:75]
    v_mfma_f32_16x16x32_bf16 a[76:79], v[140:143], v[168:171], a[76:79]
    ds_read_b128 v[204:207], v13 offset:6144
    v_mfma_f32_16x16x32_bf16 a[80:83], v[144:147], v[168:171], a[80:83]
    v_mfma_f32_16x16x32_bf16 a[84:87], v[148:151], v[168:171], a[84:87]
    ds_read_b64_tr_b16 v[236:237], v19 offset:8192
    v_mfma_f32_16x16x32_bf16 a[88:91], v[152:155], v[168:171], a[88:91]
    v_mfma_f32_16x16x32_bf16 a[92:95], v[156:159], v[168:171], a[92:95]
    ds_read_b64_tr_b16 v[238:239], v19 offset:9216
    v_mfma_f32_16x16x32_bf16 a[124:127], v[156:159], v[172:175], a[124:127]
    v_mfma_f32_16x16x32_bf16 a[120:123], v[152:155], v[172:175], a[120:123]
    ds_read_b128 v[208:211], v13 offset:8192
    v_mfma_f32_16x16x32_bf16 a[116:119], v[148:151], v[172:175], a[116:119]
    v_mfma_f32_16x16x32_bf16 a[112:115], v[144:147], v[172:175], a[112:115]
    ds_read_b64_tr_b16 v[240:241], v20 offset:8192
    v_mfma_f32_16x16x32_bf16 a[108:111], v[140:143], v[172:175], a[108:111]
    v_mfma_f32_16x16x32_bf16 a[104:107], v[136:139], v[172:175], a[104:107]
    ds_read_b64_tr_b16 v[242:243], v20 offset:9216
    v_mfma_f32_16x16x32_bf16 a[100:103], v[132:135], v[172:175], a[100:103]
    v_mfma_f32_16x16x32_bf16 a[96:99], v[128:131], v[172:175], a[96:99]
    ds_read_b128 v[212:215], v13 offset:10240
    v_mfma_f32_16x16x32_bf16 a[128:131], v[128:131], v[176:179], a[128:131]
    v_mfma_f32_16x16x32_bf16 a[132:135], v[132:135], v[176:179], a[132:135]
    ds_read_b64_tr_b16 v[244:245], v21 offset:8192
    v_mfma_f32_16x16x32_bf16 a[136:139], v[136:139], v[176:179], a[136:139]
    v_mfma_f32_16x16x32_bf16 a[140:143], v[140:143], v[176:179], a[140:143]
    ds_read_b64_tr_b16 v[246:247], v21 offset:9216
    v_mfma_f32_16x16x32_bf16 a[144:147], v[144:147], v[176:179], a[144:147]
    v_mfma_f32_16x16x32_bf16 a[148:151], v[148:151], v[176:179], a[148:151]
    ds_read_b128 v[216:219], v13 offset:12288
    v_mfma_f32_16x16x32_bf16 a[152:155], v[152:155], v[176:179], a[152:155]
    v_mfma_f32_16x16x32_bf16 a[156:159], v[156:159], v[176:179], a[156:159]
    ds_read_b64_tr_b16 v[248:249], v22 offset:8192
    v_mfma_f32_16x16x32_bf16 a[188:191], v[156:159], v[180:183], a[188:191]
    v_mfma_f32_16x16x32_bf16 a[184:187], v[152:155], v[180:183], a[184:187]
    ds_read_b64_tr_b16 v[250:251], v22 offset:9216
    v_mfma_f32_16x16x32_bf16 a[180:183], v[148:151], v[180:183], a[180:183]
    v_mfma_f32_16x16x32_bf16 a[176:179], v[144:147], v[180:183], a[176:179]
    ds_read_b128 v[220:223], v13 offset:14336
    v_mfma_f32_16x16x32_bf16 a[172:175], v[140:143], v[180:183], a[172:175]
    v_mfma_f32_16x16x32_bf16 a[168:171], v[136:139], v[180:183], a[168:171]
    ds_read_b64_tr_b16 v[252:253], v23 offset:8192
    v_mfma_f32_16x16x32_bf16 a[164:167], v[132:135], v[180:183], a[164:167]
    v_mfma_f32_16x16x32_bf16 a[160:163], v[128:131], v[180:183], a[160:163]
    ds_read_b64_tr_b16 v[254:255], v23 offset:9216
    v_mfma_f32_16x16x32_bf16 a[192:195], v[128:131], v[184:187], a[192:195]
    v_mfma_f32_16x16x32_bf16 a[196:199], v[132:135], v[184:187], a[196:199]
    v_mfma_f32_16x16x32_bf16 a[200:203], v[136:139], v[184:187], a[200:203]
    v_mfma_f32_16x16x32_bf16 a[204:207], v[140:143], v[184:187], a[204:207]
    v_mfma_f32_16x16x32_bf16 a[208:211], v[144:147], v[184:187], a[208:211]
    v_mfma_f32_16x16x32_bf16 a[212:215], v[148:151], v[184:187], a[212:215]
    v_mfma_f32_16x16x32_bf16 a[216:219], v[152:155], v[184:187], a[216:219]
    v_mfma_f32_16x16x32_bf16 a[220:223], v[156:159], v[184:187], a[220:223]
    v_mfma_f32_16x16x32_bf16 a[252:255], v[156:159], v[188:191], a[252:255]
    v_mfma_f32_16x16x32_bf16 a[248:251], v[152:155], v[188:191], a[248:251]
    v_mfma_f32_16x16x32_bf16 a[244:247], v[148:151], v[188:191], a[244:247]
    v_mfma_f32_16x16x32_bf16 a[240:243], v[144:147], v[188:191], a[240:243]
    v_mfma_f32_16x16x32_bf16 a[236:239], v[140:143], v[188:191], a[236:239]
    v_mfma_f32_16x16x32_bf16 a[232:235], v[136:139], v[188:191], a[232:235]
    v_mfma_f32_16x16x32_bf16 a[228:231], v[132:135], v[188:191], a[228:231]
    v_mfma_f32_16x16x32_bf16 a[224:227], v[128:131], v[188:191], a[224:227]
    s_waitcnt vmcnt(2) lgkmcnt(0)
    s_barrier
    s_waitcnt lgkmcnt(0)
    v_mfma_f32_16x16x32_bf16 a[0:3], v[192:195], v[224:227], a[0:3]
    v_mfma_f32_16x16x32_bf16 a[4:7], v[196:199], v[224:227], a[4:7]
    ds_read_b128 v[128:131], v12 offset:32768
    s_add_u32 m0, s64, 0
    v_mfma_f32_16x16x32_bf16 a[8:11], v[200:203], v[224:227], a[8:11]
    buffer_load_dwordx4 v8, s[16:19], s48 offen offset:0  lds
    v_mfma_f32_16x16x32_bf16 a[12:15], v[204:207], v[224:227], a[12:15]
    ds_read_b64_tr_b16 v[160:161], v16 offset:32768
    v_mfma_f32_16x16x32_bf16 a[16:19], v[208:211], v[224:227], a[16:19]
    v_mfma_f32_16x16x32_bf16 a[20:23], v[212:215], v[224:227], a[20:23]
    ds_read_b64_tr_b16 v[162:163], v16 offset:33792
    v_mfma_f32_16x16x32_bf16 a[24:27], v[216:219], v[224:227], a[24:27]
    buffer_load_dwordx4 v9, s[16:19], s49 offen offset:1024  lds
    v_mfma_f32_16x16x32_bf16 a[28:31], v[220:223], v[224:227], a[28:31]
    ds_read_b128 v[132:135], v12 offset:34816
    v_mfma_f32_16x16x32_bf16 a[60:63], v[220:223], v[228:231], a[60:63]
    v_mfma_f32_16x16x32_bf16 a[56:59], v[216:219], v[228:231], a[56:59]
    ds_read_b64_tr_b16 v[164:165], v17 offset:32768
    v_mfma_f32_16x16x32_bf16 a[52:55], v[212:215], v[228:231], a[52:55]
    buffer_load_dwordx4 v8, s[16:19], s50 offen offset:2048  lds
    v_mfma_f32_16x16x32_bf16 a[48:51], v[208:211], v[228:231], a[48:51]
    ds_read_b64_tr_b16 v[166:167], v17 offset:33792
    v_mfma_f32_16x16x32_bf16 a[44:47], v[204:207], v[228:231], a[44:47]
    v_mfma_f32_16x16x32_bf16 a[40:43], v[200:203], v[228:231], a[40:43]
    ds_read_b128 v[136:139], v12 offset:36864
    v_mfma_f32_16x16x32_bf16 a[36:39], v[196:199], v[228:231], a[36:39]
    buffer_load_dwordx4 v9, s[16:19], s51 offen offset:3072  lds
    v_mfma_f32_16x16x32_bf16 a[32:35], v[192:195], v[228:231], a[32:35]
    ds_read_b64_tr_b16 v[168:169], v18 offset:32768
    v_mfma_f32_16x16x32_bf16 a[64:67], v[192:195], v[232:235], a[64:67]
    v_mfma_f32_16x16x32_bf16 a[68:71], v[196:199], v[232:235], a[68:71]
    ds_read_b64_tr_b16 v[170:171], v18 offset:33792
    s_add_u32 m0, s64, 4096
    v_mfma_f32_16x16x32_bf16 a[72:75], v[200:203], v[232:235], a[72:75]
    buffer_load_dwordx4 v8, s[16:19], s52 offen offset:0  lds
    v_mfma_f32_16x16x32_bf16 a[76:79], v[204:207], v[232:235], a[76:79]
    ds_read_b128 v[140:143], v12 offset:38912
    v_mfma_f32_16x16x32_bf16 a[80:83], v[208:211], v[232:235], a[80:83]
    v_mfma_f32_16x16x32_bf16 a[84:87], v[212:215], v[232:235], a[84:87]
    ds_read_b64_tr_b16 v[172:173], v19 offset:32768
    v_mfma_f32_16x16x32_bf16 a[88:91], v[216:219], v[232:235], a[88:91]
    buffer_load_dwordx4 v9, s[16:19], s53 offen offset:1024  lds
    v_mfma_f32_16x16x32_bf16 a[92:95], v[220:223], v[232:235], a[92:95]
    ds_read_b64_tr_b16 v[174:175], v19 offset:33792
    v_mfma_f32_16x16x32_bf16 a[124:127], v[220:223], v[236:239], a[124:127]
    v_mfma_f32_16x16x32_bf16 a[120:123], v[216:219], v[236:239], a[120:123]
    ds_read_b128 v[144:147], v12 offset:40960
    v_mfma_f32_16x16x32_bf16 a[116:119], v[212:215], v[236:239], a[116:119]
    buffer_load_dwordx4 v8, s[16:19], s54 offen offset:2048  lds
    v_mfma_f32_16x16x32_bf16 a[112:115], v[208:211], v[236:239], a[112:115]
    ds_read_b64_tr_b16 v[176:177], v20 offset:32768
    v_mfma_f32_16x16x32_bf16 a[108:111], v[204:207], v[236:239], a[108:111]
    v_mfma_f32_16x16x32_bf16 a[104:107], v[200:203], v[236:239], a[104:107]
    ds_read_b64_tr_b16 v[178:179], v20 offset:33792
    v_mfma_f32_16x16x32_bf16 a[100:103], v[196:199], v[236:239], a[100:103]
    buffer_load_dwordx4 v9, s[16:19], s55 offen offset:3072  lds
    v_mfma_f32_16x16x32_bf16 a[96:99], v[192:195], v[236:239], a[96:99]
    ds_read_b128 v[148:151], v12 offset:43008
    v_mfma_f32_16x16x32_bf16 a[128:131], v[192:195], v[240:243], a[128:131]
    v_mfma_f32_16x16x32_bf16 a[132:135], v[196:199], v[240:243], a[132:135]
    ds_read_b64_tr_b16 v[180:181], v21 offset:32768
    s_add_u32 m0, s64, 65536
    v_mfma_f32_16x16x32_bf16 a[136:139], v[200:203], v[240:243], a[136:139]
    buffer_load_dwordx4 v10, s[20:23], s56 offen offset:0  lds
    v_mfma_f32_16x16x32_bf16 a[140:143], v[204:207], v[240:243], a[140:143]
    ds_read_b64_tr_b16 v[182:183], v21 offset:33792
    v_mfma_f32_16x16x32_bf16 a[144:147], v[208:211], v[240:243], a[144:147]
    v_mfma_f32_16x16x32_bf16 a[148:151], v[212:215], v[240:243], a[148:151]
    ds_read_b128 v[152:155], v12 offset:45056
    v_mfma_f32_16x16x32_bf16 a[152:155], v[216:219], v[240:243], a[152:155]
    buffer_load_dwordx4 v10, s[20:23], s57 offen offset:1024  lds
    v_mfma_f32_16x16x32_bf16 a[156:159], v[220:223], v[240:243], a[156:159]
    ds_read_b64_tr_b16 v[184:185], v22 offset:32768
    v_mfma_f32_16x16x32_bf16 a[188:191], v[220:223], v[244:247], a[188:191]
    v_mfma_f32_16x16x32_bf16 a[184:187], v[216:219], v[244:247], a[184:187]
    ds_read_b64_tr_b16 v[186:187], v22 offset:33792
    v_mfma_f32_16x16x32_bf16 a[180:183], v[212:215], v[244:247], a[180:183]
    buffer_load_dwordx4 v11, s[20:23], s58 offen offset:2048  lds
    v_mfma_f32_16x16x32_bf16 a[176:179], v[208:211], v[244:247], a[176:179]
    ds_read_b128 v[156:159], v12 offset:47104
    v_mfma_f32_16x16x32_bf16 a[172:175], v[204:207], v[244:247], a[172:175]
    v_mfma_f32_16x16x32_bf16 a[168:171], v[200:203], v[244:247], a[168:171]
    ds_read_b64_tr_b16 v[188:189], v23 offset:32768
    v_mfma_f32_16x16x32_bf16 a[164:167], v[196:199], v[244:247], a[164:167]
    buffer_load_dwordx4 v11, s[20:23], s59 offen offset:3072  lds
    v_mfma_f32_16x16x32_bf16 a[160:163], v[192:195], v[244:247], a[160:163]
    ds_read_b64_tr_b16 v[190:191], v23 offset:33792
    v_mfma_f32_16x16x32_bf16 a[192:195], v[192:195], v[248:251], a[192:195]
    v_mfma_f32_16x16x32_bf16 a[196:199], v[196:199], v[248:251], a[196:199]
    s_add_u32 m0, s64, 69632
    v_mfma_f32_16x16x32_bf16 a[200:203], v[200:203], v[248:251], a[200:203]
    buffer_load_dwordx4 v10, s[20:23], s60 offen offset:0  lds
    v_mfma_f32_16x16x32_bf16 a[204:207], v[204:207], v[248:251], a[204:207]
    v_mfma_f32_16x16x32_bf16 a[208:211], v[208:211], v[248:251], a[208:211]
    v_mfma_f32_16x16x32_bf16 a[212:215], v[212:215], v[248:251], a[212:215]
    v_mfma_f32_16x16x32_bf16 a[216:219], v[216:219], v[248:251], a[216:219]
    buffer_load_dwordx4 v10, s[20:23], s61 offen offset:1024  lds
    v_mfma_f32_16x16x32_bf16 a[220:223], v[220:223], v[248:251], a[220:223]
    v_mfma_f32_16x16x32_bf16 a[252:255], v[220:223], v[252:255], a[252:255]
    v_mfma_f32_16x16x32_bf16 a[248:251], v[216:219], v[252:255], a[248:251]
    v_mfma_f32_16x16x32_bf16 a[244:247], v[212:215], v[252:255], a[244:247]
    buffer_load_dwordx4 v11, s[20:23], s62 offen offset:2048  lds
    v_mfma_f32_16x16x32_bf16 a[240:243], v[208:211], v[252:255], a[240:243]
    v_mfma_f32_16x16x32_bf16 a[236:239], v[204:207], v[252:255], a[236:239]
    v_mfma_f32_16x16x32_bf16 a[232:235], v[200:203], v[252:255], a[232:235]
    v_mfma_f32_16x16x32_bf16 a[228:231], v[196:199], v[252:255], a[228:231]
    buffer_load_dwordx4 v11, s[20:23], s63 offen offset:3072  lds
    v_mfma_f32_16x16x32_bf16 a[224:227], v[192:195], v[252:255], a[224:227]
    s_waitcnt lgkmcnt(0)
    v_add_u32 v8, 128, v8
    v_mfma_f32_16x16x32_bf16 a[0:3], v[128:131], v[160:163], a[0:3]
    v_add_u32 v9, 128, v9
    v_mfma_f32_16x16x32_bf16 a[4:7], v[132:135], v[160:163], a[4:7]
    ds_read_b128 v[192:195], v13 offset:32768
    v_add_u32 v10, s66, v10
    v_mfma_f32_16x16x32_bf16 a[8:11], v[136:139], v[160:163], a[8:11]
    v_add_u32 v11, s66, v11
    v_mfma_f32_16x16x32_bf16 a[12:15], v[140:143], v[160:163], a[12:15]
    ds_read_b64_tr_b16 v[224:225], v16 offset:40960
    v_mfma_f32_16x16x32_bf16 a[16:19], v[144:147], v[160:163], a[16:19]
    buffer_load_dword v3, v14, s[16:19], 0 offen
    v_mfma_f32_16x16x32_bf16 a[20:23], v[148:151], v[160:163], a[20:23]
    ds_read_b64_tr_b16 v[226:227], v16 offset:41984
    v_mfma_f32_16x16x32_bf16 a[24:27], v[152:155], v[160:163], a[24:27]
    buffer_load_dword v3, v15, s[20:23], 0 offen
    v_mfma_f32_16x16x32_bf16 a[28:31], v[156:159], v[160:163], a[28:31]
    ds_read_b128 v[196:199], v13 offset:34816
    v_mfma_f32_16x16x32_bf16 a[60:63], v[156:159], v[164:167], a[60:63]
    v_add_u32 v14, 128, v14
    v_mfma_f32_16x16x32_bf16 a[56:59], v[152:155], v[164:167], a[56:59]
    ds_read_b64_tr_b16 v[228:229], v17 offset:40960
    v_mfma_f32_16x16x32_bf16 a[52:55], v[148:151], v[164:167], a[52:55]
    v_add_u32 v15, s66, v15
    v_mfma_f32_16x16x32_bf16 a[48:51], v[144:147], v[164:167], a[48:51]
    ds_read_b64_tr_b16 v[230:231], v17 offset:41984
    v_mfma_f32_16x16x32_bf16 a[44:47], v[140:143], v[164:167], a[44:47]
    v_mfma_f32_16x16x32_bf16 a[40:43], v[136:139], v[164:167], a[40:43]
    ds_read_b128 v[200:203], v13 offset:36864
    v_mfma_f32_16x16x32_bf16 a[36:39], v[132:135], v[164:167], a[36:39]
    v_mfma_f32_16x16x32_bf16 a[32:35], v[128:131], v[164:167], a[32:35]
    ds_read_b64_tr_b16 v[232:233], v18 offset:40960
    v_mfma_f32_16x16x32_bf16 a[64:67], v[128:131], v[168:171], a[64:67]
    v_mfma_f32_16x16x32_bf16 a[68:71], v[132:135], v[168:171], a[68:71]
    ds_read_b64_tr_b16 v[234:235], v18 offset:41984
    v_mfma_f32_16x16x32_bf16 a[72:75], v[136:139], v[168:171], a[72:75]
    v_mfma_f32_16x16x32_bf16 a[76:79], v[140:143], v[168:171], a[76:79]
    ds_read_b128 v[204:207], v13 offset:38912
    v_mfma_f32_16x16x32_bf16 a[80:83], v[144:147], v[168:171], a[80:83]
    v_mfma_f32_16x16x32_bf16 a[84:87], v[148:151], v[168:171], a[84:87]
    ds_read_b64_tr_b16 v[236:237], v19 offset:40960
    v_mfma_f32_16x16x32_bf16 a[88:91], v[152:155], v[168:171], a[88:91]
    v_mfma_f32_16x16x32_bf16 a[92:95], v[156:159], v[168:171], a[92:95]
    ds_read_b64_tr_b16 v[238:239], v19 offset:41984
    v_mfma_f32_16x16x32_bf16 a[124:127], v[156:159], v[172:175], a[124:127]
    v_mfma_f32_16x16x32_bf16 a[120:123], v[152:155], v[172:175], a[120:123]
    ds_read_b128 v[208:211], v13 offset:40960
    v_mfma_f32_16x16x32_bf16 a[116:119], v[148:151], v[172:175], a[116:119]
    v_mfma_f32_16x16x32_bf16 a[112:115], v[144:147], v[172:175], a[112:115]
    ds_read_b64_tr_b16 v[240:241], v20 offset:40960
    v_mfma_f32_16x16x32_bf16 a[108:111], v[140:143], v[172:175], a[108:111]
    v_mfma_f32_16x16x32_bf16 a[104:107], v[136:139], v[172:175], a[104:107]
    ds_read_b64_tr_b16 v[242:243], v20 offset:41984
    v_mfma_f32_16x16x32_bf16 a[100:103], v[132:135], v[172:175], a[100:103]
    v_mfma_f32_16x16x32_bf16 a[96:99], v[128:131], v[172:175], a[96:99]
    ds_read_b128 v[212:215], v13 offset:43008
    v_mfma_f32_16x16x32_bf16 a[128:131], v[128:131], v[176:179], a[128:131]
    v_mfma_f32_16x16x32_bf16 a[132:135], v[132:135], v[176:179], a[132:135]
    ds_read_b64_tr_b16 v[244:245], v21 offset:40960
    v_mfma_f32_16x16x32_bf16 a[136:139], v[136:139], v[176:179], a[136:139]
    v_mfma_f32_16x16x32_bf16 a[140:143], v[140:143], v[176:179], a[140:143]
    ds_read_b64_tr_b16 v[246:247], v21 offset:41984
    v_mfma_f32_16x16x32_bf16 a[144:147], v[144:147], v[176:179], a[144:147]
    v_mfma_f32_16x16x32_bf16 a[148:151], v[148:151], v[176:179], a[148:151]
    ds_read_b128 v[216:219], v13 offset:45056
    v_mfma_f32_16x16x32_bf16 a[152:155], v[152:155], v[176:179], a[152:155]
    v_mfma_f32_16x16x32_bf16 a[156:159], v[156:159], v[176:179], a[156:159]
    ds_read_b64_tr_b16 v[248:249], v22 offset:40960
    v_mfma_f32_16x16x32_bf16 a[188:191], v[156:159], v[180:183], a[188:191]
    v_mfma_f32_16x16x32_bf16 a[184:187], v[152:155], v[180:183], a[184:187]
    ds_read_b64_tr_b16 v[250:251], v22 offset:41984
    v_mfma_f32_16x16x32_bf16 a[180:183], v[148:151], v[180:183], a[180:183]
    v_mfma_f32_16x16x32_bf16 a[176:179], v[144:147], v[180:183], a[176:179]
    ds_read_b128 v[220:223], v13 offset:47104
    v_mfma_f32_16x16x32_bf16 a[172:175], v[140:143], v[180:183], a[172:175]
    v_mfma_f32_16x16x32_bf16 a[168:171], v[136:139], v[180:183], a[168:171]
    ds_read_b64_tr_b16 v[252:253], v23 offset:40960
    v_mfma_f32_16x16x32_bf16 a[164:167], v[132:135], v[180:183], a[164:167]
    v_mfma_f32_16x16x32_bf16 a[160:163], v[128:131], v[180:183], a[160:163]
    ds_read_b64_tr_b16 v[254:255], v23 offset:41984
    v_mfma_f32_16x16x32_bf16 a[192:195], v[128:131], v[184:187], a[192:195]
    v_mfma_f32_16x16x32_bf16 a[196:199], v[132:135], v[184:187], a[196:199]
    v_mfma_f32_16x16x32_bf16 a[200:203], v[136:139], v[184:187], a[200:203]
    v_mfma_f32_16x16x32_bf16 a[204:207], v[140:143], v[184:187], a[204:207]
    v_mfma_f32_16x16x32_bf16 a[208:211], v[144:147], v[184:187], a[208:211]
    v_mfma_f32_16x16x32_bf16 a[212:215], v[148:151], v[184:187], a[212:215]
    v_mfma_f32_16x16x32_bf16 a[216:219], v[152:155], v[184:187], a[216:219]
    v_mfma_f32_16x16x32_bf16 a[220:223], v[156:159], v[184:187], a[220:223]
    v_mfma_f32_16x16x32_bf16 a[252:255], v[156:159], v[188:191], a[252:255]
    v_mfma_f32_16x16x32_bf16 a[248:251], v[152:155], v[188:191], a[248:251]
    v_mfma_f32_16x16x32_bf16 a[244:247], v[148:151], v[188:191], a[244:247]
    v_mfma_f32_16x16x32_bf16 a[240:243], v[144:147], v[188:191], a[240:243]
    v_mfma_f32_16x16x32_bf16 a[236:239], v[140:143], v[188:191], a[236:239]
    v_mfma_f32_16x16x32_bf16 a[232:235], v[136:139], v[188:191], a[232:235]
    v_mfma_f32_16x16x32_bf16 a[228:231], v[132:135], v[188:191], a[228:231]
    v_mfma_f32_16x16x32_bf16 a[224:227], v[128:131], v[188:191], a[224:227]
    s_waitcnt vmcnt(2) lgkmcnt(0)
    s_barrier
    s_waitcnt lgkmcnt(0)
    v_mfma_f32_16x16x32_bf16 a[0:3], v[192:195], v[224:227], a[0:3]
    v_mfma_f32_16x16x32_bf16 a[4:7], v[196:199], v[224:227], a[4:7]
    ds_read_b128 v[128:131], v12 offset:0
    s_add_u32 m0, s64, 32768
    v_mfma_f32_16x16x32_bf16 a[8:11], v[200:203], v[224:227], a[8:11]
    buffer_load_dwordx4 v8, s[16:19], s48 offen offset:0  lds
    v_mfma_f32_16x16x32_bf16 a[12:15], v[204:207], v[224:227], a[12:15]
    ds_read_b64_tr_b16 v[160:161], v24 offset:0
    v_mfma_f32_16x16x32_bf16 a[16:19], v[208:211], v[224:227], a[16:19]
    v_mfma_f32_16x16x32_bf16 a[20:23], v[212:215], v[224:227], a[20:23]
    ds_read_b64_tr_b16 v[162:163], v24 offset:1024
    buffer_load_dwordx4 v9, s[16:19], s49 offen offset:1024  lds
    v_mfma_f32_16x16x32_bf16 a[24:27], v[216:219], v[224:227], a[24:27]
    v_mfma_f32_16x16x32_bf16 a[28:31], v[220:223], v[224:227], a[28:31]
    ds_read_b128 v[132:135], v12 offset:2048
    v_mfma_f32_16x16x32_bf16 a[60:63], v[220:223], v[228:231], a[60:63]
    buffer_load_dwordx4 v8, s[16:19], s50 offen offset:2048  lds
    v_mfma_f32_16x16x32_bf16 a[56:59], v[216:219], v[228:231], a[56:59]
    ds_read_b64_tr_b16 v[164:165], v25 offset:0
    v_mfma_f32_16x16x32_bf16 a[52:55], v[212:215], v[228:231], a[52:55]
    v_mfma_f32_16x16x32_bf16 a[48:51], v[208:211], v[228:231], a[48:51]
    ds_read_b64_tr_b16 v[166:167], v25 offset:1024
    buffer_load_dwordx4 v9, s[16:19], s51 offen offset:3072  lds
    v_mfma_f32_16x16x32_bf16 a[44:47], v[204:207], v[228:231], a[44:47]
    v_mfma_f32_16x16x32_bf16 a[40:43], v[200:203], v[228:231], a[40:43]
    ds_read_b128 v[136:139], v12 offset:4096
    s_add_u32 m0, s64, 36864
    v_mfma_f32_16x16x32_bf16 a[36:39], v[196:199], v[228:231], a[36:39]
    buffer_load_dwordx4 v8, s[16:19], s52 offen offset:0  lds
    v_mfma_f32_16x16x32_bf16 a[32:35], v[192:195], v[228:231], a[32:35]
    ds_read_b64_tr_b16 v[168:169], v26 offset:0
    v_mfma_f32_16x16x32_bf16 a[64:67], v[192:195], v[232:235], a[64:67]
    v_mfma_f32_16x16x32_bf16 a[68:71], v[196:199], v[232:235], a[68:71]
    ds_read_b64_tr_b16 v[170:171], v26 offset:1024
    buffer_load_dwordx4 v9, s[16:19], s53 offen offset:1024  lds
    v_mfma_f32_16x16x32_bf16 a[72:75], v[200:203], v[232:235], a[72:75]
    v_mfma_f32_16x16x32_bf16 a[76:79], v[204:207], v[232:235], a[76:79]
    ds_read_b128 v[140:143], v12 offset:6144
    v_mfma_f32_16x16x32_bf16 a[80:83], v[208:211], v[232:235], a[80:83]
    buffer_load_dwordx4 v8, s[16:19], s54 offen offset:2048  lds
    v_mfma_f32_16x16x32_bf16 a[84:87], v[212:215], v[232:235], a[84:87]
    ds_read_b64_tr_b16 v[172:173], v27 offset:0
    v_mfma_f32_16x16x32_bf16 a[88:91], v[216:219], v[232:235], a[88:91]
    v_mfma_f32_16x16x32_bf16 a[92:95], v[220:223], v[232:235], a[92:95]
    ds_read_b64_tr_b16 v[174:175], v27 offset:1024
    buffer_load_dwordx4 v9, s[16:19], s55 offen offset:3072  lds
    v_mfma_f32_16x16x32_bf16 a[124:127], v[220:223], v[236:239], a[124:127]
    v_mfma_f32_16x16x32_bf16 a[120:123], v[216:219], v[236:239], a[120:123]
    ds_read_b128 v[144:147], v12 offset:8192
    s_add_u32 m0, s64, 98304
    v_mfma_f32_16x16x32_bf16 a[116:119], v[212:215], v[236:239], a[116:119]
    buffer_load_dwordx4 v10, s[20:23], s56 offen offset:0  lds
    v_mfma_f32_16x16x32_bf16 a[112:115], v[208:211], v[236:239], a[112:115]
    ds_read_b64_tr_b16 v[176:177], v28 offset:0
    v_mfma_f32_16x16x32_bf16 a[108:111], v[204:207], v[236:239], a[108:111]
    v_mfma_f32_16x16x32_bf16 a[104:107], v[200:203], v[236:239], a[104:107]
    ds_read_b64_tr_b16 v[178:179], v28 offset:1024
    buffer_load_dwordx4 v10, s[20:23], s57 offen offset:1024  lds
    v_mfma_f32_16x16x32_bf16 a[100:103], v[196:199], v[236:239], a[100:103]
    v_mfma_f32_16x16x32_bf16 a[96:99], v[192:195], v[236:239], a[96:99]
    ds_read_b128 v[148:151], v12 offset:10240
    v_mfma_f32_16x16x32_bf16 a[128:131], v[192:195], v[240:243], a[128:131]
    buffer_load_dwordx4 v11, s[20:23], s58 offen offset:2048  lds
    v_mfma_f32_16x16x32_bf16 a[132:135], v[196:199], v[240:243], a[132:135]
    ds_read_b64_tr_b16 v[180:181], v29 offset:0
    v_mfma_f32_16x16x32_bf16 a[136:139], v[200:203], v[240:243], a[136:139]
    v_mfma_f32_16x16x32_bf16 a[140:143], v[204:207], v[240:243], a[140:143]
    ds_read_b64_tr_b16 v[182:183], v29 offset:1024
    buffer_load_dwordx4 v11, s[20:23], s59 offen offset:3072  lds
    v_mfma_f32_16x16x32_bf16 a[144:147], v[208:211], v[240:243], a[144:147]
    v_mfma_f32_16x16x32_bf16 a[148:151], v[212:215], v[240:243], a[148:151]
    ds_read_b128 v[152:155], v12 offset:12288
    s_add_u32 m0, s64, 102400
    v_mfma_f32_16x16x32_bf16 a[152:155], v[216:219], v[240:243], a[152:155]
    buffer_load_dwordx4 v10, s[20:23], s60 offen offset:0  lds
    v_mfma_f32_16x16x32_bf16 a[156:159], v[220:223], v[240:243], a[156:159]
    ds_read_b64_tr_b16 v[184:185], v30 offset:0
    v_mfma_f32_16x16x32_bf16 a[188:191], v[220:223], v[244:247], a[188:191]
    v_mfma_f32_16x16x32_bf16 a[184:187], v[216:219], v[244:247], a[184:187]
    ds_read_b64_tr_b16 v[186:187], v30 offset:1024
    buffer_load_dwordx4 v10, s[20:23], s61 offen offset:1024  lds
    v_mfma_f32_16x16x32_bf16 a[180:183], v[212:215], v[244:247], a[180:183]
    v_mfma_f32_16x16x32_bf16 a[176:179], v[208:211], v[244:247], a[176:179]
    ds_read_b128 v[156:159], v12 offset:14336
    v_mfma_f32_16x16x32_bf16 a[172:175], v[204:207], v[244:247], a[172:175]
    buffer_load_dwordx4 v11, s[20:23], s62 offen offset:2048  lds
    v_mfma_f32_16x16x32_bf16 a[168:171], v[200:203], v[244:247], a[168:171]
    ds_read_b64_tr_b16 v[188:189], v31 offset:0
    v_mfma_f32_16x16x32_bf16 a[164:167], v[196:199], v[244:247], a[164:167]
    v_mfma_f32_16x16x32_bf16 a[160:163], v[192:195], v[244:247], a[160:163]
    ds_read_b64_tr_b16 v[190:191], v31 offset:1024
    buffer_load_dwordx4 v11, s[20:23], s63 offen offset:3072  lds
    v_mfma_f32_16x16x32_bf16 a[192:195], v[192:195], v[248:251], a[192:195]
    v_add_u32 v8, 128, v8
    v_mfma_f32_16x16x32_bf16 a[196:199], v[196:199], v[248:251], a[196:199]
    v_add_u32 v9, 128, v9
    v_mfma_f32_16x16x32_bf16 a[200:203], v[200:203], v[248:251], a[200:203]
    v_add_u32 v10, s66, v10
    v_mfma_f32_16x16x32_bf16 a[204:207], v[204:207], v[248:251], a[204:207]
    v_add_u32 v11, s66, v11
    v_mfma_f32_16x16x32_bf16 a[208:211], v[208:211], v[248:251], a[208:211]
    v_mfma_f32_16x16x32_bf16 a[212:215], v[212:215], v[248:251], a[212:215]
    v_mfma_f32_16x16x32_bf16 a[216:219], v[216:219], v[248:251], a[216:219]
    buffer_load_dword v3, v14, s[16:19], 0 offen
    v_mfma_f32_16x16x32_bf16 a[220:223], v[220:223], v[248:251], a[220:223]
    v_mfma_f32_16x16x32_bf16 a[252:255], v[220:223], v[252:255], a[252:255]
    buffer_load_dword v3, v15, s[20:23], 0 offen
    v_mfma_f32_16x16x32_bf16 a[248:251], v[216:219], v[252:255], a[248:251]
    v_mfma_f32_16x16x32_bf16 a[244:247], v[212:215], v[252:255], a[244:247]
    v_add_u32 v14, 128, v14
    v_mfma_f32_16x16x32_bf16 a[240:243], v[208:211], v[252:255], a[240:243]
    v_mfma_f32_16x16x32_bf16 a[236:239], v[204:207], v[252:255], a[236:239]
    v_add_u32 v15, s66, v15
    v_mfma_f32_16x16x32_bf16 a[232:235], v[200:203], v[252:255], a[232:235]
    v_mfma_f32_16x16x32_bf16 a[228:231], v[196:199], v[252:255], a[228:231]
    v_mfma_f32_16x16x32_bf16 a[224:227], v[192:195], v[252:255], a[224:227]
    s_nop 7
    v_accvgpr_read_b32 v232, a0
    v_accvgpr_read_b32 v233, a1
    v_accvgpr_read_b32 v234, a2
    v_accvgpr_read_b32 v235, a3
    v_accvgpr_read_b32 v236, a4
    v_accvgpr_read_b32 v237, a5
    v_accvgpr_read_b32 v238, a6
    v_accvgpr_read_b32 v239, a7
    v_cvt_pk_bf16_f32 v32, v232, v233
    v_cvt_pk_bf16_f32 v33, v234, v235
    v_cvt_pk_bf16_f32 v34, v236, v237
    v_cvt_pk_bf16_f32 v35, v238, v239
    v_accvgpr_read_b32 v240, a32
    v_accvgpr_read_b32 v241, a33
    v_accvgpr_read_b32 v242, a34
    v_accvgpr_read_b32 v243, a35
    v_accvgpr_read_b32 v244, a36
    v_accvgpr_read_b32 v245, a37
    v_accvgpr_read_b32 v246, a38
    v_accvgpr_read_b32 v247, a39
    v_cvt_pk_bf16_f32 v36, v240, v241
    v_cvt_pk_bf16_f32 v37, v242, v243
    v_cvt_pk_bf16_f32 v38, v244, v245
    v_cvt_pk_bf16_f32 v39, v246, v247
    v_accvgpr_read_b32 v248, a64
    v_accvgpr_read_b32 v249, a65
    v_accvgpr_read_b32 v250, a66
    v_accvgpr_read_b32 v251, a67
    v_accvgpr_read_b32 v252, a68
    v_accvgpr_read_b32 v253, a69
    v_accvgpr_read_b32 v254, a70
    v_accvgpr_read_b32 v255, a71
    v_cvt_pk_bf16_f32 v40, v248, v249
    v_cvt_pk_bf16_f32 v41, v250, v251
    v_cvt_pk_bf16_f32 v42, v252, v253
    v_cvt_pk_bf16_f32 v43, v254, v255
    v_accvgpr_read_b32 v232, a96
    v_accvgpr_read_b32 v233, a97
    v_accvgpr_read_b32 v234, a98
    v_accvgpr_read_b32 v235, a99
    v_accvgpr_read_b32 v236, a100
    v_accvgpr_read_b32 v237, a101
    v_accvgpr_read_b32 v238, a102
    v_accvgpr_read_b32 v239, a103
    v_cvt_pk_bf16_f32 v44, v232, v233
    v_cvt_pk_bf16_f32 v45, v234, v235
    v_cvt_pk_bf16_f32 v46, v236, v237
    v_cvt_pk_bf16_f32 v47, v238, v239
    v_accvgpr_read_b32 v240, a128
    v_accvgpr_read_b32 v241, a129
    v_accvgpr_read_b32 v242, a130
    v_accvgpr_read_b32 v243, a131
    v_accvgpr_read_b32 v244, a132
    v_accvgpr_read_b32 v245, a133
    v_accvgpr_read_b32 v246, a134
    v_accvgpr_read_b32 v247, a135
    v_cvt_pk_bf16_f32 v48, v240, v241
    v_cvt_pk_bf16_f32 v49, v242, v243
    v_cvt_pk_bf16_f32 v50, v244, v245
    v_cvt_pk_bf16_f32 v51, v246, v247
    v_accvgpr_read_b32 v248, a160
    v_accvgpr_read_b32 v249, a161
    v_accvgpr_read_b32 v250, a162
    v_accvgpr_read_b32 v251, a163
    v_accvgpr_read_b32 v252, a164
    v_accvgpr_read_b32 v253, a165
    v_accvgpr_read_b32 v254, a166
    v_accvgpr_read_b32 v255, a167
    v_cvt_pk_bf16_f32 v52, v248, v249
    v_cvt_pk_bf16_f32 v53, v250, v251
    v_cvt_pk_bf16_f32 v54, v252, v253
    v_cvt_pk_bf16_f32 v55, v254, v255
    v_accvgpr_read_b32 v232, a192
    v_accvgpr_read_b32 v233, a193
    v_accvgpr_read_b32 v234, a194
    v_accvgpr_read_b32 v235, a195
    v_accvgpr_read_b32 v236, a196
    v_accvgpr_read_b32 v237, a197
    v_accvgpr_read_b32 v238, a198
    v_accvgpr_read_b32 v239, a199
    v_cvt_pk_bf16_f32 v56, v232, v233
    v_cvt_pk_bf16_f32 v57, v234, v235
    v_cvt_pk_bf16_f32 v58, v236, v237
    v_cvt_pk_bf16_f32 v59, v238, v239
    v_accvgpr_read_b32 v240, a224
    v_accvgpr_read_b32 v241, a225
    v_accvgpr_read_b32 v242, a226
    v_accvgpr_read_b32 v243, a227
    v_accvgpr_read_b32 v244, a228
    v_accvgpr_read_b32 v245, a229
    v_accvgpr_read_b32 v246, a230
    v_accvgpr_read_b32 v247, a231
    v_cvt_pk_bf16_f32 v60, v240, v241
    v_cvt_pk_bf16_f32 v61, v242, v243
    v_cvt_pk_bf16_f32 v62, v244, v245
    v_cvt_pk_bf16_f32 v63, v246, v247
    v_accvgpr_read_b32 v248, a8
    v_accvgpr_read_b32 v249, a9
    v_accvgpr_read_b32 v250, a10
    v_accvgpr_read_b32 v251, a11
    v_accvgpr_read_b32 v252, a12
    v_accvgpr_read_b32 v253, a13
    v_accvgpr_read_b32 v254, a14
    v_accvgpr_read_b32 v255, a15
    v_cvt_pk_bf16_f32 v64, v248, v249
    v_cvt_pk_bf16_f32 v65, v250, v251
    v_cvt_pk_bf16_f32 v66, v252, v253
    v_cvt_pk_bf16_f32 v67, v254, v255
    v_accvgpr_read_b32 v232, a40
    v_accvgpr_read_b32 v233, a41
    v_accvgpr_read_b32 v234, a42
    v_accvgpr_read_b32 v235, a43
    v_accvgpr_read_b32 v236, a44
    v_accvgpr_read_b32 v237, a45
    v_accvgpr_read_b32 v238, a46
    v_accvgpr_read_b32 v239, a47
    v_cvt_pk_bf16_f32 v68, v232, v233
    v_cvt_pk_bf16_f32 v69, v234, v235
    v_cvt_pk_bf16_f32 v70, v236, v237
    v_cvt_pk_bf16_f32 v71, v238, v239
    v_accvgpr_read_b32 v240, a72
    v_accvgpr_read_b32 v241, a73
    v_accvgpr_read_b32 v242, a74
    v_accvgpr_read_b32 v243, a75
    v_accvgpr_read_b32 v244, a76
    v_accvgpr_read_b32 v245, a77
    v_accvgpr_read_b32 v246, a78
    v_accvgpr_read_b32 v247, a79
    v_cvt_pk_bf16_f32 v72, v240, v241
    v_cvt_pk_bf16_f32 v73, v242, v243
    v_cvt_pk_bf16_f32 v74, v244, v245
    v_cvt_pk_bf16_f32 v75, v246, v247
    v_accvgpr_read_b32 v248, a104
    v_accvgpr_read_b32 v249, a105
    v_accvgpr_read_b32 v250, a106
    v_accvgpr_read_b32 v251, a107
    v_accvgpr_read_b32 v252, a108
    v_accvgpr_read_b32 v253, a109
    v_accvgpr_read_b32 v254, a110
    v_accvgpr_read_b32 v255, a111
    v_cvt_pk_bf16_f32 v76, v248, v249
    v_cvt_pk_bf16_f32 v77, v250, v251
    v_cvt_pk_bf16_f32 v78, v252, v253
    v_cvt_pk_bf16_f32 v79, v254, v255
    v_accvgpr_read_b32 v232, a136
    v_accvgpr_read_b32 v233, a137
    v_accvgpr_read_b32 v234, a138
    v_accvgpr_read_b32 v235, a139
    v_accvgpr_read_b32 v236, a140
    v_accvgpr_read_b32 v237, a141
    v_accvgpr_read_b32 v238, a142
    v_accvgpr_read_b32 v239, a143
    v_cvt_pk_bf16_f32 v80, v232, v233
    v_cvt_pk_bf16_f32 v81, v234, v235
    v_cvt_pk_bf16_f32 v82, v236, v237
    v_cvt_pk_bf16_f32 v83, v238, v239
    v_accvgpr_read_b32 v240, a168
    v_accvgpr_read_b32 v241, a169
    v_accvgpr_read_b32 v242, a170
    v_accvgpr_read_b32 v243, a171
    v_accvgpr_read_b32 v244, a172
    v_accvgpr_read_b32 v245, a173
    v_accvgpr_read_b32 v246, a174
    v_accvgpr_read_b32 v247, a175
    v_cvt_pk_bf16_f32 v84, v240, v241
    v_cvt_pk_bf16_f32 v85, v242, v243
    v_cvt_pk_bf16_f32 v86, v244, v245
    v_cvt_pk_bf16_f32 v87, v246, v247
    v_accvgpr_read_b32 v248, a200
    v_accvgpr_read_b32 v249, a201
    v_accvgpr_read_b32 v250, a202
    v_accvgpr_read_b32 v251, a203
    v_accvgpr_read_b32 v252, a204
    v_accvgpr_read_b32 v253, a205
    v_accvgpr_read_b32 v254, a206
    v_accvgpr_read_b32 v255, a207
    v_cvt_pk_bf16_f32 v88, v248, v249
    v_cvt_pk_bf16_f32 v89, v250, v251
    v_cvt_pk_bf16_f32 v90, v252, v253
    v_cvt_pk_bf16_f32 v91, v254, v255
    v_accvgpr_read_b32 v232, a232
    v_accvgpr_read_b32 v233, a233
    v_accvgpr_read_b32 v234, a234
    v_accvgpr_read_b32 v235, a235
    v_accvgpr_read_b32 v236, a236
    v_accvgpr_read_b32 v237, a237
    v_accvgpr_read_b32 v238, a238
    v_accvgpr_read_b32 v239, a239
    v_cvt_pk_bf16_f32 v92, v232, v233
    v_cvt_pk_bf16_f32 v93, v234, v235
    v_cvt_pk_bf16_f32 v94, v236, v237
    v_cvt_pk_bf16_f32 v95, v238, v239
    v_accvgpr_read_b32 v240, a16
    v_accvgpr_read_b32 v241, a17
    v_accvgpr_read_b32 v242, a18
    v_accvgpr_read_b32 v243, a19
    v_accvgpr_read_b32 v244, a20
    v_accvgpr_read_b32 v245, a21
    v_accvgpr_read_b32 v246, a22
    v_accvgpr_read_b32 v247, a23
    v_cvt_pk_bf16_f32 v96, v240, v241
    v_cvt_pk_bf16_f32 v97, v242, v243
    v_cvt_pk_bf16_f32 v98, v244, v245
    v_cvt_pk_bf16_f32 v99, v246, v247
    v_accvgpr_read_b32 v248, a48
    v_accvgpr_read_b32 v249, a49
    v_accvgpr_read_b32 v250, a50
    v_accvgpr_read_b32 v251, a51
    v_accvgpr_read_b32 v252, a52
    v_accvgpr_read_b32 v253, a53
    v_accvgpr_read_b32 v254, a54
    v_accvgpr_read_b32 v255, a55
    v_cvt_pk_bf16_f32 v100, v248, v249
    v_cvt_pk_bf16_f32 v101, v250, v251
    v_cvt_pk_bf16_f32 v102, v252, v253
    v_cvt_pk_bf16_f32 v103, v254, v255
    v_accvgpr_read_b32 v232, a80
    v_accvgpr_read_b32 v233, a81
    v_accvgpr_read_b32 v234, a82
    v_accvgpr_read_b32 v235, a83
    v_accvgpr_read_b32 v236, a84
    v_accvgpr_read_b32 v237, a85
    v_accvgpr_read_b32 v238, a86
    v_accvgpr_read_b32 v239, a87
    v_cvt_pk_bf16_f32 v104, v232, v233
    v_cvt_pk_bf16_f32 v105, v234, v235
    v_cvt_pk_bf16_f32 v106, v236, v237
    v_cvt_pk_bf16_f32 v107, v238, v239
    v_accvgpr_read_b32 v240, a112
    v_accvgpr_read_b32 v241, a113
    v_accvgpr_read_b32 v242, a114
    v_accvgpr_read_b32 v243, a115
    v_accvgpr_read_b32 v244, a116
    v_accvgpr_read_b32 v245, a117
    v_accvgpr_read_b32 v246, a118
    v_accvgpr_read_b32 v247, a119
    v_cvt_pk_bf16_f32 v108, v240, v241
    v_cvt_pk_bf16_f32 v109, v242, v243
    v_cvt_pk_bf16_f32 v110, v244, v245
    v_cvt_pk_bf16_f32 v111, v246, v247
    v_accvgpr_read_b32 v248, a144
    v_accvgpr_read_b32 v249, a145
    v_accvgpr_read_b32 v250, a146
    v_accvgpr_read_b32 v251, a147
    v_accvgpr_read_b32 v252, a148
    v_accvgpr_read_b32 v253, a149
    v_accvgpr_read_b32 v254, a150
    v_accvgpr_read_b32 v255, a151
    v_cvt_pk_bf16_f32 v112, v248, v249
    v_cvt_pk_bf16_f32 v113, v250, v251
    v_cvt_pk_bf16_f32 v114, v252, v253
    v_cvt_pk_bf16_f32 v115, v254, v255
    v_accvgpr_read_b32 v232, a176
    v_accvgpr_read_b32 v233, a177
    v_accvgpr_read_b32 v234, a178
    v_accvgpr_read_b32 v235, a179
    v_accvgpr_read_b32 v236, a180
    v_accvgpr_read_b32 v237, a181
    v_accvgpr_read_b32 v238, a182
    v_accvgpr_read_b32 v239, a183
    v_cvt_pk_bf16_f32 v116, v232, v233
    v_cvt_pk_bf16_f32 v117, v234, v235
    v_cvt_pk_bf16_f32 v118, v236, v237
    v_cvt_pk_bf16_f32 v119, v238, v239
    v_accvgpr_read_b32 v240, a208
    v_accvgpr_read_b32 v241, a209
    v_accvgpr_read_b32 v242, a210
    v_accvgpr_read_b32 v243, a211
    v_accvgpr_read_b32 v244, a212
    v_accvgpr_read_b32 v245, a213
    v_accvgpr_read_b32 v246, a214
    v_accvgpr_read_b32 v247, a215
    v_cvt_pk_bf16_f32 v120, v240, v241
    v_cvt_pk_bf16_f32 v121, v242, v243
    v_cvt_pk_bf16_f32 v122, v244, v245
    v_cvt_pk_bf16_f32 v123, v246, v247
    v_accvgpr_read_b32 v248, a240
    v_accvgpr_read_b32 v249, a241
    v_accvgpr_read_b32 v250, a242
    v_accvgpr_read_b32 v251, a243
    v_accvgpr_read_b32 v252, a244
    v_accvgpr_read_b32 v253, a245
    v_accvgpr_read_b32 v254, a246
    v_accvgpr_read_b32 v255, a247
    v_cvt_pk_bf16_f32 v192, v248, v249
    v_cvt_pk_bf16_f32 v193, v250, v251
    v_cvt_pk_bf16_f32 v194, v252, v253
    v_cvt_pk_bf16_f32 v195, v254, v255
    v_accvgpr_read_b32 v232, a24
    v_accvgpr_read_b32 v233, a25
    v_accvgpr_read_b32 v234, a26
    v_accvgpr_read_b32 v235, a27
    v_accvgpr_read_b32 v236, a28
    v_accvgpr_read_b32 v237, a29
    v_accvgpr_read_b32 v238, a30
    v_accvgpr_read_b32 v239, a31
    v_cvt_pk_bf16_f32 v196, v232, v233
    v_cvt_pk_bf16_f32 v197, v234, v235
    v_cvt_pk_bf16_f32 v198, v236, v237
    v_cvt_pk_bf16_f32 v199, v238, v239
    v_accvgpr_read_b32 v240, a56
    v_accvgpr_read_b32 v241, a57
    v_accvgpr_read_b32 v242, a58
    v_accvgpr_read_b32 v243, a59
    v_accvgpr_read_b32 v244, a60
    v_accvgpr_read_b32 v245, a61
    v_accvgpr_read_b32 v246, a62
    v_accvgpr_read_b32 v247, a63
    v_cvt_pk_bf16_f32 v200, v240, v241
    v_cvt_pk_bf16_f32 v201, v242, v243
    v_cvt_pk_bf16_f32 v202, v244, v245
    v_cvt_pk_bf16_f32 v203, v246, v247
    v_accvgpr_read_b32 v248, a88
    v_accvgpr_read_b32 v249, a89
    v_accvgpr_read_b32 v250, a90
    v_accvgpr_read_b32 v251, a91
    v_accvgpr_read_b32 v252, a92
    v_accvgpr_read_b32 v253, a93
    v_accvgpr_read_b32 v254, a94
    v_accvgpr_read_b32 v255, a95
    v_cvt_pk_bf16_f32 v204, v248, v249
    v_cvt_pk_bf16_f32 v205, v250, v251
    v_cvt_pk_bf16_f32 v206, v252, v253
    v_cvt_pk_bf16_f32 v207, v254, v255
    v_accvgpr_read_b32 v232, a120
    v_accvgpr_read_b32 v233, a121
    v_accvgpr_read_b32 v234, a122
    v_accvgpr_read_b32 v235, a123
    v_accvgpr_read_b32 v236, a124
    v_accvgpr_read_b32 v237, a125
    v_accvgpr_read_b32 v238, a126
    v_accvgpr_read_b32 v239, a127
    v_cvt_pk_bf16_f32 v208, v232, v233
    v_cvt_pk_bf16_f32 v209, v234, v235
    v_cvt_pk_bf16_f32 v210, v236, v237
    v_cvt_pk_bf16_f32 v211, v238, v239
    v_accvgpr_read_b32 v240, a152
    v_accvgpr_read_b32 v241, a153
    v_accvgpr_read_b32 v242, a154
    v_accvgpr_read_b32 v243, a155
    v_accvgpr_read_b32 v244, a156
    v_accvgpr_read_b32 v245, a157
    v_accvgpr_read_b32 v246, a158
    v_accvgpr_read_b32 v247, a159
    v_cvt_pk_bf16_f32 v212, v240, v241
    v_cvt_pk_bf16_f32 v213, v242, v243
    v_cvt_pk_bf16_f32 v214, v244, v245
    v_cvt_pk_bf16_f32 v215, v246, v247
    v_accvgpr_read_b32 v248, a184
    v_accvgpr_read_b32 v249, a185
    v_accvgpr_read_b32 v250, a186
    v_accvgpr_read_b32 v251, a187
    v_accvgpr_read_b32 v252, a188
    v_accvgpr_read_b32 v253, a189
    v_accvgpr_read_b32 v254, a190
    v_accvgpr_read_b32 v255, a191
    v_cvt_pk_bf16_f32 v216, v248, v249
    v_cvt_pk_bf16_f32 v217, v250, v251
    v_cvt_pk_bf16_f32 v218, v252, v253
    v_cvt_pk_bf16_f32 v219, v254, v255
    v_accvgpr_read_b32 v232, a216
    v_accvgpr_read_b32 v233, a217
    v_accvgpr_read_b32 v234, a218
    v_accvgpr_read_b32 v235, a219
    v_accvgpr_read_b32 v236, a220
    v_accvgpr_read_b32 v237, a221
    v_accvgpr_read_b32 v238, a222
    v_accvgpr_read_b32 v239, a223
    v_cvt_pk_bf16_f32 v220, v232, v233
    v_cvt_pk_bf16_f32 v221, v234, v235
    v_cvt_pk_bf16_f32 v222, v236, v237
    v_cvt_pk_bf16_f32 v223, v238, v239
    v_accvgpr_read_b32 v240, a248
    v_accvgpr_read_b32 v241, a249
    v_accvgpr_read_b32 v242, a250
    v_accvgpr_read_b32 v243, a251
    v_accvgpr_read_b32 v244, a252
    v_accvgpr_read_b32 v245, a253
    v_accvgpr_read_b32 v246, a254
    v_accvgpr_read_b32 v247, a255
    v_cvt_pk_bf16_f32 v224, v240, v241
    v_cvt_pk_bf16_f32 v225, v242, v243
    v_cvt_pk_bf16_f32 v226, v244, v245
    v_cvt_pk_bf16_f32 v227, v246, v247
K1_T2:
    s_cmp_eq_u32 s69, 2
    s_cbranch_scc1 K1_GATE
    s_waitcnt lgkmcnt(0)
    v_mfma_f32_16x16x32_bf16 a[0:3], v[160:163], v[128:131], 0
    s_add_u32 s72, s70, 32768
    s_add_u32 s72, s72, s75
    v_mfma_f32_16x16x32_bf16 a[4:7], v[160:163], v[132:135], 0
    buffer_store_dwordx4 v[192:195], v2, s[24:27], s72 offen offset:3072 sc1
    v_mfma_f32_16x16x32_bf16 a[8:11], v[160:163], v[136:139], 0
    v_mfma_f32_16x16x32_bf16 a[12:15], v[160:163], v[140:143], 0
    s_add_u32 s72, s70, 49152
    v_mfma_f32_16x16x32_bf16 a[16:19], v[160:163], v[144:147], 0
    buffer_store_dwordx4 v[196:199], v2, s[24:27], s72 offen offset:0 sc1
    v_mfma_f32_16x16x32_bf16 a[20:23], v[160:163], v[148:151], 0
    v_mfma_f32_16x16x32_bf16 a[24:27], v[160:163], v[152:155], 0
    s_add_u32 s72, s70, 49152
    v_mfma_f32_16x16x32_bf16 a[28:31], v[160:163], v[156:159], 0
    buffer_store_dwordx4 v[200:203], v2, s[24:27], s72 offen offset:1024 sc1
    v_mfma_f32_16x16x32_bf16 a[60:63], v[164:167], v[156:159], 0
    v_mfma_f32_16x16x32_bf16 a[56:59], v[164:167], v[152:155], 0
    s_add_u32 s72, s70, 49152
    v_mfma_f32_16x16x32_bf16 a[52:55], v[164:167], v[148:151], 0
    buffer_store_dwordx4 v[204:207], v2, s[24:27], s72 offen offset:2048 sc1
    v_mfma_f32_16x16x32_bf16 a[48:51], v[164:167], v[144:147], 0
    v_mfma_f32_16x16x32_bf16 a[44:47], v[164:167], v[140:143], 0
    s_add_u32 s72, s70, 49152
    v_mfma_f32_16x16x32_bf16 a[40:43], v[164:167], v[136:139], 0
    buffer_store_dwordx4 v[208:211], v2, s[24:27], s72 offen offset:3072 sc1
    v_mfma_f32_16x16x32_bf16 a[36:39], v[164:167], v[132:135], 0
    v_mfma_f32_16x16x32_bf16 a[32:35], v[164:167], v[128:131], 0
    s_add_u32 s72, s70, 49152
    s_add_u32 s72, s72, s75
    v_mfma_f32_16x16x32_bf16 a[64:67], v[168:171], v[128:131], 0
    buffer_store_dwordx4 v[212:215], v2, s[24:27], s72 offen offset:0 sc1
    v_mfma_f32_16x16x32_bf16 a[68:71], v[168:171], v[132:135], 0
    v_mfma_f32_16x16x32_bf16 a[72:75], v[168:171], v[136:139], 0
    s_add_u32 s72, s70, 49152
    s_add_u32 s72, s72, s75
    v_mfma_f32_16x16x32_bf16 a[76:79], v[168:171], v[140:143], 0
    buffer_store_dwordx4 v[216:219], v2, s[24:27], s72 offen offset:1024 sc1
    v_mfma_f32_16x16x32_bf16 a[80:83], v[168:171], v[144:147], 0
    v_mfma_f32_16x16x32_bf16 a[84:87], v[168:171], v[148:151], 0
    s_add_u32 s72, s70, 49152
    s_add_u32 s72, s72, s75
    v_mfma_f32_16x16x32_bf16 a[88:91], v[168:171], v[152:155], 0
    buffer_store_dwordx4 v[220:223], v2, s[24:27], s72 offen offset:2048 sc1
    v_mfma_f32_16x16x32_bf16 a[92:95], v[168:171], v[156:159], 0
    v_mfma_f32_16x16x32_bf16 a[124:127], v[172:175], v[156:159], 0
    s_add_u32 s72, s70, 49152
    s_add_u32 s72, s72, s75
    v_mfma_f32_16x16x32_bf16 a[120:123], v[172:175], v[152:155], 0
    buffer_store_dwordx4 v[224:227], v2, s[24:27], s72 offen offset:3072 sc1
    v_mfma_f32_16x16x32_bf16 a[116:119], v[172:175], v[148:151], 0
    v_mfma_f32_16x16x32_bf16 a[112:115], v[172:175], v[144:147], 0
    v_mfma_f32_16x16x32_bf16 a[108:111], v[172:175], v[140:143], 0
    v_mfma_f32_16x16x32_bf16 a[104:107], v[172:175], v[136:139], 0
    v_mfma_f32_16x16x32_bf16 a[100:103], v[172:175], v[132:135], 0
    v_mfma_f32_16x16x32_bf16 a[96:99], v[172:175], v[128:131], 0
    v_mfma_f32_16x16x32_bf16 a[128:131], v[176:179], v[128:131], 0
    ds_read_b128 v[192:195], v13 offset:0
    v_mfma_f32_16x16x32_bf16 a[132:135], v[176:179], v[132:135], 0
    ds_read_b64_tr_b16 v[224:225], v24 offset:8192
    v_mfma_f32_16x16x32_bf16 a[136:139], v[176:179], v[136:139], 0
    ds_read_b64_tr_b16 v[226:227], v24 offset:9216
    v_mfma_f32_16x16x32_bf16 a[140:143], v[176:179], v[140:143], 0
    ds_read_b128 v[196:199], v13 offset:2048
    v_mfma_f32_16x16x32_bf16 a[144:147], v[176:179], v[144:147], 0
    ds_read_b64_tr_b16 v[228:229], v25 offset:8192
    v_mfma_f32_16x16x32_bf16 a[148:151], v[176:179], v[148:151], 0
    ds_read_b64_tr_b16 v[230:231], v25 offset:9216
    v_mfma_f32_16x16x32_bf16 a[152:155], v[176:179], v[152:155], 0
    ds_read_b128 v[200:203], v13 offset:4096
    v_mfma_f32_16x16x32_bf16 a[156:159], v[176:179], v[156:159], 0
    ds_read_b64_tr_b16 v[232:233], v26 offset:8192
    v_mfma_f32_16x16x32_bf16 a[188:191], v[180:183], v[156:159], 0
    ds_read_b64_tr_b16 v[234:235], v26 offset:9216
    v_mfma_f32_16x16x32_bf16 a[184:187], v[180:183], v[152:155], 0
    ds_read_b128 v[204:207], v13 offset:6144
    v_mfma_f32_16x16x32_bf16 a[180:183], v[180:183], v[148:151], 0
    ds_read_b64_tr_b16 v[236:237], v27 offset:8192
    v_mfma_f32_16x16x32_bf16 a[176:179], v[180:183], v[144:147], 0
    ds_read_b64_tr_b16 v[238:239], v27 offset:9216
    v_mfma_f32_16x16x32_bf16 a[172:175], v[180:183], v[140:143], 0
    ds_read_b128 v[208:211], v13 offset:8192
    v_mfma_f32_16x16x32_bf16 a[168:171], v[180:183], v[136:139], 0
    ds_read_b64_tr_b16 v[240:241], v28 offset:8192
    v_mfma_f32_16x16x32_bf16 a[164:167], v[180:183], v[132:135], 0
    ds_read_b64_tr_b16 v[242:243], v28 offset:9216
    v_mfma_f32_16x16x32_bf16 a[160:163], v[180:183], v[128:131], 0
    ds_read_b128 v[212:215], v13 offset:10240
    v_mfma_f32_16x16x32_bf16 a[192:195], v[184:187], v[128:131], 0
    ds_read_b64_tr_b16 v[244:245], v29 offset:8192
    v_mfma_f32_16x16x32_bf16 a[196:199], v[184:187], v[132:135], 0
    ds_read_b64_tr_b16 v[246:247], v29 offset:9216
    v_mfma_f32_16x16x32_bf16 a[200:203], v[184:187], v[136:139], 0
    ds_read_b128 v[216:219], v13 offset:12288
    v_mfma_f32_16x16x32_bf16 a[204:207], v[184:187], v[140:143], 0
    ds_read_b64_tr_b16 v[248:249], v30 offset:8192
    v_mfma_f32_16x16x32_bf16 a[208:211], v[184:187], v[144:147], 0
    ds_read_b64_tr_b16 v[250:251], v30 offset:9216
    v_mfma_f32_16x16x32_bf16 a[212:215], v[184:187], v[148:151], 0
    ds_read_b128 v[220:223], v13 offset:14336
    v_mfma_f32_16x16x32_bf16 a[216:219], v[184:187], v[152:155], 0
    ds_read_b64_tr_b16 v[252:253], v31 offset:8192
    v_mfma_f32_16x16x32_bf16 a[220:223], v[184:187], v[156:159], 0
    ds_read_b64_tr_b16 v[254:255], v31 offset:9216
    v_mfma_f32_16x16x32_bf16 a[252:255], v[188:191], v[156:159], 0
    v_mfma_f32_16x16x32_bf16 a[248:251], v[188:191], v[152:155], 0
    v_mfma_f32_16x16x32_bf16 a[244:247], v[188:191], v[148:151], 0
    s_add_u32 s72, s70, 0
    v_mfma_f32_16x16x32_bf16 a[240:243], v[188:191], v[144:147], 0
    buffer_store_dwordx4 v[32:35], v2, s[24:27], s72 offen offset:0 sc1
    v_mfma_f32_16x16x32_bf16 a[236:239], v[188:191], v[140:143], 0
    v_mfma_f32_16x16x32_bf16 a[232:235], v[188:191], v[136:139], 0
    v_mfma_f32_16x16x32_bf16 a[228:231], v[188:191], v[132:135], 0
    v_mfma_f32_16x16x32_bf16 a[224:227], v[188:191], v[128:131], 0
    s_waitcnt vmcnt(12) lgkmcnt(0)
    s_barrier
    s_waitcnt lgkmcnt(0)
    v_mfma_f32_16x16x32_bf16 a[0:3], v[224:227], v[192:195], a[0:3]
    v_mfma_f32_16x16x32_bf16 a[4:7], v[224:227], v[196:199], a[4:7]
    ds_read_b128 v[128:131], v12 offset:32768
    s_add_u32 m0, s64, 0
    v_mfma_f32_16x16x32_bf16 a[8:11], v[224:227], v[200:203], a[8:11]
    buffer_load_dwordx4 v8, s[16:19], s48 offen offset:0  lds
    v_mfma_f32_16x16x32_bf16 a[12:15], v[224:227], v[204:207], a[12:15]
    ds_read_b64_tr_b16 v[160:161], v24 offset:32768
    v_mfma_f32_16x16x32_bf16 a[16:19], v[224:227], v[208:211], a[16:19]
    v_mfma_f32_16x16x32_bf16 a[20:23], v[224:227], v[212:215], a[20:23]
    ds_read_b64_tr_b16 v[162:163], v24 offset:33792
    v_mfma_f32_16x16x32_bf16 a[24:27], v[224:227], v[216:219], a[24:27]
    buffer_load_dwordx4 v9, s[16:19], s49 offen offset:1024  lds
    v_mfma_f32_16x16x32_bf16 a[28:31], v[224:227], v[220:223], a[28:31]
    ds_read_b128 v[132:135], v12 offset:34816
    v_mfma_f32_16x16x32_bf16 a[60:63], v[228:231], v[220:223], a[60:63]
    v_mfma_f32_16x16x32_bf16 a[56:59], v[228:231], v[216:219], a[56:59]
    ds_read_b64_tr_b16 v[164:165], v25 offset:32768
    v_mfma_f32_16x16x32_bf16 a[52:55], v[228:231], v[212:215], a[52:55]
    buffer_load_dwordx4 v8, s[16:19], s50 offen offset:2048  lds
    v_mfma_f32_16x16x32_bf16 a[48:51], v[228:231], v[208:211], a[48:51]
    ds_read_b64_tr_b16 v[166:167], v25 offset:33792
    v_mfma_f32_16x16x32_bf16 a[44:47], v[228:231], v[204:207], a[44:47]
    v_mfma_f32_16x16x32_bf16 a[40:43], v[228:231], v[200:203], a[40:43]
    ds_read_b128 v[136:139], v12 offset:36864
    v_mfma_f32_16x16x32_bf16 a[36:39], v[228:231], v[196:199], a[36:39]
    buffer_load_dwordx4 v9, s[16:19], s51 offen offset:3072  lds
    v_mfma_f32_16x16x32_bf16 a[32:35], v[228:231], v[192:195], a[32:35]
    ds_read_b64_tr_b16 v[168:169], v26 offset:32768
    v_mfma_f32_16x16x32_bf16 a[64:67], v[232:235], v[192:195], a[64:67]
    v_mfma_f32_16x16x32_bf16 a[68:71], v[232:235], v[196:199], a[68:71]
    ds_read_b64_tr_b16 v[170:171], v26 offset:33792
    s_add_u32 m0, s64, 4096
    v_mfma_f32_16x16x32_bf16 a[72:75], v[232:235], v[200:203], a[72:75]
    buffer_load_dwordx4 v8, s[16:19], s52 offen offset:0  lds
    v_mfma_f32_16x16x32_bf16 a[76:79], v[232:235], v[204:207], a[76:79]
    ds_read_b128 v[140:143], v12 offset:38912
    v_mfma_f32_16x16x32_bf16 a[80:83], v[232:235], v[208:211], a[80:83]
    v_mfma_f32_16x16x32_bf16 a[84:87], v[232:235], v[212:215], a[84:87]
    ds_read_b64_tr_b16 v[172:173], v27 offset:32768
    v_mfma_f32_16x16x32_bf16 a[88:91], v[232:235], v[216:219], a[88:91]
    buffer_load_dwordx4 v9, s[16:19], s53 offen offset:1024  lds
    v_mfma_f32_16x16x32_bf16 a[92:95], v[232:235], v[220:223], a[92:95]
    ds_read_b64_tr_b16 v[174:175], v27 offset:33792
    v_mfma_f32_16x16x32_bf16 a[124:127], v[236:239], v[220:223], a[124:127]
    v_mfma_f32_16x16x32_bf16 a[120:123], v[236:239], v[216:219], a[120:123]
    ds_read_b128 v[144:147], v12 offset:40960
    v_mfma_f32_16x16x32_bf16 a[116:119], v[236:239], v[212:215], a[116:119]
    buffer_load_dwordx4 v8, s[16:19], s54 offen offset:2048  lds
    v_mfma_f32_16x16x32_bf16 a[112:115], v[236:239], v[208:211], a[112:115]
    ds_read_b64_tr_b16 v[176:177], v28 offset:32768
    v_mfma_f32_16x16x32_bf16 a[108:111], v[236:239], v[204:207], a[108:111]
    v_mfma_f32_16x16x32_bf16 a[104:107], v[236:239], v[200:203], a[104:107]
    ds_read_b64_tr_b16 v[178:179], v28 offset:33792
    v_mfma_f32_16x16x32_bf16 a[100:103], v[236:239], v[196:199], a[100:103]
    buffer_load_dwordx4 v9, s[16:19], s55 offen offset:3072  lds
    v_mfma_f32_16x16x32_bf16 a[96:99], v[236:239], v[192:195], a[96:99]
    ds_read_b128 v[148:151], v12 offset:43008
    v_mfma_f32_16x16x32_bf16 a[128:131], v[240:243], v[192:195], a[128:131]
    v_mfma_f32_16x16x32_bf16 a[132:135], v[240:243], v[196:199], a[132:135]
    ds_read_b64_tr_b16 v[180:181], v29 offset:32768
    s_add_u32 m0, s64, 65536
    v_mfma_f32_16x16x32_bf16 a[136:139], v[240:243], v[200:203], a[136:139]
    buffer_load_dwordx4 v10, s[20:23], s56 offen offset:0  lds
    v_mfma_f32_16x16x32_bf16 a[140:143], v[240:243], v[204:207], a[140:143]
    ds_read_b64_tr_b16 v[182:183], v29 offset:33792
    v_mfma_f32_16x16x32_bf16 a[144:147], v[240:243], v[208:211], a[144:147]
    v_mfma_f32_16x16x32_bf16 a[148:151], v[240:243], v[212:215], a[148:151]
    ds_read_b128 v[152:155], v12 offset:45056
    v_mfma_f32_16x16x32_bf16 a[152:155], v[240:243], v[216:219], a[152:155]
    buffer_load_dwordx4 v10, s[20:23], s57 offen offset:1024  lds
    v_mfma_f32_16x16x32_bf16 a[156:159], v[240:243], v[220:223], a[156:159]
    ds_read_b64_tr_b16 v[184:185], v30 offset:32768
    v_mfma_f32_16x16x32_bf16 a[188:191], v[244:247], v[220:223], a[188:191]
    v_mfma_f32_16x16x32_bf16 a[184:187], v[244:247], v[216:219], a[184:187]
    ds_read_b64_tr_b16 v[186:187], v30 offset:33792
    v_mfma_f32_16x16x32_bf16 a[180:183], v[244:247], v[212:215], a[180:183]
    buffer_load_dwordx4 v11, s[20:23], s58 offen offset:2048  lds
    v_mfma_f32_16x16x32_bf16 a[176:179], v[244:247], v[208:211], a[176:179]
    ds_read_b128 v[156:159], v12 offset:47104
    v_mfma_f32_16x16x32_bf16 a[172:175], v[244:247], v[204:207], a[172:175]
    v_mfma_f32_16x16x32_bf16 a[168:171], v[244:247], v[200:203], a[168:171]
    ds_read_b64_tr_b16 v[188:189], v31 offset:32768
    v_mfma_f32_16x16x32_bf16 a[164:167], v[244:247], v[196:199], a[164:167]
    buffer_load_dwordx4 v11, s[20:23], s59 offen offset:3072  lds
    v_mfma_f32_16x16x32_bf16 a[160:163], v[244:247], v[192:195], a[160:163]
    ds_read_b64_tr_b16 v[190:191], v31 offset:33792
    v_mfma_f32_16x16x32_bf16 a[192:195], v[248:251], v[192:195], a[192:195]
    v_mfma_f32_16x16x32_bf16 a[196:199], v[248:251], v[196:199], a[196:199]
    s_add_u32 m0, s64, 69632
    v_mfma_f32_16x16x32_bf16 a[200:203], v[248:251], v[200:203], a[200:203]
    buffer_load_dwordx4 v10, s[20:23], s60 offen offset:0  lds
    v_mfma_f32_16x16x32_bf16 a[204:207], v[248:251], v[204:207], a[204:207]
    v_mfma_f32_16x16x32_bf16 a[208:211], v[248:251], v[208:211], a[208:211]
    v_mfma_f32_16x16x32_bf16 a[212:215], v[248:251], v[212:215], a[212:215]
    v_mfma_f32_16x16x32_bf16 a[216:219], v[248:251], v[216:219], a[216:219]
    buffer_load_dwordx4 v10, s[20:23], s61 offen offset:1024  lds
    v_mfma_f32_16x16x32_bf16 a[220:223], v[248:251], v[220:223], a[220:223]
    v_mfma_f32_16x16x32_bf16 a[252:255], v[252:255], v[220:223], a[252:255]
    v_mfma_f32_16x16x32_bf16 a[248:251], v[252:255], v[216:219], a[248:251]
    v_mfma_f32_16x16x32_bf16 a[244:247], v[252:255], v[212:215], a[244:247]
    buffer_load_dwordx4 v11, s[20:23], s62 offen offset:2048  lds
    v_mfma_f32_16x16x32_bf16 a[240:243], v[252:255], v[208:211], a[240:243]
    v_mfma_f32_16x16x32_bf16 a[236:239], v[252:255], v[204:207], a[236:239]
    v_mfma_f32_16x16x32_bf16 a[232:235], v[252:255], v[200:203], a[232:235]
    v_mfma_f32_16x16x32_bf16 a[228:231], v[252:255], v[196:199], a[228:231]
    buffer_load_dwordx4 v11, s[20:23], s63 offen offset:3072  lds
    v_mfma_f32_16x16x32_bf16 a[224:227], v[252:255], v[192:195], a[224:227]
    s_waitcnt lgkmcnt(0)
    v_add_u32 v8, 128, v8
    v_mfma_f32_16x16x32_bf16 a[0:3], v[160:163], v[128:131], a[0:3]
    v_add_u32 v9, 128, v9
    v_mfma_f32_16x16x32_bf16 a[4:7], v[160:163], v[132:135], a[4:7]
    ds_read_b128 v[192:195], v13 offset:32768
    v_add_u32 v10, s66, v10
    v_mfma_f32_16x16x32_bf16 a[8:11], v[160:163], v[136:139], a[8:11]
    v_add_u32 v11, s66, v11
    v_mfma_f32_16x16x32_bf16 a[12:15], v[160:163], v[140:143], a[12:15]
    ds_read_b64_tr_b16 v[224:225], v24 offset:40960
    v_mfma_f32_16x16x32_bf16 a[16:19], v[160:163], v[144:147], a[16:19]
    buffer_load_dword v3, v14, s[16:19], 0 offen
    v_mfma_f32_16x16x32_bf16 a[20:23], v[160:163], v[148:151], a[20:23]
    ds_read_b64_tr_b16 v[226:227], v24 offset:41984
    v_mfma_f32_16x16x32_bf16 a[24:27], v[160:163], v[152:155], a[24:27]
    buffer_load_dword v3, v15, s[20:23], 0 offen
    v_mfma_f32_16x16x32_bf16 a[28:31], v[160:163], v[156:159], a[28:31]
    ds_read_b128 v[196:199], v13 offset:34816
    v_mfma_f32_16x16x32_bf16 a[60:63], v[164:167], v[156:159], a[60:63]
    v_add_u32 v14, 128, v14
    v_mfma_f32_16x16x32_bf16 a[56:59], v[164:167], v[152:155], a[56:59]
    ds_read_b64_tr_b16 v[228:229], v25 offset:40960
    v_mfma_f32_16x16x32_bf16 a[52:55], v[164:167], v[148:151], a[52:55]
    v_add_u32 v15, s66, v15
    v_mfma_f32_16x16x32_bf16 a[48:51], v[164:167], v[144:147], a[48:51]
    ds_read_b64_tr_b16 v[230:231], v25 offset:41984
    v_mfma_f32_16x16x32_bf16 a[44:47], v[164:167], v[140:143], a[44:47]
    v_mfma_f32_16x16x32_bf16 a[40:43], v[164:167], v[136:139], a[40:43]
    ds_read_b128 v[200:203], v13 offset:36864
    v_mfma_f32_16x16x32_bf16 a[36:39], v[164:167], v[132:135], a[36:39]
    s_add_u32 s72, s70, 0
    v_mfma_f32_16x16x32_bf16 a[32:35], v[164:167], v[128:131], a[32:35]
    ds_read_b64_tr_b16 v[232:233], v26 offset:40960
    buffer_store_dwordx4 v[36:39], v2, s[24:27], s72 offen offset:1024 sc1
    v_mfma_f32_16x16x32_bf16 a[64:67], v[168:171], v[128:131], a[64:67]
    v_mfma_f32_16x16x32_bf16 a[68:71], v[168:171], v[132:135], a[68:71]
    ds_read_b64_tr_b16 v[234:235], v26 offset:41984
    v_mfma_f32_16x16x32_bf16 a[72:75], v[168:171], v[136:139], a[72:75]
    v_mfma_f32_16x16x32_bf16 a[76:79], v[168:171], v[140:143], a[76:79]
    ds_read_b128 v[204:207], v13 offset:38912
    v_mfma_f32_16x16x32_bf16 a[80:83], v[168:171], v[144:147], a[80:83]
    v_mfma_f32_16x16x32_bf16 a[84:87], v[168:171], v[148:151], a[84:87]
    ds_read_b64_tr_b16 v[236:237], v27 offset:40960
    v_mfma_f32_16x16x32_bf16 a[88:91], v[168:171], v[152:155], a[88:91]
    s_add_u32 s72, s70, 0
    v_mfma_f32_16x16x32_bf16 a[92:95], v[168:171], v[156:159], a[92:95]
    ds_read_b64_tr_b16 v[238:239], v27 offset:41984
    buffer_store_dwordx4 v[40:43], v2, s[24:27], s72 offen offset:2048 sc1
    v_mfma_f32_16x16x32_bf16 a[124:127], v[172:175], v[156:159], a[124:127]
    v_mfma_f32_16x16x32_bf16 a[120:123], v[172:175], v[152:155], a[120:123]
    ds_read_b128 v[208:211], v13 offset:40960
    v_mfma_f32_16x16x32_bf16 a[116:119], v[172:175], v[148:151], a[116:119]
    v_mfma_f32_16x16x32_bf16 a[112:115], v[172:175], v[144:147], a[112:115]
    ds_read_b64_tr_b16 v[240:241], v28 offset:40960
    v_mfma_f32_16x16x32_bf16 a[108:111], v[172:175], v[140:143], a[108:111]
    v_mfma_f32_16x16x32_bf16 a[104:107], v[172:175], v[136:139], a[104:107]
    ds_read_b64_tr_b16 v[242:243], v28 offset:41984
    v_mfma_f32_16x16x32_bf16 a[100:103], v[172:175], v[132:135], a[100:103]
    s_add_u32 s72, s70, 0
    v_mfma_f32_16x16x32_bf16 a[96:99], v[172:175], v[128:131], a[96:99]
    ds_read_b128 v[212:215], v13 offset:43008
    buffer_store_dwordx4 v[44:47], v2, s[24:27], s72 offen offset:3072 sc1
    v_mfma_f32_16x16x32_bf16 a[128:131], v[176:179], v[128:131], a[128:131]
    v_mfma_f32_16x16x32_bf16 a[132:135], v[176:179], v[132:135], a[132:135]
    ds_read_b64_tr_b16 v[244:245], v29 offset:40960
    v_mfma_f32_16x16x32_bf16 a[136:139], v[176:179], v[136:139], a[136:139]
    v_mfma_f32_16x16x32_bf16 a[140:143], v[176:179], v[140:143], a[140:143]
    ds_read_b64_tr_b16 v[246:247], v29 offset:41984
    v_mfma_f32_16x16x32_bf16 a[144:147], v[176:179], v[144:147], a[144:147]
    v_mfma_f32_16x16x32_bf16 a[148:151], v[176:179], v[148:151], a[148:151]
    ds_read_b128 v[216:219], v13 offset:45056
    v_mfma_f32_16x16x32_bf16 a[152:155], v[176:179], v[152:155], a[152:155]
    v_mfma_f32_16x16x32_bf16 a[156:159], v[176:179], v[156:159], a[156:159]
    ds_read_b64_tr_b16 v[248:249], v30 offset:40960
    v_mfma_f32_16x16x32_bf16 a[188:191], v[180:183], v[156:159], a[188:191]
    v_mfma_f32_16x16x32_bf16 a[184:187], v[180:183], v[152:155], a[184:187]
    ds_read_b64_tr_b16 v[250:251], v30 offset:41984
    v_mfma_f32_16x16x32_bf16 a[180:183], v[180:183], v[148:151], a[180:183]
    v_mfma_f32_16x16x32_bf16 a[176:179], v[180:183], v[144:147], a[176:179]
    ds_read_b128 v[220:223], v13 offset:47104
    v_mfma_f32_16x16x32_bf16 a[172:175], v[180:183], v[140:143], a[172:175]
    v_mfma_f32_16x16x32_bf16 a[168:171], v[180:183], v[136:139], a[168:171]
    ds_read_b64_tr_b16 v[252:253], v31 offset:40960
    v_mfma_f32_16x16x32_bf16 a[164:167], v[180:183], v[132:135], a[164:167]
    v_mfma_f32_16x16x32_bf16 a[160:163], v[180:183], v[128:131], a[160:163]
    ds_read_b64_tr_b16 v[254:255], v31 offset:41984
    v_mfma_f32_16x16x32_bf16 a[192:195], v[184:187], v[128:131], a[192:195]
    v_mfma_f32_16x16x32_bf16 a[196:199], v[184:187], v[132:135], a[196:199]
    v_mfma_f32_16x16x32_bf16 a[200:203], v[184:187], v[136:139], a[200:203]
    v_mfma_f32_16x16x32_bf16 a[204:207], v[184:187], v[140:143], a[204:207]
    v_mfma_f32_16x16x32_bf16 a[208:211], v[184:187], v[144:147], a[208:211]
    v_mfma_f32_16x16x32_bf16 a[212:215], v[184:187], v[148:151], a[212:215]
    v_mfma_f32_16x16x32_bf16 a[216:219], v[184:187], v[152:155], a[216:219]
    v_mfma_f32_16x16x32_bf16 a[220:223], v[184:187], v[156:159], a[220:223]
    v_mfma_f32_16x16x32_bf16 a[252:255], v[188:191], v[156:159], a[252:255]
    v_mfma_f32_16x16x32_bf16 a[248:251], v[188:191], v[152:155], a[248:251]
    v_mfma_f32_16x16x32_bf16 a[244:247], v[188:191], v[148:151], a[244:247]
    v_mfma_f32_16x16x32_bf16 a[240:243], v[188:191], v[144:147], a[240:243]
    v_mfma_f32_16x16x32_bf16 a[236:239], v[188:191], v[140:143], a[236:239]
    v_mfma_f32_16x16x32_bf16 a[232:235], v[188:191], v[136:139], a[232:235]
    v_mfma_f32_16x16x32_bf16 a[228:231], v[188:191], v[132:135], a[228:231]
    v_mfma_f32_16x16x32_bf16 a[224:227], v[188:191], v[128:131], a[224:227]
    s_waitcnt vmcnt(5) lgkmcnt(0)
    s_barrier
    s_waitcnt lgkmcnt(0)
    v_mfma_f32_16x16x32_bf16 a[0:3], v[224:227], v[192:195], a[0:3]
    v_mfma_f32_16x16x32_bf16 a[4:7], v[224:227], v[196:199], a[4:7]
    ds_read_b128 v[128:131], v12 offset:0
    s_add_u32 m0, s64, 32768
    v_mfma_f32_16x16x32_bf16 a[8:11], v[224:227], v[200:203], a[8:11]
    buffer_load_dwordx4 v8, s[16:19], s48 offen offset:0  lds
    v_mfma_f32_16x16x32_bf16 a[12:15], v[224:227], v[204:207], a[12:15]
    ds_read_b64_tr_b16 v[160:161], v24 offset:0
    v_mfma_f32_16x16x32_bf16 a[16:19], v[224:227], v[208:211], a[16:19]
    v_mfma_f32_16x16x32_bf16 a[20:23], v[224:227], v[212:215], a[20:23]
    ds_read_b64_tr_b16 v[162:163], v24 offset:1024
    v_mfma_f32_16x16x32_bf16 a[24:27], v[224:227], v[216:219], a[24:27]
    buffer_load_dwordx4 v9, s[16:19], s49 offen offset:1024  lds
    v_mfma_f32_16x16x32_bf16 a[28:31], v[224:227], v[220:223], a[28:31]
    ds_read_b128 v[132:135], v12 offset:2048
    v_mfma_f32_16x16x32_bf16 a[60:63], v[228:231], v[220:223], a[60:63]
    v_mfma_f32_16x16x32_bf16 a[56:59], v[228:231], v[216:219], a[56:59]
    ds_read_b64_tr_b16 v[164:165], v25 offset:0
    v_mfma_f32_16x16x32_bf16 a[52:55], v[228:231], v[212:215], a[52:55]
    buffer_load_dwordx4 v8, s[16:19], s50 offen offset:2048  lds
    v_mfma_f32_16x16x32_bf16 a[48:51], v[228:231], v[208:211], a[48:51]
    ds_read_b64_tr_b16 v[166:167], v25 offset:1024
    v_mfma_f32_16x16x32_bf16 a[44:47], v[228:231], v[204:207], a[44:47]
    v_mfma_f32_16x16x32_bf16 a[40:43], v[228:231], v[200:203], a[40:43]
    ds_read_b128 v[136:139], v12 offset:4096
    v_mfma_f32_16x16x32_bf16 a[36:39], v[228:231], v[196:199], a[36:39]
    buffer_load_dwordx4 v9, s[16:19], s51 offen offset:3072  lds
    v_mfma_f32_16x16x32_bf16 a[32:35], v[228:231], v[192:195], a[32:35]
    ds_read_b64_tr_b16 v[168:169], v26 offset:0
    v_mfma_f32_16x16x32_bf16 a[64:67], v[232:235], v[192:195], a[64:67]
    v_mfma_f32_16x16x32_bf16 a[68:71], v[232:235], v[196:199], a[68:71]
    ds_read_b64_tr_b16 v[170:171], v26 offset:1024
    s_add_u32 m0, s64, 36864
    v_mfma_f32_16x16x32_bf16 a[72:75], v[232:235], v[200:203], a[72:75]
    buffer_load_dwordx4 v8, s[16:19], s52 offen offset:0  lds
    v_mfma_f32_16x16x32_bf16 a[76:79], v[232:235], v[204:207], a[76:79]
    ds_read_b128 v[140:143], v12 offset:6144
    v_mfma_f32_16x16x32_bf16 a[80:83], v[232:235], v[208:211], a[80:83]
    v_mfma_f32_16x16x32_bf16 a[84:87], v[232:235], v[212:215], a[84:87]
    ds_read_b64_tr_b16 v[172:173], v27 offset:0
    v_mfma_f32_16x16x32_bf16 a[88:91], v[232:235], v[216:219], a[88:91]
    buffer_load_dwordx4 v9, s[16:19], s53 offen offset:1024  lds
    v_mfma_f32_16x16x32_bf16 a[92:95], v[232:235], v[220:223], a[92:95]
    ds_read_b64_tr_b16 v[174:175], v27 offset:1024
    v_mfma_f32_16x16x32_bf16 a[124:127], v[236:239], v[220:223], a[124:127]
    v_mfma_f32_16x16x32_bf16 a[120:123], v[236:239], v[216:219], a[120:123]
    ds_read_b128 v[144:147], v12 offset:8192
    v_mfma_f32_16x16x32_bf16 a[116:119], v[236:239], v[212:215], a[116:119]
    buffer_load_dwordx4 v8, s[16:19], s54 offen offset:2048  lds
    v_mfma_f32_16x16x32_bf16 a[112:115], v[236:239], v[208:211], a[112:115]
    ds_read_b64_tr_b16 v[176:177], v28 offset:0
    v_mfma_f32_16x16x32_bf16 a[108:111], v[236:239], v[204:207], a[108:111]
    v_mfma_f32_16x16x32_bf16 a[104:107], v[236:239], v[200:203], a[104:107]
    ds_read_b64_tr_b16 v[178:179], v28 offset:1024
    v_mfma_f32_16x16x32_bf16 a[100:103], v[236:239], v[196:199], a[100:103]
    buffer_load_dwordx4 v9, s[16:19], s55 offen offset:3072  lds
    v_mfma_f32_16x16x32_bf16 a[96:99], v[236:239], v[192:195], a[96:99]
    ds_read_b128 v[148:151], v12 offset:10240
    v_mfma_f32_16x16x32_bf16 a[128:131], v[240:243], v[192:195], a[128:131]
    v_mfma_f32_16x16x32_bf16 a[132:135], v[240:243], v[196:199], a[132:135]
    ds_read_b64_tr_b16 v[180:181], v29 offset:0
    s_add_u32 m0, s64, 98304
    v_mfma_f32_16x16x32_bf16 a[136:139], v[240:243], v[200:203], a[136:139]
    buffer_load_dwordx4 v10, s[20:23], s56 offen offset:0  lds
    v_mfma_f32_16x16x32_bf16 a[140:143], v[240:243], v[204:207], a[140:143]
    ds_read_b64_tr_b16 v[182:183], v29 offset:1024
    v_mfma_f32_16x16x32_bf16 a[144:147], v[240:243], v[208:211], a[144:147]
    v_mfma_f32_16x16x32_bf16 a[148:151], v[240:243], v[212:215], a[148:151]
    ds_read_b128 v[152:155], v12 offset:12288
    v_mfma_f32_16x16x32_bf16 a[152:155], v[240:243], v[216:219], a[152:155]
    buffer_load_dwordx4 v10, s[20:23], s57 offen offset:1024  lds
    v_mfma_f32_16x16x32_bf16 a[156:159], v[240:243], v[220:223], a[156:159]
    ds_read_b64_tr_b16 v[184:185], v30 offset:0
    v_mfma_f32_16x16x32_bf16 a[188:191], v[244:247], v[220:223], a[188:191]
    v_mfma_f32_16x16x32_bf16 a[184:187], v[244:247], v[216:219], a[184:187]
    ds_read_b64_tr_b16 v[186:187], v30 offset:1024
    v_mfma_f32_16x16x32_bf16 a[180:183], v[244:247], v[212:215], a[180:183]
    buffer_load_dwordx4 v11, s[20:23], s58 offen offset:2048  lds
    v_mfma_f32_16x16x32_bf16 a[176:179], v[244:247], v[208:211], a[176:179]
    ds_read_b128 v[156:159], v12 offset:14336
    v_mfma_f32_16x16x32_bf16 a[172:175], v[244:247], v[204:207], a[172:175]
    v_mfma_f32_16x16x32_bf16 a[168:171], v[244:247], v[200:203], a[168:171]
    ds_read_b64_tr_b16 v[188:189], v31 offset:0
    v_mfma_f32_16x16x32_bf16 a[164:167], v[244:247], v[196:199], a[164:167]
    buffer_load_dwordx4 v11, s[20:23], s59 offen offset:3072  lds
    v_mfma_f32_16x16x32_bf16 a[160:163], v[244:247], v[192:195], a[160:163]
    ds_read_b64_tr_b16 v[190:191], v31 offset:1024
    v_mfma_f32_16x16x32_bf16 a[192:195], v[248:251], v[192:195], a[192:195]
    v_mfma_f32_16x16x32_bf16 a[196:199], v[248:251], v[196:199], a[196:199]
    s_add_u32 m0, s64, 102400
    v_mfma_f32_16x16x32_bf16 a[200:203], v[248:251], v[200:203], a[200:203]
    buffer_load_dwordx4 v10, s[20:23], s60 offen offset:0  lds
    v_mfma_f32_16x16x32_bf16 a[204:207], v[248:251], v[204:207], a[204:207]
    v_mfma_f32_16x16x32_bf16 a[208:211], v[248:251], v[208:211], a[208:211]
    v_mfma_f32_16x16x32_bf16 a[212:215], v[248:251], v[212:215], a[212:215]
    v_mfma_f32_16x16x32_bf16 a[216:219], v[248:251], v[216:219], a[216:219]
    buffer_load_dwordx4 v10, s[20:23], s61 offen offset:1024  lds
    v_mfma_f32_16x16x32_bf16 a[220:223], v[248:251], v[220:223], a[220:223]
    v_mfma_f32_16x16x32_bf16 a[252:255], v[252:255], v[220:223], a[252:255]
    v_mfma_f32_16x16x32_bf16 a[248:251], v[252:255], v[216:219], a[248:251]
    v_mfma_f32_16x16x32_bf16 a[244:247], v[252:255], v[212:215], a[244:247]
    buffer_load_dwordx4 v11, s[20:23], s62 offen offset:2048  lds
    v_mfma_f32_16x16x32_bf16 a[240:243], v[252:255], v[208:211], a[240:243]
    v_mfma_f32_16x16x32_bf16 a[236:239], v[252:255], v[204:207], a[236:239]
    v_mfma_f32_16x16x32_bf16 a[232:235], v[252:255], v[200:203], a[232:235]
    v_mfma_f32_16x16x32_bf16 a[228:231], v[252:255], v[196:199], a[228:231]
    buffer_load_dwordx4 v11, s[20:23], s63 offen offset:3072  lds
    v_mfma_f32_16x16x32_bf16 a[224:227], v[252:255], v[192:195], a[224:227]
    s_waitcnt lgkmcnt(0)
    v_add_u32 v8, 128, v8
    v_mfma_f32_16x16x32_bf16 a[0:3], v[160:163], v[128:131], a[0:3]
    v_add_u32 v9, 128, v9
    v_mfma_f32_16x16x32_bf16 a[4:7], v[160:163], v[132:135], a[4:7]
    ds_read_b128 v[192:195], v13 offset:0
    v_add_u32 v10, s66, v10
    v_mfma_f32_16x16x32_bf16 a[8:11], v[160:163], v[136:139], a[8:11]
    v_add_u32 v11, s66, v11
    v_mfma_f32_16x16x32_bf16 a[12:15], v[160:163], v[140:143], a[12:15]
    ds_read_b64_tr_b16 v[224:225], v24 offset:8192
    v_mfma_f32_16x16x32_bf16 a[16:19], v[160:163], v[144:147], a[16:19]
    buffer_load_dword v3, v14, s[16:19], 0 offen
    v_mfma_f32_16x16x32_bf16 a[20:23], v[160:163], v[148:151], a[20:23]
    ds_read_b64_tr_b16 v[226:227], v24 offset:9216
    v_mfma_f32_16x16x32_bf16 a[24:27], v[160:163], v[152:155], a[24:27]
    buffer_load_dword v3, v15, s[20:23], 0 offen
    v_mfma_f32_16x16x32_bf16 a[28:31], v[160:163], v[156:159], a[28:31]
    ds_read_b128 v[196:199], v13 offset:2048
    v_mfma_f32_16x16x32_bf16 a[60:63], v[164:167], v[156:159], a[60:63]
    v_add_u32 v14, 128, v14
    v_mfma_f32_16x16x32_bf16 a[56:59], v[164:167], v[152:155], a[56:59]
    ds_read_b64_tr_b16 v[228:229], v25 offset:8192
    v_mfma_f32_16x16x32_bf16 a[52:55], v[164:167], v[148:151], a[52:55]
    v_add_u32 v15, s66, v15
    v_mfma_f32_16x16x32_bf16 a[48:51], v[164:167], v[144:147], a[48:51]
    ds_read_b64_tr_b16 v[230:231], v25 offset:9216
    v_mfma_f32_16x16x32_bf16 a[44:47], v[164:167], v[140:143], a[44:47]
    v_mfma_f32_16x16x32_bf16 a[40:43], v[164:167], v[136:139], a[40:43]
    ds_read_b128 v[200:203], v13 offset:4096
    v_mfma_f32_16x16x32_bf16 a[36:39], v[164:167], v[132:135], a[36:39]
    s_add_u32 s72, s70, 0
    s_add_u32 s72, s72, s75
    v_mfma_f32_16x16x32_bf16 a[32:35], v[164:167], v[128:131], a[32:35]
    ds_read_b64_tr_b16 v[232:233], v26 offset:8192
    buffer_store_dwordx4 v[48:51], v2, s[24:27], s72 offen offset:0 sc1
    v_mfma_f32_16x16x32_bf16 a[64:67], v[168:171], v[128:131], a[64:67]
    v_mfma_f32_16x16x32_bf16 a[68:71], v[168:171], v[132:135], a[68:71]
    ds_read_b64_tr_b16 v[234:235], v26 offset:9216
    v_mfma_f32_16x16x32_bf16 a[72:75], v[168:171], v[136:139], a[72:75]
    v_mfma_f32_16x16x32_bf16 a[76:79], v[168:171], v[140:143], a[76:79]
    ds_read_b128 v[204:207], v13 offset:6144
    v_mfma_f32_16x16x32_bf16 a[80:83], v[168:171], v[144:147], a[80:83]
    v_mfma_f32_16x16x32_bf16 a[84:87], v[168:171], v[148:151], a[84:87]
    ds_read_b64_tr_b16 v[236:237], v27 offset:8192
    v_mfma_f32_16x16x32_bf16 a[88:91], v[168:171], v[152:155], a[88:91]
    s_add_u32 s72, s70, 0
    s_add_u32 s72, s72, s75
    v_mfma_f32_16x16x32_bf16 a[92:95], v[168:171], v[156:159], a[92:95]
    ds_read_b64_tr_b16 v[238:239], v27 offset:9216
    buffer_store_dwordx4 v[52:55], v2, s[24:27], s72 offen offset:1024 sc1
    v_mfma_f32_16x16x32_bf16 a[124:127], v[172:175], v[156:159], a[124:127]
    v_mfma_f32_16x16x32_bf16 a[120:123], v[172:175], v[152:155], a[120:123]
    ds_read_b128 v[208:211], v13 offset:8192
    v_mfma_f32_16x16x32_bf16 a[116:119], v[172:175], v[148:151], a[116:119]
    v_mfma_f32_16x16x32_bf16 a[112:115], v[172:175], v[144:147], a[112:115]
    ds_read_b64_tr_b16 v[240:241], v28 offset:8192
    v_mfma_f32_16x16x32_bf16 a[108:111], v[172:175], v[140:143], a[108:111]
    v_mfma_f32_16x16x32_bf16 a[104:107], v[172:175], v[136:139], a[104:107]
    ds_read_b64_tr_b16 v[242:243], v28 offset:9216
    v_mfma_f32_16x16x32_bf16 a[100:103], v[172:175], v[132:135], a[100:103]
    s_add_u32 s72, s70, 0
    s_add_u32 s72, s72, s75
    v_mfma_f32_16x16x32_bf16 a[96:99], v[172:175], v[128:131], a[96:99]
    ds_read_b128 v[212:215], v13 offset:10240
    buffer_store_dwordx4 v[56:59], v2, s[24:27], s72 offen offset:2048 sc1
    v_mfma_f32_16x16x32_bf16 a[128:131], v[176:179], v[128:131], a[128:131]
    v_mfma_f32_16x16x32_bf16 a[132:135], v[176:179], v[132:135], a[132:135]
    ds_read_b64_tr_b16 v[244:245], v29 offset:8192
    v_mfma_f32_16x16x32_bf16 a[136:139], v[176:179], v[136:139], a[136:139]
    v_mfma_f32_16x16x32_bf16 a[140:143], v[176:179], v[140:143], a[140:143]
    ds_read_b64_tr_b16 v[246:247], v29 offset:9216
    v_mfma_f32_16x16x32_bf16 a[144:147], v[176:179], v[144:147], a[144:147]
    v_mfma_f32_16x16x32_bf16 a[148:151], v[176:179], v[148:151], a[148:151]
    ds_read_b128 v[216:219], v13 offset:12288
    v_mfma_f32_16x16x32_bf16 a[152:155], v[176:179], v[152:155], a[152:155]
    v_mfma_f32_16x16x32_bf16 a[156:159], v[176:179], v[156:159], a[156:159]
    ds_read_b64_tr_b16 v[248:249], v30 offset:8192
    v_mfma_f32_16x16x32_bf16 a[188:191], v[180:183], v[156:159], a[188:191]
    v_mfma_f32_16x16x32_bf16 a[184:187], v[180:183], v[152:155], a[184:187]
    ds_read_b64_tr_b16 v[250:251], v30 offset:9216
    v_mfma_f32_16x16x32_bf16 a[180:183], v[180:183], v[148:151], a[180:183]
    v_mfma_f32_16x16x32_bf16 a[176:179], v[180:183], v[144:147], a[176:179]
    ds_read_b128 v[220:223], v13 offset:14336
    v_mfma_f32_16x16x32_bf16 a[172:175], v[180:183], v[140:143], a[172:175]
    v_mfma_f32_16x16x32_bf16 a[168:171], v[180:183], v[136:139], a[168:171]
    ds_read_b64_tr_b16 v[252:253], v31 offset:8192
    v_mfma_f32_16x16x32_bf16 a[164:167], v[180:183], v[132:135], a[164:167]
    v_mfma_f32_16x16x32_bf16 a[160:163], v[180:183], v[128:131], a[160:163]
    ds_read_b64_tr_b16 v[254:255], v31 offset:9216
    v_mfma_f32_16x16x32_bf16 a[192:195], v[184:187], v[128:131], a[192:195]
    v_mfma_f32_16x16x32_bf16 a[196:199], v[184:187], v[132:135], a[196:199]
    v_mfma_f32_16x16x32_bf16 a[200:203], v[184:187], v[136:139], a[200:203]
    v_mfma_f32_16x16x32_bf16 a[204:207], v[184:187], v[140:143], a[204:207]
    v_mfma_f32_16x16x32_bf16 a[208:211], v[184:187], v[144:147], a[208:211]
    v_mfma_f32_16x16x32_bf16 a[212:215], v[184:187], v[148:151], a[212:215]
    v_mfma_f32_16x16x32_bf16 a[216:219], v[184:187], v[152:155], a[216:219]
    v_mfma_f32_16x16x32_bf16 a[220:223], v[184:187], v[156:159], a[220:223]
    v_mfma_f32_16x16x32_bf16 a[252:255], v[188:191], v[156:159], a[252:255]
    v_mfma_f32_16x16x32_bf16 a[248:251], v[188:191], v[152:155], a[248:251]
    v_mfma_f32_16x16x32_bf16 a[244:247], v[188:191], v[148:151], a[244:247]
    v_mfma_f32_16x16x32_bf16 a[240:243], v[188:191], v[144:147], a[240:243]
    v_mfma_f32_16x16x32_bf16 a[236:239], v[188:191], v[140:143], a[236:239]
    v_mfma_f32_16x16x32_bf16 a[232:235], v[188:191], v[136:139], a[232:235]
    v_mfma_f32_16x16x32_bf16 a[228:231], v[188:191], v[132:135], a[228:231]
    v_mfma_f32_16x16x32_bf16 a[224:227], v[188:191], v[128:131], a[224:227]
    s_waitcnt vmcnt(5) lgkmcnt(0)
    s_barrier
    s_waitcnt lgkmcnt(0)
    v_mfma_f32_16x16x32_bf16 a[0:3], v[224:227], v[192:195], a[0:3]
    v_mfma_f32_16x16x32_bf16 a[4:7], v[224:227], v[196:199], a[4:7]
    ds_read_b128 v[128:131], v12 offset:32768
    s_add_u32 m0, s64, 0
    v_mfma_f32_16x16x32_bf16 a[8:11], v[224:227], v[200:203], a[8:11]
    buffer_load_dwordx4 v8, s[16:19], s48 offen offset:0  lds
    v_mfma_f32_16x16x32_bf16 a[12:15], v[224:227], v[204:207], a[12:15]
    ds_read_b64_tr_b16 v[160:161], v24 offset:32768
    v_mfma_f32_16x16x32_bf16 a[16:19], v[224:227], v[208:211], a[16:19]
    v_mfma_f32_16x16x32_bf16 a[20:23], v[224:227], v[212:215], a[20:23]
    ds_read_b64_tr_b16 v[162:163], v24 offset:33792
    v_mfma_f32_16x16x32_bf16 a[24:27], v[224:227], v[216:219], a[24:27]
    buffer_load_dwordx4 v9, s[16:19], s49 offen offset:1024  lds
    v_mfma_f32_16x16x32_bf16 a[28:31], v[224:227], v[220:223], a[28:31]
    ds_read_b128 v[132:135], v12 offset:34816
    v_mfma_f32_16x16x32_bf16 a[60:63], v[228:231], v[220:223], a[60:63]
    v_mfma_f32_16x16x32_bf16 a[56:59], v[228:231], v[216:219], a[56:59]
    ds_read_b64_tr_b16 v[164:165], v25 offset:32768
    v_mfma_f32_16x16x32_bf16 a[52:55], v[228:231], v[212:215], a[52:55]
    buffer_load_dwordx4 v8, s[16:19], s50 offen offset:2048  lds
    v_mfma_f32_16x16x32_bf16 a[48:51], v[228:231], v[208:211], a[48:51]
    ds_read_b64_tr_b16 v[166:167], v25 offset:33792
    v_mfma_f32_16x16x32_bf16 a[44:47], v[228:231], v[204:207], a[44:47]
    v_mfma_f32_16x16x32_bf16 a[40:43], v[228:231], v[200:203], a[40:43]
    ds_read_b128 v[136:139], v12 offset:36864
    v_mfma_f32_16x16x32_bf16 a[36:39], v[228:231], v[196:199], a[36:39]
    buffer_load_dwordx4 v9, s[16:19], s51 offen offset:3072  lds
    v_mfma_f32_16x16x32_bf16 a[32:35], v[228:231], v[192:195], a[32:35]
    ds_read_b64_tr_b16 v[168:169], v26 offset:32768
    v_mfma_f32_16x16x32_bf16 a[64:67], v[232:235], v[192:195], a[64:67]
    v_mfma_f32_16x16x32_bf16 a[68:71], v[232:235], v[196:199], a[68:71]
    ds_read_b64_tr_b16 v[170:171], v26 offset:33792
    s_add_u32 m0, s64, 4096
    v_mfma_f32_16x16x32_bf16 a[72:75], v[232:235], v[200:203], a[72:75]
    buffer_load_dwordx4 v8, s[16:19], s52 offen offset:0  lds
    v_mfma_f32_16x16x32_bf16 a[76:79], v[232:235], v[204:207], a[76:79]
    ds_read_b128 v[140:143], v12 offset:38912
    v_mfma_f32_16x16x32_bf16 a[80:83], v[232:235], v[208:211], a[80:83]
    v_mfma_f32_16x16x32_bf16 a[84:87], v[232:235], v[212:215], a[84:87]
    ds_read_b64_tr_b16 v[172:173], v27 offset:32768
    v_mfma_f32_16x16x32_bf16 a[88:91], v[232:235], v[216:219], a[88:91]
    buffer_load_dwordx4 v9, s[16:19], s53 offen offset:1024  lds
    v_mfma_f32_16x16x32_bf16 a[92:95], v[232:235], v[220:223], a[92:95]
    ds_read_b64_tr_b16 v[174:175], v27 offset:33792
    v_mfma_f32_16x16x32_bf16 a[124:127], v[236:239], v[220:223], a[124:127]
    v_mfma_f32_16x16x32_bf16 a[120:123], v[236:239], v[216:219], a[120:123]
    ds_read_b128 v[144:147], v12 offset:40960
    v_mfma_f32_16x16x32_bf16 a[116:119], v[236:239], v[212:215], a[116:119]
    buffer_load_dwordx4 v8, s[16:19], s54 offen offset:2048  lds
    v_mfma_f32_16x16x32_bf16 a[112:115], v[236:239], v[208:211], a[112:115]
    ds_read_b64_tr_b16 v[176:177], v28 offset:32768
    v_mfma_f32_16x16x32_bf16 a[108:111], v[236:239], v[204:207], a[108:111]
    v_mfma_f32_16x16x32_bf16 a[104:107], v[236:239], v[200:203], a[104:107]
    ds_read_b64_tr_b16 v[178:179], v28 offset:33792
    v_mfma_f32_16x16x32_bf16 a[100:103], v[236:239], v[196:199], a[100:103]
    buffer_load_dwordx4 v9, s[16:19], s55 offen offset:3072  lds
    v_mfma_f32_16x16x32_bf16 a[96:99], v[236:239], v[192:195], a[96:99]
    ds_read_b128 v[148:151], v12 offset:43008
    v_mfma_f32_16x16x32_bf16 a[128:131], v[240:243], v[192:195], a[128:131]
    v_mfma_f32_16x16x32_bf16 a[132:135], v[240:243], v[196:199], a[132:135]
    ds_read_b64_tr_b16 v[180:181], v29 offset:32768
    s_add_u32 m0, s64, 65536
    v_mfma_f32_16x16x32_bf16 a[136:139], v[240:243], v[200:203], a[136:139]
    buffer_load_dwordx4 v10, s[20:23], s56 offen offset:0  lds
    v_mfma_f32_16x16x32_bf16 a[140:143], v[240:243], v[204:207], a[140:143]
    ds_read_b64_tr_b16 v[182:183], v29 offset:33792
    v_mfma_f32_16x16x32_bf16 a[144:147], v[240:243], v[208:211], a[144:147]
    v_mfma_f32_16x16x32_bf16 a[148:151], v[240:243], v[212:215], a[148:151]
    ds_read_b128 v[152:155], v12 offset:45056
    v_mfma_f32_16x16x32_bf16 a[152:155], v[240:243], v[216:219], a[152:155]
    buffer_load_dwordx4 v10, s[20:23], s57 offen offset:1024  lds
    v_mfma_f32_16x16x32_bf16 a[156:159], v[240:243], v[220:223], a[156:159]
    ds_read_b64_tr_b16 v[184:185], v30 offset:32768
    v_mfma_f32_16x16x32_bf16 a[188:191], v[244:247], v[220:223], a[188:191]
    v_mfma_f32_16x16x32_bf16 a[184:187], v[244:247], v[216:219], a[184:187]
    ds_read_b64_tr_b16 v[186:187], v30 offset:33792
    v_mfma_f32_16x16x32_bf16 a[180:183], v[244:247], v[212:215], a[180:183]
    buffer_load_dwordx4 v11, s[20:23], s58 offen offset:2048  lds
    v_mfma_f32_16x16x32_bf16 a[176:179], v[244:247], v[208:211], a[176:179]
    ds_read_b128 v[156:159], v12 offset:47104
    v_mfma_f32_16x16x32_bf16 a[172:175], v[244:247], v[204:207], a[172:175]
    v_mfma_f32_16x16x32_bf16 a[168:171], v[244:247], v[200:203], a[168:171]
    ds_read_b64_tr_b16 v[188:189], v31 offset:32768
    v_mfma_f32_16x16x32_bf16 a[164:167], v[244:247], v[196:199], a[164:167]
    buffer_load_dwordx4 v11, s[20:23], s59 offen offset:3072  lds
    v_mfma_f32_16x16x32_bf16 a[160:163], v[244:247], v[192:195], a[160:163]
    ds_read_b64_tr_b16 v[190:191], v31 offset:33792
    v_mfma_f32_16x16x32_bf16 a[192:195], v[248:251], v[192:195], a[192:195]
    v_mfma_f32_16x16x32_bf16 a[196:199], v[248:251], v[196:199], a[196:199]
    s_add_u32 m0, s64, 69632
    v_mfma_f32_16x16x32_bf16 a[200:203], v[248:251], v[200:203], a[200:203]
    buffer_load_dwordx4 v10, s[20:23], s60 offen offset:0  lds
    v_mfma_f32_16x16x32_bf16 a[204:207], v[248:251], v[204:207], a[204:207]
    v_mfma_f32_16x16x32_bf16 a[208:211], v[248:251], v[208:211], a[208:211]
    v_mfma_f32_16x16x32_bf16 a[212:215], v[248:251], v[212:215], a[212:215]
    v_mfma_f32_16x16x32_bf16 a[216:219], v[248:251], v[216:219], a[216:219]
    buffer_load_dwordx4 v10, s[20:23], s61 offen offset:1024  lds
    v_mfma_f32_16x16x32_bf16 a[220:223], v[248:251], v[220:223], a[220:223]
    v_mfma_f32_16x16x32_bf16 a[252:255], v[252:255], v[220:223], a[252:255]
    v_mfma_f32_16x16x32_bf16 a[248:251], v[252:255], v[216:219], a[248:251]
    v_mfma_f32_16x16x32_bf16 a[244:247], v[252:255], v[212:215], a[244:247]
    buffer_load_dwordx4 v11, s[20:23], s62 offen offset:2048  lds
    v_mfma_f32_16x16x32_bf16 a[240:243], v[252:255], v[208:211], a[240:243]
    v_mfma_f32_16x16x32_bf16 a[236:239], v[252:255], v[204:207], a[236:239]
    v_mfma_f32_16x16x32_bf16 a[232:235], v[252:255], v[200:203], a[232:235]
    v_mfma_f32_16x16x32_bf16 a[228:231], v[252:255], v[196:199], a[228:231]
    buffer_load_dwordx4 v11, s[20:23], s63 offen offset:3072  lds
    v_mfma_f32_16x16x32_bf16 a[224:227], v[252:255], v[192:195], a[224:227]
    s_waitcnt lgkmcnt(0)
    v_add_u32 v8, 128, v8
    v_mfma_f32_16x16x32_bf16 a[0:3], v[160:163], v[128:131], a[0:3]
    v_add_u32 v9, 128, v9
    v_mfma_f32_16x16x32_bf16 a[4:7], v[160:163], v[132:135], a[4:7]
    ds_read_b128 v[192:195], v13 offset:32768
    v_add_u32 v10, s66, v10
    v_mfma_f32_16x16x32_bf16 a[8:11], v[160:163], v[136:139], a[8:11]
    v_add_u32 v11, s66, v11
    v_mfma_f32_16x16x32_bf16 a[12:15], v[160:163], v[140:143], a[12:15]
    ds_read_b64_tr_b16 v[224:225], v24 offset:40960
    v_mfma_f32_16x16x32_bf16 a[16:19], v[160:163], v[144:147], a[16:19]
    buffer_load_dword v3, v14, s[16:19], 0 offen
    v_mfma_f32_16x16x32_bf16 a[20:23], v[160:163], v[148:151], a[20:23]
    ds_read_b64_tr_b16 v[226:227], v24 offset:41984
    v_mfma_f32_16x16x32_bf16 a[24:27], v[160:163], v[152:155], a[24:27]
    buffer_load_dword v3, v15, s[20:23], 0 offen
    v_mfma_f32_16x16x32_bf16 a[28:31], v[160:163], v[156:159], a[28:31]
    ds_read_b128 v[196:199], v13 offset:34816
    v_mfma_f32_16x16x32_bf16 a[60:63], v[164:167], v[156:159], a[60:63]
    v_add_u32 v14, 128, v14
    v_mfma_f32_16x16x32_bf16 a[56:59], v[164:167], v[152:155], a[56:59]
    ds_read_b64_tr_b16 v[228:229], v25 offset:40960
    v_mfma_f32_16x16x32_bf16 a[52:55], v[164:167], v[148:151], a[52:55]
    v_add_u32 v15, s66, v15
    v_mfma_f32_16x16x32_bf16 a[48:51], v[164:167], v[144:147], a[48:51]
    ds_read_b64_tr_b16 v[230:231], v25 offset:41984
    v_mfma_f32_16x16x32_bf16 a[44:47], v[164:167], v[140:143], a[44:47]
    v_mfma_f32_16x16x32_bf16 a[40:43], v[164:167], v[136:139], a[40:43]
    ds_read_b128 v[200:203], v13 offset:36864
    v_mfma_f32_16x16x32_bf16 a[36:39], v[164:167], v[132:135], a[36:39]
    s_add_u32 s72, s70, 0
    s_add_u32 s72, s72, s75
    v_mfma_f32_16x16x32_bf16 a[32:35], v[164:167], v[128:131], a[32:35]
    ds_read_b64_tr_b16 v[232:233], v26 offset:40960
    buffer_store_dwordx4 v[60:63], v2, s[24:27], s72 offen offset:3072 sc1
    v_mfma_f32_16x16x32_bf16 a[64:67], v[168:171], v[128:131], a[64:67]
    v_mfma_f32_16x16x32_bf16 a[68:71], v[168:171], v[132:135], a[68:71]
    ds_read_b64_tr_b16 v[234:235], v26 offset:41984
    v_mfma_f32_16x16x32_bf16 a[72:75], v[168:171], v[136:139], a[72:75]
    v_mfma_f32_16x16x32_bf16 a[76:79], v[168:171], v[140:143], a[76:79]
    ds_read_b128 v[204:207], v13 offset:38912
    v_mfma_f32_16x16x32_bf16 a[80:83], v[168:171], v[144:147], a[80:83]
    v_mfma_f32_16x16x32_bf16 a[84:87], v[168:171], v[148:151], a[84:87]
    ds_read_b64_tr_b16 v[236:237], v27 offset:40960
    v_mfma_f32_16x16x32_bf16 a[88:91], v[168:171], v[152:155], a[88:91]
    s_add_u32 s72, s70, 16384
    v_mfma_f32_16x16x32_bf16 a[92:95], v[168:171], v[156:159], a[92:95]
    ds_read_b64_tr_b16 v[238:239], v27 offset:41984
    buffer_store_dwordx4 v[64:67], v2, s[24:27], s72 offen offset:0 sc1
    v_mfma_f32_16x16x32_bf16 a[124:127], v[172:175], v[156:159], a[124:127]
    v_mfma_f32_16x16x32_bf16 a[120:123], v[172:175], v[152:155], a[120:123]
    ds_read_b128 v[208:211], v13 offset:40960
    v_mfma_f32_16x16x32_bf16 a[116:119], v[172:175], v[148:151], a[116:119]
    v_mfma_f32_16x16x32_bf16 a[112:115], v[172:175], v[144:147], a[112:115]
    ds_read_b64_tr_b16 v[240:241], v28 offset:40960
    v_mfma_f32_16x16x32_bf16 a[108:111], v[172:175], v[140:143], a[108:111]
    v_mfma_f32_16x16x32_bf16 a[104:107], v[172:175], v[136:139], a[104:107]
    ds_read_b64_tr_b16 v[242:243], v28 offset:41984
    v_mfma_f32_16x16x32_bf16 a[100:103], v[172:175], v[132:135], a[100:103]
    s_add_u32 s72, s70, 16384
    v_mfma_f32_16x16x32_bf16 a[96:99], v[172:175], v[128:131], a[96:99]
    ds_read_b128 v[212:215], v13 offset:43008
    buffer_store_dwordx4 v[68:71], v2, s[24:27], s72 offen offset:1024 sc1
    v_mfma_f32_16x16x32_bf16 a[128:131], v[176:179], v[128:131], a[128:131]
    v_mfma_f32_16x16x32_bf16 a[132:135], v[176:179], v[132:135], a[132:135]
    ds_read_b64_tr_b16 v[244:245], v29 offset:40960
    v_mfma_f32_16x16x32_bf16 a[136:139], v[176:179], v[136:139], a[136:139]
    v_mfma_f32_16x16x32_bf16 a[140:143], v[176:179], v[140:143], a[140:143]
    ds_read_b64_tr_b16 v[246:247], v29 offset:41984
    v_mfma_f32_16x16x32_bf16 a[144:147], v[176:179], v[144:147], a[144:147]
    v_mfma_f32_16x16x32_bf16 a[148:151], v[176:179], v[148:151], a[148:151]
    ds_read_b128 v[216:219], v13 offset:45056
    v_mfma_f32_16x16x32_bf16 a[152:155], v[176:179], v[152:155], a[152:155]
    s_add_u32 s72, s70, 16384
    v_mfma_f32_16x16x32_bf16 a[156:159], v[176:179], v[156:159], a[156:159]
    ds_read_b64_tr_b16 v[248:249], v30 offset:40960
    buffer_store_dwordx4 v[72:75], v2, s[24:27], s72 offen offset:2048 sc1
    v_mfma_f32_16x16x32_bf16 a[188:191], v[180:183], v[156:159], a[188:191]
    v_mfma_f32_16x16x32_bf16 a[184:187], v[180:183], v[152:155], a[184:187]
    ds_read_b64_tr_b16 v[250:251], v30 offset:41984
    v_mfma_f32_16x16x32_bf16 a[180:183], v[180:183], v[148:151], a[180:183]
    v_mfma_f32_16x16x32_bf16 a[176:179], v[180:183], v[144:147], a[176:179]
    ds_read_b128 v[220:223], v13 offset:47104
    v_mfma_f32_16x16x32_bf16 a[172:175], v[180:183], v[140:143], a[172:175]
    v_mfma_f32_16x16x32_bf16 a[168:171], v[180:183], v[136:139], a[168:171]
    ds_read_b64_tr_b16 v[252:253], v31 offset:40960
    v_mfma_f32_16x16x32_bf16 a[164:167], v[180:183], v[132:135], a[164:167]
    v_mfma_f32_16x16x32_bf16 a[160:163], v[180:183], v[128:131], a[160:163]
    ds_read_b64_tr_b16 v[254:255], v31 offset:41984
    v_mfma_f32_16x16x32_bf16 a[192:195], v[184:187], v[128:131], a[192:195]
    v_mfma_f32_16x16x32_bf16 a[196:199], v[184:187], v[132:135], a[196:199]
    v_mfma_f32_16x16x32_bf16 a[200:203], v[184:187], v[136:139], a[200:203]
    v_mfma_f32_16x16x32_bf16 a[204:207], v[184:187], v[140:143], a[204:207]
    v_mfma_f32_16x16x32_bf16 a[208:211], v[184:187], v[144:147], a[208:211]
    v_mfma_f32_16x16x32_bf16 a[212:215], v[184:187], v[148:151], a[212:215]
    v_mfma_f32_16x16x32_bf16 a[216:219], v[184:187], v[152:155], a[216:219]
    v_mfma_f32_16x16x32_bf16 a[220:223], v[184:187], v[156:159], a[220:223]
    v_mfma_f32_16x16x32_bf16 a[252:255], v[188:191], v[156:159], a[252:255]
    v_mfma_f32_16x16x32_bf16 a[248:251], v[188:191], v[152:155], a[248:251]
    v_mfma_f32_16x16x32_bf16 a[244:247], v[188:191], v[148:151], a[244:247]
    v_mfma_f32_16x16x32_bf16 a[240:243], v[188:191], v[144:147], a[240:243]
    v_mfma_f32_16x16x32_bf16 a[236:239], v[188:191], v[140:143], a[236:239]
    v_mfma_f32_16x16x32_bf16 a[232:235], v[188:191], v[136:139], a[232:235]
    v_mfma_f32_16x16x32_bf16 a[228:231], v[188:191], v[132:135], a[228:231]
    v_mfma_f32_16x16x32_bf16 a[224:227], v[188:191], v[128:131], a[224:227]
    s_waitcnt vmcnt(6) lgkmcnt(0)
    s_barrier
    s_waitcnt lgkmcnt(0)
    v_mfma_f32_16x16x32_bf16 a[0:3], v[224:227], v[192:195], a[0:3]
    v_mfma_f32_16x16x32_bf16 a[4:7], v[224:227], v[196:199], a[4:7]
    ds_read_b128 v[128:131], v12 offset:0
    s_add_u32 m0, s64, 32768
    v_mfma_f32_16x16x32_bf16 a[8:11], v[224:227], v[200:203], a[8:11]
    buffer_load_dwordx4 v8, s[16:19], s48 offen offset:0  lds
    v_mfma_f32_16x16x32_bf16 a[12:15], v[224:227], v[204:207], a[12:15]
    ds_read_b64_tr_b16 v[160:161], v24 offset:0
    v_mfma_f32_16x16x32_bf16 a[16:19], v[224:227], v[208:211], a[16:19]
    v_mfma_f32_16x16x32_bf16 a[20:23], v[224:227], v[212:215], a[20:23]
    ds_read_b64_tr_b16 v[162:163], v24 offset:1024
    v_mfma_f32_16x16x32_bf16 a[24:27], v[224:227], v[216:219], a[24:27]
    buffer_load_dwordx4 v9, s[16:19], s49 offen offset:1024  lds
    v_mfma_f32_16x16x32_bf16 a[28:31], v[224:227], v[220:223], a[28:31]
    ds_read_b128 v[132:135], v12 offset:2048
    v_mfma_f32_16x16x32_bf16 a[60:63], v[228:231], v[220:223], a[60:63]
    v_mfma_f32_16x16x32_bf16 a[56:59], v[228:231], v[216:219], a[56:59]
    ds_read_b64_tr_b16 v[164:165], v25 offset:0
    v_mfma_f32_16x16x32_bf16 a[52:55], v[228:231], v[212:215], a[52:55]
    buffer_load_dwordx4 v8, s[16:19], s50 offen offset:2048  lds
    v_mfma_f32_16x16x32_bf16 a[48:51], v[228:231], v[208:211], a[48:51]
    ds_read_b64_tr_b16 v[166:167], v25 offset:1024
    v_mfma_f32_16x16x32_bf16 a[44:47], v[228:231], v[204:207], a[44:47]
    v_mfma_f32_16x16x32_bf16 a[40:43], v[228:231], v[200:203], a[40:43]
    ds_read_b128 v[136:139], v12 offset:4096
    v_mfma_f32_16x16x32_bf16 a[36:39], v[228:231], v[196:199], a[36:39]
    buffer_load_dwordx4 v9, s[16:19], s51 offen offset:3072  lds
    v_mfma_f32_16x16x32_bf16 a[32:35], v[228:231], v[192:195], a[32:35]
    ds_read_b64_tr_b16 v[168:169], v26 offset:0
    v_mfma_f32_16x16x32_bf16 a[64:67], v[232:235], v[192:195], a[64:67]
    v_mfma_f32_16x16x32_bf16 a[68:71], v[232:235], v[196:199], a[68:71]
    ds_read_b64_tr_b16 v[170:171], v26 offset:1024
    s_add_u32 m0, s64, 36864
    v_mfma_f32_16x16x32_bf16 a[72:75], v[232:235], v[200:203], a[72:75]
    buffer_load_dwordx4 v8, s[16:19], s52 offen offset:0  lds
    v_mfma_f32_16x16x32_bf16 a[76:79], v[232:235], v[204:207], a[76:79]
    ds_read_b128 v[140:143], v12 offset:6144
    v_mfma_f32_16x16x32_bf16 a[80:83], v[232:235], v[208:211], a[80:83]
    v_mfma_f32_16x16x32_bf16 a[84:87], v[232:235], v[212:215], a[84:87]
    ds_read_b64_tr_b16 v[172:173], v27 offset:0
    v_mfma_f32_16x16x32_bf16 a[88:91], v[232:235], v[216:219], a[88:91]
    buffer_load_dwordx4 v9, s[16:19], s53 offen offset:1024  lds
    v_mfma_f32_16x16x32_bf16 a[92:95], v[232:235], v[220:223], a[92:95]
    ds_read_b64_tr_b16 v[174:175], v27 offset:1024
    v_mfma_f32_16x16x32_bf16 a[124:127], v[236:239], v[220:223], a[124:127]
    v_mfma_f32_16x16x32_bf16 a[120:123], v[236:239], v[216:219], a[120:123]
    ds_read_b128 v[144:147], v12 offset:8192
    v_mfma_f32_16x16x32_bf16 a[116:119], v[236:239], v[212:215], a[116:119]
    buffer_load_dwordx4 v8, s[16:19], s54 offen offset:2048  lds
    v_mfma_f32_16x16x32_bf16 a[112:115], v[236:239], v[208:211], a[112:115]
    ds_read_b64_tr_b16 v[176:177], v28 offset:0
    v_mfma_f32_16x16x32_bf16 a[108:111], v[236:239], v[204:207], a[108:111]
    v_mfma_f32_16x16x32_bf16 a[104:107], v[236:239], v[200:203], a[104:107]
    ds_read_b64_tr_b16 v[178:179], v28 offset:1024
    v_mfma_f32_16x16x32_bf16 a[100:103], v[236:239], v[196:199], a[100:103]
    buffer_load_dwordx4 v9, s[16:19], s55 offen offset:3072  lds
    v_mfma_f32_16x16x32_bf16 a[96:99], v[236:239], v[192:195], a[96:99]
    ds_read_b128 v[148:151], v12 offset:10240
    v_mfma_f32_16x16x32_bf16 a[128:131], v[240:243], v[192:195], a[128:131]
    v_mfma_f32_16x16x32_bf16 a[132:135], v[240:243], v[196:199], a[132:135]
    ds_read_b64_tr_b16 v[180:181], v29 offset:0
    s_add_u32 m0, s64, 98304
    v_mfma_f32_16x16x32_bf16 a[136:139], v[240:243], v[200:203], a[136:139]
    buffer_load_dwordx4 v10, s[20:23], s56 offen offset:0  lds
    v_mfma_f32_16x16x32_bf16 a[140:143], v[240:243], v[204:207], a[140:143]
    ds_read_b64_tr_b16 v[182:183], v29 offset:1024
    v_mfma_f32_16x16x32_bf16 a[144:147], v[240:243], v[208:211], a[144:147]
    v_mfma_f32_16x16x32_bf16 a[148:151], v[240:243], v[212:215], a[148:151]
    ds_read_b128 v[152:155], v12 offset:12288
    v_mfma_f32_16x16x32_bf16 a[152:155], v[240:243], v[216:219], a[152:155]
    buffer_load_dwordx4 v10, s[20:23], s57 offen offset:1024  lds
    v_mfma_f32_16x16x32_bf16 a[156:159], v[240:243], v[220:223], a[156:159]
    ds_read_b64_tr_b16 v[184:185], v30 offset:0
    v_mfma_f32_16x16x32_bf16 a[188:191], v[244:247], v[220:223], a[188:191]
    v_mfma_f32_16x16x32_bf16 a[184:187], v[244:247], v[216:219], a[184:187]
    ds_read_b64_tr_b16 v[186:187], v30 offset:1024
    v_mfma_f32_16x16x32_bf16 a[180:183], v[244:247], v[212:215], a[180:183]
    buffer_load_dwordx4 v11, s[20:23], s58 offen offset:2048  lds
    v_mfma_f32_16x16x32_bf16 a[176:179], v[244:247], v[208:211], a[176:179]
    ds_read_b128 v[156:159], v12 offset:14336
    v_mfma_f32_16x16x32_bf16 a[172:175], v[244:247], v[204:207], a[172:175]
    v_mfma_f32_16x16x32_bf16 a[168:171], v[244:247], v[200:203], a[168:171]
    ds_read_b64_tr_b16 v[188:189], v31 offset:0
    v_mfma_f32_16x16x32_bf16 a[164:167], v[244:247], v[196:199], a[164:167]
    buffer_load_dwordx4 v11, s[20:23], s59 offen offset:3072  lds
    v_mfma_f32_16x16x32_bf16 a[160:163], v[244:247], v[192:195], a[160:163]
    ds_read_b64_tr_b16 v[190:191], v31 offset:1024
    v_mfma_f32_16x16x32_bf16 a[192:195], v[248:251], v[192:195], a[192:195]
    v_mfma_f32_16x16x32_bf16 a[196:199], v[248:251], v[196:199], a[196:199]
    s_add_u32 m0, s64, 102400
    v_mfma_f32_16x16x32_bf16 a[200:203], v[248:251], v[200:203], a[200:203]
    buffer_load_dwordx4 v10, s[20:23], s60 offen offset:0  lds
    v_mfma_f32_16x16x32_bf16 a[204:207], v[248:251], v[204:207], a[204:207]
    v_mfma_f32_16x16x32_bf16 a[208:211], v[248:251], v[208:211], a[208:211]
    v_mfma_f32_16x16x32_bf16 a[212:215], v[248:251], v[212:215], a[212:215]
    v_mfma_f32_16x16x32_bf16 a[216:219], v[248:251], v[216:219], a[216:219]
    buffer_load_dwordx4 v10, s[20:23], s61 offen offset:1024  lds
    v_mfma_f32_16x16x32_bf16 a[220:223], v[248:251], v[220:223], a[220:223]
    v_mfma_f32_16x16x32_bf16 a[252:255], v[252:255], v[220:223], a[252:255]
    v_mfma_f32_16x16x32_bf16 a[248:251], v[252:255], v[216:219], a[248:251]
    v_mfma_f32_16x16x32_bf16 a[244:247], v[252:255], v[212:215], a[244:247]
    buffer_load_dwordx4 v11, s[20:23], s62 offen offset:2048  lds
    v_mfma_f32_16x16x32_bf16 a[240:243], v[252:255], v[208:211], a[240:243]
    v_mfma_f32_16x16x32_bf16 a[236:239], v[252:255], v[204:207], a[236:239]
    v_mfma_f32_16x16x32_bf16 a[232:235], v[252:255], v[200:203], a[232:235]
    v_mfma_f32_16x16x32_bf16 a[228:231], v[252:255], v[196:199], a[228:231]
    buffer_load_dwordx4 v11, s[20:23], s63 offen offset:3072  lds
    v_mfma_f32_16x16x32_bf16 a[224:227], v[252:255], v[192:195], a[224:227]
    s_waitcnt lgkmcnt(0)
    v_add_u32 v8, 128, v8
    v_mfma_f32_16x16x32_bf16 a[0:3], v[160:163], v[128:131], a[0:3]
    v_add_u32 v9, 128, v9
    v_mfma_f32_16x16x32_bf16 a[4:7], v[160:163], v[132:135], a[4:7]
    ds_read_b128 v[192:195], v13 offset:0
    v_add_u32 v10, s66, v10
    v_mfma_f32_16x16x32_bf16 a[8:11], v[160:163], v[136:139], a[8:11]
    v_add_u32 v11, s66, v11
    v_mfma_f32_16x16x32_bf16 a[12:15], v[160:163], v[140:143], a[12:15]
    ds_read_b64_tr_b16 v[224:225], v24 offset:8192
    v_mfma_f32_16x16x32_bf16 a[16:19], v[160:163], v[144:147], a[16:19]
    v_mfma_f32_16x16x32_bf16 a[20:23], v[160:163], v[148:151], a[20:23]
    ds_read_b64_tr_b16 v[226:227], v24 offset:9216
    v_mfma_f32_16x16x32_bf16 a[24:27], v[160:163], v[152:155], a[24:27]
    v_mfma_f32_16x16x32_bf16 a[28:31], v[160:163], v[156:159], a[28:31]
    ds_read_b128 v[196:199], v13 offset:2048
    v_mfma_f32_16x16x32_bf16 a[60:63], v[164:167], v[156:159], a[60:63]
    v_mfma_f32_16x16x32_bf16 a[56:59], v[164:167], v[152:155], a[56:59]
    ds_read_b64_tr_b16 v[228:229], v25 offset:8192
    v_mfma_f32_16x16x32_bf16 a[52:55], v[164:167], v[148:151], a[52:55]
    v_mfma_f32_16x16x32_bf16 a[48:51], v[164:167], v[144:147], a[48:51]
    ds_read_b64_tr_b16 v[230:231], v25 offset:9216
    v_mfma_f32_16x16x32_bf16 a[44:47], v[164:167], v[140:143], a[44:47]
    v_mfma_f32_16x16x32_bf16 a[40:43], v[164:167], v[136:139], a[40:43]
    ds_read_b128 v[200:203], v13 offset:4096
    v_mfma_f32_16x16x32_bf16 a[36:39], v[164:167], v[132:135], a[36:39]
    s_add_u32 s72, s70, 16384
    v_mfma_f32_16x16x32_bf16 a[32:35], v[164:167], v[128:131], a[32:35]
    ds_read_b64_tr_b16 v[232:233], v26 offset:8192
    buffer_store_dwordx4 v[76:79], v2, s[24:27], s72 offen offset:3072 sc1
    v_mfma_f32_16x16x32_bf16 a[64:67], v[168:171], v[128:131], a[64:67]
    v_mfma_f32_16x16x32_bf16 a[68:71], v[168:171], v[132:135], a[68:71]
    ds_read_b64_tr_b16 v[234:235], v26 offset:9216
    v_mfma_f32_16x16x32_bf16 a[72:75], v[168:171], v[136:139], a[72:75]
    v_mfma_f32_16x16x32_bf16 a[76:79], v[168:171], v[140:143], a[76:79]
    ds_read_b128 v[204:207], v13 offset:6144
    v_mfma_f32_16x16x32_bf16 a[80:83], v[168:171], v[144:147], a[80:83]
    v_mfma_f32_16x16x32_bf16 a[84:87], v[168:171], v[148:151], a[84:87]
    ds_read_b64_tr_b16 v[236:237], v27 offset:8192
    v_mfma_f32_16x16x32_bf16 a[88:91], v[168:171], v[152:155], a[88:91]
    s_add_u32 s72, s70, 16384
    s_add_u32 s72, s72, s75
    v_mfma_f32_16x16x32_bf16 a[92:95], v[168:171], v[156:159], a[92:95]
    ds_read_b64_tr_b16 v[238:239], v27 offset:9216
    buffer_store_dwordx4 v[80:83], v2, s[24:27], s72 offen offset:0 sc1
    v_mfma_f32_16x16x32_bf16 a[124:127], v[172:175], v[156:159], a[124:127]
    v_mfma_f32_16x16x32_bf16 a[120:123], v[172:175], v[152:155], a[120:123]
    ds_read_b128 v[208:211], v13 offset:8192
    v_mfma_f32_16x16x32_bf16 a[116:119], v[172:175], v[148:151], a[116:119]
    v_mfma_f32_16x16x32_bf16 a[112:115], v[172:175], v[144:147], a[112:115]
    ds_read_b64_tr_b16 v[240:241], v28 offset:8192
    v_mfma_f32_16x16x32_bf16 a[108:111], v[172:175], v[140:143], a[108:111]
    v_mfma_f32_16x16x32_bf16 a[104:107], v[172:175], v[136:139], a[104:107]
    ds_read_b64_tr_b16 v[242:243], v28 offset:9216
    v_mfma_f32_16x16x32_bf16 a[100:103], v[172:175], v[132:135], a[100:103]
    s_add_u32 s72, s70, 16384
    s_add_u32 s72, s72, s75
    v_mfma_f32_16x16x32_bf16 a[96:99], v[172:175], v[128:131], a[96:99]
    ds_read_b128 v[212:215], v13 offset:10240
    buffer_store_dwordx4 v[84:87], v2, s[24:27], s72 offen offset:1024 sc1
    v_mfma_f32_16x16x32_bf16 a[128:131], v[176:179], v[128:131], a[128:131]
    v_mfma_f32_16x16x32_bf16 a[132:135], v[176:179], v[132:135], a[132:135]
    ds_read_b64_tr_b16 v[244:245], v29 offset:8192
    v_mfma_f32_16x16x32_bf16 a[136:139], v[176:179], v[136:139], a[136:139]
    v_mfma_f32_16x16x32_bf16 a[140:143], v[176:179], v[140:143], a[140:143]
    ds_read_b64_tr_b16 v[246:247], v29 offset:9216
    v_mfma_f32_16x16x32_bf16 a[144:147], v[176:179], v[144:147], a[144:147]
    v_mfma_f32_16x16x32_bf16 a[148:151], v[176:179], v[148:151], a[148:151]
    ds_read_b128 v[216:219], v13 offset:12288
    v_mfma_f32_16x16x32_bf16 a[152:155], v[176:179], v[152:155], a[152:155]
    s_add_u32 s72, s70, 16384
    s_add_u32 s72, s72, s75
    v_mfma_f32_16x16x32_bf16 a[156:159], v[176:179], v[156:159], a[156:159]
    ds_read_b64_tr_b16 v[248:249], v30 offset:8192
    buffer_store_dwordx4 v[88:91], v2, s[24:27], s72 offen offset:2048 sc1
    v_mfma_f32_16x16x32_bf16 a[188:191], v[180:183], v[156:159], a[188:191]
    v_mfma_f32_16x16x32_bf16 a[184:187], v[180:183], v[152:155], a[184:187]
    ds_read_b64_tr_b16 v[250:251], v30 offset:9216
    v_mfma_f32_16x16x32_bf16 a[180:183], v[180:183], v[148:151], a[180:183]
    v_mfma_f32_16x16x32_bf16 a[176:179], v[180:183], v[144:147], a[176:179]
    ds_read_b128 v[220:223], v13 offset:14336
    v_mfma_f32_16x16x32_bf16 a[172:175], v[180:183], v[140:143], a[172:175]
    v_mfma_f32_16x16x32_bf16 a[168:171], v[180:183], v[136:139], a[168:171]
    ds_read_b64_tr_b16 v[252:253], v31 offset:8192
    v_mfma_f32_16x16x32_bf16 a[164:167], v[180:183], v[132:135], a[164:167]
    v_mfma_f32_16x16x32_bf16 a[160:163], v[180:183], v[128:131], a[160:163]
    ds_read_b64_tr_b16 v[254:255], v31 offset:9216
    v_mfma_f32_16x16x32_bf16 a[192:195], v[184:187], v[128:131], a[192:195]
    v_mfma_f32_16x16x32_bf16 a[196:199], v[184:187], v[132:135], a[196:199]
    v_mfma_f32_16x16x32_bf16 a[200:203], v[184:187], v[136:139], a[200:203]
    v_mfma_f32_16x16x32_bf16 a[204:207], v[184:187], v[140:143], a[204:207]
    v_mfma_f32_16x16x32_bf16 a[208:211], v[184:187], v[144:147], a[208:211]
    v_mfma_f32_16x16x32_bf16 a[212:215], v[184:187], v[148:151], a[212:215]
    v_mfma_f32_16x16x32_bf16 a[216:219], v[184:187], v[152:155], a[216:219]
    v_mfma_f32_16x16x32_bf16 a[220:223], v[184:187], v[156:159], a[220:223]
    v_mfma_f32_16x16x32_bf16 a[252:255], v[188:191], v[156:159], a[252:255]
    v_mfma_f32_16x16x32_bf16 a[248:251], v[188:191], v[152:155], a[248:251]
    v_mfma_f32_16x16x32_bf16 a[244:247], v[188:191], v[148:151], a[244:247]
    v_mfma_f32_16x16x32_bf16 a[240:243], v[188:191], v[144:147], a[240:243]
    v_mfma_f32_16x16x32_bf16 a[236:239], v[188:191], v[140:143], a[236:239]
    v_mfma_f32_16x16x32_bf16 a[232:235], v[188:191], v[136:139], a[232:235]
    v_mfma_f32_16x16x32_bf16 a[228:231], v[188:191], v[132:135], a[228:231]
    v_mfma_f32_16x16x32_bf16 a[224:227], v[188:191], v[128:131], a[224:227]
    s_waitcnt vmcnt(4) lgkmcnt(0)
    s_barrier
    s_waitcnt lgkmcnt(0)
    v_mfma_f32_16x16x32_bf16 a[0:3], v[224:227], v[192:195], a[0:3]
    v_mfma_f32_16x16x32_bf16 a[4:7], v[224:227], v[196:199], a[4:7]
    ds_read_b128 v[128:131], v12 offset:32768
    s_add_u32 m0, s64, 0
    v_mfma_f32_16x16x32_bf16 a[8:11], v[224:227], v[200:203], a[8:11]
    buffer_load_dwordx4 v8, s[16:19], s48 offen offset:0  lds
    v_mfma_f32_16x16x32_bf16 a[12:15], v[224:227], v[204:207], a[12:15]
    ds_read_b64_tr_b16 v[160:161], v24 offset:32768
    v_mfma_f32_16x16x32_bf16 a[16:19], v[224:227], v[208:211], a[16:19]
    v_mfma_f32_16x16x32_bf16 a[20:23], v[224:227], v[212:215], a[20:23]
    ds_read_b64_tr_b16 v[162:163], v24 offset:33792
    v_mfma_f32_16x16x32_bf16 a[24:27], v[224:227], v[216:219], a[24:27]
    buffer_load_dwordx4 v9, s[16:19], s49 offen offset:1024  lds
    v_mfma_f32_16x16x32_bf16 a[28:31], v[224:227], v[220:223], a[28:31]
    ds_read_b128 v[132:135], v12 offset:34816
    v_mfma_f32_16x16x32_bf16 a[60:63], v[228:231], v[220:223], a[60:63]
    v_mfma_f32_16x16x32_bf16 a[56:59], v[228:231], v[216:219], a[56:59]
    ds_read_b64_tr_b16 v[164:165], v25 offset:32768
    v_mfma_f32_16x16x32_bf16 a[52:55], v[228:231], v[212:215], a[52:55]
    buffer_load_dwordx4 v8, s[16:19], s50 offen offset:2048  lds
    v_mfma_f32_16x16x32_bf16 a[48:51], v[228:231], v[208:211], a[48:51]
    ds_read_b64_tr_b16 v[166:167], v25 offset:33792
    v_mfma_f32_16x16x32_bf16 a[44:47], v[228:231], v[204:207], a[44:47]
    v_mfma_f32_16x16x32_bf16 a[40:43], v[228:231], v[200:203], a[40:43]
    ds_read_b128 v[136:139], v12 offset:36864
    v_mfma_f32_16x16x32_bf16 a[36:39], v[228:231], v[196:199], a[36:39]
    buffer_load_dwordx4 v9, s[16:19], s51 offen offset:3072  lds
    v_mfma_f32_16x16x32_bf16 a[32:35], v[228:231], v[192:195], a[32:35]
    ds_read_b64_tr_b16 v[168:169], v26 offset:32768
    v_mfma_f32_16x16x32_bf16 a[64:67], v[232:235], v[192:195], a[64:67]
    v_mfma_f32_16x16x32_bf16 a[68:71], v[232:235], v[196:199], a[68:71]
    ds_read_b64_tr_b16 v[170:171], v26 offset:33792
    s_add_u32 m0, s64, 4096
    v_mfma_f32_16x16x32_bf16 a[72:75], v[232:235], v[200:203], a[72:75]
    buffer_load_dwordx4 v8, s[16:19], s52 offen offset:0  lds
    v_mfma_f32_16x16x32_bf16 a[76:79], v[232:235], v[204:207], a[76:79]
    ds_read_b128 v[140:143], v12 offset:38912
    v_mfma_f32_16x16x32_bf16 a[80:83], v[232:235], v[208:211], a[80:83]
    v_mfma_f32_16x16x32_bf16 a[84:87], v[232:235], v[212:215], a[84:87]
    ds_read_b64_tr_b16 v[172:173], v27 offset:32768
    v_mfma_f32_16x16x32_bf16 a[88:91], v[232:235], v[216:219], a[88:91]
    buffer_load_dwordx4 v9, s[16:19], s53 offen offset:1024  lds
    v_mfma_f32_16x16x32_bf16 a[92:95], v[232:235], v[220:223], a[92:95]
    ds_read_b64_tr_b16 v[174:175], v27 offset:33792
    v_mfma_f32_16x16x32_bf16 a[124:127], v[236:239], v[220:223], a[124:127]
    v_mfma_f32_16x16x32_bf16 a[120:123], v[236:239], v[216:219], a[120:123]
    ds_read_b128 v[144:147], v12 offset:40960
    v_mfma_f32_16x16x32_bf16 a[116:119], v[236:239], v[212:215], a[116:119]
    buffer_load_dwordx4 v8, s[16:19], s54 offen offset:2048  lds
    v_mfma_f32_16x16x32_bf16 a[112:115], v[236:239], v[208:211], a[112:115]
    ds_read_b64_tr_b16 v[176:177], v28 offset:32768
    v_mfma_f32_16x16x32_bf16 a[108:111], v[236:239], v[204:207], a[108:111]
    v_mfma_f32_16x16x32_bf16 a[104:107], v[236:239], v[200:203], a[104:107]
    ds_read_b64_tr_b16 v[178:179], v28 offset:33792
    v_mfma_f32_16x16x32_bf16 a[100:103], v[236:239], v[196:199], a[100:103]
    buffer_load_dwordx4 v9, s[16:19], s55 offen offset:3072  lds
    v_mfma_f32_16x16x32_bf16 a[96:99], v[236:239], v[192:195], a[96:99]
    ds_read_b128 v[148:151], v12 offset:43008
    v_mfma_f32_16x16x32_bf16 a[128:131], v[240:243], v[192:195], a[128:131]
    v_mfma_f32_16x16x32_bf16 a[132:135], v[240:243], v[196:199], a[132:135]
    ds_read_b64_tr_b16 v[180:181], v29 offset:32768
    s_add_u32 m0, s64, 65536
    v_mfma_f32_16x16x32_bf16 a[136:139], v[240:243], v[200:203], a[136:139]
    buffer_load_dwordx4 v10, s[20:23], s56 offen offset:0  lds
    v_mfma_f32_16x16x32_bf16 a[140:143], v[240:243], v[204:207], a[140:143]
    ds_read_b64_tr_b16 v[182:183], v29 offset:33792
    v_mfma_f32_16x16x32_bf16 a[144:147], v[240:243], v[208:211], a[144:147]
    v_mfma_f32_16x16x32_bf16 a[148:151], v[240:243], v[212:215], a[148:151]
    ds_read_b128 v[152:155], v12 offset:45056
    v_mfma_f32_16x16x32_bf16 a[152:155], v[240:243], v[216:219], a[152:155]
    buffer_load_dwordx4 v10, s[20:23], s57 offen offset:1024  lds
    v_mfma_f32_16x16x32_bf16 a[156:159], v[240:243], v[220:223], a[156:159]
    ds_read_b64_tr_b16 v[184:185], v30 offset:32768
    v_mfma_f32_16x16x32_bf16 a[188:191], v[244:247], v[220:223], a[188:191]
    v_mfma_f32_16x16x32_bf16 a[184:187], v[244:247], v[216:219], a[184:187]
    ds_read_b64_tr_b16 v[186:187], v30 offset:33792
    v_mfma_f32_16x16x32_bf16 a[180:183], v[244:247], v[212:215], a[180:183]
    buffer_load_dwordx4 v11, s[20:23], s58 offen offset:2048  lds
    v_mfma_f32_16x16x32_bf16 a[176:179], v[244:247], v[208:211], a[176:179]
    ds_read_b128 v[156:159], v12 offset:47104
    v_mfma_f32_16x16x32_bf16 a[172:175], v[244:247], v[204:207], a[172:175]
    v_mfma_f32_16x16x32_bf16 a[168:171], v[244:247], v[200:203], a[168:171]
    ds_read_b64_tr_b16 v[188:189], v31 offset:32768
    v_mfma_f32_16x16x32_bf16 a[164:167], v[244:247], v[196:199], a[164:167]
    buffer_load_dwordx4 v11, s[20:23], s59 offen offset:3072  lds
    v_mfma_f32_16x16x32_bf16 a[160:163], v[244:247], v[192:195], a[160:163]
    ds_read_b64_tr_b16 v[190:191], v31 offset:33792
    v_mfma_f32_16x16x32_bf16 a[192:195], v[248:251], v[192:195], a[192:195]
    v_mfma_f32_16x16x32_bf16 a[196:199], v[248:251], v[196:199], a[196:199]
    s_add_u32 m0, s64, 69632
    v_mfma_f32_16x16x32_bf16 a[200:203], v[248:251], v[200:203], a[200:203]
    buffer_load_dwordx4 v10, s[20:23], s60 offen offset:0  lds
    v_mfma_f32_16x16x32_bf16 a[204:207], v[248:251], v[204:207], a[204:207]
    v_mfma_f32_16x16x32_bf16 a[208:211], v[248:251], v[208:211], a[208:211]
    v_mfma_f32_16x16x32_bf16 a[212:215], v[248:251], v[212:215], a[212:215]
    v_mfma_f32_16x16x32_bf16 a[216:219], v[248:251], v[216:219], a[216:219]
    buffer_load_dwordx4 v10, s[20:23], s61 offen offset:1024  lds
    v_mfma_f32_16x16x32_bf16 a[220:223], v[248:251], v[220:223], a[220:223]
    v_mfma_f32_16x16x32_bf16 a[252:255], v[252:255], v[220:223], a[252:255]
    v_mfma_f32_16x16x32_bf16 a[248:251], v[252:255], v[216:219], a[248:251]
    v_mfma_f32_16x16x32_bf16 a[244:247], v[252:255], v[212:215], a[244:247]
    buffer_load_dwordx4 v11, s[20:23], s62 offen offset:2048  lds
    v_mfma_f32_16x16x32_bf16 a[240:243], v[252:255], v[208:211], a[240:243]
    v_mfma_f32_16x16x32_bf16 a[236:239], v[252:255], v[204:207], a[236:239]
    v_mfma_f32_16x16x32_bf16 a[232:235], v[252:255], v[200:203], a[232:235]
    v_mfma_f32_16x16x32_bf16 a[228:231], v[252:255], v[196:199], a[228:231]
    buffer_load_dwordx4 v11, s[20:23], s63 offen offset:3072  lds
    v_mfma_f32_16x16x32_bf16 a[224:227], v[252:255], v[192:195], a[224:227]
    s_waitcnt lgkmcnt(0)
    v_add_u32 v8, 128, v8
    v_mfma_f32_16x16x32_bf16 a[0:3], v[160:163], v[128:131], a[0:3]
    v_add_u32 v9, 128, v9
    v_mfma_f32_16x16x32_bf16 a[4:7], v[160:163], v[132:135], a[4:7]
    ds_read_b128 v[192:195], v13 offset:32768
    v_add_u32 v10, s66, v10
    v_mfma_f32_16x16x32_bf16 a[8:11], v[160:163], v[136:139], a[8:11]
    v_add_u32 v11, s66, v11
    v_mfma_f32_16x16x32_bf16 a[12:15], v[160:163], v[140:143], a[12:15]
    ds_read_b64_tr_b16 v[224:225], v24 offset:40960
    v_mfma_f32_16x16x32_bf16 a[16:19], v[160:163], v[144:147], a[16:19]
    v_mfma_f32_16x16x32_bf16 a[20:23], v[160:163], v[148:151], a[20:23]
    ds_read_b64_tr_b16 v[226:227], v24 offset:41984
    v_mfma_f32_16x16x32_bf16 a[24:27], v[160:163], v[152:155], a[24:27]
    v_mfma_f32_16x16x32_bf16 a[28:31], v[160:163], v[156:159], a[28:31]
    ds_read_b128 v[196:199], v13 offset:34816
    v_mfma_f32_16x16x32_bf16 a[60:63], v[164:167], v[156:159], a[60:63]
    v_mfma_f32_16x16x32_bf16 a[56:59], v[164:167], v[152:155], a[56:59]
    ds_read_b64_tr_b16 v[228:229], v25 offset:40960
    v_mfma_f32_16x16x32_bf16 a[52:55], v[164:167], v[148:151], a[52:55]
    v_mfma_f32_16x16x32_bf16 a[48:51], v[164:167], v[144:147], a[48:51]
    ds_read_b64_tr_b16 v[230:231], v25 offset:41984
    v_mfma_f32_16x16x32_bf16 a[44:47], v[164:167], v[140:143], a[44:47]
    v_mfma_f32_16x16x32_bf16 a[40:43], v[164:167], v[136:139], a[40:43]
    ds_read_b128 v[200:203], v13 offset:36864
    v_mfma_f32_16x16x32_bf16 a[36:39], v[164:167], v[132:135], a[36:39]
    s_add_u32 s72, s70, 16384
    s_add_u32 s72, s72, s75
    v_mfma_f32_16x16x32_bf16 a[32:35], v[164:167], v[128:131], a[32:35]
    ds_read_b64_tr_b16 v[232:233], v26 offset:40960
    buffer_store_dwordx4 v[92:95], v2, s[24:27], s72 offen offset:3072 sc1
    v_mfma_f32_16x16x32_bf16 a[64:67], v[168:171], v[128:131], a[64:67]
    v_mfma_f32_16x16x32_bf16 a[68:71], v[168:171], v[132:135], a[68:71]
    ds_read_b64_tr_b16 v[234:235], v26 offset:41984
    v_mfma_f32_16x16x32_bf16 a[72:75], v[168:171], v[136:139], a[72:75]
    v_mfma_f32_16x16x32_bf16 a[76:79], v[168:171], v[140:143], a[76:79]
    ds_read_b128 v[204:207], v13 offset:38912
    v_mfma_f32_16x16x32_bf16 a[80:83], v[168:171], v[144:147], a[80:83]
    v_mfma_f32_16x16x32_bf16 a[84:87], v[168:171], v[148:151], a[84:87]
    ds_read_b64_tr_b16 v[236:237], v27 offset:40960
    v_mfma_f32_16x16x32_bf16 a[88:91], v[168:171], v[152:155], a[88:91]
    s_add_u32 s72, s70, 32768
    v_mfma_f32_16x16x32_bf16 a[92:95], v[168:171], v[156:159], a[92:95]
    ds_read_b64_tr_b16 v[238:239], v27 offset:41984
    buffer_store_dwordx4 v[96:99], v2, s[24:27], s72 offen offset:0 sc1
    v_mfma_f32_16x16x32_bf16 a[124:127], v[172:175], v[156:159], a[124:127]
    v_mfma_f32_16x16x32_bf16 a[120:123], v[172:175], v[152:155], a[120:123]
    ds_read_b128 v[208:211], v13 offset:40960
    v_mfma_f32_16x16x32_bf16 a[116:119], v[172:175], v[148:151], a[116:119]
    v_mfma_f32_16x16x32_bf16 a[112:115], v[172:175], v[144:147], a[112:115]
    ds_read_b64_tr_b16 v[240:241], v28 offset:40960
    v_mfma_f32_16x16x32_bf16 a[108:111], v[172:175], v[140:143], a[108:111]
    v_mfma_f32_16x16x32_bf16 a[104:107], v[172:175], v[136:139], a[104:107]
    ds_read_b64_tr_b16 v[242:243], v28 offset:41984
    v_mfma_f32_16x16x32_bf16 a[100:103], v[172:175], v[132:135], a[100:103]
    s_add_u32 s72, s70, 32768
    v_mfma_f32_16x16x32_bf16 a[96:99], v[172:175], v[128:131], a[96:99]
    ds_read_b128 v[212:215], v13 offset:43008
    buffer_store_dwordx4 v[100:103], v2, s[24:27], s72 offen offset:1024 sc1
    v_mfma_f32_16x16x32_bf16 a[128:131], v[176:179], v[128:131], a[128:131]
    v_mfma_f32_16x16x32_bf16 a[132:135], v[176:179], v[132:135], a[132:135]
    ds_read_b64_tr_b16 v[244:245], v29 offset:40960
    v_mfma_f32_16x16x32_bf16 a[136:139], v[176:179], v[136:139], a[136:139]
    v_mfma_f32_16x16x32_bf16 a[140:143], v[176:179], v[140:143], a[140:143]
    ds_read_b64_tr_b16 v[246:247], v29 offset:41984
    v_mfma_f32_16x16x32_bf16 a[144:147], v[176:179], v[144:147], a[144:147]
    v_mfma_f32_16x16x32_bf16 a[148:151], v[176:179], v[148:151], a[148:151]
    ds_read_b128 v[216:219], v13 offset:45056
    v_mfma_f32_16x16x32_bf16 a[152:155], v[176:179], v[152:155], a[152:155]
    s_add_u32 s72, s70, 32768
    v_mfma_f32_16x16x32_bf16 a[156:159], v[176:179], v[156:159], a[156:159]
    ds_read_b64_tr_b16 v[248:249], v30 offset:40960
    buffer_store_dwordx4 v[104:107], v2, s[24:27], s72 offen offset:2048 sc1
    v_mfma_f32_16x16x32_bf16 a[188:191], v[180:183], v[156:159], a[188:191]
    v_mfma_f32_16x16x32_bf16 a[184:187], v[180:183], v[152:155], a[184:187]
    ds_read_b64_tr_b16 v[250:251], v30 offset:41984
    v_mfma_f32_16x16x32_bf16 a[180:183], v[180:183], v[148:151], a[180:183]
    v_mfma_f32_16x16x32_bf16 a[176:179], v[180:183], v[144:147], a[176:179]
    ds_read_b128 v[220:223], v13 offset:47104
    v_mfma_f32_16x16x32_bf16 a[172:175], v[180:183], v[140:143], a[172:175]
    v_mfma_f32_16x16x32_bf16 a[168:171], v[180:183], v[136:139], a[168:171]
    ds_read_b64_tr_b16 v[252:253], v31 offset:40960
    v_mfma_f32_16x16x32_bf16 a[164:167], v[180:183], v[132:135], a[164:167]
    v_mfma_f32_16x16x32_bf16 a[160:163], v[180:183], v[128:131], a[160:163]
    ds_read_b64_tr_b16 v[254:255], v31 offset:41984
    v_mfma_f32_16x16x32_bf16 a[192:195], v[184:187], v[128:131], a[192:195]
    v_mfma_f32_16x16x32_bf16 a[196:199], v[184:187], v[132:135], a[196:199]
    v_mfma_f32_16x16x32_bf16 a[200:203], v[184:187], v[136:139], a[200:203]
    v_mfma_f32_16x16x32_bf16 a[204:207], v[184:187], v[140:143], a[204:207]
    v_mfma_f32_16x16x32_bf16 a[208:211], v[184:187], v[144:147], a[208:211]
    v_mfma_f32_16x16x32_bf16 a[212:215], v[184:187], v[148:151], a[212:215]
    v_mfma_f32_16x16x32_bf16 a[216:219], v[184:187], v[152:155], a[216:219]
    v_mfma_f32_16x16x32_bf16 a[220:223], v[184:187], v[156:159], a[220:223]
    v_mfma_f32_16x16x32_bf16 a[252:255], v[188:191], v[156:159], a[252:255]
    v_mfma_f32_16x16x32_bf16 a[248:251], v[188:191], v[152:155], a[248:251]
    v_mfma_f32_16x16x32_bf16 a[244:247], v[188:191], v[148:151], a[244:247]
    v_mfma_f32_16x16x32_bf16 a[240:243], v[188:191], v[144:147], a[240:243]
    v_mfma_f32_16x16x32_bf16 a[236:239], v[188:191], v[140:143], a[236:239]
    v_mfma_f32_16x16x32_bf16 a[232:235], v[188:191], v[136:139], a[232:235]
    v_mfma_f32_16x16x32_bf16 a[228:231], v[188:191], v[132:135], a[228:231]
    v_mfma_f32_16x16x32_bf16 a[224:227], v[188:191], v[128:131], a[224:227]
    s_waitcnt vmcnt(4) lgkmcnt(0)
    s_barrier
    s_waitcnt lgkmcnt(0)
    v_mfma_f32_16x16x32_bf16 a[0:3], v[224:227], v[192:195], a[0:3]
    v_mfma_f32_16x16x32_bf16 a[4:7], v[224:227], v[196:199], a[4:7]
    ds_read_b128 v[128:131], v12 offset:0
    v_mfma_f32_16x16x32_bf16 a[8:11], v[224:227], v[200:203], a[8:11]
    v_mfma_f32_16x16x32_bf16 a[12:15], v[224:227], v[204:207], a[12:15]
    ds_read_b64_tr_b16 v[160:161], v24 offset:0
    v_mfma_f32_16x16x32_bf16 a[16:19], v[224:227], v[208:211], a[16:19]
    v_mfma_f32_16x16x32_bf16 a[20:23], v[224:227], v[212:215], a[20:23]
    ds_read_b64_tr_b16 v[162:163], v24 offset:1024
    v_mfma_f32_16x16x32_bf16 a[24:27], v[224:227], v[216:219], a[24:27]
    v_mfma_f32_16x16x32_bf16 a[28:31], v[224:227], v[220:223], a[28:31]
    ds_read_b128 v[132:135], v12 offset:2048
    v_mfma_f32_16x16x32_bf16 a[60:63], v[228:231], v[220:223], a[60:63]
    v_mfma_f32_16x16x32_bf16 a[56:59], v[228:231], v[216:219], a[56:59]
    ds_read_b64_tr_b16 v[164:165], v25 offset:0
    v_mfma_f32_16x16x32_bf16 a[52:55], v[228:231], v[212:215], a[52:55]
    v_mfma_f32_16x16x32_bf16 a[48:51], v[228:231], v[208:211], a[48:51]
    ds_read_b64_tr_b16 v[166:167], v25 offset:1024
    v_mfma_f32_16x16x32_bf16 a[44:47], v[228:231], v[204:207], a[44:47]
    v_mfma_f32_16x16x32_bf16 a[40:43], v[228:231], v[200:203], a[40:43]
    ds_read_b128 v[136:139], v12 offset:4096
    v_mfma_f32_16x16x32_bf16 a[36:39], v[228:231], v[196:199], a[36:39]
    v_mfma_f32_16x16x32_bf16 a[32:35], v[228:231], v[192:195], a[32:35]
    ds_read_b64_tr_b16 v[168:169], v26 offset:0
    v_mfma_f32_16x16x32_bf16 a[64:67], v[232:235], v[192:195], a[64:67]
    v_mfma_f32_16x16x32_bf16 a[68:71], v[232:235], v[196:199], a[68:71]
    ds_read_b64_tr_b16 v[170:171], v26 offset:1024
    v_mfma_f32_16x16x32_bf16 a[72:75], v[232:235], v[200:203], a[72:75]
    v_mfma_f32_16x16x32_bf16 a[76:79], v[232:235], v[204:207], a[76:79]
    ds_read_b128 v[140:143], v12 offset:6144
    v_mfma_f32_16x16x32_bf16 a[80:83], v[232:235], v[208:211], a[80:83]
    v_mfma_f32_16x16x32_bf16 a[84:87], v[232:235], v[212:215], a[84:87]
    ds_read_b64_tr_b16 v[172:173], v27 offset:0
    v_mfma_f32_16x16x32_bf16 a[88:91], v[232:235], v[216:219], a[88:91]
    v_mfma_f32_16x16x32_bf16 a[92:95], v[232:235], v[220:223], a[92:95]
    ds_read_b64_tr_b16 v[174:175], v27 offset:1024
    v_mfma_f32_16x16x32_bf16 a[124:127], v[236:239], v[220:223], a[124:127]
    v_mfma_f32_16x16x32_bf16 a[120:123], v[236:239], v[216:219], a[120:123]
    ds_read_b128 v[144:147], v12 offset:8192
    v_mfma_f32_16x16x32_bf16 a[116:119], v[236:239], v[212:215], a[116:119]
    v_mfma_f32_16x16x32_bf16 a[112:115], v[236:239], v[208:211], a[112:115]
    ds_read_b64_tr_b16 v[176:177], v28 offset:0
    v_mfma_f32_16x16x32_bf16 a[108:111], v[236:239], v[204:207], a[108:111]
    v_mfma_f32_16x16x32_bf16 a[104:107], v[236:239], v[200:203], a[104:107]
    ds_read_b64_tr_b16 v[178:179], v28 offset:1024
    v_mfma_f32_16x16x32_bf16 a[100:103], v[236:239], v[196:199], a[100:103]
    v_mfma_f32_16x16x32_bf16 a[96:99], v[236:239], v[192:195], a[96:99]
    ds_read_b128 v[148:151], v12 offset:10240
    v_mfma_f32_16x16x32_bf16 a[128:131], v[240:243], v[192:195], a[128:131]
    v_mfma_f32_16x16x32_bf16 a[132:135], v[240:243], v[196:199], a[132:135]
    ds_read_b64_tr_b16 v[180:181], v29 offset:0
    v_mfma_f32_16x16x32_bf16 a[136:139], v[240:243], v[200:203], a[136:139]
    v_mfma_f32_16x16x32_bf16 a[140:143], v[240:243], v[204:207], a[140:143]
    ds_read_b64_tr_b16 v[182:183], v29 offset:1024
    v_mfma_f32_16x16x32_bf16 a[144:147], v[240:243], v[208:211], a[144:147]
    v_mfma_f32_16x16x32_bf16 a[148:151], v[240:243], v[212:215], a[148:151]
    ds_read_b128 v[152:155], v12 offset:12288
    v_mfma_f32_16x16x32_bf16 a[152:155], v[240:243], v[216:219], a[152:155]
    v_mfma_f32_16x16x32_bf16 a[156:159], v[240:243], v[220:223], a[156:159]
    ds_read_b64_tr_b16 v[184:185], v30 offset:0
    v_mfma_f32_16x16x32_bf16 a[188:191], v[244:247], v[220:223], a[188:191]
    v_mfma_f32_16x16x32_bf16 a[184:187], v[244:247], v[216:219], a[184:187]
    ds_read_b64_tr_b16 v[186:187], v30 offset:1024
    v_mfma_f32_16x16x32_bf16 a[180:183], v[244:247], v[212:215], a[180:183]
    v_mfma_f32_16x16x32_bf16 a[176:179], v[244:247], v[208:211], a[176:179]
    ds_read_b128 v[156:159], v12 offset:14336
    v_mfma_f32_16x16x32_bf16 a[172:175], v[244:247], v[204:207], a[172:175]
    v_mfma_f32_16x16x32_bf16 a[168:171], v[244:247], v[200:203], a[168:171]
    ds_read_b64_tr_b16 v[188:189], v31 offset:0
    v_mfma_f32_16x16x32_bf16 a[164:167], v[244:247], v[196:199], a[164:167]
    v_mfma_f32_16x16x32_bf16 a[160:163], v[244:247], v[192:195], a[160:163]
    ds_read_b64_tr_b16 v[190:191], v31 offset:1024
    v_mfma_f32_16x16x32_bf16 a[192:195], v[248:251], v[192:195], a[192:195]
    v_mfma_f32_16x16x32_bf16 a[196:199], v[248:251], v[196:199], a[196:199]
    v_mfma_f32_16x16x32_bf16 a[200:203], v[248:251], v[200:203], a[200:203]
    v_mfma_f32_16x16x32_bf16 a[204:207], v[248:251], v[204:207], a[204:207]
    v_mfma_f32_16x16x32_bf16 a[208:211], v[248:251], v[208:211], a[208:211]
    v_mfma_f32_16x16x32_bf16 a[212:215], v[248:251], v[212:215], a[212:215]
    v_mfma_f32_16x16x32_bf16 a[216:219], v[248:251], v[216:219], a[216:219]
    v_mfma_f32_16x16x32_bf16 a[220:223], v[248:251], v[220:223], a[220:223]
    v_mfma_f32_16x16x32_bf16 a[252:255], v[252:255], v[220:223], a[252:255]
    v_mfma_f32_16x16x32_bf16 a[248:251], v[252:255], v[216:219], a[248:251]
    v_mfma_f32_16x16x32_bf16 a[244:247], v[252:255], v[212:215], a[244:247]
    v_mfma_f32_16x16x32_bf16 a[240:243], v[252:255], v[208:211], a[240:243]
    v_mfma_f32_16x16x32_bf16 a[236:239], v[252:255], v[204:207], a[236:239]
    v_mfma_f32_16x16x32_bf16 a[232:235], v[252:255], v[200:203], a[232:235]
    v_mfma_f32_16x16x32_bf16 a[228:231], v[252:255], v[196:199], a[228:231]
    v_mfma_f32_16x16x32_bf16 a[224:227], v[252:255], v[192:195], a[224:227]
    s_waitcnt lgkmcnt(0)
    v_mfma_f32_16x16x32_bf16 a[0:3], v[160:163], v[128:131], a[0:3]
    v_mfma_f32_16x16x32_bf16 a[4:7], v[160:163], v[132:135], a[4:7]
    ds_read_b128 v[192:195], v13 offset:0
    v_mfma_f32_16x16x32_bf16 a[8:11], v[160:163], v[136:139], a[8:11]
    v_mfma_f32_16x16x32_bf16 a[12:15], v[160:163], v[140:143], a[12:15]
    ds_read_b64_tr_b16 v[224:225], v24 offset:8192
    v_mfma_f32_16x16x32_bf16 a[16:19], v[160:163], v[144:147], a[16:19]
    v_mfma_f32_16x16x32_bf16 a[20:23], v[160:163], v[148:151], a[20:23]
    ds_read_b64_tr_b16 v[226:227], v24 offset:9216
    v_mfma_f32_16x16x32_bf16 a[24:27], v[160:163], v[152:155], a[24:27]
    v_mfma_f32_16x16x32_bf16 a[28:31], v[160:163], v[156:159], a[28:31]
    ds_read_b128 v[196:199], v13 offset:2048
    v_mfma_f32_16x16x32_bf16 a[60:63], v[164:167], v[156:159], a[60:63]
    v_mfma_f32_16x16x32_bf16 a[56:59], v[164:167], v[152:155], a[56:59]
    ds_read_b64_tr_b16 v[228:229], v25 offset:8192
    v_mfma_f32_16x16x32_bf16 a[52:55], v[164:167], v[148:151], a[52:55]
    v_mfma_f32_16x16x32_bf16 a[48:51], v[164:167], v[144:147], a[48:51]
    ds_read_b64_tr_b16 v[230:231], v25 offset:9216
    v_mfma_f32_16x16x32_bf16 a[44:47], v[164:167], v[140:143], a[44:47]
    v_mfma_f32_16x16x32_bf16 a[40:43], v[164:167], v[136:139], a[40:43]
    ds_read_b128 v[200:203], v13 offset:4096
    v_mfma_f32_16x16x32_bf16 a[36:39], v[164:167], v[132:135], a[36:39]
    s_add_u32 s72, s70, 32768
    v_mfma_f32_16x16x32_bf16 a[32:35], v[164:167], v[128:131], a[32:35]
    ds_read_b64_tr_b16 v[232:233], v26 offset:8192
    buffer_store_dwordx4 v[108:111], v2, s[24:27], s72 offen offset:3072 sc1
    v_mfma_f32_16x16x32_bf16 a[64:67], v[168:171], v[128:131], a[64:67]
    v_mfma_f32_16x16x32_bf16 a[68:71], v[168:171], v[132:135], a[68:71]
    ds_read_b64_tr_b16 v[234:235], v26 offset:9216
    v_mfma_f32_16x16x32_bf16 a[72:75], v[168:171], v[136:139], a[72:75]
    v_mfma_f32_16x16x32_bf16 a[76:79], v[168:171], v[140:143], a[76:79]
    ds_read_b128 v[204:207], v13 offset:6144
    v_mfma_f32_16x16x32_bf16 a[80:83], v[168:171], v[144:147], a[80:83]
    v_mfma_f32_16x16x32_bf16 a[84:87], v[168:171], v[148:151], a[84:87]
    ds_read_b64_tr_b16 v[236:237], v27 offset:8192
    v_mfma_f32_16x16x32_bf16 a[88:91], v[168:171], v[152:155], a[88:91]
    s_add_u32 s72, s70, 32768
    s_add_u32 s72, s72, s75
    v_mfma_f32_16x16x32_bf16 a[92:95], v[168:171], v[156:159], a[92:95]
    ds_read_b64_tr_b16 v[238:239], v27 offset:9216
    buffer_store_dwordx4 v[112:115], v2, s[24:27], s72 offen offset:0 sc1
    v_mfma_f32_16x16x32_bf16 a[124:127], v[172:175], v[156:159], a[124:127]
    v_mfma_f32_16x16x32_bf16 a[120:123], v[172:175], v[152:155], a[120:123]
    ds_read_b128 v[208:211], v13 offset:8192
    v_mfma_f32_16x16x32_bf16 a[116:119], v[172:175], v[148:151], a[116:119]
    v_mfma_f32_16x16x32_bf16 a[112:115], v[172:175], v[144:147], a[112:115]
    ds_read_b64_tr_b16 v[240:241], v28 offset:8192
    v_mfma_f32_16x16x32_bf16 a[108:111], v[172:175], v[140:143], a[108:111]
    v_mfma_f32_16x16x32_bf16 a[104:107], v[172:175], v[136:139], a[104:107]
    ds_read_b64_tr_b16 v[242:243], v28 offset:9216
    v_mfma_f32_16x16x32_bf16 a[100:103], v[172:175], v[132:135], a[100:103]
    s_add_u32 s72, s70, 32768
    s_add_u32 s72, s72, s75
    v_mfma_f32_16x16x32_bf16 a[96:99], v[172:175], v[128:131], a[96:99]
    ds_read_b128 v[212:215], v13 offset:10240
    buffer_store_dwordx4 v[116:119], v2, s[24:27], s72 offen offset:1024 sc1
    v_mfma_f32_16x16x32_bf16 a[128:131], v[176:179], v[128:131], a[128:131]
    v_mfma_f32_16x16x32_bf16 a[132:135], v[176:179], v[132:135], a[132:135]
    ds_read_b64_tr_b16 v[244:245], v29 offset:8192
    v_mfma_f32_16x16x32_bf16 a[136:139], v[176:179], v[136:139], a[136:139]
    v_mfma_f32_16x16x32_bf16 a[140:143], v[176:179], v[140:143], a[140:143]
    ds_read_b64_tr_b16 v[246:247], v29 offset:9216
    v_mfma_f32_16x16x32_bf16 a[144:147], v[176:179], v[144:147], a[144:147]
    v_mfma_f32_16x16x32_bf16 a[148:151], v[176:179], v[148:151], a[148:151]
    ds_read_b128 v[216:219], v13 offset:12288
    v_mfma_f32_16x16x32_bf16 a[152:155], v[176:179], v[152:155], a[152:155]
    s_add_u32 s72, s70, 32768
    s_add_u32 s72, s72, s75
    v_mfma_f32_16x16x32_bf16 a[156:159], v[176:179], v[156:159], a[156:159]
    ds_read_b64_tr_b16 v[248:249], v30 offset:8192
    buffer_store_dwordx4 v[120:123], v2, s[24:27], s72 offen offset:2048 sc1
    v_mfma_f32_16x16x32_bf16 a[188:191], v[180:183], v[156:159], a[188:191]
    v_mfma_f32_16x16x32_bf16 a[184:187], v[180:183], v[152:155], a[184:187]
    ds_read_b64_tr_b16 v[250:251], v30 offset:9216
    v_mfma_f32_16x16x32_bf16 a[180:183], v[180:183], v[148:151], a[180:183]
    v_mfma_f32_16x16x32_bf16 a[176:179], v[180:183], v[144:147], a[176:179]
    ds_read_b128 v[220:223], v13 offset:14336
    v_mfma_f32_16x16x32_bf16 a[172:175], v[180:183], v[140:143], a[172:175]
    v_mfma_f32_16x16x32_bf16 a[168:171], v[180:183], v[136:139], a[168:171]
    ds_read_b64_tr_b16 v[252:253], v31 offset:8192
    v_mfma_f32_16x16x32_bf16 a[164:167], v[180:183], v[132:135], a[164:167]
    v_mfma_f32_16x16x32_bf16 a[160:163], v[180:183], v[128:131], a[160:163]
    ds_read_b64_tr_b16 v[254:255], v31 offset:9216
    v_mfma_f32_16x16x32_bf16 a[192:195], v[184:187], v[128:131], a[192:195]
    v_mfma_f32_16x16x32_bf16 a[196:199], v[184:187], v[132:135], a[196:199]
    v_mfma_f32_16x16x32_bf16 a[200:203], v[184:187], v[136:139], a[200:203]
    v_mfma_f32_16x16x32_bf16 a[204:207], v[184:187], v[140:143], a[204:207]
    v_mfma_f32_16x16x32_bf16 a[208:211], v[184:187], v[144:147], a[208:211]
    v_mfma_f32_16x16x32_bf16 a[212:215], v[184:187], v[148:151], a[212:215]
    v_mfma_f32_16x16x32_bf16 a[216:219], v[184:187], v[152:155], a[216:219]
    v_mfma_f32_16x16x32_bf16 a[220:223], v[184:187], v[156:159], a[220:223]
    v_mfma_f32_16x16x32_bf16 a[252:255], v[188:191], v[156:159], a[252:255]
    v_mfma_f32_16x16x32_bf16 a[248:251], v[188:191], v[152:155], a[248:251]
    v_mfma_f32_16x16x32_bf16 a[244:247], v[188:191], v[148:151], a[244:247]
    v_mfma_f32_16x16x32_bf16 a[240:243], v[188:191], v[144:147], a[240:243]
    v_mfma_f32_16x16x32_bf16 a[236:239], v[188:191], v[140:143], a[236:239]
    v_mfma_f32_16x16x32_bf16 a[232:235], v[188:191], v[136:139], a[232:235]
    v_mfma_f32_16x16x32_bf16 a[228:231], v[188:191], v[132:135], a[228:231]
    v_mfma_f32_16x16x32_bf16 a[224:227], v[188:191], v[128:131], a[224:227]
    s_waitcnt lgkmcnt(0)
    s_lshl_b32 s92, s2, 2
    s_add_u32 s92, s92, s3
    s_mov_b32 s31, 0x20000
    s_mov_b32 s28, s98
    s_mov_b32 s29, s99
    s_mov_b32 s30, 3670016
    s_mul_i32 s93, s92, 3584
    v_lshlrev_b32 v32, 7, v1
    v_add_u32 v32, s93, v32
    v_cmp_gt_u32 vcc, 28, v1
    v_mov_b32 v33, 0x7f000000
    s_nop 0
    v_cndmask_b32 v32, v33, v32, vcc
    buffer_load_dword v3, v32, s[28:31], 0 offen
    s_mov_b32 s28, s100
    s_mov_b32 s29, s101
    s_mov_b32 s30, 1605632
    s_mul_i32 s93, s92, 1664
    v_lshlrev_b32 v32, 7, v1
    v_add_u32 v32, s93, v32
    v_cmp_gt_u32 vcc, 13, v1
    v_mov_b32 v33, 0x7f000000
    s_nop 0
    v_cndmask_b32 v32, v33, v32, vcc
    buffer_load_dword v3, v32, s[28:31], 0 offen
    s_waitcnt lgkmcnt(0)
    v_mfma_f32_16x16x32_bf16 a[0:3], v[224:227], v[192:195], a[0:3]
    v_mfma_f32_16x16x32_bf16 a[4:7], v[224:227], v[196:199], a[4:7]
    v_mfma_f32_16x16x32_bf16 a[8:11], v[224:227], v[200:203], a[8:11]
    v_mfma_f32_16x16x32_bf16 a[12:15], v[224:227], v[204:207], a[12:15]
    v_mfma_f32_16x16x32_bf16 a[16:19], v[224:227], v[208:211], a[16:19]
    v_mfma_f32_16x16x32_bf16 a[20:23], v[224:227], v[212:215], a[20:23]
    v_mfma_f32_16x16x32_bf16 a[24:27], v[224:227], v[216:219], a[24:27]
    v_mfma_f32_16x16x32_bf16 a[28:31], v[224:227], v[220:223], a[28:31]
    v_mfma_f32_16x16x32_bf16 a[60:63], v[228:231], v[220:223], a[60:63]
    v_mfma_f32_16x16x32_bf16 a[56:59], v[228:231], v[216:219], a[56:59]
    v_mfma_f32_16x16x32_bf16 a[52:55], v[228:231], v[212:215], a[52:55]
    v_mfma_f32_16x16x32_bf16 a[48:51], v[228:231], v[208:211], a[48:51]
    v_mfma_f32_16x16x32_bf16 a[44:47], v[228:231], v[204:207], a[44:47]
    v_mfma_f32_16x16x32_bf16 a[40:43], v[228:231], v[200:203], a[40:43]
    v_mfma_f32_16x16x32_bf16 a[36:39], v[228:231], v[196:199], a[36:39]
    v_mfma_f32_16x16x32_bf16 a[32:35], v[228:231], v[192:195], a[32:35]
    v_mfma_f32_16x16x32_bf16 a[64:67], v[232:235], v[192:195], a[64:67]
    v_mfma_f32_16x16x32_bf16 a[68:71], v[232:235], v[196:199], a[68:71]
    v_mfma_f32_16x16x32_bf16 a[72:75], v[232:235], v[200:203], a[72:75]
    v_mfma_f32_16x16x32_bf16 a[76:79], v[232:235], v[204:207], a[76:79]
    v_mfma_f32_16x16x32_bf16 a[80:83], v[232:235], v[208:211], a[80:83]
    v_mfma_f32_16x16x32_bf16 a[84:87], v[232:235], v[212:215], a[84:87]
    v_mfma_f32_16x16x32_bf16 a[88:91], v[232:235], v[216:219], a[88:91]
    v_mfma_f32_16x16x32_bf16 a[92:95], v[232:235], v[220:223], a[92:95]
    v_mfma_f32_16x16x32_bf16 a[124:127], v[236:239], v[220:223], a[124:127]
    v_mfma_f32_16x16x32_bf16 a[120:123], v[236:239], v[216:219], a[120:123]
    v_mfma_f32_16x16x32_bf16 a[116:119], v[236:239], v[212:215], a[116:119]
    v_mfma_f32_16x16x32_bf16 a[112:115], v[236:239], v[208:211], a[112:115]
    v_mfma_f32_16x16x32_bf16 a[108:111], v[236:239], v[204:207], a[108:111]
    v_mfma_f32_16x16x32_bf16 a[104:107], v[236:239], v[200:203], a[104:107]
    v_mfma_f32_16x16x32_bf16 a[100:103], v[236:239], v[196:199], a[100:103]
    v_mfma_f32_16x16x32_bf16 a[96:99], v[236:239], v[192:195], a[96:99]
    v_mfma_f32_16x16x32_bf16 a[128:131], v[240:243], v[192:195], a[128:131]
    v_mfma_f32_16x16x32_bf16 a[132:135], v[240:243], v[196:199], a[132:135]
    v_mfma_f32_16x16x32_bf16 a[136:139], v[240:243], v[200:203], a[136:139]
    v_mfma_f32_16x16x32_bf16 a[140:143], v[240:243], v[204:207], a[140:143]
    v_mfma_f32_16x16x32_bf16 a[144:147], v[240:243], v[208:211], a[144:147]
    v_mfma_f32_16x16x32_bf16 a[148:151], v[240:243], v[212:215], a[148:151]
    v_mfma_f32_16x16x32_bf16 a[152:155], v[240:243], v[216:219], a[152:155]
    v_mfma_f32_16x16x32_bf16 a[156:159], v[240:243], v[220:223], a[156:159]
    v_mfma_f32_16x16x32_bf16 a[188:191], v[244:247], v[220:223], a[188:191]
    v_mfma_f32_16x16x32_bf16 a[184:187], v[244:247], v[216:219], a[184:187]
    v_mfma_f32_16x16x32_bf16 a[180:183], v[244:247], v[212:215], a[180:183]
    v_mfma_f32_16x16x32_bf16 a[176:179], v[244:247], v[208:211], a[176:179]
    v_mfma_f32_16x16x32_bf16 a[172:175], v[244:247], v[204:207], a[172:175]
    v_mfma_f32_16x16x32_bf16 a[168:171], v[244:247], v[200:203], a[168:171]
    v_mfma_f32_16x16x32_bf16 a[164:167], v[244:247], v[196:199], a[164:167]
    v_mfma_f32_16x16x32_bf16 a[160:163], v[244:247], v[192:195], a[160:163]
    v_mfma_f32_16x16x32_bf16 a[192:195], v[248:251], v[192:195], a[192:195]
    v_mfma_f32_16x16x32_bf16 a[196:199], v[248:251], v[196:199], a[196:199]
    v_mfma_f32_16x16x32_bf16 a[200:203], v[248:251], v[200:203], a[200:203]
    v_mfma_f32_16x16x32_bf16 a[204:207], v[248:251], v[204:207], a[204:207]
    v_mfma_f32_16x16x32_bf16 a[208:211], v[248:251], v[208:211], a[208:211]
    v_mfma_f32_16x16x32_bf16 a[212:215], v[248:251], v[212:215], a[212:215]
    v_mfma_f32_16x16x32_bf16 a[216:219], v[248:251], v[216:219], a[216:219]
    v_mfma_f32_16x16x32_bf16 a[220:223], v[248:251], v[220:223], a[220:223]
    v_mfma_f32_16x16x32_bf16 a[252:255], v[252:255], v[220:223], a[252:255]
    v_mfma_f32_16x16x32_bf16 a[248:251], v[252:255], v[216:219], a[248:251]
    v_mfma_f32_16x16x32_bf16 a[244:247], v[252:255], v[212:215], a[244:247]
    v_mfma_f32_16x16x32_bf16 a[240:243], v[252:255], v[208:211], a[240:243]
    v_mfma_f32_16x16x32_bf16 a[236:239], v[252:255], v[204:207], a[236:239]
    v_mfma_f32_16x16x32_bf16 a[232:235], v[252:255], v[200:203], a[232:235]
    v_mfma_f32_16x16x32_bf16 a[228:231], v[252:255], v[196:199], a[228:231]
    v_mfma_f32_16x16x32_bf16 a[224:227], v[252:255], v[192:195], a[224:227]
    s_cmp_eq_u32 s69, 1
    s_cbranch_scc1 K1_EPI_F
    s_nop 7
    s_mov_b32 s73, 0x3db8aa3b
    v_accvgpr_read_b32 v32, a0
    v_accvgpr_read_b32 v33, a1
    v_accvgpr_read_b32 v34, a2
    v_accvgpr_read_b32 v35, a3
    v_accvgpr_read_b32 v36, a32
    v_accvgpr_read_b32 v37, a33
    v_accvgpr_read_b32 v38, a34
    v_accvgpr_read_b32 v39, a35
    v_mul_f32 v32, s73, v32
    v_mul_f32 v33, s73, v33
    v_mul_f32 v34, s73, v34
    v_mul_f32 v35, s73, v35
    v_mul_f32 v36, s73, v36
    v_mul_f32 v37, s73, v37
    v_mul_f32 v38, s73, v38
    v_mul_f32 v39, s73, v39
    v_cvt_pk_bf16_f32 v40, v32, v33
    v_cvt_pk_bf16_f32 v41, v34, v35
    v_cvt_pk_bf16_f32 v42, v36, v37
    v_cvt_pk_bf16_f32 v43, v38, v39
    s_add_u32 s72, s71, 0
    buffer_store_dwordx4 v[40:43], v2, s[24:27], s72 offen offset:0 sc1
    v_accvgpr_read_b32 v44, a64
    v_accvgpr_read_b32 v45, a65
    v_accvgpr_read_b32 v46, a66
    v_accvgpr_read_b32 v47, a67
    v_accvgpr_read_b32 v48, a96
    v_accvgpr_read_b32 v49, a97
    v_accvgpr_read_b32 v50, a98
    v_accvgpr_read_b32 v51, a99
    v_mul_f32 v44, s73, v44
    v_mul_f32 v45, s73, v45
    v_mul_f32 v46, s73, v46
    v_mul_f32 v47, s73, v47
    v_mul_f32 v48, s73, v48
    v_mul_f32 v49, s73, v49
    v_mul_f32 v50, s73, v50
    v_mul_f32 v51, s73, v51
    v_cvt_pk_bf16_f32 v52, v44, v45
    v_cvt_pk_bf16_f32 v53, v46, v47
    v_cvt_pk_bf16_f32 v54, v48, v49
    v_cvt_pk_bf16_f32 v55, v50, v51
    buffer_store_dwordx4 v[52:55], v2, s[24:27], s72 offen offset:1024 sc1
    v_accvgpr_read_b32 v56, a128
    v_accvgpr_read_b32 v57, a129
    v_accvgpr_read_b32 v58, a130
    v_accvgpr_read_b32 v59, a131
    v_accvgpr_read_b32 v60, a160
    v_accvgpr_read_b32 v61, a161
    v_accvgpr_read_b32 v62, a162
    v_accvgpr_read_b32 v63, a163
    v_mul_f32 v56, s73, v56
    v_mul_f32 v57, s73, v57
    v_mul_f32 v58, s73, v58
    v_mul_f32 v59, s73, v59
    v_mul_f32 v60, s73, v60
    v_mul_f32 v61, s73, v61
    v_mul_f32 v62, s73, v62
    v_mul_f32 v63, s73, v63
    v_cvt_pk_bf16_f32 v64, v56, v57
    v_cvt_pk_bf16_f32 v65, v58, v59
    v_cvt_pk_bf16_f32 v66, v60, v61
    v_cvt_pk_bf16_f32 v67, v62, v63
    buffer_store_dwordx4 v[64:67], v2, s[24:27], s72 offen offset:2048 sc1
    v_accvgpr_read_b32 v68, a192
    v_accvgpr_read_b32 v69, a193
    v_accvgpr_read_b32 v70, a194
    v_accvgpr_read_b32 v71, a195
    v_accvgpr_read_b32 v72, a224
    v_accvgpr_read_b32 v73, a225
    v_accvgpr_read_b32 v74, a226
    v_accvgpr_read_b32 v75, a227
    v_mul_f32 v68, s73, v68
    v_mul_f32 v69, s73, v69
    v_mul_f32 v70, s73, v70
    v_mul_f32 v71, s73, v71
    v_mul_f32 v72, s73, v72
    v_mul_f32 v73, s73, v73
    v_mul_f32 v74, s73, v74
    v_mul_f32 v75, s73, v75
    v_cvt_pk_bf16_f32 v76, v68, v69
    v_cvt_pk_bf16_f32 v77, v70, v71
    v_cvt_pk_bf16_f32 v78, v72, v73
    v_cvt_pk_bf16_f32 v79, v74, v75
    buffer_store_dwordx4 v[76:79], v2, s[24:27], s72 offen offset:3072 sc1
    v_accvgpr_read_b32 v80, a4
    v_accvgpr_read_b32 v81, a5
    v_accvgpr_read_b32 v82, a6
    v_accvgpr_read_b32 v83, a7
    v_accvgpr_read_b32 v84, a36
    v_accvgpr_read_b32 v85, a37
    v_accvgpr_read_b32 v86, a38
    v_accvgpr_read_b32 v87, a39
    v_mul_f32 v80, s73, v80
    v_mul_f32 v81, s73, v81
    v_mul_f32 v82, s73, v82
    v_mul_f32 v83, s73, v83
    v_mul_f32 v84, s73, v84
    v_mul_f32 v85, s73, v85
    v_mul_f32 v86, s73, v86
    v_mul_f32 v87, s73, v87
    v_cvt_pk_bf16_f32 v88, v80, v81
    v_cvt_pk_bf16_f32 v89, v82, v83
    v_cvt_pk_bf16_f32 v90, v84, v85
    v_cvt_pk_bf16_f32 v91, v86, v87
    s_add_u32 s72, s71, 8192
    buffer_store_dwordx4 v[88:91], v2, s[24:27], s72 offen offset:0 sc1
    v_accvgpr_read_b32 v92, a68
    v_accvgpr_read_b32 v93, a69
    v_accvgpr_read_b32 v94, a70
    v_accvgpr_read_b32 v95, a71
    v_accvgpr_read_b32 v96, a100
    v_accvgpr_read_b32 v97, a101
    v_accvgpr_read_b32 v98, a102
    v_accvgpr_read_b32 v99, a103
    v_mul_f32 v92, s73, v92
    v_mul_f32 v93, s73, v93
    v_mul_f32 v94, s73, v94
    v_mul_f32 v95, s73, v95
    v_mul_f32 v96, s73, v96
    v_mul_f32 v97, s73, v97
    v_mul_f32 v98, s73, v98
    v_mul_f32 v99, s73, v99
    v_cvt_pk_bf16_f32 v100, v92, v93
    v_cvt_pk_bf16_f32 v101, v94, v95
    v_cvt_pk_bf16_f32 v102, v96, v97
    v_cvt_pk_bf16_f32 v103, v98, v99
    buffer_store_dwordx4 v[100:103], v2, s[24:27], s72 offen offset:1024 sc1
    v_accvgpr_read_b32 v32, a132
    v_accvgpr_read_b32 v33, a133
    v_accvgpr_read_b32 v34, a134
    v_accvgpr_read_b32 v35, a135
    v_accvgpr_read_b32 v36, a164
    v_accvgpr_read_b32 v37, a165
    v_accvgpr_read_b32 v38, a166
    v_accvgpr_read_b32 v39, a167
    v_mul_f32 v32, s73, v32
    v_mul_f32 v33, s73, v33
    v_mul_f32 v34, s73, v34
    v_mul_f32 v35, s73, v35
    v_mul_f32 v36, s73, v36
    v_mul_f32 v37, s73, v37
    v_mul_f32 v38, s73, v38
    v_mul_f32 v39, s73, v39
    v_cvt_pk_bf16_f32 v40, v32, v33
    v_cvt_pk_bf16_f32 v41, v34, v35
    v_cvt_pk_bf16_f32 v42, v36, v37
    v_cvt_pk_bf16_f32 v43, v38, v39
    buffer_store_dwordx4 v[40:43], v2, s[24:27], s72 offen offset:2048 sc1
    v_accvgpr_read_b32 v44, a196
    v_accvgpr_read_b32 v45, a197
    v_accvgpr_read_b32 v46, a198
    v_accvgpr_read_b32 v47, a199
    v_accvgpr_read_b32 v48, a228
    v_accvgpr_read_b32 v49, a229
    v_accvgpr_read_b32 v50, a230
    v_accvgpr_read_b32 v51, a231
    v_mul_f32 v44, s73, v44
    v_mul_f32 v45, s73, v45
    v_mul_f32 v46, s73, v46
    v_mul_f32 v47, s73, v47
    v_mul_f32 v48, s73, v48
    v_mul_f32 v49, s73, v49
    v_mul_f32 v50, s73, v50
    v_mul_f32 v51, s73, v51
    v_cvt_pk_bf16_f32 v52, v44, v45
    v_cvt_pk_bf16_f32 v53, v46, v47
    v_cvt_pk_bf16_f32 v54, v48, v49
    v_cvt_pk_bf16_f32 v55, v50, v51
    buffer_store_dwordx4 v[52:55], v2, s[24:27], s72 offen offset:3072 sc1
    v_accvgpr_read_b32 v56, a8
    v_accvgpr_read_b32 v57, a9
    v_accvgpr_read_b32 v58, a10
    v_accvgpr_read_b32 v59, a11
    v_accvgpr_read_b32 v60, a40
    v_accvgpr_read_b32 v61, a41
    v_accvgpr_read_b32 v62, a42
    v_accvgpr_read_b32 v63, a43
    v_mul_f32 v56, s73, v56
    v_mul_f32 v57, s73, v57
    v_mul_f32 v58, s73, v58
    v_mul_f32 v59, s73, v59
    v_mul_f32 v60, s73, v60
    v_mul_f32 v61, s73, v61
    v_mul_f32 v62, s73, v62
    v_mul_f32 v63, s73, v63
    v_cvt_pk_bf16_f32 v64, v56, v57
    v_cvt_pk_bf16_f32 v65, v58, v59
    v_cvt_pk_bf16_f32 v66, v60, v61
    v_cvt_pk_bf16_f32 v67, v62, v63
    s_add_u32 s72, s71, 16384
    buffer_store_dwordx4 v[64:67], v2, s[24:27], s72 offen offset:0 sc1
    v_accvgpr_read_b32 v68, a72
    v_accvgpr_read_b32 v69, a73
    v_accvgpr_read_b32 v70, a74
    v_accvgpr_read_b32 v71, a75
    v_accvgpr_read_b32 v72, a104
    v_accvgpr_read_b32 v73, a105
    v_accvgpr_read_b32 v74, a106
    v_accvgpr_read_b32 v75, a107
    v_mul_f32 v68, s73, v68
    v_mul_f32 v69, s73, v69
    v_mul_f32 v70, s73, v70
    v_mul_f32 v71, s73, v71
    v_mul_f32 v72, s73, v72
    v_mul_f32 v73, s73, v73
    v_mul_f32 v74, s73, v74
    v_mul_f32 v75, s73, v75
    v_cvt_pk_bf16_f32 v76, v68, v69
    v_cvt_pk_bf16_f32 v77, v70, v71
    v_cvt_pk_bf16_f32 v78, v72, v73
    v_cvt_pk_bf16_f32 v79, v74, v75
    buffer_store_dwordx4 v[76:79], v2, s[24:27], s72 offen offset:1024 sc1
    v_accvgpr_read_b32 v80, a136
    v_accvgpr_read_b32 v81, a137
    v_accvgpr_read_b32 v82, a138
    v_accvgpr_read_b32 v83, a139
    v_accvgpr_read_b32 v84, a168
    v_accvgpr_read_b32 v85, a169
    v_accvgpr_read_b32 v86, a170
    v_accvgpr_read_b32 v87, a171
    v_mul_f32 v80, s73, v80
    v_mul_f32 v81, s73, v81
    v_mul_f32 v82, s73, v82
    v_mul_f32 v83, s73, v83
    v_mul_f32 v84, s73, v84
    v_mul_f32 v85, s73, v85
    v_mul_f32 v86, s73, v86
    v_mul_f32 v87, s73, v87
    v_cvt_pk_bf16_f32 v88, v80, v81
    v_cvt_pk_bf16_f32 v89, v82, v83
    v_cvt_pk_bf16_f32 v90, v84, v85
    v_cvt_pk_bf16_f32 v91, v86, v87
    buffer_store_dwordx4 v[88:91], v2, s[24:27], s72 offen offset:2048 sc1
    v_accvgpr_read_b32 v92, a200
    v_accvgpr_read_b32 v93, a201
    v_accvgpr_read_b32 v94, a202
    v_accvgpr_read_b32 v95, a203
    v_accvgpr_read_b32 v96, a232
    v_accvgpr_read_b32 v97, a233
    v_accvgpr_read_b32 v98, a234
    v_accvgpr_read_b32 v99, a235
    v_mul_f32 v92, s73, v92
    v_mul_f32 v93, s73, v93
    v_mul_f32 v94, s73, v94
    v_mul_f32 v95, s73, v95
    v_mul_f32 v96, s73, v96
    v_mul_f32 v97, s73, v97
    v_mul_f32 v98, s73, v98
    v_mul_f32 v99, s73, v99
    v_cvt_pk_bf16_f32 v100, v92, v93
    v_cvt_pk_bf16_f32 v101, v94, v95
    v_cvt_pk_bf16_f32 v102, v96, v97
    v_cvt_pk_bf16_f32 v103, v98, v99
    buffer_store_dwordx4 v[100:103], v2, s[24:27], s72 offen offset:3072 sc1
    v_accvgpr_read_b32 v32, a12
    v_accvgpr_read_b32 v33, a13
    v_accvgpr_read_b32 v34, a14
    v_accvgpr_read_b32 v35, a15
    v_accvgpr_read_b32 v36, a44
    v_accvgpr_read_b32 v37, a45
    v_accvgpr_read_b32 v38, a46
    v_accvgpr_read_b32 v39, a47
    v_mul_f32 v32, s73, v32
    v_mul_f32 v33, s73, v33
    v_mul_f32 v34, s73, v34
    v_mul_f32 v35, s73, v35
    v_mul_f32 v36, s73, v36
    v_mul_f32 v37, s73, v37
    v_mul_f32 v38, s73, v38
    v_mul_f32 v39, s73, v39
    v_cvt_pk_bf16_f32 v40, v32, v33
    v_cvt_pk_bf16_f32 v41, v34, v35
    v_cvt_pk_bf16_f32 v42, v36, v37
    v_cvt_pk_bf16_f32 v43, v38, v39
    s_add_u32 s72, s71, 24576
    buffer_store_dwordx4 v[40:43], v2, s[24:27], s72 offen offset:0 sc1
    v_accvgpr_read_b32 v44, a76
    v_accvgpr_read_b32 v45, a77
    v_accvgpr_read_b32 v46, a78
    v_accvgpr_read_b32 v47, a79
    v_accvgpr_read_b32 v48, a108
    v_accvgpr_read_b32 v49, a109
    v_accvgpr_read_b32 v50, a110
    v_accvgpr_read_b32 v51, a111
    v_mul_f32 v44, s73, v44
    v_mul_f32 v45, s73, v45
    v_mul_f32 v46, s73, v46
    v_mul_f32 v47, s73, v47
    v_mul_f32 v48, s73, v48
    v_mul_f32 v49, s73, v49
    v_mul_f32 v50, s73, v50
    v_mul_f32 v51, s73, v51
    v_cvt_pk_bf16_f32 v52, v44, v45
    v_cvt_pk_bf16_f32 v53, v46, v47
    v_cvt_pk_bf16_f32 v54, v48, v49
    v_cvt_pk_bf16_f32 v55, v50, v51
    buffer_store_dwordx4 v[52:55], v2, s[24:27], s72 offen offset:1024 sc1
    v_accvgpr_read_b32 v56, a140
    v_accvgpr_read_b32 v57, a141
    v_accvgpr_read_b32 v58, a142
    v_accvgpr_read_b32 v59, a143
    v_accvgpr_read_b32 v60, a172
    v_accvgpr_read_b32 v61, a173
    v_accvgpr_read_b32 v62, a174
    v_accvgpr_read_b32 v63, a175
    v_mul_f32 v56, s73, v56
    v_mul_f32 v57, s73, v57
    v_mul_f32 v58, s73, v58
    v_mul_f32 v59, s73, v59
    v_mul_f32 v60, s73, v60
    v_mul_f32 v61, s73, v61
    v_mul_f32 v62, s73, v62
    v_mul_f32 v63, s73, v63
    v_cvt_pk_bf16_f32 v64, v56, v57
    v_cvt_pk_bf16_f32 v65, v58, v59
    v_cvt_pk_bf16_f32 v66, v60, v61
    v_cvt_pk_bf16_f32 v67, v62, v63
    buffer_store_dwordx4 v[64:67], v2, s[24:27], s72 offen offset:2048 sc1
    v_accvgpr_read_b32 v68, a204
    v_accvgpr_read_b32 v69, a205
    v_accvgpr_read_b32 v70, a206
    v_accvgpr_read_b32 v71, a207
    v_accvgpr_read_b32 v72, a236
    v_accvgpr_read_b32 v73, a237
    v_accvgpr_read_b32 v74, a238
    v_accvgpr_read_b32 v75, a239
    v_mul_f32 v68, s73, v68
    v_mul_f32 v69, s73, v69
    v_mul_f32 v70, s73, v70
    v_mul_f32 v71, s73, v71
    v_mul_f32 v72, s73, v72
    v_mul_f32 v73, s73, v73
    v_mul_f32 v74, s73, v74
    v_mul_f32 v75, s73, v75
    v_cvt_pk_bf16_f32 v76, v68, v69
    v_cvt_pk_bf16_f32 v77, v70, v71
    v_cvt_pk_bf16_f32 v78, v72, v73
    v_cvt_pk_bf16_f32 v79, v74, v75
    buffer_store_dwordx4 v[76:79], v2, s[24:27], s72 offen offset:3072 sc1
    v_accvgpr_read_b32 v80, a16
    v_accvgpr_read_b32 v81, a17
    v_accvgpr_read_b32 v82, a18
    v_accvgpr_read_b32 v83, a19
    v_accvgpr_read_b32 v84, a48
    v_accvgpr_read_b32 v85, a49
    v_accvgpr_read_b32 v86, a50
    v_accvgpr_read_b32 v87, a51
    v_mul_f32 v80, s73, v80
    v_mul_f32 v81, s73, v81
    v_mul_f32 v82, s73, v82
    v_mul_f32 v83, s73, v83
    v_mul_f32 v84, s73, v84
    v_mul_f32 v85, s73, v85
    v_mul_f32 v86, s73, v86
    v_mul_f32 v87, s73, v87
    v_cvt_pk_bf16_f32 v88, v80, v81
    v_cvt_pk_bf16_f32 v89, v82, v83
    v_cvt_pk_bf16_f32 v90, v84, v85
    v_cvt_pk_bf16_f32 v91, v86, v87
    s_add_u32 s72, s71, 32768
    buffer_store_dwordx4 v[88:91], v2, s[24:27], s72 offen offset:0 sc1
    v_accvgpr_read_b32 v92, a80
    v_accvgpr_read_b32 v93, a81
    v_accvgpr_read_b32 v94, a82
    v_accvgpr_read_b32 v95, a83
    v_accvgpr_read_b32 v96, a112
    v_accvgpr_read_b32 v97, a113
    v_accvgpr_read_b32 v98, a114
    v_accvgpr_read_b32 v99, a115
    v_mul_f32 v92, s73, v92
    v_mul_f32 v93, s73, v93
    v_mul_f32 v94, s73, v94
    v_mul_f32 v95, s73, v95
    v_mul_f32 v96, s73, v96
    v_mul_f32 v97, s73, v97
    v_mul_f32 v98, s73, v98
    v_mul_f32 v99, s73, v99
    v_cvt_pk_bf16_f32 v100, v92, v93
    v_cvt_pk_bf16_f32 v101, v94, v95
    v_cvt_pk_bf16_f32 v102, v96, v97
    v_cvt_pk_bf16_f32 v103, v98, v99
    buffer_store_dwordx4 v[100:103], v2, s[24:27], s72 offen offset:1024 sc1
    v_accvgpr_read_b32 v32, a144
    v_accvgpr_read_b32 v33, a145
    v_accvgpr_read_b32 v34, a146
    v_accvgpr_read_b32 v35, a147
    v_accvgpr_read_b32 v36, a176
    v_accvgpr_read_b32 v37, a177
    v_accvgpr_read_b32 v38, a178
    v_accvgpr_read_b32 v39, a179
    v_mul_f32 v32, s73, v32
    v_mul_f32 v33, s73, v33
    v_mul_f32 v34, s73, v34
    v_mul_f32 v35, s73, v35
    v_mul_f32 v36, s73, v36
    v_mul_f32 v37, s73, v37
    v_mul_f32 v38, s73, v38
    v_mul_f32 v39, s73, v39
    v_cvt_pk_bf16_f32 v40, v32, v33
    v_cvt_pk_bf16_f32 v41, v34, v35
    v_cvt_pk_bf16_f32 v42, v36, v37
    v_cvt_pk_bf16_f32 v43, v38, v39
    buffer_store_dwordx4 v[40:43], v2, s[24:27], s72 offen offset:2048 sc1
    v_accvgpr_read_b32 v44, a208
    v_accvgpr_read_b32 v45, a209
    v_accvgpr_read_b32 v46, a210
    v_accvgpr_read_b32 v47, a211
    v_accvgpr_read_b32 v48, a240
    v_accvgpr_read_b32 v49, a241
    v_accvgpr_read_b32 v50, a242
    v_accvgpr_read_b32 v51, a243
    v_mul_f32 v44, s73, v44
    v_mul_f32 v45, s73, v45
    v_mul_f32 v46, s73, v46
    v_mul_f32 v47, s73, v47
    v_mul_f32 v48, s73, v48
    v_mul_f32 v49, s73, v49
    v_mul_f32 v50, s73, v50
    v_mul_f32 v51, s73, v51
    v_cvt_pk_bf16_f32 v52, v44, v45
    v_cvt_pk_bf16_f32 v53, v46, v47
    v_cvt_pk_bf16_f32 v54, v48, v49
    v_cvt_pk_bf16_f32 v55, v50, v51
    buffer_store_dwordx4 v[52:55], v2, s[24:27], s72 offen offset:3072 sc1
    v_accvgpr_read_b32 v56, a20
    v_accvgpr_read_b32 v57, a21
    v_accvgpr_read_b32 v58, a22
    v_accvgpr_read_b32 v59, a23
    v_accvgpr_read_b32 v60, a52
    v_accvgpr_read_b32 v61, a53
    v_accvgpr_read_b32 v62, a54
    v_accvgpr_read_b32 v63, a55
    v_mul_f32 v56, s73, v56
    v_mul_f32 v57, s73, v57
    v_mul_f32 v58, s73, v58
    v_mul_f32 v59, s73, v59
    v_mul_f32 v60, s73, v60
    v_mul_f32 v61, s73, v61
    v_mul_f32 v62, s73, v62
    v_mul_f32 v63, s73, v63
    v_cvt_pk_bf16_f32 v64, v56, v57
    v_cvt_pk_bf16_f32 v65, v58, v59
    v_cvt_pk_bf16_f32 v66, v60, v61
    v_cvt_pk_bf16_f32 v67, v62, v63
    s_add_u32 s72, s71, 40960
    buffer_store_dwordx4 v[64:67], v2, s[24:27], s72 offen offset:0 sc1
    v_accvgpr_read_b32 v68, a84
    v_accvgpr_read_b32 v69, a85
    v_accvgpr_read_b32 v70, a86
    v_accvgpr_read_b32 v71, a87
    v_accvgpr_read_b32 v72, a116
    v_accvgpr_read_b32 v73, a117
    v_accvgpr_read_b32 v74, a118
    v_accvgpr_read_b32 v75, a119
    v_mul_f32 v68, s73, v68
    v_mul_f32 v69, s73, v69
    v_mul_f32 v70, s73, v70
    v_mul_f32 v71, s73, v71
    v_mul_f32 v72, s73, v72
    v_mul_f32 v73, s73, v73
    v_mul_f32 v74, s73, v74
    v_mul_f32 v75, s73, v75
    v_cvt_pk_bf16_f32 v76, v68, v69
    v_cvt_pk_bf16_f32 v77, v70, v71
    v_cvt_pk_bf16_f32 v78, v72, v73
    v_cvt_pk_bf16_f32 v79, v74, v75
    buffer_store_dwordx4 v[76:79], v2, s[24:27], s72 offen offset:1024 sc1
    v_accvgpr_read_b32 v80, a148
    v_accvgpr_read_b32 v81, a149
    v_accvgpr_read_b32 v82, a150
    v_accvgpr_read_b32 v83, a151
    v_accvgpr_read_b32 v84, a180
    v_accvgpr_read_b32 v85, a181
    v_accvgpr_read_b32 v86, a182
    v_accvgpr_read_b32 v87, a183
    v_mul_f32 v80, s73, v80
    v_mul_f32 v81, s73, v81
    v_mul_f32 v82, s73, v82
    v_mul_f32 v83, s73, v83
    v_mul_f32 v84, s73, v84
    v_mul_f32 v85, s73, v85
    v_mul_f32 v86, s73, v86
    v_mul_f32 v87, s73, v87
    v_cvt_pk_bf16_f32 v88, v80, v81
    v_cvt_pk_bf16_f32 v89, v82, v83
    v_cvt_pk_bf16_f32 v90, v84, v85
    v_cvt_pk_bf16_f32 v91, v86, v87
    buffer_store_dwordx4 v[88:91], v2, s[24:27], s72 offen offset:2048 sc1
    v_accvgpr_read_b32 v92, a212
    v_accvgpr_read_b32 v93, a213
    v_accvgpr_read_b32 v94, a214
    v_accvgpr_read_b32 v95, a215
    v_accvgpr_read_b32 v96, a244
    v_accvgpr_read_b32 v97, a245
    v_accvgpr_read_b32 v98, a246
    v_accvgpr_read_b32 v99, a247
    v_mul_f32 v92, s73, v92
    v_mul_f32 v93, s73, v93
    v_mul_f32 v94, s73, v94
    v_mul_f32 v95, s73, v95
    v_mul_f32 v96, s73, v96
    v_mul_f32 v97, s73, v97
    v_mul_f32 v98, s73, v98
    v_mul_f32 v99, s73, v99
    v_cvt_pk_bf16_f32 v100, v92, v93
    v_cvt_pk_bf16_f32 v101, v94, v95
    v_cvt_pk_bf16_f32 v102, v96, v97
    v_cvt_pk_bf16_f32 v103, v98, v99
    buffer_store_dwordx4 v[100:103], v2, s[24:27], s72 offen offset:3072 sc1
    v_accvgpr_read_b32 v32, a24
    v_accvgpr_read_b32 v33, a25
    v_accvgpr_read_b32 v34, a26
    v_accvgpr_read_b32 v35, a27
    v_accvgpr_read_b32 v36, a56
    v_accvgpr_read_b32 v37, a57
    v_accvgpr_read_b32 v38, a58
    v_accvgpr_read_b32 v39, a59
    v_mul_f32 v32, s73, v32
    v_mul_f32 v33, s73, v33
    v_mul_f32 v34, s73, v34
    v_mul_f32 v35, s73, v35
    v_mul_f32 v36, s73, v36
    v_mul_f32 v37, s73, v37
    v_mul_f32 v38, s73, v38
    v_mul_f32 v39, s73, v39
    v_cvt_pk_bf16_f32 v40, v32, v33
    v_cvt_pk_bf16_f32 v41, v34, v35
    v_cvt_pk_bf16_f32 v42, v36, v37
    v_cvt_pk_bf16_f32 v43, v38, v39
    s_add_u32 s72, s71, 49152
    buffer_store_dwordx4 v[40:43], v2, s[24:27], s72 offen offset:0 sc1
    v_accvgpr_read_b32 v44, a88
    v_accvgpr_read_b32 v45, a89
    v_accvgpr_read_b32 v46, a90
    v_accvgpr_read_b32 v47, a91
    v_accvgpr_read_b32 v48, a120
    v_accvgpr_read_b32 v49, a121
    v_accvgpr_read_b32 v50, a122
    v_accvgpr_read_b32 v51, a123
    v_mul_f32 v44, s73, v44
    v_mul_f32 v45, s73, v45
    v_mul_f32 v46, s73, v46
    v_mul_f32 v47, s73, v47
    v_mul_f32 v48, s73, v48
    v_mul_f32 v49, s73, v49
    v_mul_f32 v50, s73, v50
    v_mul_f32 v51, s73, v51
    v_cvt_pk_bf16_f32 v52, v44, v45
    v_cvt_pk_bf16_f32 v53, v46, v47
    v_cvt_pk_bf16_f32 v54, v48, v49
    v_cvt_pk_bf16_f32 v55, v50, v51
    buffer_store_dwordx4 v[52:55], v2, s[24:27], s72 offen offset:1024 sc1
    v_accvgpr_read_b32 v56, a152
    v_accvgpr_read_b32 v57, a153
    v_accvgpr_read_b32 v58, a154
    v_accvgpr_read_b32 v59, a155
    v_accvgpr_read_b32 v60, a184
    v_accvgpr_read_b32 v61, a185
    v_accvgpr_read_b32 v62, a186
    v_accvgpr_read_b32 v63, a187
    v_mul_f32 v56, s73, v56
    v_mul_f32 v57, s73, v57
    v_mul_f32 v58, s73, v58
    v_mul_f32 v59, s73, v59
    v_mul_f32 v60, s73, v60
    v_mul_f32 v61, s73, v61
    v_mul_f32 v62, s73, v62
    v_mul_f32 v63, s73, v63
    v_cvt_pk_bf16_f32 v64, v56, v57
    v_cvt_pk_bf16_f32 v65, v58, v59
    v_cvt_pk_bf16_f32 v66, v60, v61
    v_cvt_pk_bf16_f32 v67, v62, v63
    buffer_store_dwordx4 v[64:67], v2, s[24:27], s72 offen offset:2048 sc1
    v_accvgpr_read_b32 v68, a216
    v_accvgpr_read_b32 v69, a217
    v_accvgpr_read_b32 v70, a218
    v_accvgpr_read_b32 v71, a219
    v_accvgpr_read_b32 v72, a248
    v_accvgpr_read_b32 v73, a249
    v_accvgpr_read_b32 v74, a250
    v_accvgpr_read_b32 v75, a251
    v_mul_f32 v68, s73, v68
    v_mul_f32 v69, s73, v69
    v_mul_f32 v70, s73, v70
    v_mul_f32 v71, s73, v71
    v_mul_f32 v72, s73, v72
    v_mul_f32 v73, s73, v73
    v_mul_f32 v74, s73, v74
    v_mul_f32 v75, s73, v75
    v_cvt_pk_bf16_f32 v76, v68, v69
    v_cvt_pk_bf16_f32 v77, v70, v71
    v_cvt_pk_bf16_f32 v78, v72, v73
    v_cvt_pk_bf16_f32 v79, v74, v75
    buffer_store_dwordx4 v[76:79], v2, s[24:27], s72 offen offset:3072 sc1
    v_accvgpr_read_b32 v80, a28
    v_accvgpr_read_b32 v81, a29
    v_accvgpr_read_b32 v82, a30
    v_accvgpr_read_b32 v83, a31
    v_accvgpr_read_b32 v84, a60
    v_accvgpr_read_b32 v85, a61
    v_accvgpr_read_b32 v86, a62
    v_accvgpr_read_b32 v87, a63
    v_mul_f32 v80, s73, v80
    v_mul_f32 v81, s73, v81
    v_mul_f32 v82, s73, v82
    v_mul_f32 v83, s73, v83
    v_mul_f32 v84, s73, v84
    v_mul_f32 v85, s73, v85
    v_mul_f32 v86, s73, v86
    v_mul_f32 v87, s73, v87
    v_cvt_pk_bf16_f32 v88, v80, v81
    v_cvt_pk_bf16_f32 v89, v82, v83
    v_cvt_pk_bf16_f32 v90, v84, v85
    v_cvt_pk_bf16_f32 v91, v86, v87
    s_add_u32 s72, s71, 57344
    buffer_store_dwordx4 v[88:91], v2, s[24:27], s72 offen offset:0 sc1
    v_accvgpr_read_b32 v92, a92
    v_accvgpr_read_b32 v93, a93
    v_accvgpr_read_b32 v94, a94
    v_accvgpr_read_b32 v95, a95
    v_accvgpr_read_b32 v96, a124
    v_accvgpr_read_b32 v97, a125
    v_accvgpr_read_b32 v98, a126
    v_accvgpr_read_b32 v99, a127
    v_mul_f32 v92, s73, v92
    v_mul_f32 v93, s73, v93
    v_mul_f32 v94, s73, v94
    v_mul_f32 v95, s73, v95
    v_mul_f32 v96, s73, v96
    v_mul_f32 v97, s73, v97
    v_mul_f32 v98, s73, v98
    v_mul_f32 v99, s73, v99
    v_cvt_pk_bf16_f32 v100, v92, v93
    v_cvt_pk_bf16_f32 v101, v94, v95
    v_cvt_pk_bf16_f32 v102, v96, v97
    v_cvt_pk_bf16_f32 v103, v98, v99
    buffer_store_dwordx4 v[100:103], v2, s[24:27], s72 offen offset:1024 sc1
    v_accvgpr_read_b32 v32, a156
    v_accvgpr_read_b32 v33, a157
    v_accvgpr_read_b32 v34, a158
    v_accvgpr_read_b32 v35, a159
    v_accvgpr_read_b32 v36, a188
    v_accvgpr_read_b32 v37, a189
    v_accvgpr_read_b32 v38, a190
    v_accvgpr_read_b32 v39, a191
    v_mul_f32 v32, s73, v32
    v_mul_f32 v33, s73, v33
    v_mul_f32 v34, s73, v34
    v_mul_f32 v35, s73, v35
    v_mul_f32 v36, s73, v36
    v_mul_f32 v37, s73, v37
    v_mul_f32 v38, s73, v38
    v_mul_f32 v39, s73, v39
    v_cvt_pk_bf16_f32 v40, v32, v33
    v_cvt_pk_bf16_f32 v41, v34, v35
    v_cvt_pk_bf16_f32 v42, v36, v37
    v_cvt_pk_bf16_f32 v43, v38, v39
    buffer_store_dwordx4 v[40:43], v2, s[24:27], s72 offen offset:2048 sc1
    v_accvgpr_read_b32 v44, a220
    v_accvgpr_read_b32 v45, a221
    v_accvgpr_read_b32 v46, a222
    v_accvgpr_read_b32 v47, a223
    v_accvgpr_read_b32 v48, a252
    v_accvgpr_read_b32 v49, a253
    v_accvgpr_read_b32 v50, a254
    v_accvgpr_read_b32 v51, a255
    v_mul_f32 v44, s73, v44
    v_mul_f32 v45, s73, v45
    v_mul_f32 v46, s73, v46
    v_mul_f32 v47, s73, v47
    v_mul_f32 v48, s73, v48
    v_mul_f32 v49, s73, v49
    v_mul_f32 v50, s73, v50
    v_mul_f32 v51, s73, v51
    v_cvt_pk_bf16_f32 v52, v44, v45
    v_cvt_pk_bf16_f32 v53, v46, v47
    v_cvt_pk_bf16_f32 v54, v48, v49
    v_cvt_pk_bf16_f32 v55, v50, v51
    buffer_store_dwordx4 v[52:55], v2, s[24:27], s72 offen offset:3072 sc1
    s_branch K1_DONE
K1_EPI_F:
    v_mov_b32 v120, 0xc0135761
    v_mov_b32 v122, 0xbdd2d3e8
    v_mov_b32 v124, 1.0
    v_mov_b32 v121, 0xc0135761
    v_mov_b32 v123, 0xbdd2d3e8
    v_mov_b32 v125, 1.0
    s_nop 7
    v_accvgpr_read_b32 v32, a0
    v_accvgpr_read_b32 v33, a1
    v_accvgpr_read_b32 v34, a2
    v_accvgpr_read_b32 v35, a3
    v_accvgpr_read_b32 v40, a128
    v_accvgpr_read_b32 v41, a129
    v_accvgpr_read_b32 v42, a130
    v_accvgpr_read_b32 v43, a131
    v_accvgpr_read_b32 v36, a32
    v_accvgpr_read_b32 v37, a33
    v_accvgpr_read_b32 v38, a34
    v_accvgpr_read_b32 v39, a35
    v_accvgpr_read_b32 v44, a160
    v_accvgpr_read_b32 v45, a161
    v_accvgpr_read_b32 v46, a162
    v_accvgpr_read_b32 v47, a163
    v_pk_mul_f32 v[48:49], v[32:33], v[32:33]
    v_pk_mul_f32 v[50:51], v[34:35], v[34:35]
    v_pk_mul_f32 v[52:53], v[36:37], v[36:37]
    v_pk_mul_f32 v[54:55], v[38:39], v[38:39]
    v_pk_fma_f32 v[48:49], v[48:49], v[122:123], v[120:121]
    v_pk_fma_f32 v[50:51], v[50:51], v[122:123], v[120:121]
    v_pk_fma_f32 v[52:53], v[52:53], v[122:123], v[120:121]
    v_pk_fma_f32 v[54:55], v[54:55], v[122:123], v[120:121]
    v_pk_mul_f32 v[48:49], v[48:49], v[32:33]
    v_pk_mul_f32 v[50:51], v[50:51], v[34:35]
    v_pk_mul_f32 v[52:53], v[52:53], v[36:37]
    v_pk_mul_f32 v[54:55], v[54:55], v[38:39]
    v_exp_f32 v48, v48
    v_exp_f32 v49, v49
    v_exp_f32 v50, v50
    v_exp_f32 v51, v51
    v_exp_f32 v52, v52
    v_exp_f32 v53, v53
    v_exp_f32 v54, v54
    v_exp_f32 v55, v55
    v_pk_mul_f32 v[32:33], v[32:33], v[40:41]
    v_pk_mul_f32 v[34:35], v[34:35], v[42:43]
    v_pk_mul_f32 v[36:37], v[36:37], v[44:45]
    v_pk_mul_f32 v[38:39], v[38:39], v[46:47]
    v_pk_add_f32 v[48:49], v[48:49], v[124:125]
    v_pk_add_f32 v[50:51], v[50:51], v[124:125]
    v_pk_add_f32 v[52:53], v[52:53], v[124:125]
    v_pk_add_f32 v[54:55], v[54:55], v[124:125]
    v_rcp_f32 v48, v48
    v_rcp_f32 v49, v49
    v_rcp_f32 v50, v50
    v_rcp_f32 v51, v51
    v_rcp_f32 v52, v52
    v_rcp_f32 v53, v53
    v_rcp_f32 v54, v54
    v_rcp_f32 v55, v55
    s_nop 0
    v_pk_mul_f32 v[32:33], v[32:33], v[48:49]
    v_pk_mul_f32 v[34:35], v[34:35], v[50:51]
    v_pk_mul_f32 v[36:37], v[36:37], v[52:53]
    v_pk_mul_f32 v[38:39], v[38:39], v[54:55]
    v_cvt_pk_bf16_f32 v56, v32, v33
    v_cvt_pk_bf16_f32 v57, v34, v35
    v_cvt_pk_bf16_f32 v58, v36, v37
    v_cvt_pk_bf16_f32 v59, v38, v39
    s_add_u32 s72, s71, 0
    buffer_store_dwordx4 v[56:59], v2, s[24:27], s72 offen offset:0 sc1
    v_accvgpr_read_b32 v60, a64
    v_accvgpr_read_b32 v61, a65
    v_accvgpr_read_b32 v62, a66
    v_accvgpr_read_b32 v63, a67
    v_accvgpr_read_b32 v68, a192
    v_accvgpr_read_b32 v69, a193
    v_accvgpr_read_b32 v70, a194
    v_accvgpr_read_b32 v71, a195
    v_accvgpr_read_b32 v64, a96
    v_accvgpr_read_b32 v65, a97
    v_accvgpr_read_b32 v66, a98
    v_accvgpr_read_b32 v67, a99
    v_accvgpr_read_b32 v72, a224
    v_accvgpr_read_b32 v73, a225
    v_accvgpr_read_b32 v74, a226
    v_accvgpr_read_b32 v75, a227
    v_pk_mul_f32 v[76:77], v[60:61], v[60:61]
    v_pk_mul_f32 v[78:79], v[62:63], v[62:63]
    v_pk_mul_f32 v[80:81], v[64:65], v[64:65]
    v_pk_mul_f32 v[82:83], v[66:67], v[66:67]
    v_pk_fma_f32 v[76:77], v[76:77], v[122:123], v[120:121]
    v_pk_fma_f32 v[78:79], v[78:79], v[122:123], v[120:121]
    v_pk_fma_f32 v[80:81], v[80:81], v[122:123], v[120:121]
    v_pk_fma_f32 v[82:83], v[82:83], v[122:123], v[120:121]
    v_pk_mul_f32 v[76:77], v[76:77], v[60:61]
    v_pk_mul_f32 v[78:79], v[78:79], v[62:63]
    v_pk_mul_f32 v[80:81], v[80:81], v[64:65]
    v_pk_mul_f32 v[82:83], v[82:83], v[66:67]
    v_exp_f32 v76, v76
    v_exp_f32 v77, v77
    v_exp_f32 v78, v78
    v_exp_f32 v79, v79
    v_exp_f32 v80, v80
    v_exp_f32 v81, v81
    v_exp_f32 v82, v82
    v_exp_f32 v83, v83
    v_pk_mul_f32 v[60:61], v[60:61], v[68:69]
    v_pk_mul_f32 v[62:63], v[62:63], v[70:71]
    v_pk_mul_f32 v[64:65], v[64:65], v[72:73]
    v_pk_mul_f32 v[66:67], v[66:67], v[74:75]
    v_pk_add_f32 v[76:77], v[76:77], v[124:125]
    v_pk_add_f32 v[78:79], v[78:79], v[124:125]
    v_pk_add_f32 v[80:81], v[80:81], v[124:125]
    v_pk_add_f32 v[82:83], v[82:83], v[124:125]
    v_rcp_f32 v76, v76
    v_rcp_f32 v77, v77
    v_rcp_f32 v78, v78
    v_rcp_f32 v79, v79
    v_rcp_f32 v80, v80
    v_rcp_f32 v81, v81
    v_rcp_f32 v82, v82
    v_rcp_f32 v83, v83
    s_nop 0
    v_pk_mul_f32 v[60:61], v[60:61], v[76:77]
    v_pk_mul_f32 v[62:63], v[62:63], v[78:79]
    v_pk_mul_f32 v[64:65], v[64:65], v[80:81]
    v_pk_mul_f32 v[66:67], v[66:67], v[82:83]
    v_cvt_pk_bf16_f32 v84, v60, v61
    v_cvt_pk_bf16_f32 v85, v62, v63
    v_cvt_pk_bf16_f32 v86, v64, v65
    v_cvt_pk_bf16_f32 v87, v66, v67
    buffer_store_dwordx4 v[84:87], v2, s[24:27], s72 offen offset:1024 sc1
    v_accvgpr_read_b32 v88, a4
    v_accvgpr_read_b32 v89, a5
    v_accvgpr_read_b32 v90, a6
    v_accvgpr_read_b32 v91, a7
    v_accvgpr_read_b32 v96, a132
    v_accvgpr_read_b32 v97, a133
    v_accvgpr_read_b32 v98, a134
    v_accvgpr_read_b32 v99, a135
    v_accvgpr_read_b32 v92, a36
    v_accvgpr_read_b32 v93, a37
    v_accvgpr_read_b32 v94, a38
    v_accvgpr_read_b32 v95, a39
    v_accvgpr_read_b32 v100, a164
    v_accvgpr_read_b32 v101, a165
    v_accvgpr_read_b32 v102, a166
    v_accvgpr_read_b32 v103, a167
    v_pk_mul_f32 v[104:105], v[88:89], v[88:89]
    v_pk_mul_f32 v[106:107], v[90:91], v[90:91]
    v_pk_mul_f32 v[108:109], v[92:93], v[92:93]
    v_pk_mul_f32 v[110:111], v[94:95], v[94:95]
    v_pk_fma_f32 v[104:105], v[104:105], v[122:123], v[120:121]
    v_pk_fma_f32 v[106:107], v[106:107], v[122:123], v[120:121]
    v_pk_fma_f32 v[108:109], v[108:109], v[122:123], v[120:121]
    v_pk_fma_f32 v[110:111], v[110:111], v[122:123], v[120:121]
    v_pk_mul_f32 v[104:105], v[104:105], v[88:89]
    v_pk_mul_f32 v[106:107], v[106:107], v[90:91]
    v_pk_mul_f32 v[108:109], v[108:109], v[92:93]
    v_pk_mul_f32 v[110:111], v[110:111], v[94:95]
    v_exp_f32 v104, v104
    v_exp_f32 v105, v105
    v_exp_f32 v106, v106
    v_exp_f32 v107, v107
    v_exp_f32 v108, v108
    v_exp_f32 v109, v109
    v_exp_f32 v110, v110
    v_exp_f32 v111, v111
    v_pk_mul_f32 v[88:89], v[88:89], v[96:97]
    v_pk_mul_f32 v[90:91], v[90:91], v[98:99]
    v_pk_mul_f32 v[92:93], v[92:93], v[100:101]
    v_pk_mul_f32 v[94:95], v[94:95], v[102:103]
    v_pk_add_f32 v[104:105], v[104:105], v[124:125]
    v_pk_add_f32 v[106:107], v[106:107], v[124:125]
    v_pk_add_f32 v[108:109], v[108:109], v[124:125]
    v_pk_add_f32 v[110:111], v[110:111], v[124:125]
    v_rcp_f32 v104, v104
    v_rcp_f32 v105, v105
    v_rcp_f32 v106, v106
    v_rcp_f32 v107, v107
    v_rcp_f32 v108, v108
    v_rcp_f32 v109, v109
    v_rcp_f32 v110, v110
    v_rcp_f32 v111, v111
    s_nop 0
    v_pk_mul_f32 v[88:89], v[88:89], v[104:105]
    v_pk_mul_f32 v[90:91], v[90:91], v[106:107]
    v_pk_mul_f32 v[92:93], v[92:93], v[108:109]
    v_pk_mul_f32 v[94:95], v[94:95], v[110:111]
    v_cvt_pk_bf16_f32 v112, v88, v89
    v_cvt_pk_bf16_f32 v113, v90, v91
    v_cvt_pk_bf16_f32 v114, v92, v93
    v_cvt_pk_bf16_f32 v115, v94, v95
    s_add_u32 s72, s71, 188416
    buffer_store_dwordx4 v[112:115], v2, s[24:27], s72 offen offset:0 sc1
    v_accvgpr_read_b32 v32, a68
    v_accvgpr_read_b32 v33, a69
    v_accvgpr_read_b32 v34, a70
    v_accvgpr_read_b32 v35, a71
    v_accvgpr_read_b32 v40, a196
    v_accvgpr_read_b32 v41, a197
    v_accvgpr_read_b32 v42, a198
    v_accvgpr_read_b32 v43, a199
    v_accvgpr_read_b32 v36, a100
    v_accvgpr_read_b32 v37, a101
    v_accvgpr_read_b32 v38, a102
    v_accvgpr_read_b32 v39, a103
    v_accvgpr_read_b32 v44, a228
    v_accvgpr_read_b32 v45, a229
    v_accvgpr_read_b32 v46, a230
    v_accvgpr_read_b32 v47, a231
    v_pk_mul_f32 v[48:49], v[32:33], v[32:33]
    v_pk_mul_f32 v[50:51], v[34:35], v[34:35]
    v_pk_mul_f32 v[52:53], v[36:37], v[36:37]
    v_pk_mul_f32 v[54:55], v[38:39], v[38:39]
    v_pk_fma_f32 v[48:49], v[48:49], v[122:123], v[120:121]
    v_pk_fma_f32 v[50:51], v[50:51], v[122:123], v[120:121]
    v_pk_fma_f32 v[52:53], v[52:53], v[122:123], v[120:121]
    v_pk_fma_f32 v[54:55], v[54:55], v[122:123], v[120:121]
    v_pk_mul_f32 v[48:49], v[48:49], v[32:33]
    v_pk_mul_f32 v[50:51], v[50:51], v[34:35]
    v_pk_mul_f32 v[52:53], v[52:53], v[36:37]
    v_pk_mul_f32 v[54:55], v[54:55], v[38:39]
    v_exp_f32 v48, v48
    v_exp_f32 v49, v49
    v_exp_f32 v50, v50
    v_exp_f32 v51, v51
    v_exp_f32 v52, v52
    v_exp_f32 v53, v53
    v_exp_f32 v54, v54
    v_exp_f32 v55, v55
    v_pk_mul_f32 v[32:33], v[32:33], v[40:41]
    v_pk_mul_f32 v[34:35], v[34:35], v[42:43]
    v_pk_mul_f32 v[36:37], v[36:37], v[44:45]
    v_pk_mul_f32 v[38:39], v[38:39], v[46:47]
    v_pk_add_f32 v[48:49], v[48:49], v[124:125]
    v_pk_add_f32 v[50:51], v[50:51], v[124:125]
    v_pk_add_f32 v[52:53], v[52:53], v[124:125]
    v_pk_add_f32 v[54:55], v[54:55], v[124:125]
    v_rcp_f32 v48, v48
    v_rcp_f32 v49, v49
    v_rcp_f32 v50, v50
    v_rcp_f32 v51, v51
    v_rcp_f32 v52, v52
    v_rcp_f32 v53, v53
    v_rcp_f32 v54, v54
    v_rcp_f32 v55, v55
    s_nop 0
    v_pk_mul_f32 v[32:33], v[32:33], v[48:49]
    v_pk_mul_f32 v[34:35], v[34:35], v[50:51]
    v_pk_mul_f32 v[36:37], v[36:37], v[52:53]
    v_pk_mul_f32 v[38:39], v[38:39], v[54:55]
    v_cvt_pk_bf16_f32 v56, v32, v33
    v_cvt_pk_bf16_f32 v57, v34, v35
    v_cvt_pk_bf16_f32 v58, v36, v37
    v_cvt_pk_bf16_f32 v59, v38, v39
    buffer_store_dwordx4 v[56:59], v2, s[24:27], s72 offen offset:1024 sc1
    v_accvgpr_read_b32 v60, a8
    v_accvgpr_read_b32 v61, a9
    v_accvgpr_read_b32 v62, a10
    v_accvgpr_read_b32 v63, a11
    v_accvgpr_read_b32 v68, a136
    v_accvgpr_read_b32 v69, a137
    v_accvgpr_read_b32 v70, a138
    v_accvgpr_read_b32 v71, a139
    v_accvgpr_read_b32 v64, a40
    v_accvgpr_read_b32 v65, a41
    v_accvgpr_read_b32 v66, a42
    v_accvgpr_read_b32 v67, a43
    v_accvgpr_read_b32 v72, a168
    v_accvgpr_read_b32 v73, a169
    v_accvgpr_read_b32 v74, a170
    v_accvgpr_read_b32 v75, a171
    v_pk_mul_f32 v[76:77], v[60:61], v[60:61]
    v_pk_mul_f32 v[78:79], v[62:63], v[62:63]
    v_pk_mul_f32 v[80:81], v[64:65], v[64:65]
    v_pk_mul_f32 v[82:83], v[66:67], v[66:67]
    v_pk_fma_f32 v[76:77], v[76:77], v[122:123], v[120:121]
    v_pk_fma_f32 v[78:79], v[78:79], v[122:123], v[120:121]
    v_pk_fma_f32 v[80:81], v[80:81], v[122:123], v[120:121]
    v_pk_fma_f32 v[82:83], v[82:83], v[122:123], v[120:121]
    v_pk_mul_f32 v[76:77], v[76:77], v[60:61]
    v_pk_mul_f32 v[78:79], v[78:79], v[62:63]
    v_pk_mul_f32 v[80:81], v[80:81], v[64:65]
    v_pk_mul_f32 v[82:83], v[82:83], v[66:67]
    v_exp_f32 v76, v76
    v_exp_f32 v77, v77
    v_exp_f32 v78, v78
    v_exp_f32 v79, v79
    v_exp_f32 v80, v80
    v_exp_f32 v81, v81
    v_exp_f32 v82, v82
    v_exp_f32 v83, v83
    v_pk_mul_f32 v[60:61], v[60:61], v[68:69]
    v_pk_mul_f32 v[62:63], v[62:63], v[70:71]
    v_pk_mul_f32 v[64:65], v[64:65], v[72:73]
    v_pk_mul_f32 v[66:67], v[66:67], v[74:75]
    v_pk_add_f32 v[76:77], v[76:77], v[124:125]
    v_pk_add_f32 v[78:79], v[78:79], v[124:125]
    v_pk_add_f32 v[80:81], v[80:81], v[124:125]
    v_pk_add_f32 v[82:83], v[82:83], v[124:125]
    v_rcp_f32 v76, v76
    v_rcp_f32 v77, v77
    v_rcp_f32 v78, v78
    v_rcp_f32 v79, v79
    v_rcp_f32 v80, v80
    v_rcp_f32 v81, v81
    v_rcp_f32 v82, v82
    v_rcp_f32 v83, v83
    s_nop 0
    v_pk_mul_f32 v[60:61], v[60:61], v[76:77]
    v_pk_mul_f32 v[62:63], v[62:63], v[78:79]
    v_pk_mul_f32 v[64:65], v[64:65], v[80:81]
    v_pk_mul_f32 v[66:67], v[66:67], v[82:83]
    v_cvt_pk_bf16_f32 v84, v60, v61
    v_cvt_pk_bf16_f32 v85, v62, v63
    v_cvt_pk_bf16_f32 v86, v64, v65
    v_cvt_pk_bf16_f32 v87, v66, v67
    s_add_u32 s72, s71, 376832
    buffer_store_dwordx4 v[84:87], v2, s[24:27], s72 offen offset:0 sc1
    v_accvgpr_read_b32 v88, a72
    v_accvgpr_read_b32 v89, a73
    v_accvgpr_read_b32 v90, a74
    v_accvgpr_read_b32 v91, a75
    v_accvgpr_read_b32 v96, a200
    v_accvgpr_read_b32 v97, a201
    v_accvgpr_read_b32 v98, a202
    v_accvgpr_read_b32 v99, a203
    v_accvgpr_read_b32 v92, a104
    v_accvgpr_read_b32 v93, a105
    v_accvgpr_read_b32 v94, a106
    v_accvgpr_read_b32 v95, a107
    v_accvgpr_read_b32 v100, a232
    v_accvgpr_read_b32 v101, a233
    v_accvgpr_read_b32 v102, a234
    v_accvgpr_read_b32 v103, a235
    v_pk_mul_f32 v[104:105], v[88:89], v[88:89]
    v_pk_mul_f32 v[106:107], v[90:91], v[90:91]
    v_pk_mul_f32 v[108:109], v[92:93], v[92:93]
    v_pk_mul_f32 v[110:111], v[94:95], v[94:95]
    v_pk_fma_f32 v[104:105], v[104:105], v[122:123], v[120:121]
    v_pk_fma_f32 v[106:107], v[106:107], v[122:123], v[120:121]
    v_pk_fma_f32 v[108:109], v[108:109], v[122:123], v[120:121]
    v_pk_fma_f32 v[110:111], v[110:111], v[122:123], v[120:121]
    v_pk_mul_f32 v[104:105], v[104:105], v[88:89]
    v_pk_mul_f32 v[106:107], v[106:107], v[90:91]
    v_pk_mul_f32 v[108:109], v[108:109], v[92:93]
    v_pk_mul_f32 v[110:111], v[110:111], v[94:95]
    v_exp_f32 v104, v104
    v_exp_f32 v105, v105
    v_exp_f32 v106, v106
    v_exp_f32 v107, v107
    v_exp_f32 v108, v108
    v_exp_f32 v109, v109
    v_exp_f32 v110, v110
    v_exp_f32 v111, v111
    v_pk_mul_f32 v[88:89], v[88:89], v[96:97]
    v_pk_mul_f32 v[90:91], v[90:91], v[98:99]
    v_pk_mul_f32 v[92:93], v[92:93], v[100:101]
    v_pk_mul_f32 v[94:95], v[94:95], v[102:103]
    v_pk_add_f32 v[104:105], v[104:105], v[124:125]
    v_pk_add_f32 v[106:107], v[106:107], v[124:125]
    v_pk_add_f32 v[108:109], v[108:109], v[124:125]
    v_pk_add_f32 v[110:111], v[110:111], v[124:125]
    v_rcp_f32 v104, v104
    v_rcp_f32 v105, v105
    v_rcp_f32 v106, v106
    v_rcp_f32 v107, v107
    v_rcp_f32 v108, v108
    v_rcp_f32 v109, v109
    v_rcp_f32 v110, v110
    v_rcp_f32 v111, v111
    s_nop 0
    v_pk_mul_f32 v[88:89], v[88:89], v[104:105]
    v_pk_mul_f32 v[90:91], v[90:91], v[106:107]
    v_pk_mul_f32 v[92:93], v[92:93], v[108:109]
    v_pk_mul_f32 v[94:95], v[94:95], v[110:111]
    v_cvt_pk_bf16_f32 v112, v88, v89
    v_cvt_pk_bf16_f32 v113, v90, v91
    v_cvt_pk_bf16_f32 v114, v92, v93
    v_cvt_pk_bf16_f32 v115, v94, v95
    buffer_store_dwordx4 v[112:115], v2, s[24:27], s72 offen offset:1024 sc1
    v_accvgpr_read_b32 v32, a12
    v_accvgpr_read_b32 v33, a13
    v_accvgpr_read_b32 v34, a14
    v_accvgpr_read_b32 v35, a15
    v_accvgpr_read_b32 v40, a140
    v_accvgpr_read_b32 v41, a141
    v_accvgpr_read_b32 v42, a142
    v_accvgpr_read_b32 v43, a143
    v_accvgpr_read_b32 v36, a44
    v_accvgpr_read_b32 v37, a45
    v_accvgpr_read_b32 v38, a46
    v_accvgpr_read_b32 v39, a47
    v_accvgpr_read_b32 v44, a172
    v_accvgpr_read_b32 v45, a173
    v_accvgpr_read_b32 v46, a174
    v_accvgpr_read_b32 v47, a175
    v_pk_mul_f32 v[48:49], v[32:33], v[32:33]
    v_pk_mul_f32 v[50:51], v[34:35], v[34:35]
    v_pk_mul_f32 v[52:53], v[36:37], v[36:37]
    v_pk_mul_f32 v[54:55], v[38:39], v[38:39]
    v_pk_fma_f32 v[48:49], v[48:49], v[122:123], v[120:121]
    v_pk_fma_f32 v[50:51], v[50:51], v[122:123], v[120:121]
    v_pk_fma_f32 v[52:53], v[52:53], v[122:123], v[120:121]
    v_pk_fma_f32 v[54:55], v[54:55], v[122:123], v[120:121]
    v_pk_mul_f32 v[48:49], v[48:49], v[32:33]
    v_pk_mul_f32 v[50:51], v[50:51], v[34:35]
    v_pk_mul_f32 v[52:53], v[52:53], v[36:37]
    v_pk_mul_f32 v[54:55], v[54:55], v[38:39]
    v_exp_f32 v48, v48
    v_exp_f32 v49, v49
    v_exp_f32 v50, v50
    v_exp_f32 v51, v51
    v_exp_f32 v52, v52
    v_exp_f32 v53, v53
    v_exp_f32 v54, v54
    v_exp_f32 v55, v55
    v_pk_mul_f32 v[32:33], v[32:33], v[40:41]
    v_pk_mul_f32 v[34:35], v[34:35], v[42:43]
    v_pk_mul_f32 v[36:37], v[36:37], v[44:45]
    v_pk_mul_f32 v[38:39], v[38:39], v[46:47]
    v_pk_add_f32 v[48:49], v[48:49], v[124:125]
    v_pk_add_f32 v[50:51], v[50:51], v[124:125]
    v_pk_add_f32 v[52:53], v[52:53], v[124:125]
    v_pk_add_f32 v[54:55], v[54:55], v[124:125]
    v_rcp_f32 v48, v48
    v_rcp_f32 v49, v49
    v_rcp_f32 v50, v50
    v_rcp_f32 v51, v51
    v_rcp_f32 v52, v52
    v_rcp_f32 v53, v53
    v_rcp_f32 v54, v54
    v_rcp_f32 v55, v55
    s_nop 0
    v_pk_mul_f32 v[32:33], v[32:33], v[48:49]
    v_pk_mul_f32 v[34:35], v[34:35], v[50:51]
    v_pk_mul_f32 v[36:37], v[36:37], v[52:53]
    v_pk_mul_f32 v[38:39], v[38:39], v[54:55]
    v_cvt_pk_bf16_f32 v56, v32, v33
    v_cvt_pk_bf16_f32 v57, v34, v35
    v_cvt_pk_bf16_f32 v58, v36, v37
    v_cvt_pk_bf16_f32 v59, v38, v39
    s_add_u32 s72, s71, 565248
    buffer_store_dwordx4 v[56:59], v2, s[24:27], s72 offen offset:0 sc1
    v_accvgpr_read_b32 v60, a76
    v_accvgpr_read_b32 v61, a77
    v_accvgpr_read_b32 v62, a78
    v_accvgpr_read_b32 v63, a79
    v_accvgpr_read_b32 v68, a204
    v_accvgpr_read_b32 v69, a205
    v_accvgpr_read_b32 v70, a206
    v_accvgpr_read_b32 v71, a207
    v_accvgpr_read_b32 v64, a108
    v_accvgpr_read_b32 v65, a109
    v_accvgpr_read_b32 v66, a110
    v_accvgpr_read_b32 v67, a111
    v_accvgpr_read_b32 v72, a236
    v_accvgpr_read_b32 v73, a237
    v_accvgpr_read_b32 v74, a238
    v_accvgpr_read_b32 v75, a239
    v_pk_mul_f32 v[76:77], v[60:61], v[60:61]
    v_pk_mul_f32 v[78:79], v[62:63], v[62:63]
    v_pk_mul_f32 v[80:81], v[64:65], v[64:65]
    v_pk_mul_f32 v[82:83], v[66:67], v[66:67]
    v_pk_fma_f32 v[76:77], v[76:77], v[122:123], v[120:121]
    v_pk_fma_f32 v[78:79], v[78:79], v[122:123], v[120:121]
    v_pk_fma_f32 v[80:81], v[80:81], v[122:123], v[120:121]
    v_pk_fma_f32 v[82:83], v[82:83], v[122:123], v[120:121]
    v_pk_mul_f32 v[76:77], v[76:77], v[60:61]
    v_pk_mul_f32 v[78:79], v[78:79], v[62:63]
    v_pk_mul_f32 v[80:81], v[80:81], v[64:65]
    v_pk_mul_f32 v[82:83], v[82:83], v[66:67]
    v_exp_f32 v76, v76
    v_exp_f32 v77, v77
    v_exp_f32 v78, v78
    v_exp_f32 v79, v79
    v_exp_f32 v80, v80
    v_exp_f32 v81, v81
    v_exp_f32 v82, v82
    v_exp_f32 v83, v83
    v_pk_mul_f32 v[60:61], v[60:61], v[68:69]
    v_pk_mul_f32 v[62:63], v[62:63], v[70:71]
    v_pk_mul_f32 v[64:65], v[64:65], v[72:73]
    v_pk_mul_f32 v[66:67], v[66:67], v[74:75]
    v_pk_add_f32 v[76:77], v[76:77], v[124:125]
    v_pk_add_f32 v[78:79], v[78:79], v[124:125]
    v_pk_add_f32 v[80:81], v[80:81], v[124:125]
    v_pk_add_f32 v[82:83], v[82:83], v[124:125]
    v_rcp_f32 v76, v76
    v_rcp_f32 v77, v77
    v_rcp_f32 v78, v78
    v_rcp_f32 v79, v79
    v_rcp_f32 v80, v80
    v_rcp_f32 v81, v81
    v_rcp_f32 v82, v82
    v_rcp_f32 v83, v83
    s_nop 0
    v_pk_mul_f32 v[60:61], v[60:61], v[76:77]
    v_pk_mul_f32 v[62:63], v[62:63], v[78:79]
    v_pk_mul_f32 v[64:65], v[64:65], v[80:81]
    v_pk_mul_f32 v[66:67], v[66:67], v[82:83]
    v_cvt_pk_bf16_f32 v84, v60, v61
    v_cvt_pk_bf16_f32 v85, v62, v63
    v_cvt_pk_bf16_f32 v86, v64, v65
    v_cvt_pk_bf16_f32 v87, v66, v67
    buffer_store_dwordx4 v[84:87], v2, s[24:27], s72 offen offset:1024 sc1
    v_accvgpr_read_b32 v88, a16
    v_accvgpr_read_b32 v89, a17
    v_accvgpr_read_b32 v90, a18
    v_accvgpr_read_b32 v91, a19
    v_accvgpr_read_b32 v96, a144
    v_accvgpr_read_b32 v97, a145
    v_accvgpr_read_b32 v98, a146
    v_accvgpr_read_b32 v99, a147
    v_accvgpr_read_b32 v92, a48
    v_accvgpr_read_b32 v93, a49
    v_accvgpr_read_b32 v94, a50
    v_accvgpr_read_b32 v95, a51
    v_accvgpr_read_b32 v100, a176
    v_accvgpr_read_b32 v101, a177
    v_accvgpr_read_b32 v102, a178
    v_accvgpr_read_b32 v103, a179
    v_pk_mul_f32 v[104:105], v[88:89], v[88:89]
    v_pk_mul_f32 v[106:107], v[90:91], v[90:91]
    v_pk_mul_f32 v[108:109], v[92:93], v[92:93]
    v_pk_mul_f32 v[110:111], v[94:95], v[94:95]
    v_pk_fma_f32 v[104:105], v[104:105], v[122:123], v[120:121]
    v_pk_fma_f32 v[106:107], v[106:107], v[122:123], v[120:121]
    v_pk_fma_f32 v[108:109], v[108:109], v[122:123], v[120:121]
    v_pk_fma_f32 v[110:111], v[110:111], v[122:123], v[120:121]
    v_pk_mul_f32 v[104:105], v[104:105], v[88:89]
    v_pk_mul_f32 v[106:107], v[106:107], v[90:91]
    v_pk_mul_f32 v[108:109], v[108:109], v[92:93]
    v_pk_mul_f32 v[110:111], v[110:111], v[94:95]
    v_exp_f32 v104, v104
    v_exp_f32 v105, v105
    v_exp_f32 v106, v106
    v_exp_f32 v107, v107
    v_exp_f32 v108, v108
    v_exp_f32 v109, v109
    v_exp_f32 v110, v110
    v_exp_f32 v111, v111
    v_pk_mul_f32 v[88:89], v[88:89], v[96:97]
    v_pk_mul_f32 v[90:91], v[90:91], v[98:99]
    v_pk_mul_f32 v[92:93], v[92:93], v[100:101]
    v_pk_mul_f32 v[94:95], v[94:95], v[102:103]
    v_pk_add_f32 v[104:105], v[104:105], v[124:125]
    v_pk_add_f32 v[106:107], v[106:107], v[124:125]
    v_pk_add_f32 v[108:109], v[108:109], v[124:125]
    v_pk_add_f32 v[110:111], v[110:111], v[124:125]
    v_rcp_f32 v104, v104
    v_rcp_f32 v105, v105
    v_rcp_f32 v106, v106
    v_rcp_f32 v107, v107
    v_rcp_f32 v108, v108
    v_rcp_f32 v109, v109
    v_rcp_f32 v110, v110
    v_rcp_f32 v111, v111
    s_nop 0
    v_pk_mul_f32 v[88:89], v[88:89], v[104:105]
    v_pk_mul_f32 v[90:91], v[90:91], v[106:107]
    v_pk_mul_f32 v[92:93], v[92:93], v[108:109]
    v_pk_mul_f32 v[94:95], v[94:95], v[110:111]
    v_cvt_pk_bf16_f32 v112, v88, v89
    v_cvt_pk_bf16_f32 v113, v90, v91
    v_cvt_pk_bf16_f32 v114, v92, v93
    v_cvt_pk_bf16_f32 v115, v94, v95
    s_add_u32 s72, s71, 753664
    buffer_store_dwordx4 v[112:115], v2, s[24:27], s72 offen offset:0 sc1
    v_accvgpr_read_b32 v32, a80
    v_accvgpr_read_b32 v33, a81
    v_accvgpr_read_b32 v34, a82
    v_accvgpr_read_b32 v35, a83
    v_accvgpr_read_b32 v40, a208
    v_accvgpr_read_b32 v41, a209
    v_accvgpr_read_b32 v42, a210
    v_accvgpr_read_b32 v43, a211
    v_accvgpr_read_b32 v36, a112
    v_accvgpr_read_b32 v37, a113
    v_accvgpr_read_b32 v38, a114
    v_accvgpr_read_b32 v39, a115
    v_accvgpr_read_b32 v44, a240
    v_accvgpr_read_b32 v45, a241
    v_accvgpr_read_b32 v46, a242
    v_accvgpr_read_b32 v47, a243
    v_pk_mul_f32 v[48:49], v[32:33], v[32:33]
    v_pk_mul_f32 v[50:51], v[34:35], v[34:35]
    v_pk_mul_f32 v[52:53], v[36:37], v[36:37]
    v_pk_mul_f32 v[54:55], v[38:39], v[38:39]
    v_pk_fma_f32 v[48:49], v[48:49], v[122:123], v[120:121]
    v_pk_fma_f32 v[50:51], v[50:51], v[122:123], v[120:121]
    v_pk_fma_f32 v[52:53], v[52:53], v[122:123], v[120:121]
    v_pk_fma_f32 v[54:55], v[54:55], v[122:123], v[120:121]
    v_pk_mul_f32 v[48:49], v[48:49], v[32:33]
    v_pk_mul_f32 v[50:51], v[50:51], v[34:35]
    v_pk_mul_f32 v[52:53], v[52:53], v[36:37]
    v_pk_mul_f32 v[54:55], v[54:55], v[38:39]
    v_exp_f32 v48, v48
    v_exp_f32 v49, v49
    v_exp_f32 v50, v50
    v_exp_f32 v51, v51
    v_exp_f32 v52, v52
    v_exp_f32 v53, v53
    v_exp_f32 v54, v54
    v_exp_f32 v55, v55
    v_pk_mul_f32 v[32:33], v[32:33], v[40:41]
    v_pk_mul_f32 v[34:35], v[34:35], v[42:43]
    v_pk_mul_f32 v[36:37], v[36:37], v[44:45]
    v_pk_mul_f32 v[38:39], v[38:39], v[46:47]
    v_pk_add_f32 v[48:49], v[48:49], v[124:125]
    v_pk_add_f32 v[50:51], v[50:51], v[124:125]
    v_pk_add_f32 v[52:53], v[52:53], v[124:125]
    v_pk_add_f32 v[54:55], v[54:55], v[124:125]
    v_rcp_f32 v48, v48
    v_rcp_f32 v49, v49
    v_rcp_f32 v50, v50
    v_rcp_f32 v51, v51
    v_rcp_f32 v52, v52
    v_rcp_f32 v53, v53
    v_rcp_f32 v54, v54
    v_rcp_f32 v55, v55
    s_nop 0
    v_pk_mul_f32 v[32:33], v[32:33], v[48:49]
    v_pk_mul_f32 v[34:35], v[34:35], v[50:51]
    v_pk_mul_f32 v[36:37], v[36:37], v[52:53]
    v_pk_mul_f32 v[38:39], v[38:39], v[54:55]
    v_cvt_pk_bf16_f32 v56, v32, v33
    v_cvt_pk_bf16_f32 v57, v34, v35
    v_cvt_pk_bf16_f32 v58, v36, v37
    v_cvt_pk_bf16_f32 v59, v38, v39
    buffer_store_dwordx4 v[56:59], v2, s[24:27], s72 offen offset:1024 sc1
    v_accvgpr_read_b32 v60, a20
    v_accvgpr_read_b32 v61, a21
    v_accvgpr_read_b32 v62, a22
    v_accvgpr_read_b32 v63, a23
    v_accvgpr_read_b32 v68, a148
    v_accvgpr_read_b32 v69, a149
    v_accvgpr_read_b32 v70, a150
    v_accvgpr_read_b32 v71, a151
    v_accvgpr_read_b32 v64, a52
    v_accvgpr_read_b32 v65, a53
    v_accvgpr_read_b32 v66, a54
    v_accvgpr_read_b32 v67, a55
    v_accvgpr_read_b32 v72, a180
    v_accvgpr_read_b32 v73, a181
    v_accvgpr_read_b32 v74, a182
    v_accvgpr_read_b32 v75, a183
    v_pk_mul_f32 v[76:77], v[60:61], v[60:61]
    v_pk_mul_f32 v[78:79], v[62:63], v[62:63]
    v_pk_mul_f32 v[80:81], v[64:65], v[64:65]
    v_pk_mul_f32 v[82:83], v[66:67], v[66:67]
    v_pk_fma_f32 v[76:77], v[76:77], v[122:123], v[120:121]
    v_pk_fma_f32 v[78:79], v[78:79], v[122:123], v[120:121]
    v_pk_fma_f32 v[80:81], v[80:81], v[122:123], v[120:121]
    v_pk_fma_f32 v[82:83], v[82:83], v[122:123], v[120:121]
    v_pk_mul_f32 v[76:77], v[76:77], v[60:61]
    v_pk_mul_f32 v[78:79], v[78:79], v[62:63]
    v_pk_mul_f32 v[80:81], v[80:81], v[64:65]
    v_pk_mul_f32 v[82:83], v[82:83], v[66:67]
    v_exp_f32 v76, v76
    v_exp_f32 v77, v77
    v_exp_f32 v78, v78
    v_exp_f32 v79, v79
    v_exp_f32 v80, v80
    v_exp_f32 v81, v81
    v_exp_f32 v82, v82
    v_exp_f32 v83, v83
    v_pk_mul_f32 v[60:61], v[60:61], v[68:69]
    v_pk_mul_f32 v[62:63], v[62:63], v[70:71]
    v_pk_mul_f32 v[64:65], v[64:65], v[72:73]
    v_pk_mul_f32 v[66:67], v[66:67], v[74:75]
    v_pk_add_f32 v[76:77], v[76:77], v[124:125]
    v_pk_add_f32 v[78:79], v[78:79], v[124:125]
    v_pk_add_f32 v[80:81], v[80:81], v[124:125]
    v_pk_add_f32 v[82:83], v[82:83], v[124:125]
    v_rcp_f32 v76, v76
    v_rcp_f32 v77, v77
    v_rcp_f32 v78, v78
    v_rcp_f32 v79, v79
    v_rcp_f32 v80, v80
    v_rcp_f32 v81, v81
    v_rcp_f32 v82, v82
    v_rcp_f32 v83, v83
    s_nop 0
    v_pk_mul_f32 v[60:61], v[60:61], v[76:77]
    v_pk_mul_f32 v[62:63], v[62:63], v[78:79]
    v_pk_mul_f32 v[64:65], v[64:65], v[80:81]
    v_pk_mul_f32 v[66:67], v[66:67], v[82:83]
    v_cvt_pk_bf16_f32 v84, v60, v61
    v_cvt_pk_bf16_f32 v85, v62, v63
    v_cvt_pk_bf16_f32 v86, v64, v65
    v_cvt_pk_bf16_f32 v87, v66, v67
    s_add_u32 s72, s71, 942080
    buffer_store_dwordx4 v[84:87], v2, s[24:27], s72 offen offset:0 sc1
    v_accvgpr_read_b32 v88, a84
    v_accvgpr_read_b32 v89, a85
    v_accvgpr_read_b32 v90, a86
    v_accvgpr_read_b32 v91, a87
    v_accvgpr_read_b32 v96, a212
    v_accvgpr_read_b32 v97, a213
    v_accvgpr_read_b32 v98, a214
    v_accvgpr_read_b32 v99, a215
    v_accvgpr_read_b32 v92, a116
    v_accvgpr_read_b32 v93, a117
    v_accvgpr_read_b32 v94, a118
    v_accvgpr_read_b32 v95, a119
    v_accvgpr_read_b32 v100, a244
    v_accvgpr_read_b32 v101, a245
    v_accvgpr_read_b32 v102, a246
    v_accvgpr_read_b32 v103, a247
    v_pk_mul_f32 v[104:105], v[88:89], v[88:89]
    v_pk_mul_f32 v[106:107], v[90:91], v[90:91]
    v_pk_mul_f32 v[108:109], v[92:93], v[92:93]
    v_pk_mul_f32 v[110:111], v[94:95], v[94:95]
    v_pk_fma_f32 v[104:105], v[104:105], v[122:123], v[120:121]
    v_pk_fma_f32 v[106:107], v[106:107], v[122:123], v[120:121]
    v_pk_fma_f32 v[108:109], v[108:109], v[122:123], v[120:121]
    v_pk_fma_f32 v[110:111], v[110:111], v[122:123], v[120:121]
    v_pk_mul_f32 v[104:105], v[104:105], v[88:89]
    v_pk_mul_f32 v[106:107], v[106:107], v[90:91]
    v_pk_mul_f32 v[108:109], v[108:109], v[92:93]
    v_pk_mul_f32 v[110:111], v[110:111], v[94:95]
    v_exp_f32 v104, v104
    v_exp_f32 v105, v105
    v_exp_f32 v106, v106
    v_exp_f32 v107, v107
    v_exp_f32 v108, v108
    v_exp_f32 v109, v109
    v_exp_f32 v110, v110
    v_exp_f32 v111, v111
    v_pk_mul_f32 v[88:89], v[88:89], v[96:97]
    v_pk_mul_f32 v[90:91], v[90:91], v[98:99]
    v_pk_mul_f32 v[92:93], v[92:93], v[100:101]
    v_pk_mul_f32 v[94:95], v[94:95], v[102:103]
    v_pk_add_f32 v[104:105], v[104:105], v[124:125]
    v_pk_add_f32 v[106:107], v[106:107], v[124:125]
    v_pk_add_f32 v[108:109], v[108:109], v[124:125]
    v_pk_add_f32 v[110:111], v[110:111], v[124:125]
    v_rcp_f32 v104, v104
    v_rcp_f32 v105, v105
    v_rcp_f32 v106, v106
    v_rcp_f32 v107, v107
    v_rcp_f32 v108, v108
    v_rcp_f32 v109, v109
    v_rcp_f32 v110, v110
    v_rcp_f32 v111, v111
    s_nop 0
    v_pk_mul_f32 v[88:89], v[88:89], v[104:105]
    v_pk_mul_f32 v[90:91], v[90:91], v[106:107]
    v_pk_mul_f32 v[92:93], v[92:93], v[108:109]
    v_pk_mul_f32 v[94:95], v[94:95], v[110:111]
    v_cvt_pk_bf16_f32 v112, v88, v89
    v_cvt_pk_bf16_f32 v113, v90, v91
    v_cvt_pk_bf16_f32 v114, v92, v93
    v_cvt_pk_bf16_f32 v115, v94, v95
    buffer_store_dwordx4 v[112:115], v2, s[24:27], s72 offen offset:1024 sc1
    v_accvgpr_read_b32 v32, a24
    v_accvgpr_read_b32 v33, a25
    v_accvgpr_read_b32 v34, a26
    v_accvgpr_read_b32 v35, a27
    v_accvgpr_read_b32 v40, a152
    v_accvgpr_read_b32 v41, a153
    v_accvgpr_read_b32 v42, a154
    v_accvgpr_read_b32 v43, a155
    v_accvgpr_read_b32 v36, a56
    v_accvgpr_read_b32 v37, a57
    v_accvgpr_read_b32 v38, a58
    v_accvgpr_read_b32 v39, a59
    v_accvgpr_read_b32 v44, a184
    v_accvgpr_read_b32 v45, a185
    v_accvgpr_read_b32 v46, a186
    v_accvgpr_read_b32 v47, a187
    v_pk_mul_f32 v[48:49], v[32:33], v[32:33]
    v_pk_mul_f32 v[50:51], v[34:35], v[34:35]
    v_pk_mul_f32 v[52:53], v[36:37], v[36:37]
    v_pk_mul_f32 v[54:55], v[38:39], v[38:39]
    v_pk_fma_f32 v[48:49], v[48:49], v[122:123], v[120:121]
    v_pk_fma_f32 v[50:51], v[50:51], v[122:123], v[120:121]
    v_pk_fma_f32 v[52:53], v[52:53], v[122:123], v[120:121]
    v_pk_fma_f32 v[54:55], v[54:55], v[122:123], v[120:121]
    v_pk_mul_f32 v[48:49], v[48:49], v[32:33]
    v_pk_mul_f32 v[50:51], v[50:51], v[34:35]
    v_pk_mul_f32 v[52:53], v[52:53], v[36:37]
    v_pk_mul_f32 v[54:55], v[54:55], v[38:39]
    v_exp_f32 v48, v48
    v_exp_f32 v49, v49
    v_exp_f32 v50, v50
    v_exp_f32 v51, v51
    v_exp_f32 v52, v52
    v_exp_f32 v53, v53
    v_exp_f32 v54, v54
    v_exp_f32 v55, v55
    v_pk_mul_f32 v[32:33], v[32:33], v[40:41]
    v_pk_mul_f32 v[34:35], v[34:35], v[42:43]
    v_pk_mul_f32 v[36:37], v[36:37], v[44:45]
    v_pk_mul_f32 v[38:39], v[38:39], v[46:47]
    v_pk_add_f32 v[48:49], v[48:49], v[124:125]
    v_pk_add_f32 v[50:51], v[50:51], v[124:125]
    v_pk_add_f32 v[52:53], v[52:53], v[124:125]
    v_pk_add_f32 v[54:55], v[54:55], v[124:125]
    v_rcp_f32 v48, v48
    v_rcp_f32 v49, v49
    v_rcp_f32 v50, v50
    v_rcp_f32 v51, v51
    v_rcp_f32 v52, v52
    v_rcp_f32 v53, v53
    v_rcp_f32 v54, v54
    v_rcp_f32 v55, v55
    s_nop 0
    v_pk_mul_f32 v[32:33], v[32:33], v[48:49]
    v_pk_mul_f32 v[34:35], v[34:35], v[50:51]
    v_pk_mul_f32 v[36:37], v[36:37], v[52:53]
    v_pk_mul_f32 v[38:39], v[38:39], v[54:55]
    v_cvt_pk_bf16_f32 v56, v32, v33
    v_cvt_pk_bf16_f32 v57, v34, v35
    v_cvt_pk_bf16_f32 v58, v36, v37
    v_cvt_pk_bf16_f32 v59, v38, v39
    s_add_u32 s72, s71, 1130496
    buffer_store_dwordx4 v[56:59], v2, s[24:27], s72 offen offset:0 sc1
    v_accvgpr_read_b32 v60, a88
    v_accvgpr_read_b32 v61, a89
    v_accvgpr_read_b32 v62, a90
    v_accvgpr_read_b32 v63, a91
    v_accvgpr_read_b32 v68, a216
    v_accvgpr_read_b32 v69, a217
    v_accvgpr_read_b32 v70, a218
    v_accvgpr_read_b32 v71, a219
    v_accvgpr_read_b32 v64, a120
    v_accvgpr_read_b32 v65, a121
    v_accvgpr_read_b32 v66, a122
    v_accvgpr_read_b32 v67, a123
    v_accvgpr_read_b32 v72, a248
    v_accvgpr_read_b32 v73, a249
    v_accvgpr_read_b32 v74, a250
    v_accvgpr_read_b32 v75, a251
    v_pk_mul_f32 v[76:77], v[60:61], v[60:61]
    v_pk_mul_f32 v[78:79], v[62:63], v[62:63]
    v_pk_mul_f32 v[80:81], v[64:65], v[64:65]
    v_pk_mul_f32 v[82:83], v[66:67], v[66:67]
    v_pk_fma_f32 v[76:77], v[76:77], v[122:123], v[120:121]
    v_pk_fma_f32 v[78:79], v[78:79], v[122:123], v[120:121]
    v_pk_fma_f32 v[80:81], v[80:81], v[122:123], v[120:121]
    v_pk_fma_f32 v[82:83], v[82:83], v[122:123], v[120:121]
    v_pk_mul_f32 v[76:77], v[76:77], v[60:61]
    v_pk_mul_f32 v[78:79], v[78:79], v[62:63]
    v_pk_mul_f32 v[80:81], v[80:81], v[64:65]
    v_pk_mul_f32 v[82:83], v[82:83], v[66:67]
    v_exp_f32 v76, v76
    v_exp_f32 v77, v77
    v_exp_f32 v78, v78
    v_exp_f32 v79, v79
    v_exp_f32 v80, v80
    v_exp_f32 v81, v81
    v_exp_f32 v82, v82
    v_exp_f32 v83, v83
    v_pk_mul_f32 v[60:61], v[60:61], v[68:69]
    v_pk_mul_f32 v[62:63], v[62:63], v[70:71]
    v_pk_mul_f32 v[64:65], v[64:65], v[72:73]
    v_pk_mul_f32 v[66:67], v[66:67], v[74:75]
    v_pk_add_f32 v[76:77], v[76:77], v[124:125]
    v_pk_add_f32 v[78:79], v[78:79], v[124:125]
    v_pk_add_f32 v[80:81], v[80:81], v[124:125]
    v_pk_add_f32 v[82:83], v[82:83], v[124:125]
    v_rcp_f32 v76, v76
    v_rcp_f32 v77, v77
    v_rcp_f32 v78, v78
    v_rcp_f32 v79, v79
    v_rcp_f32 v80, v80
    v_rcp_f32 v81, v81
    v_rcp_f32 v82, v82
    v_rcp_f32 v83, v83
    s_nop 0
    v_pk_mul_f32 v[60:61], v[60:61], v[76:77]
    v_pk_mul_f32 v[62:63], v[62:63], v[78:79]
    v_pk_mul_f32 v[64:65], v[64:65], v[80:81]
    v_pk_mul_f32 v[66:67], v[66:67], v[82:83]
    v_cvt_pk_bf16_f32 v84, v60, v61
    v_cvt_pk_bf16_f32 v85, v62, v63
    v_cvt_pk_bf16_f32 v86, v64, v65
    v_cvt_pk_bf16_f32 v87, v66, v67
    buffer_store_dwordx4 v[84:87], v2, s[24:27], s72 offen offset:1024 sc1
    v_accvgpr_read_b32 v88, a28
    v_accvgpr_read_b32 v89, a29
    v_accvgpr_read_b32 v90, a30
    v_accvgpr_read_b32 v91, a31
    v_accvgpr_read_b32 v96, a156
    v_accvgpr_read_b32 v97, a157
    v_accvgpr_read_b32 v98, a158
    v_accvgpr_read_b32 v99, a159
    v_accvgpr_read_b32 v92, a60
    v_accvgpr_read_b32 v93, a61
    v_accvgpr_read_b32 v94, a62
    v_accvgpr_read_b32 v95, a63
    v_accvgpr_read_b32 v100, a188
    v_accvgpr_read_b32 v101, a189
    v_accvgpr_read_b32 v102, a190
    v_accvgpr_read_b32 v103, a191
    v_pk_mul_f32 v[104:105], v[88:89], v[88:89]
    v_pk_mul_f32 v[106:107], v[90:91], v[90:91]
    v_pk_mul_f32 v[108:109], v[92:93], v[92:93]
    v_pk_mul_f32 v[110:111], v[94:95], v[94:95]
    v_pk_fma_f32 v[104:105], v[104:105], v[122:123], v[120:121]
    v_pk_fma_f32 v[106:107], v[106:107], v[122:123], v[120:121]
    v_pk_fma_f32 v[108:109], v[108:109], v[122:123], v[120:121]
    v_pk_fma_f32 v[110:111], v[110:111], v[122:123], v[120:121]
    v_pk_mul_f32 v[104:105], v[104:105], v[88:89]
    v_pk_mul_f32 v[106:107], v[106:107], v[90:91]
    v_pk_mul_f32 v[108:109], v[108:109], v[92:93]
    v_pk_mul_f32 v[110:111], v[110:111], v[94:95]
    v_exp_f32 v104, v104
    v_exp_f32 v105, v105
    v_exp_f32 v106, v106
    v_exp_f32 v107, v107
    v_exp_f32 v108, v108
    v_exp_f32 v109, v109
    v_exp_f32 v110, v110
    v_exp_f32 v111, v111
    v_pk_mul_f32 v[88:89], v[88:89], v[96:97]
    v_pk_mul_f32 v[90:91], v[90:91], v[98:99]
    v_pk_mul_f32 v[92:93], v[92:93], v[100:101]
    v_pk_mul_f32 v[94:95], v[94:95], v[102:103]
    v_pk_add_f32 v[104:105], v[104:105], v[124:125]
    v_pk_add_f32 v[106:107], v[106:107], v[124:125]
    v_pk_add_f32 v[108:109], v[108:109], v[124:125]
    v_pk_add_f32 v[110:111], v[110:111], v[124:125]
    v_rcp_f32 v104, v104
    v_rcp_f32 v105, v105
    v_rcp_f32 v106, v106
    v_rcp_f32 v107, v107
    v_rcp_f32 v108, v108
    v_rcp_f32 v109, v109
    v_rcp_f32 v110, v110
    v_rcp_f32 v111, v111
    s_nop 0
    v_pk_mul_f32 v[88:89], v[88:89], v[104:105]
    v_pk_mul_f32 v[90:91], v[90:91], v[106:107]
    v_pk_mul_f32 v[92:93], v[92:93], v[108:109]
    v_pk_mul_f32 v[94:95], v[94:95], v[110:111]
    v_cvt_pk_bf16_f32 v112, v88, v89
    v_cvt_pk_bf16_f32 v113, v90, v91
    v_cvt_pk_bf16_f32 v114, v92, v93
    v_cvt_pk_bf16_f32 v115, v94, v95
    s_add_u32 s72, s71, 1318912
    buffer_store_dwordx4 v[112:115], v2, s[24:27], s72 offen offset:0 sc1
    v_accvgpr_read_b32 v32, a92
    v_accvgpr_read_b32 v33, a93
    v_accvgpr_read_b32 v34, a94
    v_accvgpr_read_b32 v35, a95
    v_accvgpr_read_b32 v40, a220
    v_accvgpr_read_b32 v41, a221
    v_accvgpr_read_b32 v42, a222
    v_accvgpr_read_b32 v43, a223
    v_accvgpr_read_b32 v36, a124
    v_accvgpr_read_b32 v37, a125
    v_accvgpr_read_b32 v38, a126
    v_accvgpr_read_b32 v39, a127
    v_accvgpr_read_b32 v44, a252
    v_accvgpr_read_b32 v45, a253
    v_accvgpr_read_b32 v46, a254
    v_accvgpr_read_b32 v47, a255
    v_pk_mul_f32 v[48:49], v[32:33], v[32:33]
    v_pk_mul_f32 v[50:51], v[34:35], v[34:35]
    v_pk_mul_f32 v[52:53], v[36:37], v[36:37]
    v_pk_mul_f32 v[54:55], v[38:39], v[38:39]
    v_pk_fma_f32 v[48:49], v[48:49], v[122:123], v[120:121]
    v_pk_fma_f32 v[50:51], v[50:51], v[122:123], v[120:121]
    v_pk_fma_f32 v[52:53], v[52:53], v[122:123], v[120:121]
    v_pk_fma_f32 v[54:55], v[54:55], v[122:123], v[120:121]
    v_pk_mul_f32 v[48:49], v[48:49], v[32:33]
    v_pk_mul_f32 v[50:51], v[50:51], v[34:35]
    v_pk_mul_f32 v[52:53], v[52:53], v[36:37]
    v_pk_mul_f32 v[54:55], v[54:55], v[38:39]
    v_exp_f32 v48, v48
    v_exp_f32 v49, v49
    v_exp_f32 v50, v50
    v_exp_f32 v51, v51
    v_exp_f32 v52, v52
    v_exp_f32 v53, v53
    v_exp_f32 v54, v54
    v_exp_f32 v55, v55
    v_pk_mul_f32 v[32:33], v[32:33], v[40:41]
    v_pk_mul_f32 v[34:35], v[34:35], v[42:43]
    v_pk_mul_f32 v[36:37], v[36:37], v[44:45]
    v_pk_mul_f32 v[38:39], v[38:39], v[46:47]
    v_pk_add_f32 v[48:49], v[48:49], v[124:125]
    v_pk_add_f32 v[50:51], v[50:51], v[124:125]
    v_pk_add_f32 v[52:53], v[52:53], v[124:125]
    v_pk_add_f32 v[54:55], v[54:55], v[124:125]
    v_rcp_f32 v48, v48
    v_rcp_f32 v49, v49
    v_rcp_f32 v50, v50
    v_rcp_f32 v51, v51
    v_rcp_f32 v52, v52
    v_rcp_f32 v53, v53
    v_rcp_f32 v54, v54
    v_rcp_f32 v55, v55
    s_nop 0
    v_pk_mul_f32 v[32:33], v[32:33], v[48:49]
    v_pk_mul_f32 v[34:35], v[34:35], v[50:51]
    v_pk_mul_f32 v[36:37], v[36:37], v[52:53]
    v_pk_mul_f32 v[38:39], v[38:39], v[54:55]
    v_cvt_pk_bf16_f32 v56, v32, v33
    v_cvt_pk_bf16_f32 v57, v34, v35
    v_cvt_pk_bf16_f32 v58, v36, v37
    v_cvt_pk_bf16_f32 v59, v38, v39
    buffer_store_dwordx4 v[56:59], v2, s[24:27], s72 offen offset:1024 sc1
    s_branch K1_DONE
K1_GATE:
    s_add_u32 s72, s70, 0
    buffer_store_dwordx4 v[32:35], v2, s[24:27], s72 offen offset:0 sc1
    s_add_u32 s72, s70, 0
    buffer_store_dwordx4 v[36:39], v2, s[24:27], s72 offen offset:1024 sc1
    s_add_u32 s72, s70, 0
    buffer_store_dwordx4 v[40:43], v2, s[24:27], s72 offen offset:2048 sc1
    s_add_u32 s72, s70, 0
    buffer_store_dwordx4 v[44:47], v2, s[24:27], s72 offen offset:3072 sc1
    s_add_u32 s72, s70, 0
    s_add_u32 s72, s72, s75
    buffer_store_dwordx4 v[48:51], v2, s[24:27], s72 offen offset:0 sc1
    s_add_u32 s72, s70, 0
    s_add_u32 s72, s72, s75
    buffer_store_dwordx4 v[52:55], v2, s[24:27], s72 offen offset:1024 sc1
    s_add_u32 s72, s70, 0
    s_add_u32 s72, s72, s75
    buffer_store_dwordx4 v[56:59], v2, s[24:27], s72 offen offset:2048 sc1
    s_add_u32 s72, s70, 0
    s_add_u32 s72, s72, s75
    buffer_store_dwordx4 v[60:63], v2, s[24:27], s72 offen offset:3072 sc1
    s_add_u32 s72, s70, 16384
    buffer_store_dwordx4 v[64:67], v2, s[24:27], s72 offen offset:0 sc1
    s_add_u32 s72, s70, 16384
    buffer_store_dwordx4 v[68:71], v2, s[24:27], s72 offen offset:1024 sc1
    s_add_u32 s72, s70, 16384
    buffer_store_dwordx4 v[72:75], v2, s[24:27], s72 offen offset:2048 sc1
    s_add_u32 s72, s70, 16384
    buffer_store_dwordx4 v[76:79], v2, s[24:27], s72 offen offset:3072 sc1
    s_add_u32 s72, s70, 16384
    s_add_u32 s72, s72, s75
    buffer_store_dwordx4 v[80:83], v2, s[24:27], s72 offen offset:0 sc1
    s_add_u32 s72, s70, 16384
    s_add_u32 s72, s72, s75
    buffer_store_dwordx4 v[84:87], v2, s[24:27], s72 offen offset:1024 sc1
    s_add_u32 s72, s70, 16384
    s_add_u32 s72, s72, s75
    buffer_store_dwordx4 v[88:91], v2, s[24:27], s72 offen offset:2048 sc1
    s_add_u32 s72, s70, 16384
    s_add_u32 s72, s72, s75
    buffer_store_dwordx4 v[92:95], v2, s[24:27], s72 offen offset:3072 sc1
    s_add_u32 s72, s70, 32768
    buffer_store_dwordx4 v[96:99], v2, s[24:27], s72 offen offset:0 sc1
    s_add_u32 s72, s70, 32768
    buffer_store_dwordx4 v[100:103], v2, s[24:27], s72 offen offset:1024 sc1
    s_add_u32 s72, s70, 32768
    buffer_store_dwordx4 v[104:107], v2, s[24:27], s72 offen offset:2048 sc1
    s_add_u32 s72, s70, 32768
    buffer_store_dwordx4 v[108:111], v2, s[24:27], s72 offen offset:3072 sc1
    s_add_u32 s72, s70, 32768
    s_add_u32 s72, s72, s75
    buffer_store_dwordx4 v[112:115], v2, s[24:27], s72 offen offset:0 sc1
    s_add_u32 s72, s70, 32768
    s_add_u32 s72, s72, s75
    buffer_store_dwordx4 v[116:119], v2, s[24:27], s72 offen offset:1024 sc1
    s_add_u32 s72, s70, 32768
    s_add_u32 s72, s72, s75
    buffer_store_dwordx4 v[120:123], v2, s[24:27], s72 offen offset:2048 sc1
    s_add_u32 s72, s70, 32768
    s_add_u32 s72, s72, s75
    buffer_store_dwordx4 v[192:195], v2, s[24:27], s72 offen offset:3072 sc1
    s_add_u32 s72, s70, 49152
    buffer_store_dwordx4 v[196:199], v2, s[24:27], s72 offen offset:0 sc1
    s_add_u32 s72, s70, 49152
    buffer_store_dwordx4 v[200:203], v2, s[24:27], s72 offen offset:1024 sc1
    s_add_u32 s72, s70, 49152
    buffer_store_dwordx4 v[204:207], v2, s[24:27], s72 offen offset:2048 sc1
    s_add_u32 s72, s70, 49152
    buffer_store_dwordx4 v[208:211], v2, s[24:27], s72 offen offset:3072 sc1
    s_add_u32 s72, s70, 49152
    s_add_u32 s72, s72, s75
    buffer_store_dwordx4 v[212:215], v2, s[24:27], s72 offen offset:0 sc1
    s_add_u32 s72, s70, 49152
    s_add_u32 s72, s72, s75
    buffer_store_dwordx4 v[216:219], v2, s[24:27], s72 offen offset:1024 sc1
    s_add_u32 s72, s70, 49152
    s_add_u32 s72, s72, s75
    buffer_store_dwordx4 v[220:223], v2, s[24:27], s72 offen offset:2048 sc1
    s_add_u32 s72, s70, 49152
    s_add_u32 s72, s72, s75
    buffer_store_dwordx4 v[224:227], v2, s[24:27], s72 offen offset:3072 sc1
    s_lshl_b32 s92, s2, 2
    s_add_u32 s92, s92, s3
    s_mov_b32 s31, 0x20000
    s_mov_b32 s28, s98
    s_mov_b32 s29, s99
    s_mov_b32 s30, 3670016
    s_mul_i32 s93, s92, 3584
    v_lshlrev_b32 v32, 7, v1
    v_add_u32 v32, s93, v32
    v_cmp_gt_u32 vcc, 28, v1
    v_mov_b32 v33, 0x7f000000
    s_nop 0
    v_cndmask_b32 v32, v33, v32, vcc
    buffer_load_dword v3, v32, s[28:31], 0 offen
    s_mov_b32 s28, s100
    s_mov_b32 s29, s101
    s_mov_b32 s30, 1605632
    s_mul_i32 s93, s92, 1664
    v_lshlrev_b32 v32, 7, v1
    v_add_u32 v32, s93, v32
    v_cmp_gt_u32 vcc, 13, v1
    v_mov_b32 v33, 0x7f000000
    s_nop 0
    v_cndmask_b32 v32, v33, v32, vcc
    buffer_load_dword v3, v32, s[28:31], 0 offen
    s_waitcnt vmcnt(0)
    s_mov_b32 s12, s88
    s_mov_b32 s13, s89
    s_mov_b32 s14, 896
    s_mov_b32 s15, 0x20000
    s_lshl_b32 s74, s82, 7
    s_lshl_b32 s75, s3, 5
    s_add_u32 s74, s74, s75
    v_and_b32 v32, 31, v1
    v_add_u32 v32, s74, v32
    v_lshrrev_b32 v33, 5, v1
    v_lshlrev_b32 v33, 4, v33
    s_movk_i32 s75, 896
    v_mul_lo_u32 v34, v32, s75
    v_add_u32 v34, v34, v33
    v_mov_b32 v35, 0
    buffer_load_dwordx4 v[40:43], v34, s[16:19], 0 offen offset:0
    buffer_load_dwordx4 v[44:47], v33, s[12:15], 0 offen offset:0
    buffer_load_dwordx4 v[48:51], v34, s[16:19], 0 offen offset:32
    buffer_load_dwordx4 v[52:55], v33, s[12:15], 0 offen offset:32
    buffer_load_dwordx4 v[56:59], v34, s[16:19], 0 offen offset:64
    buffer_load_dwordx4 v[60:63], v33, s[12:15], 0 offen offset:64
    buffer_load_dwordx4 v[64:67], v34, s[16:19], 0 offen offset:96
    buffer_load_dwordx4 v[68:71], v33, s[12:15], 0 offen offset:96
    s_waitcnt vmcnt(0)
    v_dot2_f32_bf16 v35, v40, v44, v35
    v_dot2_f32_bf16 v35, v41, v45, v35
    v_dot2_f32_bf16 v35, v42, v46, v35
    v_dot2_f32_bf16 v35, v43, v47, v35
    v_dot2_f32_bf16 v35, v48, v52, v35
    v_dot2_f32_bf16 v35, v49, v53, v35
    v_dot2_f32_bf16 v35, v50, v54, v35
    v_dot2_f32_bf16 v35, v51, v55, v35
    v_dot2_f32_bf16 v35, v56, v60, v35
    v_dot2_f32_bf16 v35, v57, v61, v35
    v_dot2_f32_bf16 v35, v58, v62, v35
    v_dot2_f32_bf16 v35, v59, v63, v35
    v_dot2_f32_bf16 v35, v64, v68, v35
    v_dot2_f32_bf16 v35, v65, v69, v35
    v_dot2_f32_bf16 v35, v66, v70, v35
    v_dot2_f32_bf16 v35, v67, v71, v35
    buffer_load_dwordx4 v[40:43], v34, s[16:19], 0 offen offset:128
    buffer_load_dwordx4 v[44:47], v33, s[12:15], 0 offen offset:128
    buffer_load_dwordx4 v[48:51], v34, s[16:19], 0 offen offset:160
    buffer_load_dwordx4 v[52:55], v33, s[12:15], 0 offen offset:160
    buffer_load_dwordx4 v[56:59], v34, s[16:19], 0 offen offset:192
    buffer_load_dwordx4 v[60:63], v33, s[12:15], 0 offen offset:192
    buffer_load_dwordx4 v[64:67], v34, s[16:19], 0 offen offset:224
    buffer_load_dwordx4 v[68:71], v33, s[12:15], 0 offen offset:224
    s_waitcnt vmcnt(0)
    v_dot2_f32_bf16 v35, v40, v44, v35
    v_dot2_f32_bf16 v35, v41, v45, v35
    v_dot2_f32_bf16 v35, v42, v46, v35
    v_dot2_f32_bf16 v35, v43, v47, v35
    v_dot2_f32_bf16 v35, v48, v52, v35
    v_dot2_f32_bf16 v35, v49, v53, v35
    v_dot2_f32_bf16 v35, v50, v54, v35
    v_dot2_f32_bf16 v35, v51, v55, v35
    v_dot2_f32_bf16 v35, v56, v60, v35
    v_dot2_f32_bf16 v35, v57, v61, v35
    v_dot2_f32_bf16 v35, v58, v62, v35
    v_dot2_f32_bf16 v35, v59, v63, v35
    v_dot2_f32_bf16 v35, v64, v68, v35
    v_dot2_f32_bf16 v35, v65, v69, v35
    v_dot2_f32_bf16 v35, v66, v70, v35
    v_dot2_f32_bf16 v35, v67, v71, v35
    buffer_load_dwordx4 v[40:43], v34, s[16:19], 0 offen offset:256
    buffer_load_dwordx4 v[44:47], v33, s[12:15], 0 offen offset:256
    buffer_load_dwordx4 v[48:51], v34, s[16:19], 0 offen offset:288
    buffer_load_dwordx4 v[52:55], v33, s[12:15], 0 offen offset:288
    buffer_load_dwordx4 v[56:59], v34, s[16:19], 0 offen offset:320
    buffer_load_dwordx4 v[60:63], v33, s[12:15], 0 offen offset:320
    buffer_load_dwordx4 v[64:67], v34, s[16:19], 0 offen offset:352
    buffer_load_dwordx4 v[68:71], v33, s[12:15], 0 offen offset:352
    s_waitcnt vmcnt(0)
    v_dot2_f32_bf16 v35, v40, v44, v35
    v_dot2_f32_bf16 v35, v41, v45, v35
    v_dot2_f32_bf16 v35, v42, v46, v35
    v_dot2_f32_bf16 v35, v43, v47, v35
    v_dot2_f32_bf16 v35, v48, v52, v35
    v_dot2_f32_bf16 v35, v49, v53, v35
    v_dot2_f32_bf16 v35, v50, v54, v35
    v_dot2_f32_bf16 v35, v51, v55, v35
    v_dot2_f32_bf16 v35, v56, v60, v35
    v_dot2_f32_bf16 v35, v57, v61, v35
    v_dot2_f32_bf16 v35, v58, v62, v35
    v_dot2_f32_bf16 v35, v59, v63, v35
    v_dot2_f32_bf16 v35, v64, v68, v35
    v_dot2_f32_bf16 v35, v65, v69, v35
    v_dot2_f32_bf16 v35, v66, v70, v35
    v_dot2_f32_bf16 v35, v67, v71, v35
    buffer_load_dwordx4 v[40:43], v34, s[16:19], 0 offen offset:384
    buffer_load_dwordx4 v[44:47], v33, s[12:15], 0 offen offset:384
    buffer_load_dwordx4 v[48:51], v34, s[16:19], 0 offen offset:416
    buffer_load_dwordx4 v[52:55], v33, s[12:15], 0 offen offset:416
    buffer_load_dwordx4 v[56:59], v34, s[16:19], 0 offen offset:448
    buffer_load_dwordx4 v[60:63], v33, s[12:15], 0 offen offset:448
    buffer_load_dwordx4 v[64:67], v34, s[16:19], 0 offen offset:480
    buffer_load_dwordx4 v[68:71], v33, s[12:15], 0 offen offset:480
    s_waitcnt vmcnt(0)
    v_dot2_f32_bf16 v35, v40, v44, v35
    v_dot2_f32_bf16 v35, v41, v45, v35
    v_dot2_f32_bf16 v35, v42, v46, v35
    v_dot2_f32_bf16 v35, v43, v47, v35
    v_dot2_f32_bf16 v35, v48, v52, v35
    v_dot2_f32_bf16 v35, v49, v53, v35
    v_dot2_f32_bf16 v35, v50, v54, v35
    v_dot2_f32_bf16 v35, v51, v55, v35
    v_dot2_f32_bf16 v35, v56, v60, v35
    v_dot2_f32_bf16 v35, v57, v61, v35
    v_dot2_f32_bf16 v35, v58, v62, v35
    v_dot2_f32_bf16 v35, v59, v63, v35
    v_dot2_f32_bf16 v35, v64, v68, v35
    v_dot2_f32_bf16 v35, v65, v69, v35
    v_dot2_f32_bf16 v35, v66, v70, v35
    v_dot2_f32_bf16 v35, v67, v71, v35
    buffer_load_dwordx4 v[40:43], v34, s[16:19], 0 offen offset:512
    buffer_load_dwordx4 v[44:47], v33, s[12:15], 0 offen offset:512
    buffer_load_dwordx4 v[48:51], v34, s[16:19], 0 offen offset:544
    buffer_load_dwordx4 v[52:55], v33, s[12:15], 0 offen offset:544
    buffer_load_dwordx4 v[56:59], v34, s[16:19], 0 offen offset:576
    buffer_load_dwordx4 v[60:63], v33, s[12:15], 0 offen offset:576
    buffer_load_dwordx4 v[64:67], v34, s[16:19], 0 offen offset:608
    buffer_load_dwordx4 v[68:71], v33, s[12:15], 0 offen offset:608
    s_waitcnt vmcnt(0)
    v_dot2_f32_bf16 v35, v40, v44, v35
    v_dot2_f32_bf16 v35, v41, v45, v35
    v_dot2_f32_bf16 v35, v42, v46, v35
    v_dot2_f32_bf16 v35, v43, v47, v35
    v_dot2_f32_bf16 v35, v48, v52, v35
    v_dot2_f32_bf16 v35, v49, v53, v35
    v_dot2_f32_bf16 v35, v50, v54, v35
    v_dot2_f32_bf16 v35, v51, v55, v35
    v_dot2_f32_bf16 v35, v56, v60, v35
    v_dot2_f32_bf16 v35, v57, v61, v35
    v_dot2_f32_bf16 v35, v58, v62, v35
    v_dot2_f32_bf16 v35, v59, v63, v35
    v_dot2_f32_bf16 v35, v64, v68, v35
    v_dot2_f32_bf16 v35, v65, v69, v35
    v_dot2_f32_bf16 v35, v66, v70, v35
    v_dot2_f32_bf16 v35, v67, v71, v35
    buffer_load_dwordx4 v[40:43], v34, s[16:19], 0 offen offset:640
    buffer_load_dwordx4 v[44:47], v33, s[12:15], 0 offen offset:640
    buffer_load_dwordx4 v[48:51], v34, s[16:19], 0 offen offset:672
    buffer_load_dwordx4 v[52:55], v33, s[12:15], 0 offen offset:672
    buffer_load_dwordx4 v[56:59], v34, s[16:19], 0 offen offset:704
    buffer_load_dwordx4 v[60:63], v33, s[12:15], 0 offen offset:704
    buffer_load_dwordx4 v[64:67], v34, s[16:19], 0 offen offset:736
    buffer_load_dwordx4 v[68:71], v33, s[12:15], 0 offen offset:736
    s_waitcnt vmcnt(0)
    v_dot2_f32_bf16 v35, v40, v44, v35
    v_dot2_f32_bf16 v35, v41, v45, v35
    v_dot2_f32_bf16 v35, v42, v46, v35
    v_dot2_f32_bf16 v35, v43, v47, v35
    v_dot2_f32_bf16 v35, v48, v52, v35
    v_dot2_f32_bf16 v35, v49, v53, v35
    v_dot2_f32_bf16 v35, v50, v54, v35
    v_dot2_f32_bf16 v35, v51, v55, v35
    v_dot2_f32_bf16 v35, v56, v60, v35
    v_dot2_f32_bf16 v35, v57, v61, v35
    v_dot2_f32_bf16 v35, v58, v62, v35
    v_dot2_f32_bf16 v35, v59, v63, v35
    v_dot2_f32_bf16 v35, v64, v68, v35
    v_dot2_f32_bf16 v35, v65, v69, v35
    v_dot2_f32_bf16 v35, v66, v70, v35
    v_dot2_f32_bf16 v35, v67, v71, v35
    buffer_load_dwordx4 v[40:43], v34, s[16:19], 0 offen offset:768
    buffer_load_dwordx4 v[44:47], v33, s[12:15], 0 offen offset:768
    buffer_load_dwordx4 v[48:51], v34, s[16:19], 0 offen offset:800
    buffer_load_dwordx4 v[52:55], v33, s[12:15], 0 offen offset:800
    buffer_load_dwordx4 v[56:59], v34, s[16:19], 0 offen offset:832
    buffer_load_dwordx4 v[60:63], v33, s[12:15], 0 offen offset:832
    buffer_load_dwordx4 v[64:67], v34, s[16:19], 0 offen offset:864
    buffer_load_dwordx4 v[68:71], v33, s[12:15], 0 offen offset:864
    s_waitcnt vmcnt(0)
    v_dot2_f32_bf16 v35, v40, v44, v35
    v_dot2_f32_bf16 v35, v41, v45, v35
    v_dot2_f32_bf16 v35, v42, v46, v35
    v_dot2_f32_bf16 v35, v43, v47, v35
    v_dot2_f32_bf16 v35, v48, v52, v35
    v_dot2_f32_bf16 v35, v49, v53, v35
    v_dot2_f32_bf16 v35, v50, v54, v35
    v_dot2_f32_bf16 v35, v51, v55, v35
    v_dot2_f32_bf16 v35, v56, v60, v35
    v_dot2_f32_bf16 v35, v57, v61, v35
    v_dot2_f32_bf16 v35, v58, v62, v35
    v_dot2_f32_bf16 v35, v59, v63, v35
    v_dot2_f32_bf16 v35, v64, v68, v35
    v_dot2_f32_bf16 v35, v65, v69, v35
    v_dot2_f32_bf16 v35, v66, v70, v35
    v_dot2_f32_bf16 v35, v67, v71, v35
    s_nop 3
    v_mov_b32 v36, v35
    s_nop 1
    v_permlane32_swap_b32 v35, v36
    s_nop 1
    v_add_f32 v35, v35, v36
    v_mul_f32 v35, 0xbfb8aa3b, v35
    v_exp_f32 v35, v35
    s_nop 0
    v_add_f32 v35, 1.0, v35
    v_rcp_f32 v35, v35
    v_lshlrev_b32 v32, 2, v32
    v_add_u32 v32, 75497472, v32
    v_cmp_gt_u32 vcc, 32, v1
    s_and_saveexec_b64 s[76:77], vcc
    buffer_store_dword v35, v32, s[24:27], 0 offen
    s_mov_b64 exec, s[76:77]
K1_DONE:
K1_END:
    s_endpgm
.globl k2_attn_kernel
.p2align 8
.type k2_attn_kernel,@function
k2_attn_kernel:
    s_cmp_ge_u32 s2, 256
    s_cbranch_scc1 K2_END
    s_load_dwordx2 s[44:45], s[0:1], 104
    s_load_dwordx2 s[46:47], s[0:1], 96
    s_load_dwordx2 s[78:79], s[0:1], 40
    s_load_dwordx2 s[80:81], s[0:1], 72
    v_lshrrev_b32 v2, 6, v0
    v_and_b32 v1, 63, v0
    s_nop 0
    v_readfirstlane_b32 s3, v2
    s_getpc_b64 s[48:49]
CPF_2:
    v_lshlrev_b32 v112, 7, v0
    v_min_u32 v113, K2_END-CPF_2-4, v112
    global_load_dword v9, v113, s[48:49]
    v_add_u32 v112, 32768, v112
    v_min_u32 v113, K2_END-CPF_2-4, v112
    global_load_dword v9, v113, s[48:49]
    s_and_b32 s4, s2, 7
    s_lshr_b32 s5, s2, 3
    s_and_b32 s6, s5, 1
    s_lshl_b32 s24, s4, 1
    s_add_u32 s24, s24, s6
    s_lshr_b32 s5, s5, 1
    s_and_b32 s25, s5, 7
    s_lshr_b32 s26, s5, 3
    s_lshl_b32 s36, s3, 13
    s_mov_b32 s37, 268435456
    v_lshlrev_b32 v2, 4, v1
    v_add_u32 v4, s36, v2
    v_add_u32 v5, 0x1000, v4
    s_mov_b32 s10, 268435456
    s_mov_b32 s11, 0x20000
    s_mov_b32 s14, 268435456
    s_mov_b32 s15, 0x20000
    s_mov_b32 s18, 268435456
    s_mov_b32 s19, 0x20000
    s_sub_u32 s27, 15, s25
    s_lshl_b32 s4, s25, 1
    s_sub_u32 s5, 14, s4
    s_cmp_eq_u32 s26, 0
    s_cselect_b32 s28, 0, 18
    s_cselect_b32 s29, 18, s5
    s_cselect_b32 s30, 2, 0
    s_mov_b32 s86, 0
    s_waitcnt lgkmcnt(0)
    s_mov_b32 s8, s44
    s_mov_b32 s9, s45
    s_mov_b32 s12, s44
    s_mov_b32 s13, s45
    s_mov_b32 s16, s44
    s_mov_b32 s17, s45
    s_mov_b32 s20, s46
    s_mov_b32 s21, s47
    s_mov_b32 s22, 256
    s_mov_b32 s23, 0x20000
    s_mov_b32 s40, s44
    s_mov_b32 s41, s45
    s_mov_b32 s42, 0
    s_mov_b32 s43, 0x20000
    s_cmp_gt_i32 s5, 0
    s_cbranch_scc1 K2_SEG
    s_cmp_eq_u32 s26, 0
    s_cbranch_scc0 K2_SEG2
    s_add_u32 s29, s29, s5
    s_mov_b32 s30, 1
K2_SEG:
    s_barrier
    s_lshl_b32 s89, s24, 5
    s_add_u32 s89, s89, s28
    s_lshl_b32 s89, s89, 15
    s_add_u32 s32, s89, 16777216
    s_add_u32 s34, s89, 33554432
    s_lshl_b32 s90, s29, 15
    s_add_u32 s33, s32, s90
    s_add_u32 s35, s34, s90
    s_mov_b32 s10, s37
    s_mov_b32 s14, s37
    s_cmp_lt_u32 s32, s33
    s_cselect_b32 s10, s37, 0
    s_add_u32 m0, s36, 0
    s_nop 0
    buffer_load_dwordx4 v4, s[8:11], s32 offen offset:0 lds
    s_lshl_b32 s4, s24, 3
    s_add_u32 s4, s4, s25
    s_lshr_b32 s4, s4, 1
    s_lshl_b32 s4, s4, 2
    v_mov_b32 v13, s4
    v_mov_b32 v14, 0
    s_mov_b32 s91, 0x41400000
    v_add_u32 v3, 0x10000, v2
    buffer_load_dwordx4 v4, s[8:11], s32 offen offset:1024 lds
    v_lshrrev_b32 v6, 4, v1
    v_lshlrev_b32 v6, 2, v6
    v_and_b32 v112, 15, v1
    v_sub_u32 v6, v6, v112
    v_mov_b32 v7, 0xf149f2ca
    v_mov_b32 v112, 0x3f803f80
    v_accvgpr_write_b32 a64, v112
    v_accvgpr_write_b32 a65, v112
    buffer_load_dwordx4 v4, s[8:11], s32 offen offset:2048 lds
    v_accvgpr_write_b32 a66, v112
    v_accvgpr_write_b32 a67, v112
    s_lshr_b32 s4, s24, 1
    s_mul_i32 s4, s4, 7
    s_and_b32 s5, s24, 1
    s_lshl_b32 s7, s5, 2
    s_add_u32 s4, s4, s7
    s_cmp_eq_u32 s5, 0
    s_cselect_b32 s62, s37, 0
    buffer_load_dwordx4 v4, s[8:11], s32 offen offset:3072 lds
    s_mov_b32 s60, s16
    s_mov_b32 s61, s17
    s_mov_b32 s63, 0x20000
    s_lshl_b32 s7, s27, 3
    s_add_u32 s7, s7, s3
    s_mul_i32 s7, s7, 184
    s_add_u32 s7, s7, s4
    s_add_u32 s7, s7, 128
    s_add_u32 m0, s36, 4096
    s_nop 0
    buffer_load_dwordx4 v5, s[8:11], s32 offen offset:0 lds
    s_lshl_b32 s7, s7, 10
    s_add_u32 s87, s7, 50331648
    s_add_u32 s88, s87, 753664
    v_lshrrev_b32 v10, 3, v1
    v_mul_u32_u24 v10, 896, v10
    v_lshrrev_b32 v11, 4, v1
    v_lshlrev_b32 v11, 1, v11
    v_and_b32 v112, 7, v1
    buffer_load_dwordx4 v5, s[8:11], s32 offen offset:1024 lds
    v_xor_b32 v11, v11, v112
    v_lshl_add_u32 v10, v11, 4, v10
    s_lshl_b32 s4, s4, 5
    s_lshl_b32 s5, s3, 5
    s_add_u32 s4, s4, s5
    s_mul_i32 s4, s4, 896
    v_add_u32 v11, s4, v10
    s_lshl_b32 s4, s24, 8
    buffer_load_dwordx4 v5, s[8:11], s32 offen offset:2048 lds
    s_lshl_b32 s5, s3, 6
    s_add_u32 s4, s4, s5
    s_mul_i32 s4, s4, 896
    v_add_u32 v10, s4, v10
    s_mov_b32 s52, s78
    s_mov_b32 s53, s79
    s_mov_b32 s54, 3670016
    s_mov_b32 s55, 0x20000
    buffer_load_dwordx4 v5, s[8:11], s32 offen offset:3072 lds
    s_mov_b32 s56, s80
    s_mov_b32 s57, s81
    s_mov_b32 s58, 1605632
    s_mov_b32 s59, 0x20000
    s_mov_b32 s76, 3670016
    s_mov_b32 s77, 1605632
    s_lshl_b32 s4, s27, 7
    s_lshl_b32 s5, s3, 4
    s_add_u32 s32, s32, 0x8000
    s_lshl_b32 s89, s24, 7
    s_lshl_b32 s90, s27, 3
    s_add_u32 s89, s89, s90
    s_add_u32 s89, s89, s3
    s_lshl_b32 s89, s89, 13
    s_add_u32 s89, s89, 0
    s_add_u32 s90, s89, 0
    buffer_load_dwordx4 a[0:3], v2, s[16:19], s90 offen offset:0
    s_add_u32 s4, s4, s5
    v_and_b32 v112, 15, v1
    v_add_u32 v112, s4, v112
    v_lshlrev_b32 v112, 2, v112
    s_mov_b32 s64, 0
    s_mov_b32 s65, 6144
    s_mov_b32 s66, 12288
    s_mov_b32 s67, 18432
    buffer_load_dwordx4 a[8:11], v2, s[16:19], s90 offen offset:1024
    s_mov_b32 s68, 28672
    s_mov_b32 s69, 34816
    s_mov_b32 s70, 40960
    s_mov_b32 s71, 47104
    v_mov_b32 v128, 0
    v_mov_b32 v129, 0
    v_mov_b32 v130, 0
    v_mov_b32 v131, 0
    buffer_load_dwordx4 a[16:19], v2, s[16:19], s90 offen offset:2048
    v_mov_b32 v132, 0
    v_mov_b32 v133, 0
    v_mov_b32 v134, 0
    v_mov_b32 v135, 0
    v_mov_b32 v136, 0
    v_mov_b32 v137, 0
    v_mov_b32 v138, 0
    v_mov_b32 v139, 0
    buffer_load_dwordx4 a[24:27], v2, s[16:19], s90 offen offset:3072
    v_mov_b32 v140, 0
    v_mov_b32 v141, 0
    v_mov_b32 v142, 0
    v_mov_b32 v143, 0
    v_mov_b32 v144, 0
    v_mov_b32 v145, 0
    v_mov_b32 v146, 0
    v_mov_b32 v147, 0
    s_add_u32 s90, s89, 4096
    buffer_load_dwordx4 a[32:35], v2, s[16:19], s90 offen offset:0
    v_mov_b32 v148, 0
    v_mov_b32 v149, 0
    v_mov_b32 v150, 0
    v_mov_b32 v151, 0
    v_mov_b32 v152, 0
    v_mov_b32 v153, 0
    v_mov_b32 v154, 0
    v_mov_b32 v155, 0
    buffer_load_dwordx4 a[40:43], v2, s[16:19], s90 offen offset:1024
    v_mov_b32 v156, 0
    v_mov_b32 v157, 0
    v_mov_b32 v158, 0
    v_mov_b32 v159, 0
    v_mov_b32 v160, 0
    v_mov_b32 v161, 0
    v_mov_b32 v162, 0
    v_mov_b32 v163, 0
    buffer_load_dwordx4 a[48:51], v2, s[16:19], s90 offen offset:2048
    v_mov_b32 v164, 0
    v_mov_b32 v165, 0
    v_mov_b32 v166, 0
    v_mov_b32 v167, 0
    v_mov_b32 v168, 0
    v_mov_b32 v169, 0
    v_mov_b32 v170, 0
    v_mov_b32 v171, 0
    buffer_load_dwordx4 a[56:59], v2, s[16:19], s90 offen offset:3072
    v_mov_b32 v172, 0
    v_mov_b32 v173, 0
    v_mov_b32 v174, 0
    v_mov_b32 v175, 0
    v_mov_b32 v176, 0
    v_mov_b32 v177, 0
    v_mov_b32 v178, 0
    v_mov_b32 v179, 0
    s_add_u32 s90, s89, 32768
    buffer_load_dwordx4 a[4:7], v2, s[16:19], s90 offen offset:0
    v_mov_b32 v180, 0
    v_mov_b32 v181, 0
    v_mov_b32 v182, 0
    v_mov_b32 v183, 0
    v_mov_b32 v184, 0
    v_mov_b32 v185, 0
    v_mov_b32 v186, 0
    v_mov_b32 v187, 0
    buffer_load_dwordx4 a[12:15], v2, s[16:19], s90 offen offset:1024
    v_mov_b32 v188, 0
    v_mov_b32 v189, 0
    v_mov_b32 v190, 0
    v_mov_b32 v191, 0
    v_mov_b32 v192, 0
    v_mov_b32 v193, 0
    v_mov_b32 v194, 0
    v_mov_b32 v195, 0
    buffer_load_dwordx4 a[20:23], v2, s[16:19], s90 offen offset:2048
    v_mov_b32 v196, 0
    v_mov_b32 v197, 0
    v_mov_b32 v198, 0
    v_mov_b32 v199, 0
    v_mov_b32 v200, 0
    v_mov_b32 v201, 0
    v_mov_b32 v202, 0
    v_mov_b32 v203, 0
    buffer_load_dwordx4 a[28:31], v2, s[16:19], s90 offen offset:3072
    v_mov_b32 v204, 0
    v_mov_b32 v205, 0
    v_mov_b32 v206, 0
    v_mov_b32 v207, 0
    v_mov_b32 v208, 0
    v_mov_b32 v209, 0
    v_mov_b32 v210, 0
    v_mov_b32 v211, 0
    s_add_u32 s90, s89, 36864
    buffer_load_dwordx4 a[36:39], v2, s[16:19], s90 offen offset:0
    v_mov_b32 v212, 0
    v_mov_b32 v213, 0
    v_mov_b32 v214, 0
    v_mov_b32 v215, 0
    v_mov_b32 v216, 0
    v_mov_b32 v217, 0
    v_mov_b32 v218, 0
    v_mov_b32 v219, 0
    buffer_load_dwordx4 a[44:47], v2, s[16:19], s90 offen offset:1024
    v_mov_b32 v220, 0
    v_mov_b32 v221, 0
    v_mov_b32 v222, 0
    v_mov_b32 v223, 0
    v_mov_b32 v224, 0
    v_mov_b32 v225, 0
    v_mov_b32 v226, 0
    v_mov_b32 v227, 0
    buffer_load_dwordx4 a[52:55], v2, s[16:19], s90 offen offset:2048
    v_mov_b32 v228, 0
    v_mov_b32 v229, 0
    v_mov_b32 v230, 0
    v_mov_b32 v231, 0
    v_mov_b32 v232, 0
    v_mov_b32 v233, 0
    v_mov_b32 v234, 0
    v_mov_b32 v235, 0
    buffer_load_dwordx4 a[60:63], v2, s[16:19], s90 offen offset:3072
    v_mov_b32 v236, 0
    v_mov_b32 v237, 0
    v_mov_b32 v238, 0
    v_mov_b32 v239, 0
    v_mov_b32 v240, 0
    v_mov_b32 v241, 0
    v_mov_b32 v242, 0
    v_mov_b32 v243, 0
    v_mov_b32 v244, 0
    v_mov_b32 v245, 0
    v_mov_b32 v246, 0
    v_mov_b32 v247, 0
    v_mov_b32 v248, 0
    v_mov_b32 v249, 0
    v_mov_b32 v250, 0
    v_mov_b32 v251, 0
    v_mov_b32 v252, 0
    v_mov_b32 v253, 0
    v_mov_b32 v254, 0
    v_mov_b32 v255, 0
    v_mov_b32 v104, 0
    v_mov_b32 v105, 0
    v_mov_b32 v106, 0
    v_mov_b32 v107, 0
    v_mov_b32 v108, 0
    v_mov_b32 v109, 0
    v_mov_b32 v110, 0
    v_mov_b32 v111, 0
    v_mov_b32 v96, 0
    v_mov_b32 v97, 0
    v_mov_b32 v98, 0
    v_mov_b32 v99, 0
    v_mov_b32 v100, 0
    v_mov_b32 v101, 0
    v_mov_b32 v102, 0
    v_mov_b32 v103, 0
    s_mov_b32 s7, 75497472
    buffer_load_dword v9, v112, s[16:19], s7 offen
    buffer_load_dword v12, v112, s[16:19], s7 offen offset:256
K2_SEG_BOOK:
    s_lshl_b32 s4, s27, 1
    s_sub_u32 s39, s4, s28
    s_lshl_b32 s4, s27, 7
    s_lshl_b32 s5, s3, 4
    s_add_u32 s4, s4, s5
    s_lshl_b32 s5, s28, 6
    s_sub_u32 s38, s4, s5
    s_cmp_eq_u32 s86, 1
    s_cbranch_scc1 K2_W34
    s_waitcnt vmcnt(2)
    s_branch K2_WDONE
K2_W34:
    s_waitcnt vmcnt(20)
K2_WDONE:
    s_barrier
    ds_read_b128 a[68:71], v2 offset:0
    ds_read_b128 a[72:75], v2 offset:1024
    ds_read_b128 a[76:79], v2 offset:2048
    ds_read_b128 a[80:83], v2 offset:3072
    ds_read_b128 a[84:87], v2 offset:4096
    ds_read_b128 a[88:91], v2 offset:5120
    s_waitcnt lgkmcnt(5)
    v_mfma_f32_16x16x32_bf16 v[16:19], a[68:71], a[0:3], v[96:99]
    ds_read_b128 a[92:95], v2 offset:6144
    s_cmp_lt_u32 s34, s35
    s_cselect_b32 s14, s37, 0
    s_add_u32 m0, s36, 65536
    v_mfma_f32_16x16x32_bf16 v[20:23], a[68:71], a[4:7], v[100:103]
    buffer_load_dwordx4 v4, s[12:15], s34 offen offset:0 lds
    s_waitcnt lgkmcnt(5)
    v_mfma_f32_16x16x32_bf16 v[16:19], a[72:75], a[8:11], v[16:19]
    ds_read_b128 a[96:99], v2 offset:7168
    v_mfma_f32_16x16x32_bf16 v[20:23], a[72:75], a[12:15], v[20:23]
    s_waitcnt lgkmcnt(1)
    v_mfma_f32_16x16x32_bf16 v[16:19], a[76:79], a[16:19], v[16:19]
    ds_read_b128 a[100:103], v2 offset:8192
    buffer_load_dwordx4 v4, s[12:15], s34 offen offset:1024 lds
    v_mfma_f32_16x16x32_bf16 v[20:23], a[76:79], a[20:23], v[20:23]
    v_mfma_f32_16x16x32_bf16 v[16:19], a[80:83], a[24:27], v[16:19]
    ds_read_b128 a[104:107], v2 offset:9216
    v_mfma_f32_16x16x32_bf16 v[20:23], a[80:83], a[28:31], v[20:23]
    buffer_load_dwordx4 v4, s[12:15], s34 offen offset:2048 lds
    v_mfma_f32_16x16x32_bf16 v[16:19], a[84:87], a[32:35], v[16:19]
    ds_read_b128 a[108:111], v2 offset:10240
    v_mfma_f32_16x16x32_bf16 v[20:23], a[84:87], a[36:39], v[20:23]
    v_mfma_f32_16x16x32_bf16 v[16:19], a[88:91], a[40:43], v[16:19]
    ds_read_b128 a[112:115], v2 offset:11264
    buffer_load_dwordx4 v4, s[12:15], s34 offen offset:3072 lds
    v_mfma_f32_16x16x32_bf16 v[20:23], a[88:91], a[44:47], v[20:23]
    v_mfma_f32_16x16x32_bf16 v[16:19], a[92:95], a[48:51], v[16:19]
    ds_read_b128 a[116:119], v2 offset:12288
    v_mfma_f32_16x16x32_bf16 v[20:23], a[92:95], a[52:55], v[20:23]
    s_add_u32 m0, s36, 69632
    s_waitcnt lgkmcnt(1)
    v_mfma_f32_16x16x32_bf16 v[16:19], a[96:99], a[56:59], v[16:19]
    ds_read_b128 a[120:123], v2 offset:13312
    buffer_load_dwordx4 v5, s[12:15], s34 offen offset:0 lds
    v_mfma_f32_16x16x32_bf16 v[20:23], a[96:99], a[60:63], v[20:23]
    v_mfma_f32_16x16x32_bf16 v[24:27], a[100:103], a[0:3], v[96:99]
    ds_read_b128 a[124:127], v2 offset:14336
    v_mfma_f32_16x16x32_bf16 v[28:31], a[100:103], a[4:7], v[100:103]
    buffer_load_dwordx4 v5, s[12:15], s34 offen offset:1024 lds
    v_mfma_f32_16x16x32_bf16 v[24:27], a[104:107], a[8:11], v[24:27]
    ds_read_b128 a[128:131], v2 offset:15360
    v_mfma_f32_16x16x32_bf16 v[28:31], a[104:107], a[12:15], v[28:31]
    v_mfma_f32_16x16x32_bf16 v[24:27], a[108:111], a[16:19], v[24:27]
    ds_read_b128 a[68:71], v2 offset:16384
    buffer_load_dwordx4 v5, s[12:15], s34 offen offset:2048 lds
    v_mfma_f32_16x16x32_bf16 v[28:31], a[108:111], a[20:23], v[28:31]
    v_mfma_f32_16x16x32_bf16 v[24:27], a[112:115], a[24:27], v[24:27]
    ds_read_b128 a[72:75], v2 offset:17408
    v_mfma_f32_16x16x32_bf16 v[28:31], a[112:115], a[28:31], v[28:31]
    buffer_load_dwordx4 v5, s[12:15], s34 offen offset:3072 lds
    s_waitcnt lgkmcnt(1)
    v_mfma_f32_16x16x32_bf16 v[24:27], a[116:119], a[32:35], v[24:27]
    ds_read_b128 a[76:79], v2 offset:18432
    v_mfma_f32_16x16x32_bf16 v[28:31], a[116:119], a[36:39], v[28:31]
    v_mfma_f32_16x16x32_bf16 v[24:27], a[120:123], a[40:43], v[24:27]
    ds_read_b128 a[80:83], v2 offset:19456
    s_add_u32 s34, s34, 0x8000
    s_cmp_lt_u32 s32, s33
    s_cselect_b32 s10, s37, 0
    s_add_u32 m0, s36, 32768
    v_mfma_f32_16x16x32_bf16 v[28:31], a[120:123], a[44:47], v[28:31]
    buffer_load_dwordx4 v4, s[8:11], s32 offen offset:0 lds
    v_mfma_f32_16x16x32_bf16 v[24:27], a[124:127], a[48:51], v[24:27]
    ds_read_b128 a[84:87], v2 offset:20480
    v_mfma_f32_16x16x32_bf16 v[28:31], a[124:127], a[52:55], v[28:31]
    v_mfma_f32_16x16x32_bf16 v[24:27], a[128:131], a[56:59], v[24:27]
    ds_read_b128 a[88:91], v2 offset:21504
    buffer_load_dwordx4 v4, s[8:11], s32 offen offset:1024 lds
    v_mfma_f32_16x16x32_bf16 v[28:31], a[128:131], a[60:63], v[28:31]
    v_mfma_f32_16x16x32_bf16 v[32:35], a[68:71], a[0:3], v[96:99]
    ds_read_b128 a[92:95], v2 offset:22528
    v_mfma_f32_16x16x32_bf16 v[36:39], a[68:71], a[4:7], v[100:103]
    buffer_load_dwordx4 v4, s[8:11], s32 offen offset:2048 lds
    s_waitcnt lgkmcnt(1)
    v_mfma_f32_16x16x32_bf16 v[32:35], a[72:75], a[8:11], v[32:35]
    ds_read_b128 a[96:99], v2 offset:23552
    v_mfma_f32_16x16x32_bf16 v[36:39], a[72:75], a[12:15], v[36:39]
    v_mfma_f32_16x16x32_bf16 v[32:35], a[76:79], a[16:19], v[32:35]
    ds_read_b128 a[100:103], v2 offset:24576
    buffer_load_dwordx4 v4, s[8:11], s32 offen offset:3072 lds
    v_mfma_f32_16x16x32_bf16 v[36:39], a[76:79], a[20:23], v[36:39]
    v_mfma_f32_16x16x32_bf16 v[32:35], a[80:83], a[24:27], v[32:35]
    ds_read_b128 a[104:107], v2 offset:25600
    v_mfma_f32_16x16x32_bf16 v[36:39], a[80:83], a[28:31], v[36:39]
    s_add_u32 m0, s36, 36864
    v_mfma_f32_16x16x32_bf16 v[32:35], a[84:87], a[32:35], v[32:35]
    ds_read_b128 a[108:111], v2 offset:26624
    buffer_load_dwordx4 v5, s[8:11], s32 offen offset:0 lds
    v_mfma_f32_16x16x32_bf16 v[36:39], a[84:87], a[36:39], v[36:39]
    v_mfma_f32_16x16x32_bf16 v[32:35], a[88:91], a[40:43], v[32:35]
    ds_read_b128 a[112:115], v2 offset:27648
    v_mfma_f32_16x16x32_bf16 v[36:39], a[88:91], a[44:47], v[36:39]
    buffer_load_dwordx4 v5, s[8:11], s32 offen offset:1024 lds
    s_waitcnt lgkmcnt(1)
    v_mfma_f32_16x16x32_bf16 v[32:35], a[92:95], a[48:51], v[32:35]
    ds_read_b128 a[116:119], v2 offset:28672
    v_mfma_f32_16x16x32_bf16 v[36:39], a[92:95], a[52:55], v[36:39]
    v_mfma_f32_16x16x32_bf16 v[32:35], a[96:99], a[56:59], v[32:35]
    ds_read_b128 a[120:123], v2 offset:29696
    buffer_load_dwordx4 v5, s[8:11], s32 offen offset:2048 lds
    v_mfma_f32_16x16x32_bf16 v[36:39], a[96:99], a[60:63], v[36:39]
    v_mfma_f32_16x16x32_bf16 v[40:43], a[100:103], a[0:3], v[96:99]
    ds_read_b128 a[124:127], v2 offset:30720
    v_mfma_f32_16x16x32_bf16 v[44:47], a[100:103], a[4:7], v[100:103]
    buffer_load_dwordx4 v5, s[8:11], s32 offen offset:3072 lds
    v_mfma_f32_16x16x32_bf16 v[40:43], a[104:107], a[8:11], v[40:43]
    ds_read_b128 a[128:131], v2 offset:31744
    v_mfma_f32_16x16x32_bf16 v[44:47], a[104:107], a[12:15], v[44:47]
    v_mfma_f32_16x16x32_bf16 v[40:43], a[108:111], a[16:19], v[40:43]
    s_add_u32 s32, s32, 0x8000
    v_mfma_f32_16x16x32_bf16 v[44:47], a[108:111], a[20:23], v[44:47]
    s_waitcnt lgkmcnt(0)
    v_mfma_f32_16x16x32_bf16 v[40:43], a[112:115], a[24:27], v[40:43]
    v_mfma_f32_16x16x32_bf16 v[44:47], a[112:115], a[28:31], v[44:47]
    v_mfma_f32_16x16x32_bf16 v[40:43], a[116:119], a[32:35], v[40:43]
    v_mfma_f32_16x16x32_bf16 v[44:47], a[116:119], a[36:39], v[44:47]
    v_mfma_f32_16x16x32_bf16 v[40:43], a[120:123], a[40:43], v[40:43]
    v_mfma_f32_16x16x32_bf16 v[44:47], a[120:123], a[44:47], v[44:47]
    v_mfma_f32_16x16x32_bf16 v[40:43], a[124:127], a[48:51], v[40:43]
    v_mfma_f32_16x16x32_bf16 v[44:47], a[124:127], a[52:55], v[44:47]
    v_mfma_f32_16x16x32_bf16 v[40:43], a[128:131], a[56:59], v[40:43]
    v_mfma_f32_16x16x32_bf16 v[44:47], a[128:131], a[60:63], v[44:47]
    s_nop 7
    s_cmp_gt_i32 s39, 0
    s_cbranch_scc1 K2_P_NOMASK
    v_subrev_u32 v112, s38, v6
    v_cmp_ge_i32 s[44:45], 0, v112
    v_cmp_ge_i32 s[46:47], -1, v112
    v_cmp_ge_i32 s[48:49], -2, v112
    v_cmp_ge_i32 s[50:51], -3, v112
    s_nop 1
    v_cndmask_b32 v16, v7, v16, s[44:45]
    v_cndmask_b32 v17, v7, v17, s[46:47]
    v_cndmask_b32 v18, v7, v18, s[48:49]
    v_cndmask_b32 v19, v7, v19, s[50:51]
    v_cmp_ge_i32 s[44:45], 64, v112
    v_cmp_ge_i32 s[46:47], 63, v112
    v_cmp_ge_i32 s[48:49], 62, v112
    v_cmp_ge_i32 s[50:51], 61, v112
    s_nop 1
    v_cndmask_b32 v20, v7, v20, s[44:45]
    v_cndmask_b32 v21, v7, v21, s[46:47]
    v_cndmask_b32 v22, v7, v22, s[48:49]
    v_cndmask_b32 v23, v7, v23, s[50:51]
    v_cmp_ge_i32 s[44:45], -16, v112
    v_mov_b32 v114, -17
    v_cmp_ge_i32 s[46:47], v114, v112
    v_mov_b32 v115, -18
    v_cmp_ge_i32 s[48:49], v115, v112
    v_mov_b32 v116, -19
    v_cmp_ge_i32 s[50:51], v116, v112
    s_nop 1
    v_cndmask_b32 v24, v7, v24, s[44:45]
    v_cndmask_b32 v25, v7, v25, s[46:47]
    v_cndmask_b32 v26, v7, v26, s[48:49]
    v_cndmask_b32 v27, v7, v27, s[50:51]
    v_cmp_ge_i32 s[44:45], 48, v112
    v_cmp_ge_i32 s[46:47], 47, v112
    v_cmp_ge_i32 s[48:49], 46, v112
    v_cmp_ge_i32 s[50:51], 45, v112
    s_nop 1
    v_cndmask_b32 v28, v7, v28, s[44:45]
    v_cndmask_b32 v29, v7, v29, s[46:47]
    v_cndmask_b32 v30, v7, v30, s[48:49]
    v_cndmask_b32 v31, v7, v31, s[50:51]
    v_mov_b32 v113, -32
    v_cmp_ge_i32 s[44:45], v113, v112
    v_mov_b32 v114, -33
    v_cmp_ge_i32 s[46:47], v114, v112
    v_mov_b32 v115, -34
    v_cmp_ge_i32 s[48:49], v115, v112
    v_mov_b32 v116, -35
    v_cmp_ge_i32 s[50:51], v116, v112
    s_nop 1
    v_cndmask_b32 v32, v7, v32, s[44:45]
    v_cndmask_b32 v33, v7, v33, s[46:47]
    v_cndmask_b32 v34, v7, v34, s[48:49]
    v_cndmask_b32 v35, v7, v35, s[50:51]
    v_cmp_ge_i32 s[44:45], 32, v112
    v_cmp_ge_i32 s[46:47], 31, v112
    v_cmp_ge_i32 s[48:49], 30, v112
    v_cmp_ge_i32 s[50:51], 29, v112
    s_nop 1
    v_cndmask_b32 v36, v7, v36, s[44:45]
    v_cndmask_b32 v37, v7, v37, s[46:47]
    v_cndmask_b32 v38, v7, v38, s[48:49]
    v_cndmask_b32 v39, v7, v39, s[50:51]
    v_mov_b32 v113, -48
    v_cmp_ge_i32 s[44:45], v113, v112
    v_mov_b32 v114, -49
    v_cmp_ge_i32 s[46:47], v114, v112
    v_mov_b32 v115, -50
    v_cmp_ge_i32 s[48:49], v115, v112
    v_mov_b32 v116, -51
    v_cmp_ge_i32 s[50:51], v116, v112
    s_nop 1
    v_cndmask_b32 v40, v7, v40, s[44:45]
    v_cndmask_b32 v41, v7, v41, s[46:47]
    v_cndmask_b32 v42, v7, v42, s[48:49]
    v_cndmask_b32 v43, v7, v43, s[50:51]
    v_cmp_ge_i32 s[44:45], 16, v112
    v_cmp_ge_i32 s[46:47], 15, v112
    v_cmp_ge_i32 s[48:49], 14, v112
    v_cmp_ge_i32 s[50:51], 13, v112
    s_nop 1
    v_cndmask_b32 v44, v7, v44, s[44:45]
    v_cndmask_b32 v45, v7, v45, s[46:47]
    v_cndmask_b32 v46, v7, v46, s[48:49]
    v_cndmask_b32 v47, v7, v47, s[50:51]
K2_P_NOMASK:
    s_sub_u32 s39, s39, 1
    s_sub_u32 s38, s38, 64
    s_nop 7
    s_nop 3
    v_max3_f32 v112, v16, v17, v18
    v_max3_f32 v112, v112, v19, v24
    v_max3_f32 v112, v112, v25, v26
    v_max3_f32 v112, v112, v27, v32
    v_max3_f32 v112, v112, v33, v34
    v_max3_f32 v112, v112, v35, v40
    v_max3_f32 v112, v112, v41, v42
    v_max_f32 v112, v112, v43
    v_mov_b32 v113, v112
    s_nop 1
    v_permlane16_swap_b32 v112, v113
    s_nop 1
    v_max_f32 v112, v112, v113
    v_mov_b32 v113, v112
    s_nop 1
    v_permlane32_swap_b32 v112, v113
    s_nop 1
    v_max_f32 v112, v112, v113
    v_cmp_gt_f32 vcc, 0xe0ad78ec, v112
    s_nop 1
    v_cndmask_b32_e64 v112, v112, 0, vcc
    v_sub_f32 v16, v16, v112
    v_sub_f32 v17, v17, v112
    v_sub_f32 v18, v18, v112
    v_sub_f32 v19, v19, v112
    v_sub_f32 v24, v24, v112
    v_sub_f32 v25, v25, v112
    v_sub_f32 v26, v26, v112
    v_sub_f32 v27, v27, v112
    v_sub_f32 v32, v32, v112
    v_sub_f32 v33, v33, v112
    v_sub_f32 v34, v34, v112
    v_sub_f32 v35, v35, v112
    v_sub_f32 v40, v40, v112
    v_sub_f32 v41, v41, v112
    v_sub_f32 v42, v42, v112
    v_sub_f32 v43, v43, v112
    v_sub_f32 v96, v96, v112
    v_sub_f32 v97, v97, v112
    v_sub_f32 v98, v98, v112
    v_sub_f32 v99, v99, v112
    v_max3_f32 v114, v20, v21, v22
    v_max3_f32 v114, v114, v23, v28
    v_max3_f32 v114, v114, v29, v30
    v_max3_f32 v114, v114, v31, v36
    v_max3_f32 v114, v114, v37, v38
    v_max3_f32 v114, v114, v39, v44
    v_max3_f32 v114, v114, v45, v46
    v_max_f32 v114, v114, v47
    v_mov_b32 v115, v114
    s_nop 1
    v_permlane16_swap_b32 v114, v115
    s_nop 1
    v_max_f32 v114, v114, v115
    v_mov_b32 v115, v114
    s_nop 1
    v_permlane32_swap_b32 v114, v115
    s_nop 1
    v_max_f32 v114, v114, v115
    v_cmp_gt_f32 vcc, 0xe0ad78ec, v114
    s_nop 1
    v_cndmask_b32_e64 v114, v114, 0, vcc
    v_sub_f32 v20, v20, v114
    v_sub_f32 v21, v21, v114
    v_sub_f32 v22, v22, v114
    v_sub_f32 v23, v23, v114
    v_sub_f32 v28, v28, v114
    v_sub_f32 v29, v29, v114
    v_sub_f32 v30, v30, v114
    v_sub_f32 v31, v31, v114
    v_sub_f32 v36, v36, v114
    v_sub_f32 v37, v37, v114
    v_sub_f32 v38, v38, v114
    v_sub_f32 v39, v39, v114
    v_sub_f32 v44, v44, v114
    v_sub_f32 v45, v45, v114
    v_sub_f32 v46, v46, v114
    v_sub_f32 v47, v47, v114
    v_sub_f32 v100, v100, v114
    v_sub_f32 v101, v101, v114
    v_sub_f32 v102, v102, v114
    v_sub_f32 v103, v103, v114
    s_nop 1
    s_waitcnt vmcnt(0) lgkmcnt(0)
    s_barrier
    s_cmp_eq_u32 s86, 1
    s_cbranch_scc0 K2_NOFLAG
    s_mov_b32 s86, 0
    s_cmp_lg_u32 s3, 0
    s_cbranch_scc1 K2_NOFLAG
    s_and_b32 s5, s25, 1
    s_lshl_b32 s5, s5, 4
    s_lshl_b32 s5, 1, s5
    v_mov_b32 v112, s5
    v_cmp_eq_u32 vcc, 0, v1
    s_and_saveexec_b64 s[6:7], vcc
    buffer_atomic_add v112, v13, s[20:23], 0 offen
    s_mov_b64 exec, s[6:7]
K2_NOFLAG:
    s_cmp_lt_u32 s32, s33
    s_cselect_b32 s10, s37, 0
    s_add_u32 m0, s36, 0
    s_nop 0
    buffer_load_dwordx4 v4, s[8:11], s32 offen offset:0 lds
    buffer_load_dwordx4 v4, s[8:11], s32 offen offset:1024 lds
    buffer_load_dwordx4 v4, s[8:11], s32 offen offset:2048 lds
    ds_read_b128 a[68:71], v2 offset:32768
    ds_read_b128 a[72:75], v2 offset:33792
    ds_read_b128 a[76:79], v2 offset:34816
    ds_read_b128 a[80:83], v2 offset:35840
    ds_read_b128 a[84:87], v2 offset:36864
    ds_read_b128 a[88:91], v2 offset:37888
    ds_read_b128 a[92:95], v2 offset:38912
    ds_read_b128 a[96:99], v2 offset:39936
    s_sub_u32 s31, s29, 1
    s_cmp_eq_u32 s30, 2
    s_cselect_b32 s85, 1, -1
    s_cselect_b32 s82, -1, 1
    s_mov_b32 s84, 0
    s_cmp_le_u32 s31, 2
    s_cbranch_scc1 K2_SP0
K2_LOOP:
    s_waitcnt lgkmcnt(0)
    v_mfma_f32_16x16x32_bf16 v[48:51], a[68:71], a[0:3], v[96:99]
    ds_read_b128 a[100:103], v2 offset:40960
    s_add_u32 m0, s36, 0
    v_mfma_f32_16x16x32_bf16 v[52:55], a[68:71], a[4:7], v[100:103]
    v_exp_f32 v16, v16
    v_mfma_f32_16x16x32_bf16 v[48:51], a[72:75], a[8:11], v[48:51]
    ds_read_b128 a[104:107], v2 offset:41984
    v_add_f32 v104, v104, v16
    v_mfma_f32_16x16x32_bf16 v[52:55], a[72:75], a[12:15], v[52:55]
    buffer_load_dwordx4 v4, s[8:11], s32 offen offset:3072 lds
    v_mfma_f32_16x16x32_bf16 v[48:51], a[76:79], a[16:19], v[48:51]
    v_exp_f32 v17, v17
    v_mfma_f32_16x16x32_bf16 v[52:55], a[76:79], a[20:23], v[52:55]
    ds_read_b128 a[108:111], v2 offset:43008
    v_add_f32 v104, v104, v17
    v_mfma_f32_16x16x32_bf16 v[48:51], a[80:83], a[24:27], v[48:51]
    ds_read_b128 a[112:115], v2 offset:44032
    v_mfma_f32_16x16x32_bf16 v[52:55], a[80:83], a[28:31], v[52:55]
    v_exp_f32 v18, v18
    v_mfma_f32_16x16x32_bf16 v[48:51], a[84:87], a[32:35], v[48:51]
    ds_read_b128 a[116:119], v2 offset:45056
    s_add_u32 m0, s36, 4096
    v_mfma_f32_16x16x32_bf16 v[52:55], a[84:87], a[36:39], v[52:55]
    buffer_load_dwordx4 v5, s[8:11], s32 offen offset:0 lds
    v_mfma_f32_16x16x32_bf16 v[48:51], a[88:91], a[40:43], v[48:51]
    v_exp_f32 v19, v19
    v_mfma_f32_16x16x32_bf16 v[52:55], a[88:91], a[44:47], v[52:55]
    ds_read_b128 a[120:123], v2 offset:46080
    v_add_f32 v104, v104, v18
    v_mfma_f32_16x16x32_bf16 v[48:51], a[92:95], a[48:51], v[48:51]
    ds_read_b128 a[124:127], v2 offset:47104
    v_add_f32 v104, v104, v19
    v_mfma_f32_16x16x32_bf16 v[52:55], a[92:95], a[52:55], v[52:55]
    v_exp_f32 v20, v20
    v_mfma_f32_16x16x32_bf16 v[48:51], a[96:99], a[56:59], v[48:51]
    ds_read_b128 a[128:131], v2 offset:48128
    v_add_f32 v108, v108, v20
    v_mfma_f32_16x16x32_bf16 v[52:55], a[96:99], a[60:63], v[52:55]
    buffer_load_dwordx4 v5, s[8:11], s32 offen offset:1024 lds
    s_waitcnt lgkmcnt(3)
    v_mfma_f32_16x16x32_bf16 v[56:59], a[100:103], a[0:3], v[96:99]
    v_exp_f32 v21, v21
    v_mfma_f32_16x16x32_bf16 v[60:63], a[100:103], a[4:7], v[100:103]
    ds_read_b128 a[68:71], v2 offset:49152
    v_add_f32 v108, v108, v21
    v_mfma_f32_16x16x32_bf16 v[56:59], a[104:107], a[8:11], v[56:59]
    ds_read_b128 a[72:75], v2 offset:50176
    v_mfma_f32_16x16x32_bf16 v[60:63], a[104:107], a[12:15], v[60:63]
    v_exp_f32 v22, v22
    v_mfma_f32_16x16x32_bf16 v[56:59], a[108:111], a[16:19], v[56:59]
    ds_read_b128 a[76:79], v2 offset:51200
    v_add_f32 v108, v108, v22
    v_mfma_f32_16x16x32_bf16 v[60:63], a[108:111], a[20:23], v[60:63]
    buffer_load_dwordx4 v5, s[8:11], s32 offen offset:2048 lds
    v_mfma_f32_16x16x32_bf16 v[56:59], a[112:115], a[24:27], v[56:59]
    v_exp_f32 v23, v23
    v_mfma_f32_16x16x32_bf16 v[60:63], a[112:115], a[28:31], v[60:63]
    ds_read_b128 a[80:83], v2 offset:52224
    v_add_f32 v108, v108, v23
    v_mfma_f32_16x16x32_bf16 v[56:59], a[116:119], a[32:35], v[56:59]
    ds_read_b128 a[84:87], v2 offset:53248
    v_mfma_f32_16x16x32_bf16 v[60:63], a[116:119], a[36:39], v[60:63]
    v_exp_f32 v24, v24
    s_waitcnt lgkmcnt(2)
    v_mfma_f32_16x16x32_bf16 v[56:59], a[120:123], a[40:43], v[56:59]
    ds_read_b128 a[88:91], v2 offset:54272
    v_add_f32 v104, v104, v24
    v_mfma_f32_16x16x32_bf16 v[60:63], a[120:123], a[44:47], v[60:63]
    buffer_load_dwordx4 v5, s[8:11], s32 offen offset:3072 lds
    v_mfma_f32_16x16x32_bf16 v[56:59], a[124:127], a[48:51], v[56:59]
    v_exp_f32 v25, v25
    v_mfma_f32_16x16x32_bf16 v[60:63], a[124:127], a[52:55], v[60:63]
    ds_read_b128 a[92:95], v2 offset:55296
    v_add_f32 v104, v104, v25
    v_mfma_f32_16x16x32_bf16 v[56:59], a[128:131], a[56:59], v[56:59]
    ds_read_b128 a[96:99], v2 offset:56320
    v_mfma_f32_16x16x32_bf16 v[60:63], a[128:131], a[60:63], v[60:63]
    v_exp_f32 v26, v26
    v_mfma_f32_16x16x32_bf16 v[64:67], a[68:71], a[0:3], v[96:99]
    ds_read_b128 a[100:103], v2 offset:57344
    s_add_u32 s32, s32, 0x8000
    v_mfma_f32_16x16x32_bf16 v[68:71], a[68:71], a[4:7], v[100:103]
    s_cmp_lt_u32 s34, s35
    s_cselect_b32 s14, s37, 0
    v_mfma_f32_16x16x32_bf16 v[64:67], a[72:75], a[8:11], v[64:67]
    v_exp_f32 v27, v27
    v_mfma_f32_16x16x32_bf16 v[68:71], a[72:75], a[12:15], v[68:71]
    ds_read_b128 a[104:107], v2 offset:58368
    s_add_u32 m0, s36, 98304
    v_mfma_f32_16x16x32_bf16 v[64:67], a[76:79], a[16:19], v[64:67]
    ds_read_b128 a[108:111], v2 offset:59392
    v_add_f32 v104, v104, v26
    v_mfma_f32_16x16x32_bf16 v[68:71], a[76:79], a[20:23], v[68:71]
    v_exp_f32 v28, v28
    s_waitcnt lgkmcnt(2)
    v_mfma_f32_16x16x32_bf16 v[64:67], a[80:83], a[24:27], v[64:67]
    ds_read_b128 a[112:115], v2 offset:60416
    v_add_f32 v104, v104, v27
    v_mfma_f32_16x16x32_bf16 v[68:71], a[80:83], a[28:31], v[68:71]
    buffer_load_dwordx4 v4, s[12:15], s34 offen offset:0 lds
    v_mfma_f32_16x16x32_bf16 v[64:67], a[84:87], a[32:35], v[64:67]
    v_exp_f32 v29, v29
    v_mfma_f32_16x16x32_bf16 v[68:71], a[84:87], a[36:39], v[68:71]
    ds_read_b128 a[116:119], v2 offset:61440
    v_add_f32 v108, v108, v28
    v_mfma_f32_16x16x32_bf16 v[64:67], a[88:91], a[40:43], v[64:67]
    ds_read_b128 a[120:123], v2 offset:62464
    v_add_f32 v108, v108, v29
    v_mfma_f32_16x16x32_bf16 v[68:71], a[88:91], a[44:47], v[68:71]
    v_exp_f32 v30, v30
    v_mfma_f32_16x16x32_bf16 v[64:67], a[92:95], a[48:51], v[64:67]
    ds_read_b128 a[124:127], v2 offset:63488
    v_add_f32 v108, v108, v30
    v_mfma_f32_16x16x32_bf16 v[68:71], a[92:95], a[52:55], v[68:71]
    buffer_load_dwordx4 v4, s[12:15], s34 offen offset:1024 lds
    v_mfma_f32_16x16x32_bf16 v[64:67], a[96:99], a[56:59], v[64:67]
    v_exp_f32 v31, v31
    v_mfma_f32_16x16x32_bf16 v[68:71], a[96:99], a[60:63], v[68:71]
    ds_read_b128 a[128:131], v2 offset:64512
    v_add_f32 v108, v108, v31
    v_mfma_f32_16x16x32_bf16 v[72:75], a[100:103], a[0:3], v[96:99]
    v_cvt_pk_bf16_f32 v80, v16, v17
    v_cvt_pk_bf16_f32 v81, v18, v19
    v_mfma_f32_16x16x32_bf16 v[76:79], a[100:103], a[4:7], v[100:103]
    v_cvt_pk_bf16_f32 v82, v24, v25
    v_cvt_pk_bf16_f32 v83, v26, v27
    s_waitcnt lgkmcnt(1)
    v_mfma_f32_16x16x32_bf16 v[72:75], a[104:107], a[8:11], v[72:75]
    v_cvt_pk_bf16_f32 v84, v20, v21
    v_cvt_pk_bf16_f32 v85, v22, v23
    v_mfma_f32_16x16x32_bf16 v[76:79], a[104:107], a[12:15], v[76:79]
    v_cvt_pk_bf16_f32 v86, v28, v29
    v_cvt_pk_bf16_f32 v87, v30, v31
    v_mfma_f32_16x16x32_bf16 v[72:75], a[108:111], a[16:19], v[72:75]
    v_exp_f32 v32, v32
    v_mfma_f32_16x16x32_bf16 v[76:79], a[108:111], a[20:23], v[76:79]
    buffer_load_dwordx4 v4, s[12:15], s34 offen offset:2048 lds
    v_mfma_f32_16x16x32_bf16 v[72:75], a[112:115], a[24:27], v[72:75]
    v_exp_f32 v33, v33
    v_mfma_f32_16x16x32_bf16 v[76:79], a[112:115], a[28:31], v[76:79]
    ds_read_b128 a[132:135], v3 offset:0
    ds_read_b128 a[136:139], v3 offset:1024
    v_mfma_f32_16x16x32_bf16 v[72:75], a[116:119], a[32:35], v[72:75]
    v_exp_f32 v34, v34
    v_mfma_f32_16x16x32_bf16 v[76:79], a[116:119], a[36:39], v[76:79]
    buffer_load_dwordx4 v4, s[12:15], s34 offen offset:3072 lds
    v_mfma_f32_16x16x32_bf16 v[72:75], a[120:123], a[40:43], v[72:75]
    v_exp_f32 v35, v35
    v_mfma_f32_16x16x32_bf16 v[76:79], a[120:123], a[44:47], v[76:79]
    ds_read_b128 a[140:143], v3 offset:2048
    ds_read_b128 a[144:147], v3 offset:3072
    v_mfma_f32_16x16x32_bf16 v[72:75], a[124:127], a[48:51], v[72:75]
    v_exp_f32 v36, v36
    v_mfma_f32_16x16x32_bf16 v[76:79], a[124:127], a[52:55], v[76:79]
    s_add_u32 m0, s36, 102400
    ds_read_b128 a[148:151], v3 offset:4096
    s_waitcnt lgkmcnt(3)
    v_mfma_f32_16x16x32_bf16 v[72:75], a[128:131], a[56:59], v[72:75]
    v_exp_f32 v37, v37
    v_mfma_f32_16x16x32_bf16 v[76:79], a[128:131], a[60:63], v[76:79]
    buffer_load_dwordx4 v5, s[12:15], s34 offen offset:0 lds
    v_mfma_f32_16x16x32_bf16 v[128:131], a[132:135], v[80:83], v[128:131]
    v_exp_f32 v38, v38
    v_mfma_f32_16x16x32_bf16 v[132:135], a[132:135], v[84:87], v[132:135]
    ds_read_b128 a[152:155], v3 offset:5120
    ds_read_b128 a[156:159], v3 offset:6144
    v_mfma_f32_16x16x32_bf16 v[136:139], a[136:139], v[80:83], v[136:139]
    v_exp_f32 v39, v39
    v_mfma_f32_16x16x32_bf16 v[140:143], a[136:139], v[84:87], v[140:143]
    buffer_load_dwordx4 v5, s[12:15], s34 offen offset:1024 lds
    s_waitcnt lgkmcnt(2)
    v_mfma_f32_16x16x32_bf16 v[144:147], a[140:143], v[80:83], v[144:147]
    v_exp_f32 v40, v40
    v_mfma_f32_16x16x32_bf16 v[148:151], a[140:143], v[84:87], v[148:151]
    ds_read_b128 a[160:163], v3 offset:7168
    ds_read_b128 a[164:167], v3 offset:8192
    v_mfma_f32_16x16x32_bf16 v[152:155], a[144:147], v[80:83], v[152:155]
    v_exp_f32 v41, v41
    v_mfma_f32_16x16x32_bf16 v[156:159], a[144:147], v[84:87], v[156:159]
    buffer_load_dwordx4 v5, s[12:15], s34 offen offset:2048 lds
    v_mfma_f32_16x16x32_bf16 v[160:163], a[148:151], v[80:83], v[160:163]
    v_exp_f32 v42, v42
    v_mfma_f32_16x16x32_bf16 v[164:167], a[148:151], v[84:87], v[164:167]
    ds_read_b128 a[168:171], v3 offset:9216
    ds_read_b128 a[172:175], v3 offset:10240
    s_waitcnt lgkmcnt(4)
    v_mfma_f32_16x16x32_bf16 v[168:171], a[152:155], v[80:83], v[168:171]
    v_exp_f32 v43, v43
    v_mfma_f32_16x16x32_bf16 v[172:175], a[152:155], v[84:87], v[172:175]
    buffer_load_dwordx4 v5, s[12:15], s34 offen offset:3072 lds
    v_mfma_f32_16x16x32_bf16 v[176:179], a[156:159], v[80:83], v[176:179]
    v_exp_f32 v44, v44
    v_mfma_f32_16x16x32_bf16 v[180:183], a[156:159], v[84:87], v[180:183]
    ds_read_b128 a[176:179], v3 offset:11264
    ds_read_b128 a[180:183], v3 offset:12288
    s_waitcnt lgkmcnt(4)
    v_mfma_f32_16x16x32_bf16 v[184:187], a[160:163], v[80:83], v[184:187]
    v_exp_f32 v45, v45
    v_mfma_f32_16x16x32_bf16 v[188:191], a[160:163], v[84:87], v[188:191]
    s_add_u32 s34, s34, 0x8000
    ds_read_b128 a[184:187], v3 offset:13312
    v_mfma_f32_16x16x32_bf16 v[192:195], a[164:167], v[80:83], v[192:195]
    v_exp_f32 v46, v46
    v_mfma_f32_16x16x32_bf16 v[196:199], a[164:167], v[84:87], v[196:199]
    ds_read_b128 a[188:191], v3 offset:14336
    ds_read_b128 a[192:195], v3 offset:15360
    s_waitcnt lgkmcnt(5)
    v_mfma_f32_16x16x32_bf16 v[200:203], a[168:171], v[80:83], v[200:203]
    v_exp_f32 v47, v47
    v_mfma_f32_16x16x32_bf16 v[204:207], a[168:171], v[84:87], v[204:207]
    ds_read_b128 a[196:199], v3 offset:16384
    ds_read_b128 a[200:203], v3 offset:17408
    v_mfma_f32_16x16x32_bf16 v[208:211], a[172:175], v[80:83], v[208:211]
    v_cvt_pk_bf16_f32 v88, v32, v33
    v_cvt_pk_bf16_f32 v89, v34, v35
    v_mfma_f32_16x16x32_bf16 v[212:215], a[172:175], v[84:87], v[212:215]
    v_cvt_pk_bf16_f32 v90, v40, v41
    v_cvt_pk_bf16_f32 v91, v42, v43
    s_waitcnt lgkmcnt(4)
    v_mfma_f32_16x16x32_bf16 v[216:219], a[176:179], v[80:83], v[216:219]
    v_cvt_pk_bf16_f32 v92, v36, v37
    v_cvt_pk_bf16_f32 v93, v38, v39
    v_mfma_f32_16x16x32_bf16 v[220:223], a[176:179], v[84:87], v[220:223]
    v_cvt_pk_bf16_f32 v94, v44, v45
    v_cvt_pk_bf16_f32 v95, v46, v47
    v_mfma_f32_16x16x32_bf16 v[224:227], a[180:183], v[80:83], v[224:227]
    ds_read_b128 a[204:207], v3 offset:18432
    ds_read_b128 a[208:211], v3 offset:19456
    v_mfma_f32_16x16x32_bf16 v[228:231], a[180:183], v[84:87], v[228:231]
    ds_read_b128 a[212:215], v3 offset:20480
    ds_read_b128 a[216:219], v3 offset:21504
    v_mfma_f32_16x16x32_bf16 v[232:235], a[184:187], v[80:83], v[232:235]
    v_max3_f32 v8, v48, v49, v50
    v_add_f32 v104, v104, v32
    v_mfma_f32_16x16x32_bf16 v[236:239], a[184:187], v[84:87], v[236:239]
    ds_read_b128 a[220:223], v3 offset:22528
    v_max3_f32 v8, v8, v51, v52
    s_waitcnt lgkmcnt(5)
    v_mfma_f32_16x16x32_bf16 v[240:243], a[188:191], v[80:83], v[240:243]
    v_max3_f32 v8, v8, v53, v54
    v_add_f32 v104, v104, v33
    v_mfma_f32_16x16x32_bf16 v[244:247], a[188:191], v[84:87], v[244:247]
    ds_read_b128 a[224:227], v3 offset:23552
    v_max3_f32 v8, v8, v55, v56
    v_mfma_f32_16x16x32_bf16 v[248:251], a[192:195], v[80:83], v[248:251]
    ds_read_b128 a[132:135], v3 offset:24576
    v_max3_f32 v8, v8, v57, v58
    v_mfma_f32_16x16x32_bf16 v[252:255], a[192:195], v[84:87], v[252:255]
    v_max3_f32 v8, v8, v59, v60
    v_add_f32 v104, v104, v34
    v_mfma_f32_16x16x32_bf16 v[128:131], a[196:199], v[88:91], v[128:131]
    ds_read_b128 a[136:139], v3 offset:25600
    v_max3_f32 v8, v8, v61, v62
    v_mfma_f32_16x16x32_bf16 v[132:135], a[196:199], v[92:95], v[132:135]
    v_max3_f32 v8, v8, v63, v64
    v_add_f32 v104, v104, v35
    v_mfma_f32_16x16x32_bf16 v[136:139], a[200:203], v[88:91], v[136:139]
    ds_read_b128 a[140:143], v3 offset:26624
    v_max3_f32 v8, v8, v65, v66
    v_mfma_f32_16x16x32_bf16 v[140:143], a[200:203], v[92:95], v[140:143]
    v_max3_f32 v8, v8, v67, v68
    v_add_f32 v108, v108, v36
    s_waitcnt lgkmcnt(2)
    v_mfma_f32_16x16x32_bf16 v[144:147], a[204:207], v[88:91], v[144:147]
    ds_read_b128 a[144:147], v3 offset:27648
    v_max3_f32 v8, v8, v69, v70
    v_mfma_f32_16x16x32_bf16 v[148:151], a[204:207], v[92:95], v[148:151]
    v_max3_f32 v8, v8, v71, v72
    v_add_f32 v108, v108, v37
    v_mfma_f32_16x16x32_bf16 v[152:155], a[208:211], v[88:91], v[152:155]
    ds_read_b128 a[148:151], v3 offset:28672
    v_max3_f32 v8, v8, v73, v74
    v_mfma_f32_16x16x32_bf16 v[156:159], a[208:211], v[92:95], v[156:159]
    v_max3_f32 v8, v8, v75, v76
    v_add_f32 v108, v108, v38
    v_mfma_f32_16x16x32_bf16 v[160:163], a[212:215], v[88:91], v[160:163]
    ds_read_b128 a[152:155], v3 offset:29696
    v_max3_f32 v8, v8, v77, v78
    v_mfma_f32_16x16x32_bf16 v[164:167], a[212:215], v[92:95], v[164:167]
    v_max_f32 v8, v8, v79
    v_add_f32 v108, v108, v39
    v_mfma_f32_16x16x32_bf16 v[168:171], a[216:219], v[88:91], v[168:171]
    ds_read_b128 a[156:159], v3 offset:30720
    v_add_f32 v104, v104, v40
    v_mfma_f32_16x16x32_bf16 v[172:175], a[216:219], v[92:95], v[172:175]
    v_cmp_lt_f32 vcc, s91, v8
    v_add_f32 v104, v104, v41
    v_mfma_f32_16x16x32_bf16 v[176:179], a[220:223], v[88:91], v[176:179]
    ds_read_b128 a[160:163], v3 offset:31744
    s_sub_u32 s39, s39, 1
    v_mfma_f32_16x16x32_bf16 v[180:183], a[220:223], v[92:95], v[180:183]
    s_sub_u32 s38, s38, 64
    v_add_f32 v104, v104, v42
    v_mfma_f32_16x16x32_bf16 v[184:187], a[224:227], v[88:91], v[184:187]
    v_add_f32 v104, v104, v43
    v_add_f32 v108, v108, v44
    v_mfma_f32_16x16x32_bf16 v[188:191], a[224:227], v[92:95], v[188:191]
    v_add_f32 v108, v108, v45
    v_add_f32 v108, v108, v46
    v_mfma_f32_16x16x32_bf16 v[192:195], a[132:135], v[88:91], v[192:195]
    s_waitcnt vmcnt(0) lgkmcnt(0)
    s_barrier
    v_mfma_f32_16x16x32_bf16 v[196:199], a[132:135], v[92:95], v[196:199]
    s_cmp_lt_u32 s32, s33
    s_cselect_b32 s10, s37, 0
    ds_read_b128 a[68:71], v2 offset:0
    ds_read_b128 a[72:75], v2 offset:1024
    v_mfma_f32_16x16x32_bf16 v[200:203], a[136:139], v[88:91], v[200:203]
    s_add_u32 m0, s36, 32768
    ds_read_b128 a[76:79], v2 offset:2048
    v_mfma_f32_16x16x32_bf16 v[204:207], a[136:139], v[92:95], v[204:207]
    buffer_load_dwordx4 v4, s[8:11], s32 offen offset:0 lds
    v_mfma_f32_16x16x32_bf16 v[208:211], a[140:143], v[88:91], v[208:211]
    ds_read_b128 a[80:83], v2 offset:3072
    v_add_f32 v108, v108, v47
    v_mfma_f32_16x16x32_bf16 v[212:215], a[140:143], v[92:95], v[212:215]
    v_mfma_f32_16x16x32_bf16 v[216:219], a[144:147], v[88:91], v[216:219]
    ds_read_b128 a[84:87], v2 offset:4096
    v_mfma_f32_16x16x32_bf16 v[220:223], a[144:147], v[92:95], v[220:223]
    buffer_load_dwordx4 v4, s[8:11], s32 offen offset:1024 lds
    v_mfma_f32_16x16x32_bf16 v[224:227], a[148:151], v[88:91], v[224:227]
    ds_read_b128 a[88:91], v2 offset:5120
    v_mfma_f32_16x16x32_bf16 v[228:231], a[148:151], v[92:95], v[228:231]
    v_mfma_f32_16x16x32_bf16 v[232:235], a[152:155], v[88:91], v[232:235]
    ds_read_b128 a[92:95], v2 offset:6144
    v_mfma_f32_16x16x32_bf16 v[236:239], a[152:155], v[92:95], v[236:239]
    buffer_load_dwordx4 v4, s[8:11], s32 offen offset:2048 lds
    v_mfma_f32_16x16x32_bf16 v[240:243], a[156:159], v[88:91], v[240:243]
    ds_read_b128 a[96:99], v2 offset:7168
    v_mfma_f32_16x16x32_bf16 v[244:247], a[156:159], v[92:95], v[244:247]
    v_mfma_f32_16x16x32_bf16 v[248:251], a[160:163], v[88:91], v[248:251]
    v_mfma_f32_16x16x32_bf16 v[252:255], a[160:163], v[92:95], v[252:255]
    s_cbranch_vccnz K2_RESC0
K2_FB0:
    s_sub_u32 s31, s31, 1
    s_cmp_le_u32 s31, 2
    s_cbranch_scc1 K2_SP1
    s_waitcnt lgkmcnt(0)
    v_mfma_f32_16x16x32_bf16 v[16:19], a[68:71], a[0:3], v[96:99]
    ds_read_b128 a[100:103], v2 offset:8192
    s_add_u32 m0, s36, 32768
    v_mfma_f32_16x16x32_bf16 v[20:23], a[68:71], a[4:7], v[100:103]
    v_exp_f32 v48, v48
    v_mfma_f32_16x16x32_bf16 v[16:19], a[72:75], a[8:11], v[16:19]
    ds_read_b128 a[104:107], v2 offset:9216
    v_add_f32 v104, v104, v48
    v_mfma_f32_16x16x32_bf16 v[20:23], a[72:75], a[12:15], v[20:23]
    buffer_load_dwordx4 v4, s[8:11], s32 offen offset:3072 lds
    v_mfma_f32_16x16x32_bf16 v[16:19], a[76:79], a[16:19], v[16:19]
    v_exp_f32 v49, v49
    v_mfma_f32_16x16x32_bf16 v[20:23], a[76:79], a[20:23], v[20:23]
    ds_read_b128 a[108:111], v2 offset:10240
    v_add_f32 v104, v104, v49
    v_mfma_f32_16x16x32_bf16 v[16:19], a[80:83], a[24:27], v[16:19]
    ds_read_b128 a[112:115], v2 offset:11264
    v_mfma_f32_16x16x32_bf16 v[20:23], a[80:83], a[28:31], v[20:23]
    v_exp_f32 v50, v50
    v_mfma_f32_16x16x32_bf16 v[16:19], a[84:87], a[32:35], v[16:19]
    ds_read_b128 a[116:119], v2 offset:12288
    s_add_u32 m0, s36, 36864
    v_mfma_f32_16x16x32_bf16 v[20:23], a[84:87], a[36:39], v[20:23]
    buffer_load_dwordx4 v5, s[8:11], s32 offen offset:0 lds
    v_mfma_f32_16x16x32_bf16 v[16:19], a[88:91], a[40:43], v[16:19]
    v_exp_f32 v51, v51
    v_mfma_f32_16x16x32_bf16 v[20:23], a[88:91], a[44:47], v[20:23]
    ds_read_b128 a[120:123], v2 offset:13312
    v_add_f32 v104, v104, v50
    v_mfma_f32_16x16x32_bf16 v[16:19], a[92:95], a[48:51], v[16:19]
    ds_read_b128 a[124:127], v2 offset:14336
    v_add_f32 v104, v104, v51
    v_mfma_f32_16x16x32_bf16 v[20:23], a[92:95], a[52:55], v[20:23]
    v_exp_f32 v52, v52
    v_mfma_f32_16x16x32_bf16 v[16:19], a[96:99], a[56:59], v[16:19]
    ds_read_b128 a[128:131], v2 offset:15360
    v_add_f32 v108, v108, v52
    v_mfma_f32_16x16x32_bf16 v[20:23], a[96:99], a[60:63], v[20:23]
    buffer_load_dwordx4 v5, s[8:11], s32 offen offset:1024 lds
    s_waitcnt lgkmcnt(3)
    v_mfma_f32_16x16x32_bf16 v[24:27], a[100:103], a[0:3], v[96:99]
    v_exp_f32 v53, v53
    v_mfma_f32_16x16x32_bf16 v[28:31], a[100:103], a[4:7], v[100:103]
    ds_read_b128 a[68:71], v2 offset:16384
    v_add_f32 v108, v108, v53
    v_mfma_f32_16x16x32_bf16 v[24:27], a[104:107], a[8:11], v[24:27]
    ds_read_b128 a[72:75], v2 offset:17408
    v_mfma_f32_16x16x32_bf16 v[28:31], a[104:107], a[12:15], v[28:31]
    v_exp_f32 v54, v54
    v_mfma_f32_16x16x32_bf16 v[24:27], a[108:111], a[16:19], v[24:27]
    ds_read_b128 a[76:79], v2 offset:18432
    v_add_f32 v108, v108, v54
    v_mfma_f32_16x16x32_bf16 v[28:31], a[108:111], a[20:23], v[28:31]
    buffer_load_dwordx4 v5, s[8:11], s32 offen offset:2048 lds
    v_mfma_f32_16x16x32_bf16 v[24:27], a[112:115], a[24:27], v[24:27]
    v_exp_f32 v55, v55
    v_mfma_f32_16x16x32_bf16 v[28:31], a[112:115], a[28:31], v[28:31]
    ds_read_b128 a[80:83], v2 offset:19456
    v_add_f32 v108, v108, v55
    v_mfma_f32_16x16x32_bf16 v[24:27], a[116:119], a[32:35], v[24:27]
    ds_read_b128 a[84:87], v2 offset:20480
    v_mfma_f32_16x16x32_bf16 v[28:31], a[116:119], a[36:39], v[28:31]
    v_exp_f32 v56, v56
    s_waitcnt lgkmcnt(2)
    v_mfma_f32_16x16x32_bf16 v[24:27], a[120:123], a[40:43], v[24:27]
    ds_read_b128 a[88:91], v2 offset:21504
    v_add_f32 v104, v104, v56
    v_mfma_f32_16x16x32_bf16 v[28:31], a[120:123], a[44:47], v[28:31]
    buffer_load_dwordx4 v5, s[8:11], s32 offen offset:3072 lds
    v_mfma_f32_16x16x32_bf16 v[24:27], a[124:127], a[48:51], v[24:27]
    v_exp_f32 v57, v57
    v_mfma_f32_16x16x32_bf16 v[28:31], a[124:127], a[52:55], v[28:31]
    ds_read_b128 a[92:95], v2 offset:22528
    v_add_f32 v104, v104, v57
    v_mfma_f32_16x16x32_bf16 v[24:27], a[128:131], a[56:59], v[24:27]
    ds_read_b128 a[96:99], v2 offset:23552
    v_mfma_f32_16x16x32_bf16 v[28:31], a[128:131], a[60:63], v[28:31]
    v_exp_f32 v58, v58
    v_mfma_f32_16x16x32_bf16 v[32:35], a[68:71], a[0:3], v[96:99]
    ds_read_b128 a[100:103], v2 offset:24576
    s_add_u32 s32, s32, 0x8000
    v_mfma_f32_16x16x32_bf16 v[36:39], a[68:71], a[4:7], v[100:103]
    s_cmp_lt_u32 s34, s35
    s_cselect_b32 s14, s37, 0
    v_mfma_f32_16x16x32_bf16 v[32:35], a[72:75], a[8:11], v[32:35]
    v_exp_f32 v59, v59
    v_mfma_f32_16x16x32_bf16 v[36:39], a[72:75], a[12:15], v[36:39]
    ds_read_b128 a[104:107], v2 offset:25600
    s_add_u32 m0, s36, 65536
    v_mfma_f32_16x16x32_bf16 v[32:35], a[76:79], a[16:19], v[32:35]
    ds_read_b128 a[108:111], v2 offset:26624
    v_add_f32 v104, v104, v58
    v_mfma_f32_16x16x32_bf16 v[36:39], a[76:79], a[20:23], v[36:39]
    v_exp_f32 v60, v60
    s_waitcnt lgkmcnt(2)
    v_mfma_f32_16x16x32_bf16 v[32:35], a[80:83], a[24:27], v[32:35]
    ds_read_b128 a[112:115], v2 offset:27648
    v_add_f32 v104, v104, v59
    v_mfma_f32_16x16x32_bf16 v[36:39], a[80:83], a[28:31], v[36:39]
    buffer_load_dwordx4 v4, s[12:15], s34 offen offset:0 lds
    v_mfma_f32_16x16x32_bf16 v[32:35], a[84:87], a[32:35], v[32:35]
    v_exp_f32 v61, v61
    v_mfma_f32_16x16x32_bf16 v[36:39], a[84:87], a[36:39], v[36:39]
    ds_read_b128 a[116:119], v2 offset:28672
    v_add_f32 v108, v108, v60
    v_mfma_f32_16x16x32_bf16 v[32:35], a[88:91], a[40:43], v[32:35]
    ds_read_b128 a[120:123], v2 offset:29696
    v_add_f32 v108, v108, v61
    v_mfma_f32_16x16x32_bf16 v[36:39], a[88:91], a[44:47], v[36:39]
    v_exp_f32 v62, v62
    v_mfma_f32_16x16x32_bf16 v[32:35], a[92:95], a[48:51], v[32:35]
    ds_read_b128 a[124:127], v2 offset:30720
    v_add_f32 v108, v108, v62
    v_mfma_f32_16x16x32_bf16 v[36:39], a[92:95], a[52:55], v[36:39]
    buffer_load_dwordx4 v4, s[12:15], s34 offen offset:1024 lds
    v_mfma_f32_16x16x32_bf16 v[32:35], a[96:99], a[56:59], v[32:35]
    v_exp_f32 v63, v63
    v_mfma_f32_16x16x32_bf16 v[36:39], a[96:99], a[60:63], v[36:39]
    ds_read_b128 a[128:131], v2 offset:31744
    v_add_f32 v108, v108, v63
    v_mfma_f32_16x16x32_bf16 v[40:43], a[100:103], a[0:3], v[96:99]
    v_cvt_pk_bf16_f32 v80, v48, v49
    v_cvt_pk_bf16_f32 v81, v50, v51
    v_mfma_f32_16x16x32_bf16 v[44:47], a[100:103], a[4:7], v[100:103]
    v_cvt_pk_bf16_f32 v82, v56, v57
    v_cvt_pk_bf16_f32 v83, v58, v59
    s_waitcnt lgkmcnt(1)
    v_mfma_f32_16x16x32_bf16 v[40:43], a[104:107], a[8:11], v[40:43]
    v_cvt_pk_bf16_f32 v84, v52, v53
    v_cvt_pk_bf16_f32 v85, v54, v55
    v_mfma_f32_16x16x32_bf16 v[44:47], a[104:107], a[12:15], v[44:47]
    v_cvt_pk_bf16_f32 v86, v60, v61
    v_cvt_pk_bf16_f32 v87, v62, v63
    v_mfma_f32_16x16x32_bf16 v[40:43], a[108:111], a[16:19], v[40:43]
    v_exp_f32 v64, v64
    v_mfma_f32_16x16x32_bf16 v[44:47], a[108:111], a[20:23], v[44:47]
    buffer_load_dwordx4 v4, s[12:15], s34 offen offset:2048 lds
    v_mfma_f32_16x16x32_bf16 v[40:43], a[112:115], a[24:27], v[40:43]
    v_exp_f32 v65, v65
    v_mfma_f32_16x16x32_bf16 v[44:47], a[112:115], a[28:31], v[44:47]
    ds_read_b128 a[132:135], v3 offset:32768
    ds_read_b128 a[136:139], v3 offset:33792
    v_mfma_f32_16x16x32_bf16 v[40:43], a[116:119], a[32:35], v[40:43]
    v_exp_f32 v66, v66
    v_mfma_f32_16x16x32_bf16 v[44:47], a[116:119], a[36:39], v[44:47]
    buffer_load_dwordx4 v4, s[12:15], s34 offen offset:3072 lds
    v_mfma_f32_16x16x32_bf16 v[40:43], a[120:123], a[40:43], v[40:43]
    v_exp_f32 v67, v67
    v_mfma_f32_16x16x32_bf16 v[44:47], a[120:123], a[44:47], v[44:47]
    ds_read_b128 a[140:143], v3 offset:34816
    ds_read_b128 a[144:147], v3 offset:35840
    v_mfma_f32_16x16x32_bf16 v[40:43], a[124:127], a[48:51], v[40:43]
    v_exp_f32 v68, v68
    v_mfma_f32_16x16x32_bf16 v[44:47], a[124:127], a[52:55], v[44:47]
    s_add_u32 m0, s36, 69632
    ds_read_b128 a[148:151], v3 offset:36864
    s_waitcnt lgkmcnt(3)
    v_mfma_f32_16x16x32_bf16 v[40:43], a[128:131], a[56:59], v[40:43]
    v_exp_f32 v69, v69
    v_mfma_f32_16x16x32_bf16 v[44:47], a[128:131], a[60:63], v[44:47]
    buffer_load_dwordx4 v5, s[12:15], s34 offen offset:0 lds
    v_mfma_f32_16x16x32_bf16 v[128:131], a[132:135], v[80:83], v[128:131]
    v_exp_f32 v70, v70
    v_mfma_f32_16x16x32_bf16 v[132:135], a[132:135], v[84:87], v[132:135]
    ds_read_b128 a[152:155], v3 offset:37888
    ds_read_b128 a[156:159], v3 offset:38912
    v_mfma_f32_16x16x32_bf16 v[136:139], a[136:139], v[80:83], v[136:139]
    v_exp_f32 v71, v71
    v_mfma_f32_16x16x32_bf16 v[140:143], a[136:139], v[84:87], v[140:143]
    buffer_load_dwordx4 v5, s[12:15], s34 offen offset:1024 lds
    s_waitcnt lgkmcnt(2)
    v_mfma_f32_16x16x32_bf16 v[144:147], a[140:143], v[80:83], v[144:147]
    v_exp_f32 v72, v72
    v_mfma_f32_16x16x32_bf16 v[148:151], a[140:143], v[84:87], v[148:151]
    ds_read_b128 a[160:163], v3 offset:39936
    ds_read_b128 a[164:167], v3 offset:40960
    v_mfma_f32_16x16x32_bf16 v[152:155], a[144:147], v[80:83], v[152:155]
    v_exp_f32 v73, v73
    v_mfma_f32_16x16x32_bf16 v[156:159], a[144:147], v[84:87], v[156:159]
    buffer_load_dwordx4 v5, s[12:15], s34 offen offset:2048 lds
    v_mfma_f32_16x16x32_bf16 v[160:163], a[148:151], v[80:83], v[160:163]
    v_exp_f32 v74, v74
    v_mfma_f32_16x16x32_bf16 v[164:167], a[148:151], v[84:87], v[164:167]
    ds_read_b128 a[168:171], v3 offset:41984
    ds_read_b128 a[172:175], v3 offset:43008
    s_waitcnt lgkmcnt(4)
    v_mfma_f32_16x16x32_bf16 v[168:171], a[152:155], v[80:83], v[168:171]
    v_exp_f32 v75, v75
    v_mfma_f32_16x16x32_bf16 v[172:175], a[152:155], v[84:87], v[172:175]
    buffer_load_dwordx4 v5, s[12:15], s34 offen offset:3072 lds
    v_mfma_f32_16x16x32_bf16 v[176:179], a[156:159], v[80:83], v[176:179]
    v_exp_f32 v76, v76
    v_mfma_f32_16x16x32_bf16 v[180:183], a[156:159], v[84:87], v[180:183]
    ds_read_b128 a[176:179], v3 offset:44032
    ds_read_b128 a[180:183], v3 offset:45056
    s_waitcnt lgkmcnt(4)
    v_mfma_f32_16x16x32_bf16 v[184:187], a[160:163], v[80:83], v[184:187]
    v_exp_f32 v77, v77
    v_mfma_f32_16x16x32_bf16 v[188:191], a[160:163], v[84:87], v[188:191]
    s_add_u32 s34, s34, 0x8000
    ds_read_b128 a[184:187], v3 offset:46080
    v_mfma_f32_16x16x32_bf16 v[192:195], a[164:167], v[80:83], v[192:195]
    v_exp_f32 v78, v78
    v_mfma_f32_16x16x32_bf16 v[196:199], a[164:167], v[84:87], v[196:199]
    ds_read_b128 a[188:191], v3 offset:47104
    ds_read_b128 a[192:195], v3 offset:48128
    s_waitcnt lgkmcnt(5)
    v_mfma_f32_16x16x32_bf16 v[200:203], a[168:171], v[80:83], v[200:203]
    v_exp_f32 v79, v79
    v_mfma_f32_16x16x32_bf16 v[204:207], a[168:171], v[84:87], v[204:207]
    ds_read_b128 a[196:199], v3 offset:49152
    ds_read_b128 a[200:203], v3 offset:50176
    v_mfma_f32_16x16x32_bf16 v[208:211], a[172:175], v[80:83], v[208:211]
    v_cvt_pk_bf16_f32 v88, v64, v65
    v_cvt_pk_bf16_f32 v89, v66, v67
    v_mfma_f32_16x16x32_bf16 v[212:215], a[172:175], v[84:87], v[212:215]
    v_cvt_pk_bf16_f32 v90, v72, v73
    v_cvt_pk_bf16_f32 v91, v74, v75
    s_waitcnt lgkmcnt(4)
    v_mfma_f32_16x16x32_bf16 v[216:219], a[176:179], v[80:83], v[216:219]
    v_cvt_pk_bf16_f32 v92, v68, v69
    v_cvt_pk_bf16_f32 v93, v70, v71
    v_mfma_f32_16x16x32_bf16 v[220:223], a[176:179], v[84:87], v[220:223]
    v_cvt_pk_bf16_f32 v94, v76, v77
    v_cvt_pk_bf16_f32 v95, v78, v79
    v_mfma_f32_16x16x32_bf16 v[224:227], a[180:183], v[80:83], v[224:227]
    ds_read_b128 a[204:207], v3 offset:51200
    ds_read_b128 a[208:211], v3 offset:52224
    v_mfma_f32_16x16x32_bf16 v[228:231], a[180:183], v[84:87], v[228:231]
    ds_read_b128 a[212:215], v3 offset:53248
    ds_read_b128 a[216:219], v3 offset:54272
    v_mfma_f32_16x16x32_bf16 v[232:235], a[184:187], v[80:83], v[232:235]
    v_max3_f32 v8, v16, v17, v18
    v_add_f32 v104, v104, v64
    v_mfma_f32_16x16x32_bf16 v[236:239], a[184:187], v[84:87], v[236:239]
    ds_read_b128 a[220:223], v3 offset:55296
    v_max3_f32 v8, v8, v19, v20
    s_waitcnt lgkmcnt(5)
    v_mfma_f32_16x16x32_bf16 v[240:243], a[188:191], v[80:83], v[240:243]
    v_max3_f32 v8, v8, v21, v22
    v_add_f32 v104, v104, v65
    v_mfma_f32_16x16x32_bf16 v[244:247], a[188:191], v[84:87], v[244:247]
    ds_read_b128 a[224:227], v3 offset:56320
    v_max3_f32 v8, v8, v23, v24
    v_mfma_f32_16x16x32_bf16 v[248:251], a[192:195], v[80:83], v[248:251]
    ds_read_b128 a[132:135], v3 offset:57344
    v_max3_f32 v8, v8, v25, v26
    v_mfma_f32_16x16x32_bf16 v[252:255], a[192:195], v[84:87], v[252:255]
    v_max3_f32 v8, v8, v27, v28
    v_add_f32 v104, v104, v66
    v_mfma_f32_16x16x32_bf16 v[128:131], a[196:199], v[88:91], v[128:131]
    ds_read_b128 a[136:139], v3 offset:58368
    v_max3_f32 v8, v8, v29, v30
    v_mfma_f32_16x16x32_bf16 v[132:135], a[196:199], v[92:95], v[132:135]
    v_max3_f32 v8, v8, v31, v32
    v_add_f32 v104, v104, v67
    v_mfma_f32_16x16x32_bf16 v[136:139], a[200:203], v[88:91], v[136:139]
    ds_read_b128 a[140:143], v3 offset:59392
    v_max3_f32 v8, v8, v33, v34
    v_mfma_f32_16x16x32_bf16 v[140:143], a[200:203], v[92:95], v[140:143]
    v_max3_f32 v8, v8, v35, v36
    v_add_f32 v108, v108, v68
    s_waitcnt lgkmcnt(2)
    v_mfma_f32_16x16x32_bf16 v[144:147], a[204:207], v[88:91], v[144:147]
    ds_read_b128 a[144:147], v3 offset:60416
    v_max3_f32 v8, v8, v37, v38
    v_mfma_f32_16x16x32_bf16 v[148:151], a[204:207], v[92:95], v[148:151]
    v_max3_f32 v8, v8, v39, v40
    v_add_f32 v108, v108, v69
    v_mfma_f32_16x16x32_bf16 v[152:155], a[208:211], v[88:91], v[152:155]
    ds_read_b128 a[148:151], v3 offset:61440
    v_max3_f32 v8, v8, v41, v42
    v_mfma_f32_16x16x32_bf16 v[156:159], a[208:211], v[92:95], v[156:159]
    v_max3_f32 v8, v8, v43, v44
    v_add_f32 v108, v108, v70
    v_mfma_f32_16x16x32_bf16 v[160:163], a[212:215], v[88:91], v[160:163]
    ds_read_b128 a[152:155], v3 offset:62464
    v_max3_f32 v8, v8, v45, v46
    v_mfma_f32_16x16x32_bf16 v[164:167], a[212:215], v[92:95], v[164:167]
    v_max_f32 v8, v8, v47
    v_add_f32 v108, v108, v71
    v_mfma_f32_16x16x32_bf16 v[168:171], a[216:219], v[88:91], v[168:171]
    ds_read_b128 a[156:159], v3 offset:63488
    v_add_f32 v104, v104, v72
    v_mfma_f32_16x16x32_bf16 v[172:175], a[216:219], v[92:95], v[172:175]
    v_cmp_lt_f32 vcc, s91, v8
    v_add_f32 v104, v104, v73
    v_mfma_f32_16x16x32_bf16 v[176:179], a[220:223], v[88:91], v[176:179]
    ds_read_b128 a[160:163], v3 offset:64512
    s_sub_u32 s39, s39, 1
    v_mfma_f32_16x16x32_bf16 v[180:183], a[220:223], v[92:95], v[180:183]
    s_sub_u32 s38, s38, 64
    v_add_f32 v104, v104, v74
    v_mfma_f32_16x16x32_bf16 v[184:187], a[224:227], v[88:91], v[184:187]
    v_add_f32 v104, v104, v75
    v_add_f32 v108, v108, v76
    v_mfma_f32_16x16x32_bf16 v[188:191], a[224:227], v[92:95], v[188:191]
    v_add_f32 v108, v108, v77
    v_add_f32 v108, v108, v78
    v_mfma_f32_16x16x32_bf16 v[192:195], a[132:135], v[88:91], v[192:195]
    s_waitcnt vmcnt(0) lgkmcnt(0)
    s_barrier
    v_mfma_f32_16x16x32_bf16 v[196:199], a[132:135], v[92:95], v[196:199]
    s_cmp_lt_u32 s32, s33
    s_cselect_b32 s10, s37, 0
    ds_read_b128 a[68:71], v2 offset:32768
    ds_read_b128 a[72:75], v2 offset:33792
    v_mfma_f32_16x16x32_bf16 v[200:203], a[136:139], v[88:91], v[200:203]
    s_add_u32 m0, s36, 0
    ds_read_b128 a[76:79], v2 offset:34816
    v_mfma_f32_16x16x32_bf16 v[204:207], a[136:139], v[92:95], v[204:207]
    buffer_load_dwordx4 v4, s[8:11], s32 offen offset:0 lds
    v_mfma_f32_16x16x32_bf16 v[208:211], a[140:143], v[88:91], v[208:211]
    ds_read_b128 a[80:83], v2 offset:35840
    v_add_f32 v108, v108, v79
    v_mfma_f32_16x16x32_bf16 v[212:215], a[140:143], v[92:95], v[212:215]
    v_mfma_f32_16x16x32_bf16 v[216:219], a[144:147], v[88:91], v[216:219]
    ds_read_b128 a[84:87], v2 offset:36864
    v_mfma_f32_16x16x32_bf16 v[220:223], a[144:147], v[92:95], v[220:223]
    buffer_load_dwordx4 v4, s[8:11], s32 offen offset:1024 lds
    v_mfma_f32_16x16x32_bf16 v[224:227], a[148:151], v[88:91], v[224:227]
    ds_read_b128 a[88:91], v2 offset:37888
    v_mfma_f32_16x16x32_bf16 v[228:231], a[148:151], v[92:95], v[228:231]
    v_mfma_f32_16x16x32_bf16 v[232:235], a[152:155], v[88:91], v[232:235]
    ds_read_b128 a[92:95], v2 offset:38912
    v_mfma_f32_16x16x32_bf16 v[236:239], a[152:155], v[92:95], v[236:239]
    buffer_load_dwordx4 v4, s[8:11], s32 offen offset:2048 lds
    v_mfma_f32_16x16x32_bf16 v[240:243], a[156:159], v[88:91], v[240:243]
    ds_read_b128 a[96:99], v2 offset:39936
    v_mfma_f32_16x16x32_bf16 v[244:247], a[156:159], v[92:95], v[244:247]
    v_mfma_f32_16x16x32_bf16 v[248:251], a[160:163], v[88:91], v[248:251]
    v_mfma_f32_16x16x32_bf16 v[252:255], a[160:163], v[92:95], v[252:255]
    s_cbranch_vccnz K2_RESC1
K2_FB1:
    s_sub_u32 s31, s31, 1
    s_cmp_gt_u32 s31, 2
    s_cbranch_scc1 K2_LOOP
K2_SP0:
    s_mov_b32 s84, 2
    s_cmp_eq_u32 s31, s82
    s_cbranch_scc1 K2_H0
    s_cmp_eq_u32 s31, 0
    s_cbranch_scc1 K2_TAIL0
    s_waitcnt lgkmcnt(0)
    v_mfma_f32_16x16x32_bf16 v[48:51], a[68:71], a[0:3], v[96:99]
    ds_read_b128 a[100:103], v2 offset:40960
    s_add_u32 m0, s36, 0
    v_mfma_f32_16x16x32_bf16 v[52:55], a[68:71], a[4:7], v[100:103]
    v_exp_f32 v16, v16
    v_mfma_f32_16x16x32_bf16 v[48:51], a[72:75], a[8:11], v[48:51]
    ds_read_b128 a[104:107], v2 offset:41984
    v_add_f32 v104, v104, v16
    v_mfma_f32_16x16x32_bf16 v[52:55], a[72:75], a[12:15], v[52:55]
    buffer_load_dwordx4 v4, s[8:11], s32 offen offset:3072 lds
    v_mfma_f32_16x16x32_bf16 v[48:51], a[76:79], a[16:19], v[48:51]
    v_exp_f32 v17, v17
    v_mfma_f32_16x16x32_bf16 v[52:55], a[76:79], a[20:23], v[52:55]
    ds_read_b128 a[108:111], v2 offset:43008
    v_add_f32 v104, v104, v17
    v_mfma_f32_16x16x32_bf16 v[48:51], a[80:83], a[24:27], v[48:51]
    ds_read_b128 a[112:115], v2 offset:44032
    v_mfma_f32_16x16x32_bf16 v[52:55], a[80:83], a[28:31], v[52:55]
    v_exp_f32 v18, v18
    v_mfma_f32_16x16x32_bf16 v[48:51], a[84:87], a[32:35], v[48:51]
    ds_read_b128 a[116:119], v2 offset:45056
    s_add_u32 m0, s36, 4096
    v_mfma_f32_16x16x32_bf16 v[52:55], a[84:87], a[36:39], v[52:55]
    buffer_load_dwordx4 v5, s[8:11], s32 offen offset:0 lds
    v_mfma_f32_16x16x32_bf16 v[48:51], a[88:91], a[40:43], v[48:51]
    v_exp_f32 v19, v19
    v_mfma_f32_16x16x32_bf16 v[52:55], a[88:91], a[44:47], v[52:55]
    ds_read_b128 a[120:123], v2 offset:46080
    v_add_f32 v104, v104, v18
    v_mfma_f32_16x16x32_bf16 v[48:51], a[92:95], a[48:51], v[48:51]
    ds_read_b128 a[124:127], v2 offset:47104
    v_add_f32 v104, v104, v19
    v_mfma_f32_16x16x32_bf16 v[52:55], a[92:95], a[52:55], v[52:55]
    v_exp_f32 v20, v20
    v_mfma_f32_16x16x32_bf16 v[48:51], a[96:99], a[56:59], v[48:51]
    ds_read_b128 a[128:131], v2 offset:48128
    v_add_f32 v108, v108, v20
    v_mfma_f32_16x16x32_bf16 v[52:55], a[96:99], a[60:63], v[52:55]
    buffer_load_dwordx4 v5, s[8:11], s32 offen offset:1024 lds
    s_waitcnt lgkmcnt(3)
    v_mfma_f32_16x16x32_bf16 v[56:59], a[100:103], a[0:3], v[96:99]
    v_exp_f32 v21, v21
    v_mfma_f32_16x16x32_bf16 v[60:63], a[100:103], a[4:7], v[100:103]
    ds_read_b128 a[68:71], v2 offset:49152
    v_add_f32 v108, v108, v21
    v_mfma_f32_16x16x32_bf16 v[56:59], a[104:107], a[8:11], v[56:59]
    ds_read_b128 a[72:75], v2 offset:50176
    v_mfma_f32_16x16x32_bf16 v[60:63], a[104:107], a[12:15], v[60:63]
    v_exp_f32 v22, v22
    v_mfma_f32_16x16x32_bf16 v[56:59], a[108:111], a[16:19], v[56:59]
    ds_read_b128 a[76:79], v2 offset:51200
    v_add_f32 v108, v108, v22
    v_mfma_f32_16x16x32_bf16 v[60:63], a[108:111], a[20:23], v[60:63]
    buffer_load_dwordx4 v5, s[8:11], s32 offen offset:2048 lds
    v_mfma_f32_16x16x32_bf16 v[56:59], a[112:115], a[24:27], v[56:59]
    v_exp_f32 v23, v23
    v_mfma_f32_16x16x32_bf16 v[60:63], a[112:115], a[28:31], v[60:63]
    ds_read_b128 a[80:83], v2 offset:52224
    v_add_f32 v108, v108, v23
    v_mfma_f32_16x16x32_bf16 v[56:59], a[116:119], a[32:35], v[56:59]
    ds_read_b128 a[84:87], v2 offset:53248
    v_mfma_f32_16x16x32_bf16 v[60:63], a[116:119], a[36:39], v[60:63]
    v_exp_f32 v24, v24
    s_waitcnt lgkmcnt(2)
    v_mfma_f32_16x16x32_bf16 v[56:59], a[120:123], a[40:43], v[56:59]
    ds_read_b128 a[88:91], v2 offset:54272
    v_add_f32 v104, v104, v24
    v_mfma_f32_16x16x32_bf16 v[60:63], a[120:123], a[44:47], v[60:63]
    buffer_load_dwordx4 v5, s[8:11], s32 offen offset:3072 lds
    v_mfma_f32_16x16x32_bf16 v[56:59], a[124:127], a[48:51], v[56:59]
    v_exp_f32 v25, v25
    v_mfma_f32_16x16x32_bf16 v[60:63], a[124:127], a[52:55], v[60:63]
    ds_read_b128 a[92:95], v2 offset:55296
    v_add_f32 v104, v104, v25
    v_mfma_f32_16x16x32_bf16 v[56:59], a[128:131], a[56:59], v[56:59]
    ds_read_b128 a[96:99], v2 offset:56320
    v_mfma_f32_16x16x32_bf16 v[60:63], a[128:131], a[60:63], v[60:63]
    v_exp_f32 v26, v26
    v_mfma_f32_16x16x32_bf16 v[64:67], a[68:71], a[0:3], v[96:99]
    ds_read_b128 a[100:103], v2 offset:57344
    s_add_u32 s32, s32, 0x8000
    v_mfma_f32_16x16x32_bf16 v[68:71], a[68:71], a[4:7], v[100:103]
    s_cmp_lt_u32 s34, s35
    s_cselect_b32 s14, s37, 0
    v_mfma_f32_16x16x32_bf16 v[64:67], a[72:75], a[8:11], v[64:67]
    v_exp_f32 v27, v27
    v_mfma_f32_16x16x32_bf16 v[68:71], a[72:75], a[12:15], v[68:71]
    ds_read_b128 a[104:107], v2 offset:58368
    s_add_u32 m0, s36, 98304
    v_mfma_f32_16x16x32_bf16 v[64:67], a[76:79], a[16:19], v[64:67]
    ds_read_b128 a[108:111], v2 offset:59392
    v_add_f32 v104, v104, v26
    v_mfma_f32_16x16x32_bf16 v[68:71], a[76:79], a[20:23], v[68:71]
    v_exp_f32 v28, v28
    s_waitcnt lgkmcnt(2)
    v_mfma_f32_16x16x32_bf16 v[64:67], a[80:83], a[24:27], v[64:67]
    ds_read_b128 a[112:115], v2 offset:60416
    v_add_f32 v104, v104, v27
    v_mfma_f32_16x16x32_bf16 v[68:71], a[80:83], a[28:31], v[68:71]
    buffer_load_dwordx4 v4, s[12:15], s34 offen offset:0 lds
    v_mfma_f32_16x16x32_bf16 v[64:67], a[84:87], a[32:35], v[64:67]
    v_exp_f32 v29, v29
    v_mfma_f32_16x16x32_bf16 v[68:71], a[84:87], a[36:39], v[68:71]
    ds_read_b128 a[116:119], v2 offset:61440
    v_add_f32 v108, v108, v28
    v_mfma_f32_16x16x32_bf16 v[64:67], a[88:91], a[40:43], v[64:67]
    ds_read_b128 a[120:123], v2 offset:62464
    v_add_f32 v108, v108, v29
    v_mfma_f32_16x16x32_bf16 v[68:71], a[88:91], a[44:47], v[68:71]
    v_exp_f32 v30, v30
    v_mfma_f32_16x16x32_bf16 v[64:67], a[92:95], a[48:51], v[64:67]
    ds_read_b128 a[124:127], v2 offset:63488
    v_add_f32 v108, v108, v30
    v_mfma_f32_16x16x32_bf16 v[68:71], a[92:95], a[52:55], v[68:71]
    buffer_load_dwordx4 v4, s[12:15], s34 offen offset:1024 lds
    v_mfma_f32_16x16x32_bf16 v[64:67], a[96:99], a[56:59], v[64:67]
    v_exp_f32 v31, v31
    v_mfma_f32_16x16x32_bf16 v[68:71], a[96:99], a[60:63], v[68:71]
    ds_read_b128 a[128:131], v2 offset:64512
    v_add_f32 v108, v108, v31
    v_mfma_f32_16x16x32_bf16 v[72:75], a[100:103], a[0:3], v[96:99]
    v_cvt_pk_bf16_f32 v80, v16, v17
    v_cvt_pk_bf16_f32 v81, v18, v19
    v_mfma_f32_16x16x32_bf16 v[76:79], a[100:103], a[4:7], v[100:103]
    v_cvt_pk_bf16_f32 v82, v24, v25
    v_cvt_pk_bf16_f32 v83, v26, v27
    s_waitcnt lgkmcnt(1)
    v_mfma_f32_16x16x32_bf16 v[72:75], a[104:107], a[8:11], v[72:75]
    v_cvt_pk_bf16_f32 v84, v20, v21
    v_cvt_pk_bf16_f32 v85, v22, v23
    v_mfma_f32_16x16x32_bf16 v[76:79], a[104:107], a[12:15], v[76:79]
    v_cvt_pk_bf16_f32 v86, v28, v29
    v_cvt_pk_bf16_f32 v87, v30, v31
    v_mfma_f32_16x16x32_bf16 v[72:75], a[108:111], a[16:19], v[72:75]
    v_exp_f32 v32, v32
    v_mfma_f32_16x16x32_bf16 v[76:79], a[108:111], a[20:23], v[76:79]
    buffer_load_dwordx4 v4, s[12:15], s34 offen offset:2048 lds
    v_mfma_f32_16x16x32_bf16 v[72:75], a[112:115], a[24:27], v[72:75]
    v_exp_f32 v33, v33
    v_mfma_f32_16x16x32_bf16 v[76:79], a[112:115], a[28:31], v[76:79]
    ds_read_b128 a[132:135], v3 offset:0
    ds_read_b128 a[136:139], v3 offset:1024
    v_mfma_f32_16x16x32_bf16 v[72:75], a[116:119], a[32:35], v[72:75]
    v_exp_f32 v34, v34
    v_mfma_f32_16x16x32_bf16 v[76:79], a[116:119], a[36:39], v[76:79]
    buffer_load_dwordx4 v4, s[12:15], s34 offen offset:3072 lds
    v_mfma_f32_16x16x32_bf16 v[72:75], a[120:123], a[40:43], v[72:75]
    v_exp_f32 v35, v35
    v_mfma_f32_16x16x32_bf16 v[76:79], a[120:123], a[44:47], v[76:79]
    ds_read_b128 a[140:143], v3 offset:2048
    ds_read_b128 a[144:147], v3 offset:3072
    v_mfma_f32_16x16x32_bf16 v[72:75], a[124:127], a[48:51], v[72:75]
    v_exp_f32 v36, v36
    v_mfma_f32_16x16x32_bf16 v[76:79], a[124:127], a[52:55], v[76:79]
    s_add_u32 m0, s36, 102400
    ds_read_b128 a[148:151], v3 offset:4096
    s_waitcnt lgkmcnt(3)
    v_mfma_f32_16x16x32_bf16 v[72:75], a[128:131], a[56:59], v[72:75]
    v_exp_f32 v37, v37
    v_mfma_f32_16x16x32_bf16 v[76:79], a[128:131], a[60:63], v[76:79]
    buffer_load_dwordx4 v5, s[12:15], s34 offen offset:0 lds
    v_mfma_f32_16x16x32_bf16 v[128:131], a[132:135], v[80:83], v[128:131]
    v_exp_f32 v38, v38
    v_mfma_f32_16x16x32_bf16 v[132:135], a[132:135], v[84:87], v[132:135]
    ds_read_b128 a[152:155], v3 offset:5120
    ds_read_b128 a[156:159], v3 offset:6144
    v_mfma_f32_16x16x32_bf16 v[136:139], a[136:139], v[80:83], v[136:139]
    v_exp_f32 v39, v39
    v_mfma_f32_16x16x32_bf16 v[140:143], a[136:139], v[84:87], v[140:143]
    buffer_load_dwordx4 v5, s[12:15], s34 offen offset:1024 lds
    s_waitcnt lgkmcnt(2)
    v_mfma_f32_16x16x32_bf16 v[144:147], a[140:143], v[80:83], v[144:147]
    v_exp_f32 v40, v40
    s_cmp_gt_i32 s39, 0
    s_cbranch_scc0 K2_I0_MASK
K2_I0_NOMASK:
    v_mfma_f32_16x16x32_bf16 v[148:151], a[140:143], v[84:87], v[148:151]
    ds_read_b128 a[160:163], v3 offset:7168
    ds_read_b128 a[164:167], v3 offset:8192
    v_mfma_f32_16x16x32_bf16 v[152:155], a[144:147], v[80:83], v[152:155]
    v_exp_f32 v41, v41
    v_mfma_f32_16x16x32_bf16 v[156:159], a[144:147], v[84:87], v[156:159]
    buffer_load_dwordx4 v5, s[12:15], s34 offen offset:2048 lds
    v_mfma_f32_16x16x32_bf16 v[160:163], a[148:151], v[80:83], v[160:163]
    v_exp_f32 v42, v42
    v_mfma_f32_16x16x32_bf16 v[164:167], a[148:151], v[84:87], v[164:167]
    ds_read_b128 a[168:171], v3 offset:9216
    ds_read_b128 a[172:175], v3 offset:10240
    s_waitcnt lgkmcnt(4)
    v_mfma_f32_16x16x32_bf16 v[168:171], a[152:155], v[80:83], v[168:171]
    v_exp_f32 v43, v43
    v_mfma_f32_16x16x32_bf16 v[172:175], a[152:155], v[84:87], v[172:175]
    buffer_load_dwordx4 v5, s[12:15], s34 offen offset:3072 lds
    v_mfma_f32_16x16x32_bf16 v[176:179], a[156:159], v[80:83], v[176:179]
    v_exp_f32 v44, v44
    v_mfma_f32_16x16x32_bf16 v[180:183], a[156:159], v[84:87], v[180:183]
    ds_read_b128 a[176:179], v3 offset:11264
    ds_read_b128 a[180:183], v3 offset:12288
    s_waitcnt lgkmcnt(4)
    v_mfma_f32_16x16x32_bf16 v[184:187], a[160:163], v[80:83], v[184:187]
    v_exp_f32 v45, v45
    v_mfma_f32_16x16x32_bf16 v[188:191], a[160:163], v[84:87], v[188:191]
    s_add_u32 s34, s34, 0x8000
    ds_read_b128 a[184:187], v3 offset:13312
    v_mfma_f32_16x16x32_bf16 v[192:195], a[164:167], v[80:83], v[192:195]
    v_exp_f32 v46, v46
    v_mfma_f32_16x16x32_bf16 v[196:199], a[164:167], v[84:87], v[196:199]
    ds_read_b128 a[188:191], v3 offset:14336
    ds_read_b128 a[192:195], v3 offset:15360
    s_waitcnt lgkmcnt(5)
    v_mfma_f32_16x16x32_bf16 v[200:203], a[168:171], v[80:83], v[200:203]
    v_exp_f32 v47, v47
    v_mfma_f32_16x16x32_bf16 v[204:207], a[168:171], v[84:87], v[204:207]
    ds_read_b128 a[196:199], v3 offset:16384
    ds_read_b128 a[200:203], v3 offset:17408
    v_mfma_f32_16x16x32_bf16 v[208:211], a[172:175], v[80:83], v[208:211]
    v_cvt_pk_bf16_f32 v88, v32, v33
    v_cvt_pk_bf16_f32 v89, v34, v35
    v_mfma_f32_16x16x32_bf16 v[212:215], a[172:175], v[84:87], v[212:215]
    v_cvt_pk_bf16_f32 v90, v40, v41
    v_cvt_pk_bf16_f32 v91, v42, v43
    s_waitcnt lgkmcnt(4)
    v_mfma_f32_16x16x32_bf16 v[216:219], a[176:179], v[80:83], v[216:219]
    v_cvt_pk_bf16_f32 v92, v36, v37
    v_cvt_pk_bf16_f32 v93, v38, v39
    v_mfma_f32_16x16x32_bf16 v[220:223], a[176:179], v[84:87], v[220:223]
    v_cvt_pk_bf16_f32 v94, v44, v45
    v_cvt_pk_bf16_f32 v95, v46, v47
    v_mfma_f32_16x16x32_bf16 v[224:227], a[180:183], v[80:83], v[224:227]
    ds_read_b128 a[204:207], v3 offset:18432
    ds_read_b128 a[208:211], v3 offset:19456
    v_mfma_f32_16x16x32_bf16 v[228:231], a[180:183], v[84:87], v[228:231]
    ds_read_b128 a[212:215], v3 offset:20480
    ds_read_b128 a[216:219], v3 offset:21504
    v_mfma_f32_16x16x32_bf16 v[232:235], a[184:187], v[80:83], v[232:235]
    v_max3_f32 v8, v48, v49, v50
    v_add_f32 v104, v104, v32
    v_mfma_f32_16x16x32_bf16 v[236:239], a[184:187], v[84:87], v[236:239]
    ds_read_b128 a[220:223], v3 offset:22528
    v_max3_f32 v8, v8, v51, v52
    s_waitcnt lgkmcnt(5)
    v_mfma_f32_16x16x32_bf16 v[240:243], a[188:191], v[80:83], v[240:243]
    v_max3_f32 v8, v8, v53, v54
    v_add_f32 v104, v104, v33
    v_mfma_f32_16x16x32_bf16 v[244:247], a[188:191], v[84:87], v[244:247]
    ds_read_b128 a[224:227], v3 offset:23552
    v_max3_f32 v8, v8, v55, v56
    v_mfma_f32_16x16x32_bf16 v[248:251], a[192:195], v[80:83], v[248:251]
    ds_read_b128 a[132:135], v3 offset:24576
    v_max3_f32 v8, v8, v57, v58
    v_mfma_f32_16x16x32_bf16 v[252:255], a[192:195], v[84:87], v[252:255]
    v_max3_f32 v8, v8, v59, v60
    v_add_f32 v104, v104, v34
    v_mfma_f32_16x16x32_bf16 v[128:131], a[196:199], v[88:91], v[128:131]
    ds_read_b128 a[136:139], v3 offset:25600
    v_max3_f32 v8, v8, v61, v62
    v_mfma_f32_16x16x32_bf16 v[132:135], a[196:199], v[92:95], v[132:135]
    v_max3_f32 v8, v8, v63, v64
    v_add_f32 v104, v104, v35
    v_mfma_f32_16x16x32_bf16 v[136:139], a[200:203], v[88:91], v[136:139]
    ds_read_b128 a[140:143], v3 offset:26624
    v_max3_f32 v8, v8, v65, v66
    v_mfma_f32_16x16x32_bf16 v[140:143], a[200:203], v[92:95], v[140:143]
    v_max3_f32 v8, v8, v67, v68
    v_add_f32 v108, v108, v36
    s_waitcnt lgkmcnt(2)
    v_mfma_f32_16x16x32_bf16 v[144:147], a[204:207], v[88:91], v[144:147]
    ds_read_b128 a[144:147], v3 offset:27648
    v_max3_f32 v8, v8, v69, v70
    v_mfma_f32_16x16x32_bf16 v[148:151], a[204:207], v[92:95], v[148:151]
    v_max3_f32 v8, v8, v71, v72
    v_add_f32 v108, v108, v37
    v_mfma_f32_16x16x32_bf16 v[152:155], a[208:211], v[88:91], v[152:155]
    ds_read_b128 a[148:151], v3 offset:28672
    v_max3_f32 v8, v8, v73, v74
    v_mfma_f32_16x16x32_bf16 v[156:159], a[208:211], v[92:95], v[156:159]
    v_max3_f32 v8, v8, v75, v76
    v_add_f32 v108, v108, v38
    v_mfma_f32_16x16x32_bf16 v[160:163], a[212:215], v[88:91], v[160:163]
    ds_read_b128 a[152:155], v3 offset:29696
    v_max3_f32 v8, v8, v77, v78
    v_mfma_f32_16x16x32_bf16 v[164:167], a[212:215], v[92:95], v[164:167]
    v_max_f32 v8, v8, v79
    v_add_f32 v108, v108, v39
    v_mfma_f32_16x16x32_bf16 v[168:171], a[216:219], v[88:91], v[168:171]
    ds_read_b128 a[156:159], v3 offset:30720
    v_add_f32 v104, v104, v40
    v_mfma_f32_16x16x32_bf16 v[172:175], a[216:219], v[92:95], v[172:175]
    v_cmp_lt_f32 vcc, s91, v8
    v_add_f32 v104, v104, v41
    v_mfma_f32_16x16x32_bf16 v[176:179], a[220:223], v[88:91], v[176:179]
    ds_read_b128 a[160:163], v3 offset:31744
    s_sub_u32 s39, s39, 1
    v_mfma_f32_16x16x32_bf16 v[180:183], a[220:223], v[92:95], v[180:183]
    s_sub_u32 s38, s38, 64
    v_add_f32 v104, v104, v42
    v_mfma_f32_16x16x32_bf16 v[184:187], a[224:227], v[88:91], v[184:187]
    v_add_f32 v104, v104, v43
    v_add_f32 v108, v108, v44
    v_mfma_f32_16x16x32_bf16 v[188:191], a[224:227], v[92:95], v[188:191]
    v_add_f32 v108, v108, v45
    v_add_f32 v108, v108, v46
    v_mfma_f32_16x16x32_bf16 v[192:195], a[132:135], v[88:91], v[192:195]
    s_waitcnt vmcnt(0) lgkmcnt(0)
    s_barrier
    v_mfma_f32_16x16x32_bf16 v[196:199], a[132:135], v[92:95], v[196:199]
    s_cmp_lt_u32 s32, s33
    s_cselect_b32 s10, s37, 0
    ds_read_b128 a[68:71], v2 offset:0
    ds_read_b128 a[72:75], v2 offset:1024
    v_mfma_f32_16x16x32_bf16 v[200:203], a[136:139], v[88:91], v[200:203]
    s_add_u32 m0, s36, 32768
    ds_read_b128 a[76:79], v2 offset:2048
    v_mfma_f32_16x16x32_bf16 v[204:207], a[136:139], v[92:95], v[204:207]
    buffer_load_dwordx4 v4, s[8:11], s32 offen offset:0 lds
    v_mfma_f32_16x16x32_bf16 v[208:211], a[140:143], v[88:91], v[208:211]
    ds_read_b128 a[80:83], v2 offset:3072
    v_add_f32 v108, v108, v47
    v_mfma_f32_16x16x32_bf16 v[212:215], a[140:143], v[92:95], v[212:215]
    v_mfma_f32_16x16x32_bf16 v[216:219], a[144:147], v[88:91], v[216:219]
    ds_read_b128 a[84:87], v2 offset:4096
    v_mfma_f32_16x16x32_bf16 v[220:223], a[144:147], v[92:95], v[220:223]
    buffer_load_dwordx4 v4, s[8:11], s32 offen offset:1024 lds
    v_mfma_f32_16x16x32_bf16 v[224:227], a[148:151], v[88:91], v[224:227]
    ds_read_b128 a[88:91], v2 offset:5120
    v_mfma_f32_16x16x32_bf16 v[228:231], a[148:151], v[92:95], v[228:231]
    v_mfma_f32_16x16x32_bf16 v[232:235], a[152:155], v[88:91], v[232:235]
    ds_read_b128 a[92:95], v2 offset:6144
    v_mfma_f32_16x16x32_bf16 v[236:239], a[152:155], v[92:95], v[236:239]
    buffer_load_dwordx4 v4, s[8:11], s32 offen offset:2048 lds
    v_mfma_f32_16x16x32_bf16 v[240:243], a[156:159], v[88:91], v[240:243]
    ds_read_b128 a[96:99], v2 offset:7168
    v_mfma_f32_16x16x32_bf16 v[244:247], a[156:159], v[92:95], v[244:247]
    v_mfma_f32_16x16x32_bf16 v[248:251], a[160:163], v[88:91], v[248:251]
    v_mfma_f32_16x16x32_bf16 v[252:255], a[160:163], v[92:95], v[252:255]
    s_cbranch_vccnz K2_RESC0
K2_BACK0:
    s_sub_u32 s31, s31, 1
K2_SP1:
    s_mov_b32 s84, 2
    s_cmp_eq_u32 s31, s85
    s_cbranch_scc1 K2_FL0
K2_FLB0:
    s_cmp_eq_u32 s31, s82
    s_cbranch_scc1 K2_H1
    s_cmp_eq_u32 s31, 0
    s_cbranch_scc1 K2_TAIL1
    s_waitcnt lgkmcnt(0)
    v_mfma_f32_16x16x32_bf16 v[16:19], a[68:71], a[0:3], v[96:99]
    ds_read_b128 a[100:103], v2 offset:8192
    s_add_u32 m0, s36, 32768
    v_mfma_f32_16x16x32_bf16 v[20:23], a[68:71], a[4:7], v[100:103]
    v_exp_f32 v48, v48
    v_mfma_f32_16x16x32_bf16 v[16:19], a[72:75], a[8:11], v[16:19]
    ds_read_b128 a[104:107], v2 offset:9216
    v_add_f32 v104, v104, v48
    v_mfma_f32_16x16x32_bf16 v[20:23], a[72:75], a[12:15], v[20:23]
    buffer_load_dwordx4 v4, s[8:11], s32 offen offset:3072 lds
    v_mfma_f32_16x16x32_bf16 v[16:19], a[76:79], a[16:19], v[16:19]
    v_exp_f32 v49, v49
    v_mfma_f32_16x16x32_bf16 v[20:23], a[76:79], a[20:23], v[20:23]
    ds_read_b128 a[108:111], v2 offset:10240
    v_add_f32 v104, v104, v49
    v_mfma_f32_16x16x32_bf16 v[16:19], a[80:83], a[24:27], v[16:19]
    ds_read_b128 a[112:115], v2 offset:11264
    v_mfma_f32_16x16x32_bf16 v[20:23], a[80:83], a[28:31], v[20:23]
    v_exp_f32 v50, v50
    v_mfma_f32_16x16x32_bf16 v[16:19], a[84:87], a[32:35], v[16:19]
    ds_read_b128 a[116:119], v2 offset:12288
    s_add_u32 m0, s36, 36864
    v_mfma_f32_16x16x32_bf16 v[20:23], a[84:87], a[36:39], v[20:23]
    buffer_load_dwordx4 v5, s[8:11], s32 offen offset:0 lds
    v_mfma_f32_16x16x32_bf16 v[16:19], a[88:91], a[40:43], v[16:19]
    v_exp_f32 v51, v51
    v_mfma_f32_16x16x32_bf16 v[20:23], a[88:91], a[44:47], v[20:23]
    ds_read_b128 a[120:123], v2 offset:13312
    v_add_f32 v104, v104, v50
    v_mfma_f32_16x16x32_bf16 v[16:19], a[92:95], a[48:51], v[16:19]
    ds_read_b128 a[124:127], v2 offset:14336
    v_add_f32 v104, v104, v51
    v_mfma_f32_16x16x32_bf16 v[20:23], a[92:95], a[52:55], v[20:23]
    v_exp_f32 v52, v52
    v_mfma_f32_16x16x32_bf16 v[16:19], a[96:99], a[56:59], v[16:19]
    ds_read_b128 a[128:131], v2 offset:15360
    v_add_f32 v108, v108, v52
    v_mfma_f32_16x16x32_bf16 v[20:23], a[96:99], a[60:63], v[20:23]
    buffer_load_dwordx4 v5, s[8:11], s32 offen offset:1024 lds
    s_waitcnt lgkmcnt(3)
    v_mfma_f32_16x16x32_bf16 v[24:27], a[100:103], a[0:3], v[96:99]
    v_exp_f32 v53, v53
    v_mfma_f32_16x16x32_bf16 v[28:31], a[100:103], a[4:7], v[100:103]
    ds_read_b128 a[68:71], v2 offset:16384
    v_add_f32 v108, v108, v53
    v_mfma_f32_16x16x32_bf16 v[24:27], a[104:107], a[8:11], v[24:27]
    ds_read_b128 a[72:75], v2 offset:17408
    v_mfma_f32_16x16x32_bf16 v[28:31], a[104:107], a[12:15], v[28:31]
    v_exp_f32 v54, v54
    v_mfma_f32_16x16x32_bf16 v[24:27], a[108:111], a[16:19], v[24:27]
    ds_read_b128 a[76:79], v2 offset:18432
    v_add_f32 v108, v108, v54
    v_mfma_f32_16x16x32_bf16 v[28:31], a[108:111], a[20:23], v[28:31]
    buffer_load_dwordx4 v5, s[8:11], s32 offen offset:2048 lds
    v_mfma_f32_16x16x32_bf16 v[24:27], a[112:115], a[24:27], v[24:27]
    v_exp_f32 v55, v55
    v_mfma_f32_16x16x32_bf16 v[28:31], a[112:115], a[28:31], v[28:31]
    ds_read_b128 a[80:83], v2 offset:19456
    v_add_f32 v108, v108, v55
    v_mfma_f32_16x16x32_bf16 v[24:27], a[116:119], a[32:35], v[24:27]
    ds_read_b128 a[84:87], v2 offset:20480
    v_mfma_f32_16x16x32_bf16 v[28:31], a[116:119], a[36:39], v[28:31]
    v_exp_f32 v56, v56
    s_waitcnt lgkmcnt(2)
    v_mfma_f32_16x16x32_bf16 v[24:27], a[120:123], a[40:43], v[24:27]
    ds_read_b128 a[88:91], v2 offset:21504
    v_add_f32 v104, v104, v56
    v_mfma_f32_16x16x32_bf16 v[28:31], a[120:123], a[44:47], v[28:31]
    buffer_load_dwordx4 v5, s[8:11], s32 offen offset:3072 lds
    v_mfma_f32_16x16x32_bf16 v[24:27], a[124:127], a[48:51], v[24:27]
    v_exp_f32 v57, v57
    v_mfma_f32_16x16x32_bf16 v[28:31], a[124:127], a[52:55], v[28:31]
    ds_read_b128 a[92:95], v2 offset:22528
    v_add_f32 v104, v104, v57
    v_mfma_f32_16x16x32_bf16 v[24:27], a[128:131], a[56:59], v[24:27]
    ds_read_b128 a[96:99], v2 offset:23552
    v_mfma_f32_16x16x32_bf16 v[28:31], a[128:131], a[60:63], v[28:31]
    v_exp_f32 v58, v58
    v_mfma_f32_16x16x32_bf16 v[32:35], a[68:71], a[0:3], v[96:99]
    ds_read_b128 a[100:103], v2 offset:24576
    s_add_u32 s32, s32, 0x8000
    v_mfma_f32_16x16x32_bf16 v[36:39], a[68:71], a[4:7], v[100:103]
    s_cmp_lt_u32 s34, s35
    s_cselect_b32 s14, s37, 0
    v_mfma_f32_16x16x32_bf16 v[32:35], a[72:75], a[8:11], v[32:35]
    v_exp_f32 v59, v59
    v_mfma_f32_16x16x32_bf16 v[36:39], a[72:75], a[12:15], v[36:39]
    ds_read_b128 a[104:107], v2 offset:25600
    s_add_u32 m0, s36, 65536
    v_mfma_f32_16x16x32_bf16 v[32:35], a[76:79], a[16:19], v[32:35]
    ds_read_b128 a[108:111], v2 offset:26624
    v_add_f32 v104, v104, v58
    v_mfma_f32_16x16x32_bf16 v[36:39], a[76:79], a[20:23], v[36:39]
    v_exp_f32 v60, v60
    s_waitcnt lgkmcnt(2)
    v_mfma_f32_16x16x32_bf16 v[32:35], a[80:83], a[24:27], v[32:35]
    ds_read_b128 a[112:115], v2 offset:27648
    v_add_f32 v104, v104, v59
    v_mfma_f32_16x16x32_bf16 v[36:39], a[80:83], a[28:31], v[36:39]
    buffer_load_dwordx4 v4, s[12:15], s34 offen offset:0 lds
    v_mfma_f32_16x16x32_bf16 v[32:35], a[84:87], a[32:35], v[32:35]
    v_exp_f32 v61, v61
    v_mfma_f32_16x16x32_bf16 v[36:39], a[84:87], a[36:39], v[36:39]
    ds_read_b128 a[116:119], v2 offset:28672
    v_add_f32 v108, v108, v60
    v_mfma_f32_16x16x32_bf16 v[32:35], a[88:91], a[40:43], v[32:35]
    ds_read_b128 a[120:123], v2 offset:29696
    v_add_f32 v108, v108, v61
    v_mfma_f32_16x16x32_bf16 v[36:39], a[88:91], a[44:47], v[36:39]
    v_exp_f32 v62, v62
    v_mfma_f32_16x16x32_bf16 v[32:35], a[92:95], a[48:51], v[32:35]
    ds_read_b128 a[124:127], v2 offset:30720
    v_add_f32 v108, v108, v62
    v_mfma_f32_16x16x32_bf16 v[36:39], a[92:95], a[52:55], v[36:39]
    buffer_load_dwordx4 v4, s[12:15], s34 offen offset:1024 lds
    v_mfma_f32_16x16x32_bf16 v[32:35], a[96:99], a[56:59], v[32:35]
    v_exp_f32 v63, v63
    v_mfma_f32_16x16x32_bf16 v[36:39], a[96:99], a[60:63], v[36:39]
    ds_read_b128 a[128:131], v2 offset:31744
    v_add_f32 v108, v108, v63
    v_mfma_f32_16x16x32_bf16 v[40:43], a[100:103], a[0:3], v[96:99]
    v_cvt_pk_bf16_f32 v80, v48, v49
    v_cvt_pk_bf16_f32 v81, v50, v51
    v_mfma_f32_16x16x32_bf16 v[44:47], a[100:103], a[4:7], v[100:103]
    v_cvt_pk_bf16_f32 v82, v56, v57
    v_cvt_pk_bf16_f32 v83, v58, v59
    s_waitcnt lgkmcnt(1)
    v_mfma_f32_16x16x32_bf16 v[40:43], a[104:107], a[8:11], v[40:43]
    v_cvt_pk_bf16_f32 v84, v52, v53
    v_cvt_pk_bf16_f32 v85, v54, v55
    v_mfma_f32_16x16x32_bf16 v[44:47], a[104:107], a[12:15], v[44:47]
    v_cvt_pk_bf16_f32 v86, v60, v61
    v_cvt_pk_bf16_f32 v87, v62, v63
    v_mfma_f32_16x16x32_bf16 v[40:43], a[108:111], a[16:19], v[40:43]
    v_exp_f32 v64, v64
    v_mfma_f32_16x16x32_bf16 v[44:47], a[108:111], a[20:23], v[44:47]
    buffer_load_dwordx4 v4, s[12:15], s34 offen offset:2048 lds
    v_mfma_f32_16x16x32_bf16 v[40:43], a[112:115], a[24:27], v[40:43]
    v_exp_f32 v65, v65
    v_mfma_f32_16x16x32_bf16 v[44:47], a[112:115], a[28:31], v[44:47]
    ds_read_b128 a[132:135], v3 offset:32768
    ds_read_b128 a[136:139], v3 offset:33792
    v_mfma_f32_16x16x32_bf16 v[40:43], a[116:119], a[32:35], v[40:43]
    v_exp_f32 v66, v66
    v_mfma_f32_16x16x32_bf16 v[44:47], a[116:119], a[36:39], v[44:47]
    buffer_load_dwordx4 v4, s[12:15], s34 offen offset:3072 lds
    v_mfma_f32_16x16x32_bf16 v[40:43], a[120:123], a[40:43], v[40:43]
    v_exp_f32 v67, v67
    v_mfma_f32_16x16x32_bf16 v[44:47], a[120:123], a[44:47], v[44:47]
    ds_read_b128 a[140:143], v3 offset:34816
    ds_read_b128 a[144:147], v3 offset:35840
    v_mfma_f32_16x16x32_bf16 v[40:43], a[124:127], a[48:51], v[40:43]
    v_exp_f32 v68, v68
    v_mfma_f32_16x16x32_bf16 v[44:47], a[124:127], a[52:55], v[44:47]
    s_add_u32 m0, s36, 69632
    ds_read_b128 a[148:151], v3 offset:36864
    s_waitcnt lgkmcnt(3)
    v_mfma_f32_16x16x32_bf16 v[40:43], a[128:131], a[56:59], v[40:43]
    v_exp_f32 v69, v69
    v_mfma_f32_16x16x32_bf16 v[44:47], a[128:131], a[60:63], v[44:47]
    buffer_load_dwordx4 v5, s[12:15], s34 offen offset:0 lds
    v_mfma_f32_16x16x32_bf16 v[128:131], a[132:135], v[80:83], v[128:131]
    v_exp_f32 v70, v70
    v_mfma_f32_16x16x32_bf16 v[132:135], a[132:135], v[84:87], v[132:135]
    ds_read_b128 a[152:155], v3 offset:37888
    ds_read_b128 a[156:159], v3 offset:38912
    v_mfma_f32_16x16x32_bf16 v[136:139], a[136:139], v[80:83], v[136:139]
    v_exp_f32 v71, v71
    v_mfma_f32_16x16x32_bf16 v[140:143], a[136:139], v[84:87], v[140:143]
    buffer_load_dwordx4 v5, s[12:15], s34 offen offset:1024 lds
    s_waitcnt lgkmcnt(2)
    v_mfma_f32_16x16x32_bf16 v[144:147], a[140:143], v[80:83], v[144:147]
    v_exp_f32 v72, v72
    s_cmp_gt_i32 s39, 0
    s_cbranch_scc0 K2_I1_MASK
K2_I1_NOMASK:
    v_mfma_f32_16x16x32_bf16 v[148:151], a[140:143], v[84:87], v[148:151]
    ds_read_b128 a[160:163], v3 offset:39936
    ds_read_b128 a[164:167], v3 offset:40960
    v_mfma_f32_16x16x32_bf16 v[152:155], a[144:147], v[80:83], v[152:155]
    v_exp_f32 v73, v73
    v_mfma_f32_16x16x32_bf16 v[156:159], a[144:147], v[84:87], v[156:159]
    buffer_load_dwordx4 v5, s[12:15], s34 offen offset:2048 lds
    v_mfma_f32_16x16x32_bf16 v[160:163], a[148:151], v[80:83], v[160:163]
    v_exp_f32 v74, v74
    v_mfma_f32_16x16x32_bf16 v[164:167], a[148:151], v[84:87], v[164:167]
    ds_read_b128 a[168:171], v3 offset:41984
    ds_read_b128 a[172:175], v3 offset:43008
    s_waitcnt lgkmcnt(4)
    v_mfma_f32_16x16x32_bf16 v[168:171], a[152:155], v[80:83], v[168:171]
    v_exp_f32 v75, v75
    v_mfma_f32_16x16x32_bf16 v[172:175], a[152:155], v[84:87], v[172:175]
    buffer_load_dwordx4 v5, s[12:15], s34 offen offset:3072 lds
    v_mfma_f32_16x16x32_bf16 v[176:179], a[156:159], v[80:83], v[176:179]
    v_exp_f32 v76, v76
    v_mfma_f32_16x16x32_bf16 v[180:183], a[156:159], v[84:87], v[180:183]
    ds_read_b128 a[176:179], v3 offset:44032
    ds_read_b128 a[180:183], v3 offset:45056
    s_waitcnt lgkmcnt(4)
    v_mfma_f32_16x16x32_bf16 v[184:187], a[160:163], v[80:83], v[184:187]
    v_exp_f32 v77, v77
    v_mfma_f32_16x16x32_bf16 v[188:191], a[160:163], v[84:87], v[188:191]
    s_add_u32 s34, s34, 0x8000
    ds_read_b128 a[184:187], v3 offset:46080
    v_mfma_f32_16x16x32_bf16 v[192:195], a[164:167], v[80:83], v[192:195]
    v_exp_f32 v78, v78
    v_mfma_f32_16x16x32_bf16 v[196:199], a[164:167], v[84:87], v[196:199]
    ds_read_b128 a[188:191], v3 offset:47104
    ds_read_b128 a[192:195], v3 offset:48128
    s_waitcnt lgkmcnt(5)
    v_mfma_f32_16x16x32_bf16 v[200:203], a[168:171], v[80:83], v[200:203]
    v_exp_f32 v79, v79
    v_mfma_f32_16x16x32_bf16 v[204:207], a[168:171], v[84:87], v[204:207]
    ds_read_b128 a[196:199], v3 offset:49152
    ds_read_b128 a[200:203], v3 offset:50176
    v_mfma_f32_16x16x32_bf16 v[208:211], a[172:175], v[80:83], v[208:211]
    v_cvt_pk_bf16_f32 v88, v64, v65
    v_cvt_pk_bf16_f32 v89, v66, v67
    v_mfma_f32_16x16x32_bf16 v[212:215], a[172:175], v[84:87], v[212:215]
    v_cvt_pk_bf16_f32 v90, v72, v73
    v_cvt_pk_bf16_f32 v91, v74, v75
    s_waitcnt lgkmcnt(4)
    v_mfma_f32_16x16x32_bf16 v[216:219], a[176:179], v[80:83], v[216:219]
    v_cvt_pk_bf16_f32 v92, v68, v69
    v_cvt_pk_bf16_f32 v93, v70, v71
    v_mfma_f32_16x16x32_bf16 v[220:223], a[176:179], v[84:87], v[220:223]
    v_cvt_pk_bf16_f32 v94, v76, v77
    v_cvt_pk_bf16_f32 v95, v78, v79
    v_mfma_f32_16x16x32_bf16 v[224:227], a[180:183], v[80:83], v[224:227]
    ds_read_b128 a[204:207], v3 offset:51200
    ds_read_b128 a[208:211], v3 offset:52224
    v_mfma_f32_16x16x32_bf16 v[228:231], a[180:183], v[84:87], v[228:231]
    ds_read_b128 a[212:215], v3 offset:53248
    ds_read_b128 a[216:219], v3 offset:54272
    v_mfma_f32_16x16x32_bf16 v[232:235], a[184:187], v[80:83], v[232:235]
    v_max3_f32 v8, v16, v17, v18
    v_add_f32 v104, v104, v64
    v_mfma_f32_16x16x32_bf16 v[236:239], a[184:187], v[84:87], v[236:239]
    ds_read_b128 a[220:223], v3 offset:55296
    v_max3_f32 v8, v8, v19, v20
    s_waitcnt lgkmcnt(5)
    v_mfma_f32_16x16x32_bf16 v[240:243], a[188:191], v[80:83], v[240:243]
    v_max3_f32 v8, v8, v21, v22
    v_add_f32 v104, v104, v65
    v_mfma_f32_16x16x32_bf16 v[244:247], a[188:191], v[84:87], v[244:247]
    ds_read_b128 a[224:227], v3 offset:56320
    v_max3_f32 v8, v8, v23, v24
    v_mfma_f32_16x16x32_bf16 v[248:251], a[192:195], v[80:83], v[248:251]
    ds_read_b128 a[132:135], v3 offset:57344
    v_max3_f32 v8, v8, v25, v26
    v_mfma_f32_16x16x32_bf16 v[252:255], a[192:195], v[84:87], v[252:255]
    v_max3_f32 v8, v8, v27, v28
    v_add_f32 v104, v104, v66
    v_mfma_f32_16x16x32_bf16 v[128:131], a[196:199], v[88:91], v[128:131]
    ds_read_b128 a[136:139], v3 offset:58368
    v_max3_f32 v8, v8, v29, v30
    v_mfma_f32_16x16x32_bf16 v[132:135], a[196:199], v[92:95], v[132:135]
    v_max3_f32 v8, v8, v31, v32
    v_add_f32 v104, v104, v67
    v_mfma_f32_16x16x32_bf16 v[136:139], a[200:203], v[88:91], v[136:139]
    ds_read_b128 a[140:143], v3 offset:59392
    v_max3_f32 v8, v8, v33, v34
    v_mfma_f32_16x16x32_bf16 v[140:143], a[200:203], v[92:95], v[140:143]
    v_max3_f32 v8, v8, v35, v36
    v_add_f32 v108, v108, v68
    s_waitcnt lgkmcnt(2)
    v_mfma_f32_16x16x32_bf16 v[144:147], a[204:207], v[88:91], v[144:147]
    ds_read_b128 a[144:147], v3 offset:60416
    v_max3_f32 v8, v8, v37, v38
    v_mfma_f32_16x16x32_bf16 v[148:151], a[204:207], v[92:95], v[148:151]
    v_max3_f32 v8, v8, v39, v40
    v_add_f32 v108, v108, v69
    v_mfma_f32_16x16x32_bf16 v[152:155], a[208:211], v[88:91], v[152:155]
    ds_read_b128 a[148:151], v3 offset:61440
    v_max3_f32 v8, v8, v41, v42
    v_mfma_f32_16x16x32_bf16 v[156:159], a[208:211], v[92:95], v[156:159]
    v_max3_f32 v8, v8, v43, v44
    v_add_f32 v108, v108, v70
    v_mfma_f32_16x16x32_bf16 v[160:163], a[212:215], v[88:91], v[160:163]
    ds_read_b128 a[152:155], v3 offset:62464
    v_max3_f32 v8, v8, v45, v46
    v_mfma_f32_16x16x32_bf16 v[164:167], a[212:215], v[92:95], v[164:167]
    v_max_f32 v8, v8, v47
    v_add_f32 v108, v108, v71
    v_mfma_f32_16x16x32_bf16 v[168:171], a[216:219], v[88:91], v[168:171]
    ds_read_b128 a[156:159], v3 offset:63488
    v_add_f32 v104, v104, v72
    v_mfma_f32_16x16x32_bf16 v[172:175], a[216:219], v[92:95], v[172:175]
    v_cmp_lt_f32 vcc, s91, v8
    v_add_f32 v104, v104, v73
    v_mfma_f32_16x16x32_bf16 v[176:179], a[220:223], v[88:91], v[176:179]
    ds_read_b128 a[160:163], v3 offset:64512
    s_sub_u32 s39, s39, 1
    v_mfma_f32_16x16x32_bf16 v[180:183], a[220:223], v[92:95], v[180:183]
    s_sub_u32 s38, s38, 64
    v_add_f32 v104, v104, v74
    v_mfma_f32_16x16x32_bf16 v[184:187], a[224:227], v[88:91], v[184:187]
    v_add_f32 v104, v104, v75
    v_add_f32 v108, v108, v76
    v_mfma_f32_16x16x32_bf16 v[188:191], a[224:227], v[92:95], v[188:191]
    v_add_f32 v108, v108, v77
    v_add_f32 v108, v108, v78
    v_mfma_f32_16x16x32_bf16 v[192:195], a[132:135], v[88:91], v[192:195]
    s_waitcnt vmcnt(0) lgkmcnt(0)
    s_barrier
    v_mfma_f32_16x16x32_bf16 v[196:199], a[132:135], v[92:95], v[196:199]
    s_cmp_lt_u32 s32, s33
    s_cselect_b32 s10, s37, 0
    ds_read_b128 a[68:71], v2 offset:32768
    ds_read_b128 a[72:75], v2 offset:33792
    v_mfma_f32_16x16x32_bf16 v[200:203], a[136:139], v[88:91], v[200:203]
    s_add_u32 m0, s36, 0
    ds_read_b128 a[76:79], v2 offset:34816
    v_mfma_f32_16x16x32_bf16 v[204:207], a[136:139], v[92:95], v[204:207]
    buffer_load_dwordx4 v4, s[8:11], s32 offen offset:0 lds
    v_mfma_f32_16x16x32_bf16 v[208:211], a[140:143], v[88:91], v[208:211]
    ds_read_b128 a[80:83], v2 offset:35840
    v_add_f32 v108, v108, v79
    v_mfma_f32_16x16x32_bf16 v[212:215], a[140:143], v[92:95], v[212:215]
    v_mfma_f32_16x16x32_bf16 v[216:219], a[144:147], v[88:91], v[216:219]
    ds_read_b128 a[84:87], v2 offset:36864
    v_mfma_f32_16x16x32_bf16 v[220:223], a[144:147], v[92:95], v[220:223]
    buffer_load_dwordx4 v4, s[8:11], s32 offen offset:1024 lds
    v_mfma_f32_16x16x32_bf16 v[224:227], a[148:151], v[88:91], v[224:227]
    ds_read_b128 a[88:91], v2 offset:37888
    v_mfma_f32_16x16x32_bf16 v[228:231], a[148:151], v[92:95], v[228:231]
    v_mfma_f32_16x16x32_bf16 v[232:235], a[152:155], v[88:91], v[232:235]
    ds_read_b128 a[92:95], v2 offset:38912
    v_mfma_f32_16x16x32_bf16 v[236:239], a[152:155], v[92:95], v[236:239]
    buffer_load_dwordx4 v4, s[8:11], s32 offen offset:2048 lds
    v_mfma_f32_16x16x32_bf16 v[240:243], a[156:159], v[88:91], v[240:243]
    ds_read_b128 a[96:99], v2 offset:39936
    v_mfma_f32_16x16x32_bf16 v[244:247], a[156:159], v[92:95], v[244:247]
    v_mfma_f32_16x16x32_bf16 v[248:251], a[160:163], v[88:91], v[248:251]
    v_mfma_f32_16x16x32_bf16 v[252:255], a[160:163], v[92:95], v[252:255]
    s_cbranch_vccnz K2_RESC1
K2_BACK1:
    s_sub_u32 s31, s31, 1
    s_cmp_eq_u32 s31, s85
    s_cbranch_scc0 K2_SP0
    buffer_load_dword v14, v13, s[20:23], 0 offen sc1
    s_branch K2_SP0
K2_FL0:
    buffer_load_dword v14, v13, s[20:23], 0 offen sc1
    s_branch K2_FLB0
K2_H0:
    s_waitcnt lgkmcnt(0)
    v_mfma_f32_16x16x32_bf16 v[52:55], a[68:71], a[4:7], v[100:103]
    v_exp_f32 v16, v16
    ds_read_b128 a[100:103], v2 offset:40960
    ds_read_b128 a[104:107], v2 offset:41984
    ds_read_b128 a[108:111], v2 offset:43008
    s_cmp_lt_u32 s34, s35
    s_cselect_b32 s14, s37, 0
    v_mfma_f32_16x16x32_bf16 v[52:55], a[72:75], a[12:15], v[52:55]
    v_exp_f32 v17, v17
    ds_read_b128 a[112:115], v2 offset:44032
    s_add_u32 m0, s36, 98304
    v_mfma_f32_16x16x32_bf16 v[52:55], a[76:79], a[20:23], v[52:55]
    v_exp_f32 v18, v18
    ds_read_b128 a[116:119], v2 offset:45056
    buffer_load_dwordx4 v4, s[12:15], s34 offen offset:0 lds
    v_mfma_f32_16x16x32_bf16 v[52:55], a[80:83], a[28:31], v[52:55]
    v_exp_f32 v19, v19
    ds_read_b128 a[120:123], v2 offset:46080
    v_mfma_f32_16x16x32_bf16 v[52:55], a[84:87], a[36:39], v[52:55]
    v_exp_f32 v20, v20
    ds_read_b128 a[124:127], v2 offset:47104
    v_mfma_f32_16x16x32_bf16 v[52:55], a[88:91], a[44:47], v[52:55]
    v_exp_f32 v21, v21
    ds_read_b128 a[128:131], v2 offset:48128
    buffer_load_dwordx4 v4, s[12:15], s34 offen offset:1024 lds
    v_mfma_f32_16x16x32_bf16 v[52:55], a[92:95], a[52:55], v[52:55]
    v_exp_f32 v22, v22
    ds_read_b128 a[68:71], v2 offset:49152
    v_mfma_f32_16x16x32_bf16 v[52:55], a[96:99], a[60:63], v[52:55]
    v_exp_f32 v23, v23
    ds_read_b128 a[72:75], v2 offset:50176
    s_waitcnt lgkmcnt(5)
    v_mfma_f32_16x16x32_bf16 v[60:63], a[100:103], a[4:7], v[100:103]
    v_exp_f32 v24, v24
    ds_read_b128 a[76:79], v2 offset:51200
    buffer_load_dwordx4 v4, s[12:15], s34 offen offset:2048 lds
    v_mfma_f32_16x16x32_bf16 v[60:63], a[104:107], a[12:15], v[60:63]
    v_exp_f32 v25, v25
    ds_read_b128 a[80:83], v2 offset:52224
    v_mfma_f32_16x16x32_bf16 v[60:63], a[108:111], a[20:23], v[60:63]
    v_exp_f32 v26, v26
    ds_read_b128 a[84:87], v2 offset:53248
    v_mfma_f32_16x16x32_bf16 v[60:63], a[112:115], a[28:31], v[60:63]
    v_exp_f32 v27, v27
    ds_read_b128 a[88:91], v2 offset:54272
    buffer_load_dwordx4 v4, s[12:15], s34 offen offset:3072 lds
    v_mfma_f32_16x16x32_bf16 v[60:63], a[116:119], a[36:39], v[60:63]
    v_exp_f32 v28, v28
    ds_read_b128 a[92:95], v2 offset:55296
    s_waitcnt lgkmcnt(5)
    v_mfma_f32_16x16x32_bf16 v[60:63], a[120:123], a[44:47], v[60:63]
    v_exp_f32 v29, v29
    ds_read_b128 a[96:99], v2 offset:56320
    v_mfma_f32_16x16x32_bf16 v[60:63], a[124:127], a[52:55], v[60:63]
    v_exp_f32 v30, v30
    ds_read_b128 a[100:103], v2 offset:57344
    s_add_u32 m0, s36, 102400
    v_mfma_f32_16x16x32_bf16 v[60:63], a[128:131], a[60:63], v[60:63]
    v_exp_f32 v31, v31
    ds_read_b128 a[104:107], v2 offset:58368
    buffer_load_dwordx4 v5, s[12:15], s34 offen offset:0 lds
    v_mfma_f32_16x16x32_bf16 v[68:71], a[68:71], a[4:7], v[100:103]
    ds_read_b128 a[108:111], v2 offset:59392
    v_add_f32 v104, v104, v16
    v_mfma_f32_16x16x32_bf16 v[68:71], a[72:75], a[12:15], v[68:71]
    v_cvt_pk_bf16_f32 v80, v16, v17
    v_cvt_pk_bf16_f32 v81, v18, v19
    ds_read_b128 a[112:115], v2 offset:60416
    s_waitcnt lgkmcnt(5)
    v_mfma_f32_16x16x32_bf16 v[68:71], a[76:79], a[20:23], v[68:71]
    v_cvt_pk_bf16_f32 v82, v24, v25
    v_cvt_pk_bf16_f32 v83, v26, v27
    ds_read_b128 a[116:119], v2 offset:61440
    buffer_load_dwordx4 v5, s[12:15], s34 offen offset:1024 lds
    v_mfma_f32_16x16x32_bf16 v[68:71], a[80:83], a[28:31], v[68:71]
    v_cvt_pk_bf16_f32 v84, v20, v21
    v_cvt_pk_bf16_f32 v85, v22, v23
    ds_read_b128 a[120:123], v2 offset:62464
    v_mfma_f32_16x16x32_bf16 v[68:71], a[84:87], a[36:39], v[68:71]
    v_cvt_pk_bf16_f32 v86, v28, v29
    v_cvt_pk_bf16_f32 v87, v30, v31
    ds_read_b128 a[124:127], v2 offset:63488
    ds_read_b128 a[132:135], v3 offset:0
    v_mfma_f32_16x16x32_bf16 v[68:71], a[88:91], a[44:47], v[68:71]
    ds_read_b128 a[128:131], v2 offset:64512
    buffer_load_dwordx4 v5, s[12:15], s34 offen offset:2048 lds
    ds_read_b128 a[136:139], v3 offset:1024
    v_mfma_f32_16x16x32_bf16 v[68:71], a[92:95], a[52:55], v[68:71]
    v_add_f32 v104, v104, v17
    v_add_f32 v104, v104, v18
    s_waitcnt lgkmcnt(6)
    v_mfma_f32_16x16x32_bf16 v[68:71], a[96:99], a[60:63], v[68:71]
    v_exp_f32 v32, v32
    ds_read_b128 a[140:143], v3 offset:2048
    v_mfma_f32_16x16x32_bf16 v[76:79], a[100:103], a[4:7], v[100:103]
    v_exp_f32 v33, v33
    buffer_load_dwordx4 v5, s[12:15], s34 offen offset:3072 lds
    v_mfma_f32_16x16x32_bf16 v[76:79], a[104:107], a[12:15], v[76:79]
    v_exp_f32 v34, v34
    ds_read_b128 a[144:147], v3 offset:3072
    v_mfma_f32_16x16x32_bf16 v[76:79], a[108:111], a[20:23], v[76:79]
    v_exp_f32 v35, v35
    ds_read_b128 a[148:151], v3 offset:4096
    v_mfma_f32_16x16x32_bf16 v[76:79], a[112:115], a[28:31], v[76:79]
    v_exp_f32 v36, v36
    s_add_u32 s34, s34, 0x8000
    s_waitcnt lgkmcnt(3)
    v_mfma_f32_16x16x32_bf16 v[76:79], a[116:119], a[36:39], v[76:79]
    v_exp_f32 v37, v37
    ds_read_b128 a[152:155], v3 offset:5120
    v_mfma_f32_16x16x32_bf16 v[76:79], a[120:123], a[44:47], v[76:79]
    v_exp_f32 v38, v38
    v_mfma_f32_16x16x32_bf16 v[76:79], a[124:127], a[52:55], v[76:79]
    v_exp_f32 v39, v39
    ds_read_b128 a[156:159], v3 offset:6144
    v_mfma_f32_16x16x32_bf16 v[76:79], a[128:131], a[60:63], v[76:79]
    v_exp_f32 v40, v40
    v_mfma_f32_16x16x32_bf16 v[128:131], a[132:135], v[80:83], v[128:131]
    v_exp_f32 v41, v41
    ds_read_b128 a[160:163], v3 offset:7168
    v_mfma_f32_16x16x32_bf16 v[132:135], a[132:135], v[84:87], v[132:135]
    v_exp_f32 v42, v42
    ds_read_b128 a[164:167], v3 offset:8192
    v_mfma_f32_16x16x32_bf16 v[136:139], a[136:139], v[80:83], v[136:139]
    v_exp_f32 v43, v43
    v_mfma_f32_16x16x32_bf16 v[140:143], a[136:139], v[84:87], v[140:143]
    v_exp_f32 v44, v44
    ds_read_b128 a[168:171], v3 offset:9216
    s_waitcnt lgkmcnt(3)
    v_mfma_f32_16x16x32_bf16 v[144:147], a[140:143], v[80:83], v[144:147]
    v_exp_f32 v45, v45
    v_mfma_f32_16x16x32_bf16 v[148:151], a[140:143], v[84:87], v[148:151]
    v_exp_f32 v46, v46
    ds_read_b128 a[172:175], v3 offset:10240
    v_mfma_f32_16x16x32_bf16 v[152:155], a[144:147], v[80:83], v[152:155]
    v_exp_f32 v47, v47
    v_mfma_f32_16x16x32_bf16 v[156:159], a[144:147], v[84:87], v[156:159]
    ds_read_b128 a[176:179], v3 offset:11264
    v_add_f32 v104, v104, v19
    v_mfma_f32_16x16x32_bf16 v[160:163], a[148:151], v[80:83], v[160:163]
    v_cvt_pk_bf16_f32 v88, v32, v33
    v_cvt_pk_bf16_f32 v89, v34, v35
    ds_read_b128 a[180:183], v3 offset:12288
    v_mfma_f32_16x16x32_bf16 v[164:167], a[148:151], v[84:87], v[164:167]
    v_cvt_pk_bf16_f32 v90, v40, v41
    v_cvt_pk_bf16_f32 v91, v42, v43
    v_mfma_f32_16x16x32_bf16 v[168:171], a[152:155], v[80:83], v[168:171]
    v_cvt_pk_bf16_f32 v92, v36, v37
    v_cvt_pk_bf16_f32 v93, v38, v39
    ds_read_b128 a[184:187], v3 offset:13312
    v_mfma_f32_16x16x32_bf16 v[172:175], a[152:155], v[84:87], v[172:175]
    v_cvt_pk_bf16_f32 v94, v44, v45
    v_cvt_pk_bf16_f32 v95, v46, v47
    v_mfma_f32_16x16x32_bf16 v[176:179], a[156:159], v[80:83], v[176:179]
    ds_read_b128 a[188:191], v3 offset:14336
    v_subrev_u32 v112, s38, v6
    v_cmp_ge_i32 s[44:45], 0, v112
    v_cmp_ge_i32 s[46:47], -1, v112
    v_cmp_ge_i32 s[48:49], -2, v112
    v_cmp_ge_i32 s[50:51], -3, v112
    s_nop 1
    v_cndmask_b32 v48, v7, v48, s[44:45]
    v_cndmask_b32 v49, v7, v49, s[46:47]
    v_cndmask_b32 v50, v7, v50, s[48:49]
    v_cndmask_b32 v51, v7, v51, s[50:51]
    v_cmp_ge_i32 s[44:45], 64, v112
    v_cmp_ge_i32 s[46:47], 63, v112
    v_cmp_ge_i32 s[48:49], 62, v112
    v_cmp_ge_i32 s[50:51], 61, v112
    s_nop 1
    v_cndmask_b32 v52, v7, v52, s[44:45]
    v_cndmask_b32 v53, v7, v53, s[46:47]
    v_cndmask_b32 v54, v7, v54, s[48:49]
    v_cndmask_b32 v55, v7, v55, s[50:51]
    v_cmp_ge_i32 s[44:45], -16, v112
    v_mov_b32 v114, -17
    v_cmp_ge_i32 s[46:47], v114, v112
    v_mov_b32 v115, -18
    v_cmp_ge_i32 s[48:49], v115, v112
    v_mov_b32 v116, -19
    v_cmp_ge_i32 s[50:51], v116, v112
    s_nop 1
    v_cndmask_b32 v56, v7, v56, s[44:45]
    v_cndmask_b32 v57, v7, v57, s[46:47]
    v_cndmask_b32 v58, v7, v58, s[48:49]
    v_cndmask_b32 v59, v7, v59, s[50:51]
    v_cmp_ge_i32 s[44:45], 48, v112
    v_cmp_ge_i32 s[46:47], 47, v112
    v_cmp_ge_i32 s[48:49], 46, v112
    v_cmp_ge_i32 s[50:51], 45, v112
    s_nop 1
    v_cndmask_b32 v60, v7, v60, s[44:45]
    v_cndmask_b32 v61, v7, v61, s[46:47]
    v_cndmask_b32 v62, v7, v62, s[48:49]
    v_cndmask_b32 v63, v7, v63, s[50:51]
    v_mov_b32 v113, -32
    v_cmp_ge_i32 s[44:45], v113, v112
    v_mov_b32 v114, -33
    v_cmp_ge_i32 s[46:47], v114, v112
    v_mov_b32 v115, -34
    v_cmp_ge_i32 s[48:49], v115, v112
    v_mov_b32 v116, -35
    v_cmp_ge_i32 s[50:51], v116, v112
    s_nop 1
    v_cndmask_b32 v64, v7, v64, s[44:45]
    v_cndmask_b32 v65, v7, v65, s[46:47]
    v_cndmask_b32 v66, v7, v66, s[48:49]
    v_cndmask_b32 v67, v7, v67, s[50:51]
    v_cmp_ge_i32 s[44:45], 32, v112
    v_cmp_ge_i32 s[46:47], 31, v112
    v_cmp_ge_i32 s[48:49], 30, v112
    v_cmp_ge_i32 s[50:51], 29, v112
    s_nop 1
    v_cndmask_b32 v68, v7, v68, s[44:45]
    v_cndmask_b32 v69, v7, v69, s[46:47]
    v_cndmask_b32 v70, v7, v70, s[48:49]
    v_cndmask_b32 v71, v7, v71, s[50:51]
    v_mov_b32 v113, -48
    v_cmp_ge_i32 s[44:45], v113, v112
    v_mov_b32 v114, -49
    v_cmp_ge_i32 s[46:47], v114, v112
    v_mov_b32 v115, -50
    v_cmp_ge_i32 s[48:49], v115, v112
    v_mov_b32 v116, -51
    v_cmp_ge_i32 s[50:51], v116, v112
    s_nop 1
    v_cndmask_b32 v72, v7, v72, s[44:45]
    v_cndmask_b32 v73, v7, v73, s[46:47]
    v_cndmask_b32 v74, v7, v74, s[48:49]
    v_cndmask_b32 v75, v7, v75, s[50:51]
    v_cmp_ge_i32 s[44:45], 16, v112
    v_cmp_ge_i32 s[46:47], 15, v112
    v_cmp_ge_i32 s[48:49], 14, v112
    v_cmp_ge_i32 s[50:51], 13, v112
    s_nop 1
    v_cndmask_b32 v76, v7, v76, s[44:45]
    v_cndmask_b32 v77, v7, v77, s[46:47]
    v_cndmask_b32 v78, v7, v78, s[48:49]
    v_cndmask_b32 v79, v7, v79, s[50:51]
    v_add_f32 v108, v108, v20
    v_mfma_f32_16x16x32_bf16 v[180:183], a[156:159], v[84:87], v[180:183]
    v_add_f32 v108, v108, v21
    v_add_f32 v108, v108, v22
    s_waitcnt lgkmcnt(2)
    v_mfma_f32_16x16x32_bf16 v[184:187], a[160:163], v[80:83], v[184:187]
    ds_read_b128 a[192:195], v3 offset:15360
    v_max3_f32 v8, v52, v53, v54
    v_mfma_f32_16x16x32_bf16 v[188:191], a[160:163], v[84:87], v[188:191]
    ds_read_b128 a[196:199], v3 offset:16384
    v_max3_f32 v8, v8, v55, v60
    v_mfma_f32_16x16x32_bf16 v[192:195], a[164:167], v[80:83], v[192:195]
    v_max3_f32 v8, v8, v61, v62
    v_add_f32 v108, v108, v23
    v_mfma_f32_16x16x32_bf16 v[196:199], a[164:167], v[84:87], v[196:199]
    ds_read_b128 a[200:203], v3 offset:17408
    v_max3_f32 v8, v8, v63, v68
    v_mfma_f32_16x16x32_bf16 v[200:203], a[168:171], v[80:83], v[200:203]
    v_max3_f32 v8, v8, v69, v70
    v_add_f32 v104, v104, v24
    v_mfma_f32_16x16x32_bf16 v[204:207], a[168:171], v[84:87], v[204:207]
    ds_read_b128 a[204:207], v3 offset:18432
    v_max3_f32 v8, v8, v71, v76
    v_mfma_f32_16x16x32_bf16 v[208:211], a[172:175], v[80:83], v[208:211]
    v_max3_f32 v8, v8, v77, v78
    v_add_f32 v104, v104, v25
    v_mfma_f32_16x16x32_bf16 v[212:215], a[172:175], v[84:87], v[212:215]
    ds_read_b128 a[208:211], v3 offset:19456
    v_max_f32 v8, v8, v79
    v_mfma_f32_16x16x32_bf16 v[216:219], a[176:179], v[80:83], v[216:219]
    ds_read_b128 a[212:215], v3 offset:20480
    v_add_f32 v104, v104, v26
    v_mfma_f32_16x16x32_bf16 v[220:223], a[176:179], v[84:87], v[220:223]
    v_cmp_lt_f32 vcc, s91, v8
    v_add_f32 v104, v104, v27
    v_mfma_f32_16x16x32_bf16 v[224:227], a[180:183], v[80:83], v[224:227]
    ds_read_b128 a[216:219], v3 offset:21504
    v_add_f32 v108, v108, v28
    v_mfma_f32_16x16x32_bf16 v[228:231], a[180:183], v[84:87], v[228:231]
    v_add_f32 v108, v108, v29
    v_add_f32 v108, v108, v30
    s_waitcnt lgkmcnt(3)
    v_mfma_f32_16x16x32_bf16 v[232:235], a[184:187], v[80:83], v[232:235]
    ds_read_b128 a[220:223], v3 offset:22528
    v_add_f32 v108, v108, v31
    v_mfma_f32_16x16x32_bf16 v[236:239], a[184:187], v[84:87], v[236:239]
    v_add_f32 v104, v104, v32
    v_add_f32 v104, v104, v33
    v_mfma_f32_16x16x32_bf16 v[240:243], a[188:191], v[80:83], v[240:243]
    ds_read_b128 a[224:227], v3 offset:23552
    v_add_f32 v104, v104, v34
    v_mfma_f32_16x16x32_bf16 v[244:247], a[188:191], v[84:87], v[244:247]
    ds_read_b128 a[132:135], v3 offset:24576
    v_add_f32 v104, v104, v35
    v_mfma_f32_16x16x32_bf16 v[248:251], a[192:195], v[80:83], v[248:251]
    v_add_f32 v108, v108, v36
    v_add_f32 v108, v108, v37
    v_mfma_f32_16x16x32_bf16 v[252:255], a[192:195], v[84:87], v[252:255]
    ds_read_b128 a[136:139], v3 offset:25600
    v_add_f32 v108, v108, v38
    v_mfma_f32_16x16x32_bf16 v[128:131], a[196:199], v[88:91], v[128:131]
    v_add_f32 v108, v108, v39
    v_add_f32 v104, v104, v40
    v_mfma_f32_16x16x32_bf16 v[132:135], a[196:199], v[92:95], v[132:135]
    ds_read_b128 a[140:143], v3 offset:26624
    v_add_f32 v104, v104, v41
    v_mfma_f32_16x16x32_bf16 v[136:139], a[200:203], v[88:91], v[136:139]
    v_add_f32 v104, v104, v42
    v_add_f32 v104, v104, v43
    v_mfma_f32_16x16x32_bf16 v[140:143], a[200:203], v[92:95], v[140:143]
    ds_read_b128 a[144:147], v3 offset:27648
    v_add_f32 v108, v108, v44
    v_mfma_f32_16x16x32_bf16 v[144:147], a[204:207], v[88:91], v[144:147]
    ds_read_b128 a[148:151], v3 offset:28672
    v_add_f32 v108, v108, v45
    v_mfma_f32_16x16x32_bf16 v[148:151], a[204:207], v[92:95], v[148:151]
    v_add_f32 v108, v108, v46
    v_add_f32 v108, v108, v47
    s_waitcnt lgkmcnt(3)
    v_mfma_f32_16x16x32_bf16 v[152:155], a[208:211], v[88:91], v[152:155]
    ds_read_b128 a[152:155], v3 offset:29696
    v_mfma_f32_16x16x32_bf16 v[156:159], a[208:211], v[92:95], v[156:159]
    v_mfma_f32_16x16x32_bf16 v[160:163], a[212:215], v[88:91], v[160:163]
    ds_read_b128 a[156:159], v3 offset:30720
    v_mfma_f32_16x16x32_bf16 v[164:167], a[212:215], v[92:95], v[164:167]
    v_mfma_f32_16x16x32_bf16 v[168:171], a[216:219], v[88:91], v[168:171]
    ds_read_b128 a[160:163], v3 offset:31744
    v_mfma_f32_16x16x32_bf16 v[172:175], a[216:219], v[92:95], v[172:175]
    v_mfma_f32_16x16x32_bf16 v[176:179], a[220:223], v[88:91], v[176:179]
    v_mfma_f32_16x16x32_bf16 v[180:183], a[220:223], v[92:95], v[180:183]
    v_mfma_f32_16x16x32_bf16 v[184:187], a[224:227], v[88:91], v[184:187]
    v_mfma_f32_16x16x32_bf16 v[188:191], a[224:227], v[92:95], v[188:191]
    v_mfma_f32_16x16x32_bf16 v[192:195], a[132:135], v[88:91], v[192:195]
    s_waitcnt vmcnt(0) lgkmcnt(0)
    s_barrier
    v_mfma_f32_16x16x32_bf16 v[196:199], a[132:135], v[92:95], v[196:199]
    v_mfma_f32_16x16x32_bf16 v[200:203], a[136:139], v[88:91], v[200:203]
    v_mfma_f32_16x16x32_bf16 v[204:207], a[136:139], v[92:95], v[204:207]
    v_mfma_f32_16x16x32_bf16 v[208:211], a[140:143], v[88:91], v[208:211]
    v_mfma_f32_16x16x32_bf16 v[212:215], a[140:143], v[92:95], v[212:215]
    v_mfma_f32_16x16x32_bf16 v[216:219], a[144:147], v[88:91], v[216:219]
    v_mfma_f32_16x16x32_bf16 v[220:223], a[144:147], v[92:95], v[220:223]
    v_mfma_f32_16x16x32_bf16 v[224:227], a[148:151], v[88:91], v[224:227]
    v_mfma_f32_16x16x32_bf16 v[228:231], a[148:151], v[92:95], v[228:231]
    v_mfma_f32_16x16x32_bf16 v[232:235], a[152:155], v[88:91], v[232:235]
    v_mfma_f32_16x16x32_bf16 v[236:239], a[152:155], v[92:95], v[236:239]
    v_mfma_f32_16x16x32_bf16 v[240:243], a[156:159], v[88:91], v[240:243]
    v_mfma_f32_16x16x32_bf16 v[244:247], a[156:159], v[92:95], v[244:247]
    v_mfma_f32_16x16x32_bf16 v[248:251], a[160:163], v[88:91], v[248:251]
    v_mfma_f32_16x16x32_bf16 v[252:255], a[160:163], v[92:95], v[252:255]
    s_cbranch_vccz K2_HB0
    s_mov_b32 s84, 1
    s_branch K2_RESC0
K2_HB0:
    ds_read_b128 a[132:135], v3 offset:32768
    ds_read_b128 a[136:139], v3 offset:33792
    ds_read_b128 a[140:143], v3 offset:34816
    ds_read_b128 a[144:147], v3 offset:35840
    ds_read_b128 a[148:151], v3 offset:36864
    ds_read_b128 a[152:155], v3 offset:37888
    v_exp_f32 v52, v52
    v_exp_f32 v53, v53
    v_exp_f32 v54, v54
    v_exp_f32 v55, v55
    v_exp_f32 v60, v60
    v_exp_f32 v61, v61
    v_exp_f32 v62, v62
    v_exp_f32 v63, v63
    v_cvt_pk_bf16_f32 v84, v52, v53
    v_cvt_pk_bf16_f32 v85, v54, v55
    v_cvt_pk_bf16_f32 v86, v60, v61
    v_cvt_pk_bf16_f32 v87, v62, v63
    s_nop 1
    s_waitcnt lgkmcnt(5)
    v_mfma_f32_16x16x32_bf16 v[132:135], a[132:135], v[84:87], v[132:135]
    v_exp_f32 v68, v68
    ds_read_b128 a[156:159], v3 offset:38912
    s_waitcnt lgkmcnt(5)
    v_mfma_f32_16x16x32_bf16 v[140:143], a[136:139], v[84:87], v[140:143]
    v_exp_f32 v69, v69
    ds_read_b128 a[160:163], v3 offset:39936
    s_waitcnt lgkmcnt(5)
    v_mfma_f32_16x16x32_bf16 v[148:151], a[140:143], v[84:87], v[148:151]
    v_exp_f32 v70, v70
    ds_read_b128 a[164:167], v3 offset:40960
    s_waitcnt lgkmcnt(2)
    v_mfma_f32_16x16x32_bf16 v[156:159], a[144:147], v[84:87], v[156:159]
    v_exp_f32 v71, v71
    ds_read_b128 a[168:171], v3 offset:41984
    v_mfma_f32_16x16x32_bf16 v[164:167], a[148:151], v[84:87], v[164:167]
    v_exp_f32 v76, v76
    ds_read_b128 a[172:175], v3 offset:43008
    v_mfma_f32_16x16x32_bf16 v[172:175], a[152:155], v[84:87], v[172:175]
    v_exp_f32 v77, v77
    ds_read_b128 a[176:179], v3 offset:44032
    v_mfma_f32_16x16x32_bf16 v[180:183], a[156:159], v[84:87], v[180:183]
    v_exp_f32 v78, v78
    ds_read_b128 a[180:183], v3 offset:45056
    s_waitcnt lgkmcnt(2)
    v_mfma_f32_16x16x32_bf16 v[188:191], a[160:163], v[84:87], v[188:191]
    v_exp_f32 v79, v79
    ds_read_b128 a[184:187], v3 offset:46080
    v_mfma_f32_16x16x32_bf16 v[196:199], a[164:167], v[84:87], v[196:199]
    ds_read_b128 a[188:191], v3 offset:47104
    v_mfma_f32_16x16x32_bf16 v[204:207], a[168:171], v[84:87], v[204:207]
    v_cvt_pk_bf16_f32 v92, v68, v69
    v_cvt_pk_bf16_f32 v93, v70, v71
    ds_read_b128 a[192:195], v3 offset:48128
    v_mfma_f32_16x16x32_bf16 v[212:215], a[172:175], v[84:87], v[212:215]
    v_cvt_pk_bf16_f32 v94, v76, v77
    v_cvt_pk_bf16_f32 v95, v78, v79
    ds_read_b128 a[196:199], v3 offset:49152
    s_waitcnt lgkmcnt(2)
    v_mfma_f32_16x16x32_bf16 v[220:223], a[176:179], v[84:87], v[220:223]
    v_add_f32 v108, v108, v52
    v_add_f32 v108, v108, v53
    ds_read_b128 a[200:203], v3 offset:50176
    v_mfma_f32_16x16x32_bf16 v[228:231], a[180:183], v[84:87], v[228:231]
    v_add_f32 v108, v108, v54
    v_add_f32 v108, v108, v55
    ds_read_b128 a[204:207], v3 offset:51200
    v_mfma_f32_16x16x32_bf16 v[236:239], a[184:187], v[84:87], v[236:239]
    v_add_f32 v108, v108, v60
    v_add_f32 v108, v108, v61
    ds_read_b128 a[208:211], v3 offset:52224
    v_mfma_f32_16x16x32_bf16 v[244:247], a[188:191], v[84:87], v[244:247]
    v_add_f32 v108, v108, v62
    v_add_f32 v108, v108, v63
    ds_read_b128 a[212:215], v3 offset:53248
    s_waitcnt lgkmcnt(2)
    v_mfma_f32_16x16x32_bf16 v[252:255], a[192:195], v[84:87], v[252:255]
    v_add_f32 v108, v108, v68
    v_add_f32 v108, v108, v69
    ds_read_b128 a[216:219], v3 offset:54272
    v_mfma_f32_16x16x32_bf16 v[132:135], a[196:199], v[92:95], v[132:135]
    v_add_f32 v108, v108, v70
    v_add_f32 v108, v108, v71
    ds_read_b128 a[220:223], v3 offset:55296
    v_mfma_f32_16x16x32_bf16 v[140:143], a[200:203], v[92:95], v[140:143]
    v_add_f32 v108, v108, v76
    v_add_f32 v108, v108, v77
    ds_read_b128 a[224:227], v3 offset:56320
    v_mfma_f32_16x16x32_bf16 v[148:151], a[204:207], v[92:95], v[148:151]
    v_add_f32 v108, v108, v78
    v_add_f32 v108, v108, v79
    ds_read_b128 a[132:135], v3 offset:57344
    s_waitcnt lgkmcnt(2)
    v_mfma_f32_16x16x32_bf16 v[156:159], a[208:211], v[92:95], v[156:159]
    ds_read_b128 a[136:139], v3 offset:58368
    v_mfma_f32_16x16x32_bf16 v[164:167], a[212:215], v[92:95], v[164:167]
    ds_read_b128 a[140:143], v3 offset:59392
    v_mfma_f32_16x16x32_bf16 v[172:175], a[216:219], v[92:95], v[172:175]
    ds_read_b128 a[144:147], v3 offset:60416
    v_mfma_f32_16x16x32_bf16 v[180:183], a[220:223], v[92:95], v[180:183]
    ds_read_b128 a[148:151], v3 offset:61440
    s_waitcnt lgkmcnt(2)
    v_mfma_f32_16x16x32_bf16 v[188:191], a[224:227], v[92:95], v[188:191]
    ds_read_b128 a[152:155], v3 offset:62464
    v_mfma_f32_16x16x32_bf16 v[196:199], a[132:135], v[92:95], v[196:199]
    ds_read_b128 a[156:159], v3 offset:63488
    v_mfma_f32_16x16x32_bf16 v[204:207], a[136:139], v[92:95], v[204:207]
    ds_read_b128 a[160:163], v3 offset:64512
    v_mfma_f32_16x16x32_bf16 v[212:215], a[140:143], v[92:95], v[212:215]
    s_waitcnt lgkmcnt(1)
    v_mfma_f32_16x16x32_bf16 v[220:223], a[144:147], v[92:95], v[220:223]
    v_mfma_f32_16x16x32_bf16 v[228:231], a[148:151], v[92:95], v[228:231]
    v_mfma_f32_16x16x32_bf16 v[236:239], a[152:155], v[92:95], v[236:239]
    v_mfma_f32_16x16x32_bf16 v[244:247], a[156:159], v[92:95], v[244:247]
    s_waitcnt lgkmcnt(0)
    v_mfma_f32_16x16x32_bf16 v[252:255], a[160:163], v[92:95], v[252:255]
    s_branch K2_EPI
K2_H1:
    s_waitcnt lgkmcnt(0)
    v_mfma_f32_16x16x32_bf16 v[20:23], a[68:71], a[4:7], v[100:103]
    v_exp_f32 v48, v48
    ds_read_b128 a[100:103], v2 offset:8192
    ds_read_b128 a[104:107], v2 offset:9216
    ds_read_b128 a[108:111], v2 offset:10240
    s_cmp_lt_u32 s34, s35
    s_cselect_b32 s14, s37, 0
    v_mfma_f32_16x16x32_bf16 v[20:23], a[72:75], a[12:15], v[20:23]
    v_exp_f32 v49, v49
    ds_read_b128 a[112:115], v2 offset:11264
    s_add_u32 m0, s36, 65536
    v_mfma_f32_16x16x32_bf16 v[20:23], a[76:79], a[20:23], v[20:23]
    v_exp_f32 v50, v50
    ds_read_b128 a[116:119], v2 offset:12288
    buffer_load_dwordx4 v4, s[12:15], s34 offen offset:0 lds
    v_mfma_f32_16x16x32_bf16 v[20:23], a[80:83], a[28:31], v[20:23]
    v_exp_f32 v51, v51
    ds_read_b128 a[120:123], v2 offset:13312
    v_mfma_f32_16x16x32_bf16 v[20:23], a[84:87], a[36:39], v[20:23]
    v_exp_f32 v52, v52
    ds_read_b128 a[124:127], v2 offset:14336
    v_mfma_f32_16x16x32_bf16 v[20:23], a[88:91], a[44:47], v[20:23]
    v_exp_f32 v53, v53
    ds_read_b128 a[128:131], v2 offset:15360
    buffer_load_dwordx4 v4, s[12:15], s34 offen offset:1024 lds
    v_mfma_f32_16x16x32_bf16 v[20:23], a[92:95], a[52:55], v[20:23]
    v_exp_f32 v54, v54
    ds_read_b128 a[68:71], v2 offset:16384
    v_mfma_f32_16x16x32_bf16 v[20:23], a[96:99], a[60:63], v[20:23]
    v_exp_f32 v55, v55
    ds_read_b128 a[72:75], v2 offset:17408
    s_waitcnt lgkmcnt(5)
    v_mfma_f32_16x16x32_bf16 v[28:31], a[100:103], a[4:7], v[100:103]
    v_exp_f32 v56, v56
    ds_read_b128 a[76:79], v2 offset:18432
    buffer_load_dwordx4 v4, s[12:15], s34 offen offset:2048 lds
    v_mfma_f32_16x16x32_bf16 v[28:31], a[104:107], a[12:15], v[28:31]
    v_exp_f32 v57, v57
    ds_read_b128 a[80:83], v2 offset:19456
    v_mfma_f32_16x16x32_bf16 v[28:31], a[108:111], a[20:23], v[28:31]
    v_exp_f32 v58, v58
    ds_read_b128 a[84:87], v2 offset:20480
    v_mfma_f32_16x16x32_bf16 v[28:31], a[112:115], a[28:31], v[28:31]
    v_exp_f32 v59, v59
    ds_read_b128 a[88:91], v2 offset:21504
    buffer_load_dwordx4 v4, s[12:15], s34 offen offset:3072 lds
    v_mfma_f32_16x16x32_bf16 v[28:31], a[116:119], a[36:39], v[28:31]
    v_exp_f32 v60, v60
    ds_read_b128 a[92:95], v2 offset:22528
    s_waitcnt lgkmcnt(5)
    v_mfma_f32_16x16x32_bf16 v[28:31], a[120:123], a[44:47], v[28:31]
    v_exp_f32 v61, v61
    ds_read_b128 a[96:99], v2 offset:23552
    v_mfma_f32_16x16x32_bf16 v[28:31], a[124:127], a[52:55], v[28:31]
    v_exp_f32 v62, v62
    ds_read_b128 a[100:103], v2 offset:24576
    s_add_u32 m0, s36, 69632
    v_mfma_f32_16x16x32_bf16 v[28:31], a[128:131], a[60:63], v[28:31]
    v_exp_f32 v63, v63
    ds_read_b128 a[104:107], v2 offset:25600
    buffer_load_dwordx4 v5, s[12:15], s34 offen offset:0 lds
    v_mfma_f32_16x16x32_bf16 v[36:39], a[68:71], a[4:7], v[100:103]
    ds_read_b128 a[108:111], v2 offset:26624
    v_add_f32 v104, v104, v48
    v_mfma_f32_16x16x32_bf16 v[36:39], a[72:75], a[12:15], v[36:39]
    v_cvt_pk_bf16_f32 v80, v48, v49
    v_cvt_pk_bf16_f32 v81, v50, v51
    ds_read_b128 a[112:115], v2 offset:27648
    s_waitcnt lgkmcnt(5)
    v_mfma_f32_16x16x32_bf16 v[36:39], a[76:79], a[20:23], v[36:39]
    v_cvt_pk_bf16_f32 v82, v56, v57
    v_cvt_pk_bf16_f32 v83, v58, v59
    ds_read_b128 a[116:119], v2 offset:28672
    buffer_load_dwordx4 v5, s[12:15], s34 offen offset:1024 lds
    v_mfma_f32_16x16x32_bf16 v[36:39], a[80:83], a[28:31], v[36:39]
    v_cvt_pk_bf16_f32 v84, v52, v53
    v_cvt_pk_bf16_f32 v85, v54, v55
    ds_read_b128 a[120:123], v2 offset:29696
    v_mfma_f32_16x16x32_bf16 v[36:39], a[84:87], a[36:39], v[36:39]
    v_cvt_pk_bf16_f32 v86, v60, v61
    v_cvt_pk_bf16_f32 v87, v62, v63
    ds_read_b128 a[124:127], v2 offset:30720
    ds_read_b128 a[132:135], v3 offset:32768
    v_mfma_f32_16x16x32_bf16 v[36:39], a[88:91], a[44:47], v[36:39]
    ds_read_b128 a[128:131], v2 offset:31744
    buffer_load_dwordx4 v5, s[12:15], s34 offen offset:2048 lds
    ds_read_b128 a[136:139], v3 offset:33792
    v_mfma_f32_16x16x32_bf16 v[36:39], a[92:95], a[52:55], v[36:39]
    v_add_f32 v104, v104, v49
    v_add_f32 v104, v104, v50
    s_waitcnt lgkmcnt(6)
    v_mfma_f32_16x16x32_bf16 v[36:39], a[96:99], a[60:63], v[36:39]
    v_exp_f32 v64, v64
    ds_read_b128 a[140:143], v3 offset:34816
    v_mfma_f32_16x16x32_bf16 v[44:47], a[100:103], a[4:7], v[100:103]
    v_exp_f32 v65, v65
    buffer_load_dwordx4 v5, s[12:15], s34 offen offset:3072 lds
    v_mfma_f32_16x16x32_bf16 v[44:47], a[104:107], a[12:15], v[44:47]
    v_exp_f32 v66, v66
    ds_read_b128 a[144:147], v3 offset:35840
    v_mfma_f32_16x16x32_bf16 v[44:47], a[108:111], a[20:23], v[44:47]
    v_exp_f32 v67, v67
    ds_read_b128 a[148:151], v3 offset:36864
    v_mfma_f32_16x16x32_bf16 v[44:47], a[112:115], a[28:31], v[44:47]
    v_exp_f32 v68, v68
    s_add_u32 s34, s34, 0x8000
    s_waitcnt lgkmcnt(3)
    v_mfma_f32_16x16x32_bf16 v[44:47], a[116:119], a[36:39], v[44:47]
    v_exp_f32 v69, v69
    ds_read_b128 a[152:155], v3 offset:37888
    v_mfma_f32_16x16x32_bf16 v[44:47], a[120:123], a[44:47], v[44:47]
    v_exp_f32 v70, v70
    v_mfma_f32_16x16x32_bf16 v[44:47], a[124:127], a[52:55], v[44:47]
    v_exp_f32 v71, v71
    ds_read_b128 a[156:159], v3 offset:38912
    v_mfma_f32_16x16x32_bf16 v[44:47], a[128:131], a[60:63], v[44:47]
    v_exp_f32 v72, v72
    v_mfma_f32_16x16x32_bf16 v[128:131], a[132:135], v[80:83], v[128:131]
    v_exp_f32 v73, v73
    ds_read_b128 a[160:163], v3 offset:39936
    v_mfma_f32_16x16x32_bf16 v[132:135], a[132:135], v[84:87], v[132:135]
    v_exp_f32 v74, v74
    ds_read_b128 a[164:167], v3 offset:40960
    v_mfma_f32_16x16x32_bf16 v[136:139], a[136:139], v[80:83], v[136:139]
    v_exp_f32 v75, v75
    v_mfma_f32_16x16x32_bf16 v[140:143], a[136:139], v[84:87], v[140:143]
    v_exp_f32 v76, v76
    ds_read_b128 a[168:171], v3 offset:41984
    s_waitcnt lgkmcnt(3)
    v_mfma_f32_16x16x32_bf16 v[144:147], a[140:143], v[80:83], v[144:147]
    v_exp_f32 v77, v77
    v_mfma_f32_16x16x32_bf16 v[148:151], a[140:143], v[84:87], v[148:151]
    v_exp_f32 v78, v78
    ds_read_b128 a[172:175], v3 offset:43008
    v_mfma_f32_16x16x32_bf16 v[152:155], a[144:147], v[80:83], v[152:155]
    v_exp_f32 v79, v79
    v_mfma_f32_16x16x32_bf16 v[156:159], a[144:147], v[84:87], v[156:159]
    ds_read_b128 a[176:179], v3 offset:44032
    v_add_f32 v104, v104, v51
    v_mfma_f32_16x16x32_bf16 v[160:163], a[148:151], v[80:83], v[160:163]
    v_cvt_pk_bf16_f32 v88, v64, v65
    v_cvt_pk_bf16_f32 v89, v66, v67
    ds_read_b128 a[180:183], v3 offset:45056
    v_mfma_f32_16x16x32_bf16 v[164:167], a[148:151], v[84:87], v[164:167]
    v_cvt_pk_bf16_f32 v90, v72, v73
    v_cvt_pk_bf16_f32 v91, v74, v75
    v_mfma_f32_16x16x32_bf16 v[168:171], a[152:155], v[80:83], v[168:171]
    v_cvt_pk_bf16_f32 v92, v68, v69
    v_cvt_pk_bf16_f32 v93, v70, v71
    ds_read_b128 a[184:187], v3 offset:46080
    v_mfma_f32_16x16x32_bf16 v[172:175], a[152:155], v[84:87], v[172:175]
    v_cvt_pk_bf16_f32 v94, v76, v77
    v_cvt_pk_bf16_f32 v95, v78, v79
    v_mfma_f32_16x16x32_bf16 v[176:179], a[156:159], v[80:83], v[176:179]
    ds_read_b128 a[188:191], v3 offset:47104
    v_subrev_u32 v112, s38, v6
    v_cmp_ge_i32 s[44:45], 0, v112
    v_cmp_ge_i32 s[46:47], -1, v112
    v_cmp_ge_i32 s[48:49], -2, v112
    v_cmp_ge_i32 s[50:51], -3, v112
    s_nop 1
    v_cndmask_b32 v16, v7, v16, s[44:45]
    v_cndmask_b32 v17, v7, v17, s[46:47]
    v_cndmask_b32 v18, v7, v18, s[48:49]
    v_cndmask_b32 v19, v7, v19, s[50:51]
    v_cmp_ge_i32 s[44:45], 64, v112
    v_cmp_ge_i32 s[46:47], 63, v112
    v_cmp_ge_i32 s[48:49], 62, v112
    v_cmp_ge_i32 s[50:51], 61, v112
    s_nop 1
    v_cndmask_b32 v20, v7, v20, s[44:45]
    v_cndmask_b32 v21, v7, v21, s[46:47]
    v_cndmask_b32 v22, v7, v22, s[48:49]
    v_cndmask_b32 v23, v7, v23, s[50:51]
    v_cmp_ge_i32 s[44:45], -16, v112
    v_mov_b32 v114, -17
    v_cmp_ge_i32 s[46:47], v114, v112
    v_mov_b32 v115, -18
    v_cmp_ge_i32 s[48:49], v115, v112
    v_mov_b32 v116, -19
    v_cmp_ge_i32 s[50:51], v116, v112
    s_nop 1
    v_cndmask_b32 v24, v7, v24, s[44:45]
    v_cndmask_b32 v25, v7, v25, s[46:47]
    v_cndmask_b32 v26, v7, v26, s[48:49]
    v_cndmask_b32 v27, v7, v27, s[50:51]
    v_cmp_ge_i32 s[44:45], 48, v112
    v_cmp_ge_i32 s[46:47], 47, v112
    v_cmp_ge_i32 s[48:49], 46, v112
    v_cmp_ge_i32 s[50:51], 45, v112
    s_nop 1
    v_cndmask_b32 v28, v7, v28, s[44:45]
    v_cndmask_b32 v29, v7, v29, s[46:47]
    v_cndmask_b32 v30, v7, v30, s[48:49]
    v_cndmask_b32 v31, v7, v31, s[50:51]
    v_mov_b32 v113, -32
    v_cmp_ge_i32 s[44:45], v113, v112
    v_mov_b32 v114, -33
    v_cmp_ge_i32 s[46:47], v114, v112
    v_mov_b32 v115, -34
    v_cmp_ge_i32 s[48:49], v115, v112
    v_mov_b32 v116, -35
    v_cmp_ge_i32 s[50:51], v116, v112
    s_nop 1
    v_cndmask_b32 v32, v7, v32, s[44:45]
    v_cndmask_b32 v33, v7, v33, s[46:47]
    v_cndmask_b32 v34, v7, v34, s[48:49]
    v_cndmask_b32 v35, v7, v35, s[50:51]
    v_cmp_ge_i32 s[44:45], 32, v112
    v_cmp_ge_i32 s[46:47], 31, v112
    v_cmp_ge_i32 s[48:49], 30, v112
    v_cmp_ge_i32 s[50:51], 29, v112
    s_nop 1
    v_cndmask_b32 v36, v7, v36, s[44:45]
    v_cndmask_b32 v37, v7, v37, s[46:47]
    v_cndmask_b32 v38, v7, v38, s[48:49]
    v_cndmask_b32 v39, v7, v39, s[50:51]
    v_mov_b32 v113, -48
    v_cmp_ge_i32 s[44:45], v113, v112
    v_mov_b32 v114, -49
    v_cmp_ge_i32 s[46:47], v114, v112
    v_mov_b32 v115, -50
    v_cmp_ge_i32 s[48:49], v115, v112
    v_mov_b32 v116, -51
    v_cmp_ge_i32 s[50:51], v116, v112
    s_nop 1
    v_cndmask_b32 v40, v7, v40, s[44:45]
    v_cndmask_b32 v41, v7, v41, s[46:47]
    v_cndmask_b32 v42, v7, v42, s[48:49]
    v_cndmask_b32 v43, v7, v43, s[50:51]
    v_cmp_ge_i32 s[44:45], 16, v112
    v_cmp_ge_i32 s[46:47], 15, v112
    v_cmp_ge_i32 s[48:49], 14, v112
    v_cmp_ge_i32 s[50:51], 13, v112
    s_nop 1
    v_cndmask_b32 v44, v7, v44, s[44:45]
    v_cndmask_b32 v45, v7, v45, s[46:47]
    v_cndmask_b32 v46, v7, v46, s[48:49]
    v_cndmask_b32 v47, v7, v47, s[50:51]
    v_add_f32 v108, v108, v52
    v_mfma_f32_16x16x32_bf16 v[180:183], a[156:159], v[84:87], v[180:183]
    v_add_f32 v108, v108, v53
    v_add_f32 v108, v108, v54
    s_waitcnt lgkmcnt(2)
    v_mfma_f32_16x16x32_bf16 v[184:187], a[160:163], v[80:83], v[184:187]
    ds_read_b128 a[192:195], v3 offset:48128
    v_max3_f32 v8, v20, v21, v22
    v_mfma_f32_16x16x32_bf16 v[188:191], a[160:163], v[84:87], v[188:191]
    ds_read_b128 a[196:199], v3 offset:49152
    v_max3_f32 v8, v8, v23, v28
    v_mfma_f32_16x16x32_bf16 v[192:195], a[164:167], v[80:83], v[192:195]
    v_max3_f32 v8, v8, v29, v30
    v_add_f32 v108, v108, v55
    v_mfma_f32_16x16x32_bf16 v[196:199], a[164:167], v[84:87], v[196:199]
    ds_read_b128 a[200:203], v3 offset:50176
    v_max3_f32 v8, v8, v31, v36
    v_mfma_f32_16x16x32_bf16 v[200:203], a[168:171], v[80:83], v[200:203]
    v_max3_f32 v8, v8, v37, v38
    v_add_f32 v104, v104, v56
    v_mfma_f32_16x16x32_bf16 v[204:207], a[168:171], v[84:87], v[204:207]
    ds_read_b128 a[204:207], v3 offset:51200
    v_max3_f32 v8, v8, v39, v44
    v_mfma_f32_16x16x32_bf16 v[208:211], a[172:175], v[80:83], v[208:211]
    v_max3_f32 v8, v8, v45, v46
    v_add_f32 v104, v104, v57
    v_mfma_f32_16x16x32_bf16 v[212:215], a[172:175], v[84:87], v[212:215]
    ds_read_b128 a[208:211], v3 offset:52224
    v_max_f32 v8, v8, v47
    v_mfma_f32_16x16x32_bf16 v[216:219], a[176:179], v[80:83], v[216:219]
    ds_read_b128 a[212:215], v3 offset:53248
    v_add_f32 v104, v104, v58
    v_mfma_f32_16x16x32_bf16 v[220:223], a[176:179], v[84:87], v[220:223]
    v_cmp_lt_f32 vcc, s91, v8
    v_add_f32 v104, v104, v59
    v_mfma_f32_16x16x32_bf16 v[224:227], a[180:183], v[80:83], v[224:227]
    ds_read_b128 a[216:219], v3 offset:54272
    v_add_f32 v108, v108, v60
    v_mfma_f32_16x16x32_bf16 v[228:231], a[180:183], v[84:87], v[228:231]
    v_add_f32 v108, v108, v61
    v_add_f32 v108, v108, v62
    s_waitcnt lgkmcnt(3)
    v_mfma_f32_16x16x32_bf16 v[232:235], a[184:187], v[80:83], v[232:235]
    ds_read_b128 a[220:223], v3 offset:55296
    v_add_f32 v108, v108, v63
    v_mfma_f32_16x16x32_bf16 v[236:239], a[184:187], v[84:87], v[236:239]
    v_add_f32 v104, v104, v64
    v_add_f32 v104, v104, v65
    v_mfma_f32_16x16x32_bf16 v[240:243], a[188:191], v[80:83], v[240:243]
    ds_read_b128 a[224:227], v3 offset:56320
    v_add_f32 v104, v104, v66
    v_mfma_f32_16x16x32_bf16 v[244:247], a[188:191], v[84:87], v[244:247]
    ds_read_b128 a[132:135], v3 offset:57344
    v_add_f32 v104, v104, v67
    v_mfma_f32_16x16x32_bf16 v[248:251], a[192:195], v[80:83], v[248:251]
    v_add_f32 v108, v108, v68
    v_add_f32 v108, v108, v69
    v_mfma_f32_16x16x32_bf16 v[252:255], a[192:195], v[84:87], v[252:255]
    ds_read_b128 a[136:139], v3 offset:58368
    v_add_f32 v108, v108, v70
    v_mfma_f32_16x16x32_bf16 v[128:131], a[196:199], v[88:91], v[128:131]
    v_add_f32 v108, v108, v71
    v_add_f32 v104, v104, v72
    v_mfma_f32_16x16x32_bf16 v[132:135], a[196:199], v[92:95], v[132:135]
    ds_read_b128 a[140:143], v3 offset:59392
    v_add_f32 v104, v104, v73
    v_mfma_f32_16x16x32_bf16 v[136:139], a[200:203], v[88:91], v[136:139]
    v_add_f32 v104, v104, v74
    v_add_f32 v104, v104, v75
    v_mfma_f32_16x16x32_bf16 v[140:143], a[200:203], v[92:95], v[140:143]
    ds_read_b128 a[144:147], v3 offset:60416
    v_add_f32 v108, v108, v76
    v_mfma_f32_16x16x32_bf16 v[144:147], a[204:207], v[88:91], v[144:147]
    ds_read_b128 a[148:151], v3 offset:61440
    v_add_f32 v108, v108, v77
    v_mfma_f32_16x16x32_bf16 v[148:151], a[204:207], v[92:95], v[148:151]
    v_add_f32 v108, v108, v78
    v_add_f32 v108, v108, v79
    s_waitcnt lgkmcnt(3)
    v_mfma_f32_16x16x32_bf16 v[152:155], a[208:211], v[88:91], v[152:155]
    ds_read_b128 a[152:155], v3 offset:62464
    v_mfma_f32_16x16x32_bf16 v[156:159], a[208:211], v[92:95], v[156:159]
    v_mfma_f32_16x16x32_bf16 v[160:163], a[212:215], v[88:91], v[160:163]
    ds_read_b128 a[156:159], v3 offset:63488
    v_mfma_f32_16x16x32_bf16 v[164:167], a[212:215], v[92:95], v[164:167]
    v_mfma_f32_16x16x32_bf16 v[168:171], a[216:219], v[88:91], v[168:171]
    ds_read_b128 a[160:163], v3 offset:64512
    v_mfma_f32_16x16x32_bf16 v[172:175], a[216:219], v[92:95], v[172:175]
    v_mfma_f32_16x16x32_bf16 v[176:179], a[220:223], v[88:91], v[176:179]
    v_mfma_f32_16x16x32_bf16 v[180:183], a[220:223], v[92:95], v[180:183]
    v_mfma_f32_16x16x32_bf16 v[184:187], a[224:227], v[88:91], v[184:187]
    v_mfma_f32_16x16x32_bf16 v[188:191], a[224:227], v[92:95], v[188:191]
    v_mfma_f32_16x16x32_bf16 v[192:195], a[132:135], v[88:91], v[192:195]
    s_waitcnt vmcnt(0) lgkmcnt(0)
    s_barrier
    v_mfma_f32_16x16x32_bf16 v[196:199], a[132:135], v[92:95], v[196:199]
    v_mfma_f32_16x16x32_bf16 v[200:203], a[136:139], v[88:91], v[200:203]
    v_mfma_f32_16x16x32_bf16 v[204:207], a[136:139], v[92:95], v[204:207]
    v_mfma_f32_16x16x32_bf16 v[208:211], a[140:143], v[88:91], v[208:211]
    v_mfma_f32_16x16x32_bf16 v[212:215], a[140:143], v[92:95], v[212:215]
    v_mfma_f32_16x16x32_bf16 v[216:219], a[144:147], v[88:91], v[216:219]
    v_mfma_f32_16x16x32_bf16 v[220:223], a[144:147], v[92:95], v[220:223]
    v_mfma_f32_16x16x32_bf16 v[224:227], a[148:151], v[88:91], v[224:227]
    v_mfma_f32_16x16x32_bf16 v[228:231], a[148:151], v[92:95], v[228:231]
    v_mfma_f32_16x16x32_bf16 v[232:235], a[152:155], v[88:91], v[232:235]
    v_mfma_f32_16x16x32_bf16 v[236:239], a[152:155], v[92:95], v[236:239]
    v_mfma_f32_16x16x32_bf16 v[240:243], a[156:159], v[88:91], v[240:243]
    v_mfma_f32_16x16x32_bf16 v[244:247], a[156:159], v[92:95], v[244:247]
    v_mfma_f32_16x16x32_bf16 v[248:251], a[160:163], v[88:91], v[248:251]
    v_mfma_f32_16x16x32_bf16 v[252:255], a[160:163], v[92:95], v[252:255]
    s_cbranch_vccz K2_HB1
    s_mov_b32 s84, 1
    s_branch K2_RESC1
K2_HB1:
    ds_read_b128 a[132:135], v3 offset:0
    ds_read_b128 a[136:139], v3 offset:1024
    ds_read_b128 a[140:143], v3 offset:2048
    ds_read_b128 a[144:147], v3 offset:3072
    ds_read_b128 a[148:151], v3 offset:4096
    ds_read_b128 a[152:155], v3 offset:5120
    v_exp_f32 v20, v20
    v_exp_f32 v21, v21
    v_exp_f32 v22, v22
    v_exp_f32 v23, v23
    v_exp_f32 v28, v28
    v_exp_f32 v29, v29
    v_exp_f32 v30, v30
    v_exp_f32 v31, v31
    v_cvt_pk_bf16_f32 v84, v20, v21
    v_cvt_pk_bf16_f32 v85, v22, v23
    v_cvt_pk_bf16_f32 v86, v28, v29
    v_cvt_pk_bf16_f32 v87, v30, v31
    s_nop 1
    s_waitcnt lgkmcnt(5)
    v_mfma_f32_16x16x32_bf16 v[132:135], a[132:135], v[84:87], v[132:135]
    v_exp_f32 v36, v36
    ds_read_b128 a[156:159], v3 offset:6144
    s_waitcnt lgkmcnt(5)
    v_mfma_f32_16x16x32_bf16 v[140:143], a[136:139], v[84:87], v[140:143]
    v_exp_f32 v37, v37
    ds_read_b128 a[160:163], v3 offset:7168
    s_waitcnt lgkmcnt(5)
    v_mfma_f32_16x16x32_bf16 v[148:151], a[140:143], v[84:87], v[148:151]
    v_exp_f32 v38, v38
    ds_read_b128 a[164:167], v3 offset:8192
    s_waitcnt lgkmcnt(2)
    v_mfma_f32_16x16x32_bf16 v[156:159], a[144:147], v[84:87], v[156:159]
    v_exp_f32 v39, v39
    ds_read_b128 a[168:171], v3 offset:9216
    v_mfma_f32_16x16x32_bf16 v[164:167], a[148:151], v[84:87], v[164:167]
    v_exp_f32 v44, v44
    ds_read_b128 a[172:175], v3 offset:10240
    v_mfma_f32_16x16x32_bf16 v[172:175], a[152:155], v[84:87], v[172:175]
    v_exp_f32 v45, v45
    ds_read_b128 a[176:179], v3 offset:11264
    v_mfma_f32_16x16x32_bf16 v[180:183], a[156:159], v[84:87], v[180:183]
    v_exp_f32 v46, v46
    ds_read_b128 a[180:183], v3 offset:12288
    s_waitcnt lgkmcnt(2)
    v_mfma_f32_16x16x32_bf16 v[188:191], a[160:163], v[84:87], v[188:191]
    v_exp_f32 v47, v47
    ds_read_b128 a[184:187], v3 offset:13312
    v_mfma_f32_16x16x32_bf16 v[196:199], a[164:167], v[84:87], v[196:199]
    ds_read_b128 a[188:191], v3 offset:14336
    v_mfma_f32_16x16x32_bf16 v[204:207], a[168:171], v[84:87], v[204:207]
    v_cvt_pk_bf16_f32 v92, v36, v37
    v_cvt_pk_bf16_f32 v93, v38, v39
    ds_read_b128 a[192:195], v3 offset:15360
    v_mfma_f32_16x16x32_bf16 v[212:215], a[172:175], v[84:87], v[212:215]
    v_cvt_pk_bf16_f32 v94, v44, v45
    v_cvt_pk_bf16_f32 v95, v46, v47
    ds_read_b128 a[196:199], v3 offset:16384
    s_waitcnt lgkmcnt(2)
    v_mfma_f32_16x16x32_bf16 v[220:223], a[176:179], v[84:87], v[220:223]
    v_add_f32 v108, v108, v20
    v_add_f32 v108, v108, v21
    ds_read_b128 a[200:203], v3 offset:17408
    v_mfma_f32_16x16x32_bf16 v[228:231], a[180:183], v[84:87], v[228:231]
    v_add_f32 v108, v108, v22
    v_add_f32 v108, v108, v23
    ds_read_b128 a[204:207], v3 offset:18432
    v_mfma_f32_16x16x32_bf16 v[236:239], a[184:187], v[84:87], v[236:239]
    v_add_f32 v108, v108, v28
    v_add_f32 v108, v108, v29
    ds_read_b128 a[208:211], v3 offset:19456
    v_mfma_f32_16x16x32_bf16 v[244:247], a[188:191], v[84:87], v[244:247]
    v_add_f32 v108, v108, v30
    v_add_f32 v108, v108, v31
    ds_read_b128 a[212:215], v3 offset:20480
    s_waitcnt lgkmcnt(2)
    v_mfma_f32_16x16x32_bf16 v[252:255], a[192:195], v[84:87], v[252:255]
    v_add_f32 v108, v108, v36
    v_add_f32 v108, v108, v37
    ds_read_b128 a[216:219], v3 offset:21504
    v_mfma_f32_16x16x32_bf16 v[132:135], a[196:199], v[92:95], v[132:135]
    v_add_f32 v108, v108, v38
    v_add_f32 v108, v108, v39
    ds_read_b128 a[220:223], v3 offset:22528
    v_mfma_f32_16x16x32_bf16 v[140:143], a[200:203], v[92:95], v[140:143]
    v_add_f32 v108, v108, v44
    v_add_f32 v108, v108, v45
    ds_read_b128 a[224:227], v3 offset:23552
    v_mfma_f32_16x16x32_bf16 v[148:151], a[204:207], v[92:95], v[148:151]
    v_add_f32 v108, v108, v46
    v_add_f32 v108, v108, v47
    ds_read_b128 a[132:135], v3 offset:24576
    s_waitcnt lgkmcnt(2)
    v_mfma_f32_16x16x32_bf16 v[156:159], a[208:211], v[92:95], v[156:159]
    ds_read_b128 a[136:139], v3 offset:25600
    v_mfma_f32_16x16x32_bf16 v[164:167], a[212:215], v[92:95], v[164:167]
    ds_read_b128 a[140:143], v3 offset:26624
    v_mfma_f32_16x16x32_bf16 v[172:175], a[216:219], v[92:95], v[172:175]
    ds_read_b128 a[144:147], v3 offset:27648
    v_mfma_f32_16x16x32_bf16 v[180:183], a[220:223], v[92:95], v[180:183]
    ds_read_b128 a[148:151], v3 offset:28672
    s_waitcnt lgkmcnt(2)
    v_mfma_f32_16x16x32_bf16 v[188:191], a[224:227], v[92:95], v[188:191]
    ds_read_b128 a[152:155], v3 offset:29696
    v_mfma_f32_16x16x32_bf16 v[196:199], a[132:135], v[92:95], v[196:199]
    ds_read_b128 a[156:159], v3 offset:30720
    v_mfma_f32_16x16x32_bf16 v[204:207], a[136:139], v[92:95], v[204:207]
    ds_read_b128 a[160:163], v3 offset:31744
    v_mfma_f32_16x16x32_bf16 v[212:215], a[140:143], v[92:95], v[212:215]
    s_waitcnt lgkmcnt(1)
    v_mfma_f32_16x16x32_bf16 v[220:223], a[144:147], v[92:95], v[220:223]
    v_mfma_f32_16x16x32_bf16 v[228:231], a[148:151], v[92:95], v[228:231]
    v_mfma_f32_16x16x32_bf16 v[236:239], a[152:155], v[92:95], v[236:239]
    v_mfma_f32_16x16x32_bf16 v[244:247], a[156:159], v[92:95], v[244:247]
    s_waitcnt lgkmcnt(0)
    v_mfma_f32_16x16x32_bf16 v[252:255], a[160:163], v[92:95], v[252:255]
    s_branch K2_EPI
K2_I0_MASK:
    v_subrev_u32 v112, s38, v6
    v_cmp_ge_i32 s[44:45], 0, v112
    v_cmp_ge_i32 s[46:47], -1, v112
    v_cmp_ge_i32 s[48:49], -2, v112
    v_cmp_ge_i32 s[50:51], -3, v112
    s_nop 1
    v_cndmask_b32 v48, v7, v48, s[44:45]
    v_cndmask_b32 v49, v7, v49, s[46:47]
    v_cndmask_b32 v50, v7, v50, s[48:49]
    v_cndmask_b32 v51, v7, v51, s[50:51]
    v_cmp_ge_i32 s[44:45], 64, v112
    v_cmp_ge_i32 s[46:47], 63, v112
    v_cmp_ge_i32 s[48:49], 62, v112
    v_cmp_ge_i32 s[50:51], 61, v112
    s_nop 1
    v_cndmask_b32 v52, v7, v52, s[44:45]
    v_cndmask_b32 v53, v7, v53, s[46:47]
    v_cndmask_b32 v54, v7, v54, s[48:49]
    v_cndmask_b32 v55, v7, v55, s[50:51]
    v_cmp_ge_i32 s[44:45], -16, v112
    v_mov_b32 v114, -17
    v_cmp_ge_i32 s[46:47], v114, v112
    v_mov_b32 v115, -18
    v_cmp_ge_i32 s[48:49], v115, v112
    v_mov_b32 v116, -19
    v_cmp_ge_i32 s[50:51], v116, v112
    s_nop 1
    v_cndmask_b32 v56, v7, v56, s[44:45]
    v_cndmask_b32 v57, v7, v57, s[46:47]
    v_cndmask_b32 v58, v7, v58, s[48:49]
    v_cndmask_b32 v59, v7, v59, s[50:51]
    v_cmp_ge_i32 s[44:45], 48, v112
    v_cmp_ge_i32 s[46:47], 47, v112
    v_cmp_ge_i32 s[48:49], 46, v112
    v_cmp_ge_i32 s[50:51], 45, v112
    s_nop 1
    v_cndmask_b32 v60, v7, v60, s[44:45]
    v_cndmask_b32 v61, v7, v61, s[46:47]
    v_cndmask_b32 v62, v7, v62, s[48:49]
    v_cndmask_b32 v63, v7, v63, s[50:51]
    v_mov_b32 v113, -32
    v_cmp_ge_i32 s[44:45], v113, v112
    v_mov_b32 v114, -33
    v_cmp_ge_i32 s[46:47], v114, v112
    v_mov_b32 v115, -34
    v_cmp_ge_i32 s[48:49], v115, v112
    v_mov_b32 v116, -35
    v_cmp_ge_i32 s[50:51], v116, v112
    s_nop 1
    v_cndmask_b32 v64, v7, v64, s[44:45]
    v_cndmask_b32 v65, v7, v65, s[46:47]
    v_cndmask_b32 v66, v7, v66, s[48:49]
    v_cndmask_b32 v67, v7, v67, s[50:51]
    v_cmp_ge_i32 s[44:45], 32, v112
    v_cmp_ge_i32 s[46:47], 31, v112
    v_cmp_ge_i32 s[48:49], 30, v112
    v_cmp_ge_i32 s[50:51], 29, v112
    s_nop 1
    v_cndmask_b32 v68, v7, v68, s[44:45]
    v_cndmask_b32 v69, v7, v69, s[46:47]
    v_cndmask_b32 v70, v7, v70, s[48:49]
    v_cndmask_b32 v71, v7, v71, s[50:51]
    v_mov_b32 v113, -48
    v_cmp_ge_i32 s[44:45], v113, v112
    v_mov_b32 v114, -49
    v_cmp_ge_i32 s[46:47], v114, v112
    v_mov_b32 v115, -50
    v_cmp_ge_i32 s[48:49], v115, v112
    v_mov_b32 v116, -51
    v_cmp_ge_i32 s[50:51], v116, v112
    s_nop 1
    v_cndmask_b32 v72, v7, v72, s[44:45]
    v_cndmask_b32 v73, v7, v73, s[46:47]
    v_cndmask_b32 v74, v7, v74, s[48:49]
    v_cndmask_b32 v75, v7, v75, s[50:51]
    v_cmp_ge_i32 s[44:45], 16, v112
    v_cmp_ge_i32 s[46:47], 15, v112
    v_cmp_ge_i32 s[48:49], 14, v112
    v_cmp_ge_i32 s[50:51], 13, v112
    s_nop 1
    v_cndmask_b32 v76, v7, v76, s[44:45]
    v_cndmask_b32 v77, v7, v77, s[46:47]
    v_cndmask_b32 v78, v7, v78, s[48:49]
    v_cndmask_b32 v79, v7, v79, s[50:51]
    s_branch K2_I0_NOMASK
K2_I1_MASK:
    v_subrev_u32 v112, s38, v6
    v_cmp_ge_i32 s[44:45], 0, v112
    v_cmp_ge_i32 s[46:47], -1, v112
    v_cmp_ge_i32 s[48:49], -2, v112
    v_cmp_ge_i32 s[50:51], -3, v112
    s_nop 1
    v_cndmask_b32 v16, v7, v16, s[44:45]
    v_cndmask_b32 v17, v7, v17, s[46:47]
    v_cndmask_b32 v18, v7, v18, s[48:49]
    v_cndmask_b32 v19, v7, v19, s[50:51]
    v_cmp_ge_i32 s[44:45], 64, v112
    v_cmp_ge_i32 s[46:47], 63, v112
    v_cmp_ge_i32 s[48:49], 62, v112
    v_cmp_ge_i32 s[50:51], 61, v112
    s_nop 1
    v_cndmask_b32 v20, v7, v20, s[44:45]
    v_cndmask_b32 v21, v7, v21, s[46:47]
    v_cndmask_b32 v22, v7, v22, s[48:49]
    v_cndmask_b32 v23, v7, v23, s[50:51]
    v_cmp_ge_i32 s[44:45], -16, v112
    v_mov_b32 v114, -17
    v_cmp_ge_i32 s[46:47], v114, v112
    v_mov_b32 v115, -18
    v_cmp_ge_i32 s[48:49], v115, v112
    v_mov_b32 v116, -19
    v_cmp_ge_i32 s[50:51], v116, v112
    s_nop 1
    v_cndmask_b32 v24, v7, v24, s[44:45]
    v_cndmask_b32 v25, v7, v25, s[46:47]
    v_cndmask_b32 v26, v7, v26, s[48:49]
    v_cndmask_b32 v27, v7, v27, s[50:51]
    v_cmp_ge_i32 s[44:45], 48, v112
    v_cmp_ge_i32 s[46:47], 47, v112
    v_cmp_ge_i32 s[48:49], 46, v112
    v_cmp_ge_i32 s[50:51], 45, v112
    s_nop 1
    v_cndmask_b32 v28, v7, v28, s[44:45]
    v_cndmask_b32 v29, v7, v29, s[46:47]
    v_cndmask_b32 v30, v7, v30, s[48:49]
    v_cndmask_b32 v31, v7, v31, s[50:51]
    v_mov_b32 v113, -32
    v_cmp_ge_i32 s[44:45], v113, v112
    v_mov_b32 v114, -33
    v_cmp_ge_i32 s[46:47], v114, v112
    v_mov_b32 v115, -34
    v_cmp_ge_i32 s[48:49], v115, v112
    v_mov_b32 v116, -35
    v_cmp_ge_i32 s[50:51], v116, v112
    s_nop 1
    v_cndmask_b32 v32, v7, v32, s[44:45]
    v_cndmask_b32 v33, v7, v33, s[46:47]
    v_cndmask_b32 v34, v7, v34, s[48:49]
    v_cndmask_b32 v35, v7, v35, s[50:51]
    v_cmp_ge_i32 s[44:45], 32, v112
    v_cmp_ge_i32 s[46:47], 31, v112
    v_cmp_ge_i32 s[48:49], 30, v112
    v_cmp_ge_i32 s[50:51], 29, v112
    s_nop 1
    v_cndmask_b32 v36, v7, v36, s[44:45]
    v_cndmask_b32 v37, v7, v37, s[46:47]
    v_cndmask_b32 v38, v7, v38, s[48:49]
    v_cndmask_b32 v39, v7, v39, s[50:51]
    v_mov_b32 v113, -48
    v_cmp_ge_i32 s[44:45], v113, v112
    v_mov_b32 v114, -49
    v_cmp_ge_i32 s[46:47], v114, v112
    v_mov_b32 v115, -50
    v_cmp_ge_i32 s[48:49], v115, v112
    v_mov_b32 v116, -51
    v_cmp_ge_i32 s[50:51], v116, v112
    s_nop 1
    v_cndmask_b32 v40, v7, v40, s[44:45]
    v_cndmask_b32 v41, v7, v41, s[46:47]
    v_cndmask_b32 v42, v7, v42, s[48:49]
    v_cndmask_b32 v43, v7, v43, s[50:51]
    v_cmp_ge_i32 s[44:45], 16, v112
    v_cmp_ge_i32 s[46:47], 15, v112
    v_cmp_ge_i32 s[48:49], 14, v112
    v_cmp_ge_i32 s[50:51], 13, v112
    s_nop 1
    v_cndmask_b32 v44, v7, v44, s[44:45]
    v_cndmask_b32 v45, v7, v45, s[46:47]
    v_cndmask_b32 v46, v7, v46, s[48:49]
    v_cndmask_b32 v47, v7, v47, s[50:51]
    s_branch K2_I1_NOMASK
K2_RESC0:
    s_nop 7
    s_nop 3
    v_max3_f32 v112, v48, v49, v50
    v_max3_f32 v112, v112, v51, v56
    v_max3_f32 v112, v112, v57, v58
    v_max3_f32 v112, v112, v59, v64
    v_max3_f32 v112, v112, v65, v66
    v_max3_f32 v112, v112, v67, v72
    v_max3_f32 v112, v112, v73, v74
    v_max_f32 v112, v112, v75
    v_mov_b32 v113, v112
    s_nop 1
    v_permlane16_swap_b32 v112, v113
    s_nop 1
    v_max_f32 v112, v112, v113
    v_mov_b32 v113, v112
    s_nop 1
    v_permlane32_swap_b32 v112, v113
    s_nop 1
    v_max_f32 v112, v112, v113
    v_max_f32 v112, 0, v112
    v_sub_f32 v48, v48, v112
    v_sub_f32 v49, v49, v112
    v_sub_f32 v50, v50, v112
    v_sub_f32 v51, v51, v112
    v_sub_f32 v56, v56, v112
    v_sub_f32 v57, v57, v112
    v_sub_f32 v58, v58, v112
    v_sub_f32 v59, v59, v112
    v_sub_f32 v64, v64, v112
    v_sub_f32 v65, v65, v112
    v_sub_f32 v66, v66, v112
    v_sub_f32 v67, v67, v112
    v_sub_f32 v72, v72, v112
    v_sub_f32 v73, v73, v112
    v_sub_f32 v74, v74, v112
    v_sub_f32 v75, v75, v112
    v_sub_f32 v96, v96, v112
    v_sub_f32 v97, v97, v112
    v_sub_f32 v98, v98, v112
    v_sub_f32 v99, v99, v112
    v_sub_f32 v113, 0, v112
    v_exp_f32 v113, v113
    s_nop 0
    v_mul_f32 v128, v128, v113
    v_mul_f32 v129, v129, v113
    v_mul_f32 v130, v130, v113
    v_mul_f32 v131, v131, v113
    v_mul_f32 v136, v136, v113
    v_mul_f32 v137, v137, v113
    v_mul_f32 v138, v138, v113
    v_mul_f32 v139, v139, v113
    v_mul_f32 v144, v144, v113
    v_mul_f32 v145, v145, v113
    v_mul_f32 v146, v146, v113
    v_mul_f32 v147, v147, v113
    v_mul_f32 v152, v152, v113
    v_mul_f32 v153, v153, v113
    v_mul_f32 v154, v154, v113
    v_mul_f32 v155, v155, v113
    v_mul_f32 v160, v160, v113
    v_mul_f32 v161, v161, v113
    v_mul_f32 v162, v162, v113
    v_mul_f32 v163, v163, v113
    v_mul_f32 v168, v168, v113
    v_mul_f32 v169, v169, v113
    v_mul_f32 v170, v170, v113
    v_mul_f32 v171, v171, v113
    v_mul_f32 v176, v176, v113
    v_mul_f32 v177, v177, v113
    v_mul_f32 v178, v178, v113
    v_mul_f32 v179, v179, v113
    v_mul_f32 v184, v184, v113
    v_mul_f32 v185, v185, v113
    v_mul_f32 v186, v186, v113
    v_mul_f32 v187, v187, v113
    v_mul_f32 v192, v192, v113
    v_mul_f32 v193, v193, v113
    v_mul_f32 v194, v194, v113
    v_mul_f32 v195, v195, v113
    v_mul_f32 v200, v200, v113
    v_mul_f32 v201, v201, v113
    v_mul_f32 v202, v202, v113
    v_mul_f32 v203, v203, v113
    v_mul_f32 v208, v208, v113
    v_mul_f32 v209, v209, v113
    v_mul_f32 v210, v210, v113
    v_mul_f32 v211, v211, v113
    v_mul_f32 v216, v216, v113
    v_mul_f32 v217, v217, v113
    v_mul_f32 v218, v218, v113
    v_mul_f32 v219, v219, v113
    v_mul_f32 v224, v224, v113
    v_mul_f32 v225, v225, v113
    v_mul_f32 v226, v226, v113
    v_mul_f32 v227, v227, v113
    v_mul_f32 v232, v232, v113
    v_mul_f32 v233, v233, v113
    v_mul_f32 v234, v234, v113
    v_mul_f32 v235, v235, v113
    v_mul_f32 v240, v240, v113
    v_mul_f32 v241, v241, v113
    v_mul_f32 v242, v242, v113
    v_mul_f32 v243, v243, v113
    v_mul_f32 v248, v248, v113
    v_mul_f32 v249, v249, v113
    v_mul_f32 v250, v250, v113
    v_mul_f32 v251, v251, v113
    v_mul_f32 v104, v104, v113
    v_mul_f32 v105, v105, v113
    v_mul_f32 v106, v106, v113
    v_mul_f32 v107, v107, v113
    v_max3_f32 v114, v52, v53, v54
    v_max3_f32 v114, v114, v55, v60
    v_max3_f32 v114, v114, v61, v62
    v_max3_f32 v114, v114, v63, v68
    v_max3_f32 v114, v114, v69, v70
    v_max3_f32 v114, v114, v71, v76
    v_max3_f32 v114, v114, v77, v78
    v_max_f32 v114, v114, v79
    v_mov_b32 v115, v114
    s_nop 1
    v_permlane16_swap_b32 v114, v115
    s_nop 1
    v_max_f32 v114, v114, v115
    v_mov_b32 v115, v114
    s_nop 1
    v_permlane32_swap_b32 v114, v115
    s_nop 1
    v_max_f32 v114, v114, v115
    v_max_f32 v114, 0, v114
    v_sub_f32 v52, v52, v114
    v_sub_f32 v53, v53, v114
    v_sub_f32 v54, v54, v114
    v_sub_f32 v55, v55, v114
    v_sub_f32 v60, v60, v114
    v_sub_f32 v61, v61, v114
    v_sub_f32 v62, v62, v114
    v_sub_f32 v63, v63, v114
    v_sub_f32 v68, v68, v114
    v_sub_f32 v69, v69, v114
    v_sub_f32 v70, v70, v114
    v_sub_f32 v71, v71, v114
    v_sub_f32 v76, v76, v114
    v_sub_f32 v77, v77, v114
    v_sub_f32 v78, v78, v114
    v_sub_f32 v79, v79, v114
    v_sub_f32 v100, v100, v114
    v_sub_f32 v101, v101, v114
    v_sub_f32 v102, v102, v114
    v_sub_f32 v103, v103, v114
    v_sub_f32 v115, 0, v114
    v_exp_f32 v115, v115
    s_nop 0
    v_mul_f32 v132, v132, v115
    v_mul_f32 v133, v133, v115
    v_mul_f32 v134, v134, v115
    v_mul_f32 v135, v135, v115
    v_mul_f32 v140, v140, v115
    v_mul_f32 v141, v141, v115
    v_mul_f32 v142, v142, v115
    v_mul_f32 v143, v143, v115
    v_mul_f32 v148, v148, v115
    v_mul_f32 v149, v149, v115
    v_mul_f32 v150, v150, v115
    v_mul_f32 v151, v151, v115
    v_mul_f32 v156, v156, v115
    v_mul_f32 v157, v157, v115
    v_mul_f32 v158, v158, v115
    v_mul_f32 v159, v159, v115
    v_mul_f32 v164, v164, v115
    v_mul_f32 v165, v165, v115
    v_mul_f32 v166, v166, v115
    v_mul_f32 v167, v167, v115
    v_mul_f32 v172, v172, v115
    v_mul_f32 v173, v173, v115
    v_mul_f32 v174, v174, v115
    v_mul_f32 v175, v175, v115
    v_mul_f32 v180, v180, v115
    v_mul_f32 v181, v181, v115
    v_mul_f32 v182, v182, v115
    v_mul_f32 v183, v183, v115
    v_mul_f32 v188, v188, v115
    v_mul_f32 v189, v189, v115
    v_mul_f32 v190, v190, v115
    v_mul_f32 v191, v191, v115
    v_mul_f32 v196, v196, v115
    v_mul_f32 v197, v197, v115
    v_mul_f32 v198, v198, v115
    v_mul_f32 v199, v199, v115
    v_mul_f32 v204, v204, v115
    v_mul_f32 v205, v205, v115
    v_mul_f32 v206, v206, v115
    v_mul_f32 v207, v207, v115
    v_mul_f32 v212, v212, v115
    v_mul_f32 v213, v213, v115
    v_mul_f32 v214, v214, v115
    v_mul_f32 v215, v215, v115
    v_mul_f32 v220, v220, v115
    v_mul_f32 v221, v221, v115
    v_mul_f32 v222, v222, v115
    v_mul_f32 v223, v223, v115
    v_mul_f32 v228, v228, v115
    v_mul_f32 v229, v229, v115
    v_mul_f32 v230, v230, v115
    v_mul_f32 v231, v231, v115
    v_mul_f32 v236, v236, v115
    v_mul_f32 v237, v237, v115
    v_mul_f32 v238, v238, v115
    v_mul_f32 v239, v239, v115
    v_mul_f32 v244, v244, v115
    v_mul_f32 v245, v245, v115
    v_mul_f32 v246, v246, v115
    v_mul_f32 v247, v247, v115
    v_mul_f32 v252, v252, v115
    v_mul_f32 v253, v253, v115
    v_mul_f32 v254, v254, v115
    v_mul_f32 v255, v255, v115
    v_mul_f32 v108, v108, v115
    v_mul_f32 v109, v109, v115
    v_mul_f32 v110, v110, v115
    v_mul_f32 v111, v111, v115
    s_nop 1
    s_cmp_eq_u32 s84, 1
    s_cbranch_scc1 K2_HB0
    s_cmp_eq_u32 s84, 2
    s_cbranch_scc1 K2_BACK0
    s_branch K2_FB0
K2_RESC1:
    s_nop 7
    s_nop 3
    v_max3_f32 v112, v16, v17, v18
    v_max3_f32 v112, v112, v19, v24
    v_max3_f32 v112, v112, v25, v26
    v_max3_f32 v112, v112, v27, v32
    v_max3_f32 v112, v112, v33, v34
    v_max3_f32 v112, v112, v35, v40
    v_max3_f32 v112, v112, v41, v42
    v_max_f32 v112, v112, v43
    v_mov_b32 v113, v112
    s_nop 1
    v_permlane16_swap_b32 v112, v113
    s_nop 1
    v_max_f32 v112, v112, v113
    v_mov_b32 v113, v112
    s_nop 1
    v_permlane32_swap_b32 v112, v113
    s_nop 1
    v_max_f32 v112, v112, v113
    v_max_f32 v112, 0, v112
    v_sub_f32 v16, v16, v112
    v_sub_f32 v17, v17, v112
    v_sub_f32 v18, v18, v112
    v_sub_f32 v19, v19, v112
    v_sub_f32 v24, v24, v112
    v_sub_f32 v25, v25, v112
    v_sub_f32 v26, v26, v112
    v_sub_f32 v27, v27, v112
    v_sub_f32 v32, v32, v112
    v_sub_f32 v33, v33, v112
    v_sub_f32 v34, v34, v112
    v_sub_f32 v35, v35, v112
    v_sub_f32 v40, v40, v112
    v_sub_f32 v41, v41, v112
    v_sub_f32 v42, v42, v112
    v_sub_f32 v43, v43, v112
    v_sub_f32 v96, v96, v112
    v_sub_f32 v97, v97, v112
    v_sub_f32 v98, v98, v112
    v_sub_f32 v99, v99, v112
    v_sub_f32 v113, 0, v112
    v_exp_f32 v113, v113
    s_nop 0
    v_mul_f32 v128, v128, v113
    v_mul_f32 v129, v129, v113
    v_mul_f32 v130, v130, v113
    v_mul_f32 v131, v131, v113
    v_mul_f32 v136, v136, v113
    v_mul_f32 v137, v137, v113
    v_mul_f32 v138, v138, v113
    v_mul_f32 v139, v139, v113
    v_mul_f32 v144, v144, v113
    v_mul_f32 v145, v145, v113
    v_mul_f32 v146, v146, v113
    v_mul_f32 v147, v147, v113
    v_mul_f32 v152, v152, v113
    v_mul_f32 v153, v153, v113
    v_mul_f32 v154, v154, v113
    v_mul_f32 v155, v155, v113
    v_mul_f32 v160, v160, v113
    v_mul_f32 v161, v161, v113
    v_mul_f32 v162, v162, v113
    v_mul_f32 v163, v163, v113
    v_mul_f32 v168, v168, v113
    v_mul_f32 v169, v169, v113
    v_mul_f32 v170, v170, v113
    v_mul_f32 v171, v171, v113
    v_mul_f32 v176, v176, v113
    v_mul_f32 v177, v177, v113
    v_mul_f32 v178, v178, v113
    v_mul_f32 v179, v179, v113
    v_mul_f32 v184, v184, v113
    v_mul_f32 v185, v185, v113
    v_mul_f32 v186, v186, v113
    v_mul_f32 v187, v187, v113
    v_mul_f32 v192, v192, v113
    v_mul_f32 v193, v193, v113
    v_mul_f32 v194, v194, v113
    v_mul_f32 v195, v195, v113
    v_mul_f32 v200, v200, v113
    v_mul_f32 v201, v201, v113
    v_mul_f32 v202, v202, v113
    v_mul_f32 v203, v203, v113
    v_mul_f32 v208, v208, v113
    v_mul_f32 v209, v209, v113
    v_mul_f32 v210, v210, v113
    v_mul_f32 v211, v211, v113
    v_mul_f32 v216, v216, v113
    v_mul_f32 v217, v217, v113
    v_mul_f32 v218, v218, v113
    v_mul_f32 v219, v219, v113
    v_mul_f32 v224, v224, v113
    v_mul_f32 v225, v225, v113
    v_mul_f32 v226, v226, v113
    v_mul_f32 v227, v227, v113
    v_mul_f32 v232, v232, v113
    v_mul_f32 v233, v233, v113
    v_mul_f32 v234, v234, v113
    v_mul_f32 v235, v235, v113
    v_mul_f32 v240, v240, v113
    v_mul_f32 v241, v241, v113
    v_mul_f32 v242, v242, v113
    v_mul_f32 v243, v243, v113
    v_mul_f32 v248, v248, v113
    v_mul_f32 v249, v249, v113
    v_mul_f32 v250, v250, v113
    v_mul_f32 v251, v251, v113
    v_mul_f32 v104, v104, v113
    v_mul_f32 v105, v105, v113
    v_mul_f32 v106, v106, v113
    v_mul_f32 v107, v107, v113
    v_max3_f32 v114, v20, v21, v22
    v_max3_f32 v114, v114, v23, v28
    v_max3_f32 v114, v114, v29, v30
    v_max3_f32 v114, v114, v31, v36
    v_max3_f32 v114, v114, v37, v38
    v_max3_f32 v114, v114, v39, v44
    v_max3_f32 v114, v114, v45, v46
    v_max_f32 v114, v114, v47
    v_mov_b32 v115, v114
    s_nop 1
    v_permlane16_swap_b32 v114, v115
    s_nop 1
    v_max_f32 v114, v114, v115
    v_mov_b32 v115, v114
    s_nop 1
    v_permlane32_swap_b32 v114, v115
    s_nop 1
    v_max_f32 v114, v114, v115
    v_max_f32 v114, 0, v114
    v_sub_f32 v20, v20, v114
    v_sub_f32 v21, v21, v114
    v_sub_f32 v22, v22, v114
    v_sub_f32 v23, v23, v114
    v_sub_f32 v28, v28, v114
    v_sub_f32 v29, v29, v114
    v_sub_f32 v30, v30, v114
    v_sub_f32 v31, v31, v114
    v_sub_f32 v36, v36, v114
    v_sub_f32 v37, v37, v114
    v_sub_f32 v38, v38, v114
    v_sub_f32 v39, v39, v114
    v_sub_f32 v44, v44, v114
    v_sub_f32 v45, v45, v114
    v_sub_f32 v46, v46, v114
    v_sub_f32 v47, v47, v114
    v_sub_f32 v100, v100, v114
    v_sub_f32 v101, v101, v114
    v_sub_f32 v102, v102, v114
    v_sub_f32 v103, v103, v114
    v_sub_f32 v115, 0, v114
    v_exp_f32 v115, v115
    s_nop 0
    v_mul_f32 v132, v132, v115
    v_mul_f32 v133, v133, v115
    v_mul_f32 v134, v134, v115
    v_mul_f32 v135, v135, v115
    v_mul_f32 v140, v140, v115
    v_mul_f32 v141, v141, v115
    v_mul_f32 v142, v142, v115
    v_mul_f32 v143, v143, v115
    v_mul_f32 v148, v148, v115
    v_mul_f32 v149, v149, v115
    v_mul_f32 v150, v150, v115
    v_mul_f32 v151, v151, v115
    v_mul_f32 v156, v156, v115
    v_mul_f32 v157, v157, v115
    v_mul_f32 v158, v158, v115
    v_mul_f32 v159, v159, v115
    v_mul_f32 v164, v164, v115
    v_mul_f32 v165, v165, v115
    v_mul_f32 v166, v166, v115
    v_mul_f32 v167, v167, v115
    v_mul_f32 v172, v172, v115
    v_mul_f32 v173, v173, v115
    v_mul_f32 v174, v174, v115
    v_mul_f32 v175, v175, v115
    v_mul_f32 v180, v180, v115
    v_mul_f32 v181, v181, v115
    v_mul_f32 v182, v182, v115
    v_mul_f32 v183, v183, v115
    v_mul_f32 v188, v188, v115
    v_mul_f32 v189, v189, v115
    v_mul_f32 v190, v190, v115
    v_mul_f32 v191, v191, v115
    v_mul_f32 v196, v196, v115
    v_mul_f32 v197, v197, v115
    v_mul_f32 v198, v198, v115
    v_mul_f32 v199, v199, v115
    v_mul_f32 v204, v204, v115
    v_mul_f32 v205, v205, v115
    v_mul_f32 v206, v206, v115
    v_mul_f32 v207, v207, v115
    v_mul_f32 v212, v212, v115
    v_mul_f32 v213, v213, v115
    v_mul_f32 v214, v214, v115
    v_mul_f32 v215, v215, v115
    v_mul_f32 v220, v220, v115
    v_mul_f32 v221, v221, v115
    v_mul_f32 v222, v222, v115
    v_mul_f32 v223, v223, v115
    v_mul_f32 v228, v228, v115
    v_mul_f32 v229, v229, v115
    v_mul_f32 v230, v230, v115
    v_mul_f32 v231, v231, v115
    v_mul_f32 v236, v236, v115
    v_mul_f32 v237, v237, v115
    v_mul_f32 v238, v238, v115
    v_mul_f32 v239, v239, v115
    v_mul_f32 v244, v244, v115
    v_mul_f32 v245, v245, v115
    v_mul_f32 v246, v246, v115
    v_mul_f32 v247, v247, v115
    v_mul_f32 v252, v252, v115
    v_mul_f32 v253, v253, v115
    v_mul_f32 v254, v254, v115
    v_mul_f32 v255, v255, v115
    v_mul_f32 v108, v108, v115
    v_mul_f32 v109, v109, v115
    v_mul_f32 v110, v110, v115
    v_mul_f32 v111, v111, v115
    s_nop 1
    s_cmp_eq_u32 s84, 1
    s_cbranch_scc1 K2_HB1
    s_cmp_eq_u32 s84, 2
    s_cbranch_scc1 K2_BACK1
    s_branch K2_FB1
K2_TAIL0:
    s_mov_b32 s83, 0
    s_mov_b32 s42, 0
    s_cmp_eq_u32 s30, 2
    s_cbranch_scc0 K2_T0_NOPRE
    v_readfirstlane_b32 s4, v14
    s_lshl_b32 s5, s25, 4
    s_and_b32 s5, s5, 16
    s_nop 1
    s_lshr_b32 s4, s4, s5
    s_and_b32 s4, s4, 0xffff
    s_cmp_lg_u32 s4, 0
    s_cbranch_scc0 K2_T0_NOPRE
    s_mov_b32 s83, 1
    s_mov_b32 s42, s37
    s_lshl_b32 s6, s24, 3
    s_add_u32 s6, s6, s25
    s_lshl_b32 s7, s6, 2
    s_add_u32 s7, s7, s3
    s_lshl_b32 s4, s7, 14
    s_add_u32 s4, s4, 83886080
    s_lshl_b32 s5, s7, 10
    s_add_u32 s5, s5, 94371840
    v_lshlrev_b32 v120, 3, v1
    buffer_load_dwordx2 v[122:123], v120, s[16:19], s5 offen sc1
    buffer_load_dwordx2 v[124:125], v120, s[16:19], s5 offen offset:512 sc1
    s_add_u32 s5, s4, 0
    buffer_load_dwordx4 a[0:3], v2, s[16:19], s5 offen offset:0 sc1
    buffer_load_dwordx4 a[4:7], v2, s[16:19], s5 offen offset:1024 sc1
    buffer_load_dwordx4 a[8:11], v2, s[16:19], s5 offen offset:2048 sc1
    buffer_load_dwordx4 a[12:15], v2, s[16:19], s5 offen offset:3072 sc1
    s_add_u32 s5, s4, 4096
    buffer_load_dwordx4 a[16:19], v2, s[16:19], s5 offen offset:0 sc1
    buffer_load_dwordx4 a[20:23], v2, s[16:19], s5 offen offset:1024 sc1
    buffer_load_dwordx4 a[24:27], v2, s[16:19], s5 offen offset:2048 sc1
    buffer_load_dwordx4 a[28:31], v2, s[16:19], s5 offen offset:3072 sc1
    s_add_u32 s5, s4, 8192
    buffer_load_dwordx4 a[32:35], v2, s[16:19], s5 offen offset:0 sc1
    buffer_load_dwordx4 a[36:39], v2, s[16:19], s5 offen offset:1024 sc1
    buffer_load_dwordx4 a[40:43], v2, s[16:19], s5 offen offset:2048 sc1
    buffer_load_dwordx4 a[44:47], v2, s[16:19], s5 offen offset:3072 sc1
    s_add_u32 s5, s4, 12288
    buffer_load_dwordx4 a[48:51], v2, s[16:19], s5 offen offset:0 sc1
    buffer_load_dwordx4 a[52:55], v2, s[16:19], s5 offen offset:1024 sc1
    buffer_load_dwordx4 a[56:59], v2, s[16:19], s5 offen offset:2048 sc1
    buffer_load_dwordx4 a[60:63], v2, s[16:19], s5 offen offset:3072 sc1
K2_T0_NOPRE:
    ds_read_b128 a[132:135], v3 offset:0
    ds_read_b128 a[136:139], v3 offset:1024
    ds_read_b128 a[140:143], v3 offset:2048
    ds_read_b128 a[144:147], v3 offset:3072
    v_exp_f32 v16, v16
    v_exp_f32 v17, v17
    v_exp_f32 v18, v18
    v_exp_f32 v19, v19
    v_exp_f32 v20, v20
    v_exp_f32 v21, v21
    v_exp_f32 v22, v22
    v_exp_f32 v23, v23
    v_exp_f32 v24, v24
    v_exp_f32 v25, v25
    v_exp_f32 v26, v26
    v_exp_f32 v27, v27
    v_exp_f32 v28, v28
    v_exp_f32 v29, v29
    v_exp_f32 v30, v30
    v_exp_f32 v31, v31
    v_cvt_pk_bf16_f32 v80, v16, v17
    v_cvt_pk_bf16_f32 v81, v18, v19
    v_cvt_pk_bf16_f32 v82, v24, v25
    v_cvt_pk_bf16_f32 v83, v26, v27
    v_cvt_pk_bf16_f32 v84, v20, v21
    v_cvt_pk_bf16_f32 v85, v22, v23
    v_cvt_pk_bf16_f32 v86, v28, v29
    v_cvt_pk_bf16_f32 v87, v30, v31
    s_nop 1
    s_waitcnt lgkmcnt(3)
    v_mfma_f32_16x16x32_bf16 v[128:131], a[132:135], v[80:83], v[128:131]
    v_exp_f32 v32, v32
    ds_read_b128 a[148:151], v3 offset:4096
    ds_read_b128 a[152:155], v3 offset:5120
    ds_read_b128 a[156:159], v3 offset:6144
    v_mfma_f32_16x16x32_bf16 v[132:135], a[132:135], v[84:87], v[132:135]
    v_exp_f32 v33, v33
    s_waitcnt lgkmcnt(5)
    v_mfma_f32_16x16x32_bf16 v[136:139], a[136:139], v[80:83], v[136:139]
    v_exp_f32 v34, v34
    ds_read_b128 a[160:163], v3 offset:7168
    v_mfma_f32_16x16x32_bf16 v[140:143], a[136:139], v[84:87], v[140:143]
    v_exp_f32 v35, v35
    s_waitcnt lgkmcnt(5)
    v_mfma_f32_16x16x32_bf16 v[144:147], a[140:143], v[80:83], v[144:147]
    v_exp_f32 v36, v36
    ds_read_b128 a[164:167], v3 offset:8192
    v_mfma_f32_16x16x32_bf16 v[148:151], a[140:143], v[84:87], v[148:151]
    v_exp_f32 v37, v37
    s_waitcnt lgkmcnt(2)
    v_mfma_f32_16x16x32_bf16 v[152:155], a[144:147], v[80:83], v[152:155]
    v_exp_f32 v38, v38
    ds_read_b128 a[168:171], v3 offset:9216
    v_mfma_f32_16x16x32_bf16 v[156:159], a[144:147], v[84:87], v[156:159]
    v_exp_f32 v39, v39
    v_mfma_f32_16x16x32_bf16 v[160:163], a[148:151], v[80:83], v[160:163]
    v_exp_f32 v40, v40
    ds_read_b128 a[172:175], v3 offset:10240
    v_mfma_f32_16x16x32_bf16 v[164:167], a[148:151], v[84:87], v[164:167]
    v_exp_f32 v41, v41
    v_mfma_f32_16x16x32_bf16 v[168:171], a[152:155], v[80:83], v[168:171]
    v_exp_f32 v42, v42
    ds_read_b128 a[176:179], v3 offset:11264
    v_mfma_f32_16x16x32_bf16 v[172:175], a[152:155], v[84:87], v[172:175]
    v_exp_f32 v43, v43
    v_mfma_f32_16x16x32_bf16 v[176:179], a[156:159], v[80:83], v[176:179]
    v_exp_f32 v44, v44
    ds_read_b128 a[180:183], v3 offset:12288
    v_mfma_f32_16x16x32_bf16 v[180:183], a[156:159], v[84:87], v[180:183]
    v_exp_f32 v45, v45
    s_waitcnt lgkmcnt(2)
    v_mfma_f32_16x16x32_bf16 v[184:187], a[160:163], v[80:83], v[184:187]
    v_exp_f32 v46, v46
    ds_read_b128 a[184:187], v3 offset:13312
    v_mfma_f32_16x16x32_bf16 v[188:191], a[160:163], v[84:87], v[188:191]
    v_exp_f32 v47, v47
    v_mfma_f32_16x16x32_bf16 v[192:195], a[164:167], v[80:83], v[192:195]
    ds_read_b128 a[188:191], v3 offset:14336
    v_mfma_f32_16x16x32_bf16 v[196:199], a[164:167], v[84:87], v[196:199]
    v_cvt_pk_bf16_f32 v88, v32, v33
    v_cvt_pk_bf16_f32 v89, v34, v35
    v_mfma_f32_16x16x32_bf16 v[200:203], a[168:171], v[80:83], v[200:203]
    v_cvt_pk_bf16_f32 v90, v40, v41
    v_cvt_pk_bf16_f32 v91, v42, v43
    ds_read_b128 a[192:195], v3 offset:15360
    v_mfma_f32_16x16x32_bf16 v[204:207], a[168:171], v[84:87], v[204:207]
    v_cvt_pk_bf16_f32 v92, v36, v37
    v_cvt_pk_bf16_f32 v93, v38, v39
    v_mfma_f32_16x16x32_bf16 v[208:211], a[172:175], v[80:83], v[208:211]
    v_cvt_pk_bf16_f32 v94, v44, v45
    v_cvt_pk_bf16_f32 v95, v46, v47
    ds_read_b128 a[196:199], v3 offset:16384
    v_mfma_f32_16x16x32_bf16 v[212:215], a[172:175], v[84:87], v[212:215]
    v_add_f32 v104, v104, v16
    v_add_f32 v104, v104, v17
    s_waitcnt lgkmcnt(2)
    v_mfma_f32_16x16x32_bf16 v[216:219], a[176:179], v[80:83], v[216:219]
    v_add_f32 v104, v104, v18
    v_add_f32 v104, v104, v19
    ds_read_b128 a[200:203], v3 offset:17408
    v_mfma_f32_16x16x32_bf16 v[220:223], a[176:179], v[84:87], v[220:223]
    v_add_f32 v108, v108, v20
    v_add_f32 v108, v108, v21
    v_mfma_f32_16x16x32_bf16 v[224:227], a[180:183], v[80:83], v[224:227]
    v_add_f32 v108, v108, v22
    v_add_f32 v108, v108, v23
    ds_read_b128 a[204:207], v3 offset:18432
    v_mfma_f32_16x16x32_bf16 v[228:231], a[180:183], v[84:87], v[228:231]
    v_add_f32 v104, v104, v24
    v_add_f32 v104, v104, v25
    v_mfma_f32_16x16x32_bf16 v[232:235], a[184:187], v[80:83], v[232:235]
    v_add_f32 v104, v104, v26
    v_add_f32 v104, v104, v27
    ds_read_b128 a[208:211], v3 offset:19456
    v_mfma_f32_16x16x32_bf16 v[236:239], a[184:187], v[84:87], v[236:239]
    v_add_f32 v108, v108, v28
    v_add_f32 v108, v108, v29
    v_mfma_f32_16x16x32_bf16 v[240:243], a[188:191], v[80:83], v[240:243]
    v_add_f32 v108, v108, v30
    v_add_f32 v108, v108, v31
    ds_read_b128 a[212:215], v3 offset:20480
    v_mfma_f32_16x16x32_bf16 v[244:247], a[188:191], v[84:87], v[244:247]
    v_add_f32 v104, v104, v32
    v_add_f32 v104, v104, v33
    s_waitcnt lgkmcnt(2)
    v_mfma_f32_16x16x32_bf16 v[248:251], a[192:195], v[80:83], v[248:251]
    v_add_f32 v104, v104, v34
    v_add_f32 v104, v104, v35
    ds_read_b128 a[216:219], v3 offset:21504
    v_mfma_f32_16x16x32_bf16 v[252:255], a[192:195], v[84:87], v[252:255]
    v_add_f32 v108, v108, v36
    v_add_f32 v108, v108, v37
    v_mfma_f32_16x16x32_bf16 v[128:131], a[196:199], v[88:91], v[128:131]
    v_add_f32 v108, v108, v38
    v_add_f32 v108, v108, v39
    ds_read_b128 a[220:223], v3 offset:22528
    v_mfma_f32_16x16x32_bf16 v[132:135], a[196:199], v[92:95], v[132:135]
    v_add_f32 v104, v104, v40
    v_add_f32 v104, v104, v41
    v_mfma_f32_16x16x32_bf16 v[136:139], a[200:203], v[88:91], v[136:139]
    v_add_f32 v104, v104, v42
    v_add_f32 v104, v104, v43
    ds_read_b128 a[224:227], v3 offset:23552
    v_mfma_f32_16x16x32_bf16 v[140:143], a[200:203], v[92:95], v[140:143]
    v_add_f32 v108, v108, v44
    v_add_f32 v108, v108, v45
    v_mfma_f32_16x16x32_bf16 v[144:147], a[204:207], v[88:91], v[144:147]
    v_add_f32 v108, v108, v46
    v_add_f32 v108, v108, v47
    ds_read_b128 a[132:135], v3 offset:24576
    v_mfma_f32_16x16x32_bf16 v[148:151], a[204:207], v[92:95], v[148:151]
    s_waitcnt lgkmcnt(2)
    v_mfma_f32_16x16x32_bf16 v[152:155], a[208:211], v[88:91], v[152:155]
    ds_read_b128 a[136:139], v3 offset:25600
    v_mfma_f32_16x16x32_bf16 v[156:159], a[208:211], v[92:95], v[156:159]
    v_mfma_f32_16x16x32_bf16 v[160:163], a[212:215], v[88:91], v[160:163]
    ds_read_b128 a[140:143], v3 offset:26624
    v_mfma_f32_16x16x32_bf16 v[164:167], a[212:215], v[92:95], v[164:167]
    v_mfma_f32_16x16x32_bf16 v[168:171], a[216:219], v[88:91], v[168:171]
    ds_read_b128 a[144:147], v3 offset:27648
    v_mfma_f32_16x16x32_bf16 v[172:175], a[216:219], v[92:95], v[172:175]
    v_mfma_f32_16x16x32_bf16 v[176:179], a[220:223], v[88:91], v[176:179]
    ds_read_b128 a[148:151], v3 offset:28672
    v_mfma_f32_16x16x32_bf16 v[180:183], a[220:223], v[92:95], v[180:183]
    s_waitcnt lgkmcnt(2)
    v_mfma_f32_16x16x32_bf16 v[184:187], a[224:227], v[88:91], v[184:187]
    ds_read_b128 a[152:155], v3 offset:29696
    v_mfma_f32_16x16x32_bf16 v[188:191], a[224:227], v[92:95], v[188:191]
    v_mfma_f32_16x16x32_bf16 v[192:195], a[132:135], v[88:91], v[192:195]
    ds_read_b128 a[156:159], v3 offset:30720
    v_mfma_f32_16x16x32_bf16 v[196:199], a[132:135], v[92:95], v[196:199]
    v_mfma_f32_16x16x32_bf16 v[200:203], a[136:139], v[88:91], v[200:203]
    ds_read_b128 a[160:163], v3 offset:31744
    v_mfma_f32_16x16x32_bf16 v[204:207], a[136:139], v[92:95], v[204:207]
    v_mfma_f32_16x16x32_bf16 v[208:211], a[140:143], v[88:91], v[208:211]
    v_mfma_f32_16x16x32_bf16 v[212:215], a[140:143], v[92:95], v[212:215]
    s_waitcnt lgkmcnt(1)
    v_mfma_f32_16x16x32_bf16 v[216:219], a[144:147], v[88:91], v[216:219]
    v_mfma_f32_16x16x32_bf16 v[220:223], a[144:147], v[92:95], v[220:223]
    v_mfma_f32_16x16x32_bf16 v[224:227], a[148:151], v[88:91], v[224:227]
    v_mfma_f32_16x16x32_bf16 v[228:231], a[148:151], v[92:95], v[228:231]
    v_mfma_f32_16x16x32_bf16 v[232:235], a[152:155], v[88:91], v[232:235]
    v_mfma_f32_16x16x32_bf16 v[236:239], a[152:155], v[92:95], v[236:239]
    v_mfma_f32_16x16x32_bf16 v[240:243], a[156:159], v[88:91], v[240:243]
    v_mfma_f32_16x16x32_bf16 v[244:247], a[156:159], v[92:95], v[244:247]
    s_waitcnt lgkmcnt(0)
    v_mfma_f32_16x16x32_bf16 v[248:251], a[160:163], v[88:91], v[248:251]
    v_mfma_f32_16x16x32_bf16 v[252:255], a[160:163], v[92:95], v[252:255]
    s_branch K2_EPI
K2_TAIL1:
    s_mov_b32 s83, 0
    s_mov_b32 s42, 0
    s_cmp_eq_u32 s30, 2
    s_cbranch_scc0 K2_T1_NOPRE
    v_readfirstlane_b32 s4, v14
    s_lshl_b32 s5, s25, 4
    s_and_b32 s5, s5, 16
    s_nop 1
    s_lshr_b32 s4, s4, s5
    s_and_b32 s4, s4, 0xffff
    s_cmp_lg_u32 s4, 0
    s_cbranch_scc0 K2_T1_NOPRE
    s_mov_b32 s83, 1
    s_mov_b32 s42, s37
    s_lshl_b32 s6, s24, 3
    s_add_u32 s6, s6, s25
    s_lshl_b32 s7, s6, 2
    s_add_u32 s7, s7, s3
    s_lshl_b32 s4, s7, 14
    s_add_u32 s4, s4, 83886080
    s_lshl_b32 s5, s7, 10
    s_add_u32 s5, s5, 94371840
    v_lshlrev_b32 v120, 3, v1
    buffer_load_dwordx2 v[122:123], v120, s[16:19], s5 offen sc1
    buffer_load_dwordx2 v[124:125], v120, s[16:19], s5 offen offset:512 sc1
    s_add_u32 s5, s4, 0
    buffer_load_dwordx4 a[0:3], v2, s[16:19], s5 offen offset:0 sc1
    buffer_load_dwordx4 a[4:7], v2, s[16:19], s5 offen offset:1024 sc1
    buffer_load_dwordx4 a[8:11], v2, s[16:19], s5 offen offset:2048 sc1
    buffer_load_dwordx4 a[12:15], v2, s[16:19], s5 offen offset:3072 sc1
    s_add_u32 s5, s4, 4096
    buffer_load_dwordx4 a[16:19], v2, s[16:19], s5 offen offset:0 sc1
    buffer_load_dwordx4 a[20:23], v2, s[16:19], s5 offen offset:1024 sc1
    buffer_load_dwordx4 a[24:27], v2, s[16:19], s5 offen offset:2048 sc1
    buffer_load_dwordx4 a[28:31], v2, s[16:19], s5 offen offset:3072 sc1
    s_add_u32 s5, s4, 8192
    buffer_load_dwordx4 a[32:35], v2, s[16:19], s5 offen offset:0 sc1
    buffer_load_dwordx4 a[36:39], v2, s[16:19], s5 offen offset:1024 sc1
    buffer_load_dwordx4 a[40:43], v2, s[16:19], s5 offen offset:2048 sc1
    buffer_load_dwordx4 a[44:47], v2, s[16:19], s5 offen offset:3072 sc1
    s_add_u32 s5, s4, 12288
    buffer_load_dwordx4 a[48:51], v2, s[16:19], s5 offen offset:0 sc1
    buffer_load_dwordx4 a[52:55], v2, s[16:19], s5 offen offset:1024 sc1
    buffer_load_dwordx4 a[56:59], v2, s[16:19], s5 offen offset:2048 sc1
    buffer_load_dwordx4 a[60:63], v2, s[16:19], s5 offen offset:3072 sc1
K2_T1_NOPRE:
    ds_read_b128 a[132:135], v3 offset:32768
    ds_read_b128 a[136:139], v3 offset:33792
    ds_read_b128 a[140:143], v3 offset:34816
    ds_read_b128 a[144:147], v3 offset:35840
    v_exp_f32 v48, v48
    v_exp_f32 v49, v49
    v_exp_f32 v50, v50
    v_exp_f32 v51, v51
    v_exp_f32 v52, v52
    v_exp_f32 v53, v53
    v_exp_f32 v54, v54
    v_exp_f32 v55, v55
    v_exp_f32 v56, v56
    v_exp_f32 v57, v57
    v_exp_f32 v58, v58
    v_exp_f32 v59, v59
    v_exp_f32 v60, v60
    v_exp_f32 v61, v61
    v_exp_f32 v62, v62
    v_exp_f32 v63, v63
    v_cvt_pk_bf16_f32 v80, v48, v49
    v_cvt_pk_bf16_f32 v81, v50, v51
    v_cvt_pk_bf16_f32 v82, v56, v57
    v_cvt_pk_bf16_f32 v83, v58, v59
    v_cvt_pk_bf16_f32 v84, v52, v53
    v_cvt_pk_bf16_f32 v85, v54, v55
    v_cvt_pk_bf16_f32 v86, v60, v61
    v_cvt_pk_bf16_f32 v87, v62, v63
    s_nop 1
    s_waitcnt lgkmcnt(3)
    v_mfma_f32_16x16x32_bf16 v[128:131], a[132:135], v[80:83], v[128:131]
    v_exp_f32 v64, v64
    ds_read_b128 a[148:151], v3 offset:36864
    ds_read_b128 a[152:155], v3 offset:37888
    ds_read_b128 a[156:159], v3 offset:38912
    v_mfma_f32_16x16x32_bf16 v[132:135], a[132:135], v[84:87], v[132:135]
    v_exp_f32 v65, v65
    s_waitcnt lgkmcnt(5)
    v_mfma_f32_16x16x32_bf16 v[136:139], a[136:139], v[80:83], v[136:139]
    v_exp_f32 v66, v66
    ds_read_b128 a[160:163], v3 offset:39936
    v_mfma_f32_16x16x32_bf16 v[140:143], a[136:139], v[84:87], v[140:143]
    v_exp_f32 v67, v67
    s_waitcnt lgkmcnt(5)
    v_mfma_f32_16x16x32_bf16 v[144:147], a[140:143], v[80:83], v[144:147]
    v_exp_f32 v68, v68
    ds_read_b128 a[164:167], v3 offset:40960
    v_mfma_f32_16x16x32_bf16 v[148:151], a[140:143], v[84:87], v[148:151]
    v_exp_f32 v69, v69
    s_waitcnt lgkmcnt(2)
    v_mfma_f32_16x16x32_bf16 v[152:155], a[144:147], v[80:83], v[152:155]
    v_exp_f32 v70, v70
    ds_read_b128 a[168:171], v3 offset:41984
    v_mfma_f32_16x16x32_bf16 v[156:159], a[144:147], v[84:87], v[156:159]
    v_exp_f32 v71, v71
    v_mfma_f32_16x16x32_bf16 v[160:163], a[148:151], v[80:83], v[160:163]
    v_exp_f32 v72, v72
    ds_read_b128 a[172:175], v3 offset:43008
    v_mfma_f32_16x16x32_bf16 v[164:167], a[148:151], v[84:87], v[164:167]
    v_exp_f32 v73, v73
    v_mfma_f32_16x16x32_bf16 v[168:171], a[152:155], v[80:83], v[168:171]
    v_exp_f32 v74, v74
    ds_read_b128 a[176:179], v3 offset:44032
    v_mfma_f32_16x16x32_bf16 v[172:175], a[152:155], v[84:87], v[172:175]
    v_exp_f32 v75, v75
    v_mfma_f32_16x16x32_bf16 v[176:179], a[156:159], v[80:83], v[176:179]
    v_exp_f32 v76, v76
    ds_read_b128 a[180:183], v3 offset:45056
    v_mfma_f32_16x16x32_bf16 v[180:183], a[156:159], v[84:87], v[180:183]
    v_exp_f32 v77, v77
    s_waitcnt lgkmcnt(2)
    v_mfma_f32_16x16x32_bf16 v[184:187], a[160:163], v[80:83], v[184:187]
    v_exp_f32 v78, v78
    ds_read_b128 a[184:187], v3 offset:46080
    v_mfma_f32_16x16x32_bf16 v[188:191], a[160:163], v[84:87], v[188:191]
    v_exp_f32 v79, v79
    v_mfma_f32_16x16x32_bf16 v[192:195], a[164:167], v[80:83], v[192:195]
    ds_read_b128 a[188:191], v3 offset:47104
    v_mfma_f32_16x16x32_bf16 v[196:199], a[164:167], v[84:87], v[196:199]
    v_cvt_pk_bf16_f32 v88, v64, v65
    v_cvt_pk_bf16_f32 v89, v66, v67
    v_mfma_f32_16x16x32_bf16 v[200:203], a[168:171], v[80:83], v[200:203]
    v_cvt_pk_bf16_f32 v90, v72, v73
    v_cvt_pk_bf16_f32 v91, v74, v75
    ds_read_b128 a[192:195], v3 offset:48128
    v_mfma_f32_16x16x32_bf16 v[204:207], a[168:171], v[84:87], v[204:207]
    v_cvt_pk_bf16_f32 v92, v68, v69
    v_cvt_pk_bf16_f32 v93, v70, v71
    v_mfma_f32_16x16x32_bf16 v[208:211], a[172:175], v[80:83], v[208:211]
    v_cvt_pk_bf16_f32 v94, v76, v77
    v_cvt_pk_bf16_f32 v95, v78, v79
    ds_read_b128 a[196:199], v3 offset:49152
    v_mfma_f32_16x16x32_bf16 v[212:215], a[172:175], v[84:87], v[212:215]
    v_add_f32 v104, v104, v48
    v_add_f32 v104, v104, v49
    s_waitcnt lgkmcnt(2)
    v_mfma_f32_16x16x32_bf16 v[216:219], a[176:179], v[80:83], v[216:219]
    v_add_f32 v104, v104, v50
    v_add_f32 v104, v104, v51
    ds_read_b128 a[200:203], v3 offset:50176
    v_mfma_f32_16x16x32_bf16 v[220:223], a[176:179], v[84:87], v[220:223]
    v_add_f32 v108, v108, v52
    v_add_f32 v108, v108, v53
    v_mfma_f32_16x16x32_bf16 v[224:227], a[180:183], v[80:83], v[224:227]
    v_add_f32 v108, v108, v54
    v_add_f32 v108, v108, v55
    ds_read_b128 a[204:207], v3 offset:51200
    v_mfma_f32_16x16x32_bf16 v[228:231], a[180:183], v[84:87], v[228:231]
    v_add_f32 v104, v104, v56
    v_add_f32 v104, v104, v57
    v_mfma_f32_16x16x32_bf16 v[232:235], a[184:187], v[80:83], v[232:235]
    v_add_f32 v104, v104, v58
    v_add_f32 v104, v104, v59
    ds_read_b128 a[208:211], v3 offset:52224
    v_mfma_f32_16x16x32_bf16 v[236:239], a[184:187], v[84:87], v[236:239]
    v_add_f32 v108, v108, v60
    v_add_f32 v108, v108, v61
    v_mfma_f32_16x16x32_bf16 v[240:243], a[188:191], v[80:83], v[240:243]
    v_add_f32 v108, v108, v62
    v_add_f32 v108, v108, v63
    ds_read_b128 a[212:215], v3 offset:53248
    v_mfma_f32_16x16x32_bf16 v[244:247], a[188:191], v[84:87], v[244:247]
    v_add_f32 v104, v104, v64
    v_add_f32 v104, v104, v65
    s_waitcnt lgkmcnt(2)
    v_mfma_f32_16x16x32_bf16 v[248:251], a[192:195], v[80:83], v[248:251]
    v_add_f32 v104, v104, v66
    v_add_f32 v104, v104, v67
    ds_read_b128 a[216:219], v3 offset:54272
    v_mfma_f32_16x16x32_bf16 v[252:255], a[192:195], v[84:87], v[252:255]
    v_add_f32 v108, v108, v68
    v_add_f32 v108, v108, v69
    v_mfma_f32_16x16x32_bf16 v[128:131], a[196:199], v[88:91], v[128:131]
    v_add_f32 v108, v108, v70
    v_add_f32 v108, v108, v71
    ds_read_b128 a[220:223], v3 offset:55296
    v_mfma_f32_16x16x32_bf16 v[132:135], a[196:199], v[92:95], v[132:135]
    v_add_f32 v104, v104, v72
    v_add_f32 v104, v104, v73
    v_mfma_f32_16x16x32_bf16 v[136:139], a[200:203], v[88:91], v[136:139]
    v_add_f32 v104, v104, v74
    v_add_f32 v104, v104, v75
    ds_read_b128 a[224:227], v3 offset:56320
    v_mfma_f32_16x16x32_bf16 v[140:143], a[200:203], v[92:95], v[140:143]
    v_add_f32 v108, v108, v76
    v_add_f32 v108, v108, v77
    v_mfma_f32_16x16x32_bf16 v[144:147], a[204:207], v[88:91], v[144:147]
    v_add_f32 v108, v108, v78
    v_add_f32 v108, v108, v79
    ds_read_b128 a[132:135], v3 offset:57344
    v_mfma_f32_16x16x32_bf16 v[148:151], a[204:207], v[92:95], v[148:151]
    s_waitcnt lgkmcnt(2)
    v_mfma_f32_16x16x32_bf16 v[152:155], a[208:211], v[88:91], v[152:155]
    ds_read_b128 a[136:139], v3 offset:58368
    v_mfma_f32_16x16x32_bf16 v[156:159], a[208:211], v[92:95], v[156:159]
    v_mfma_f32_16x16x32_bf16 v[160:163], a[212:215], v[88:91], v[160:163]
    ds_read_b128 a[140:143], v3 offset:59392
    v_mfma_f32_16x16x32_bf16 v[164:167], a[212:215], v[92:95], v[164:167]
    v_mfma_f32_16x16x32_bf16 v[168:171], a[216:219], v[88:91], v[168:171]
    ds_read_b128 a[144:147], v3 offset:60416
    v_mfma_f32_16x16x32_bf16 v[172:175], a[216:219], v[92:95], v[172:175]
    v_mfma_f32_16x16x32_bf16 v[176:179], a[220:223], v[88:91], v[176:179]
    ds_read_b128 a[148:151], v3 offset:61440
    v_mfma_f32_16x16x32_bf16 v[180:183], a[220:223], v[92:95], v[180:183]
    s_waitcnt lgkmcnt(2)
    v_mfma_f32_16x16x32_bf16 v[184:187], a[224:227], v[88:91], v[184:187]
    ds_read_b128 a[152:155], v3 offset:62464
    v_mfma_f32_16x16x32_bf16 v[188:191], a[224:227], v[92:95], v[188:191]
    v_mfma_f32_16x16x32_bf16 v[192:195], a[132:135], v[88:91], v[192:195]
    ds_read_b128 a[156:159], v3 offset:63488
    v_mfma_f32_16x16x32_bf16 v[196:199], a[132:135], v[92:95], v[196:199]
    v_mfma_f32_16x16x32_bf16 v[200:203], a[136:139], v[88:91], v[200:203]
    ds_read_b128 a[160:163], v3 offset:64512
    v_mfma_f32_16x16x32_bf16 v[204:207], a[136:139], v[92:95], v[204:207]
    v_mfma_f32_16x16x32_bf16 v[208:211], a[140:143], v[88:91], v[208:211]
    v_mfma_f32_16x16x32_bf16 v[212:215], a[140:143], v[92:95], v[212:215]
    s_waitcnt lgkmcnt(1)
    v_mfma_f32_16x16x32_bf16 v[216:219], a[144:147], v[88:91], v[216:219]
    v_mfma_f32_16x16x32_bf16 v[220:223], a[144:147], v[92:95], v[220:223]
    v_mfma_f32_16x16x32_bf16 v[224:227], a[148:151], v[88:91], v[224:227]
    v_mfma_f32_16x16x32_bf16 v[228:231], a[148:151], v[92:95], v[228:231]
    v_mfma_f32_16x16x32_bf16 v[232:235], a[152:155], v[88:91], v[232:235]
    v_mfma_f32_16x16x32_bf16 v[236:239], a[152:155], v[92:95], v[236:239]
    v_mfma_f32_16x16x32_bf16 v[240:243], a[156:159], v[88:91], v[240:243]
    v_mfma_f32_16x16x32_bf16 v[244:247], a[156:159], v[92:95], v[244:247]
    s_waitcnt lgkmcnt(0)
    v_mfma_f32_16x16x32_bf16 v[248:251], a[160:163], v[88:91], v[248:251]
    v_mfma_f32_16x16x32_bf16 v[252:255], a[160:163], v[92:95], v[252:255]
K2_EPI:
    s_waitcnt vmcnt(0) lgkmcnt(0)
    s_nop 7
    v_mov_b32 v105, v104
    s_nop 1
    v_permlane16_swap_b32 v104, v105
    s_nop 1
    v_add_f32 v104, v104, v105
    v_mov_b32 v105, v104
    s_nop 1
    v_permlane32_swap_b32 v104, v105
    s_nop 1
    v_add_f32 v104, v104, v105
    v_mov_b32 v109, v108
    s_nop 1
    v_permlane16_swap_b32 v108, v109
    s_nop 1
    v_add_f32 v108, v108, v109
    v_mov_b32 v109, v108
    s_nop 1
    v_permlane32_swap_b32 v108, v109
    s_nop 1
    v_add_f32 v108, v108, v109
    s_lshl_b32 s6, s24, 3
    s_add_u32 s6, s6, s25
    s_cmp_eq_u32 s30, 0
    s_cbranch_scc1 K2_EPI_PART
    s_barrier
    s_cmp_eq_u32 s30, 2
    s_cbranch_scc1 K2_EPI_MERGE
    v_rcp_f32 v116, v104
    v_rcp_f32 v117, v108
    s_nop 0
    v_mul_f32 v116, v116, v9
    v_mul_f32 v117, v117, v12
    v_mul_f32 v128, v128, v116
    v_mul_f32 v129, v129, v116
    v_mul_f32 v130, v130, v116
    v_mul_f32 v131, v131, v116
    v_mul_f32 v136, v136, v116
    v_mul_f32 v137, v137, v116
    s_add_u32 m0, s36, 0
    s_nop 0
    buffer_load_dwordx4 v10, s[52:55], s64 offen offset:0 lds
    v_mul_f32 v138, v138, v116
    v_mul_f32 v139, v139, v116
    v_cvt_pk_bf16_f32 v16, v128, v129
    v_cvt_pk_bf16_f32 v17, v130, v131
    v_cvt_pk_bf16_f32 v18, v136, v137
    v_cvt_pk_bf16_f32 v19, v138, v139
    buffer_load_dwordx4 v10, s[52:55], s65 offen offset:1024 lds
    v_mul_f32 v144, v144, v116
    v_mul_f32 v145, v145, v116
    v_mul_f32 v146, v146, v116
    v_mul_f32 v147, v147, v116
    v_mul_f32 v152, v152, v116
    v_mul_f32 v153, v153, v116
    buffer_load_dwordx4 v10, s[52:55], s66 offen offset:2048 lds
    v_mul_f32 v154, v154, v116
    v_mul_f32 v155, v155, v116
    v_cvt_pk_bf16_f32 v20, v144, v145
    v_cvt_pk_bf16_f32 v21, v146, v147
    v_cvt_pk_bf16_f32 v22, v152, v153
    v_cvt_pk_bf16_f32 v23, v154, v155
    buffer_load_dwordx4 v10, s[52:55], s67 offen offset:3072 lds
    v_mul_f32 v160, v160, v116
    v_mul_f32 v161, v161, v116
    v_mul_f32 v162, v162, v116
    v_mul_f32 v163, v163, v116
    v_mul_f32 v168, v168, v116
    v_mul_f32 v169, v169, v116
    s_add_u32 m0, s36, 4096
    s_nop 0
    buffer_load_dwordx4 v10, s[52:55], s68 offen offset:0 lds
    v_mul_f32 v170, v170, v116
    v_mul_f32 v171, v171, v116
    v_cvt_pk_bf16_f32 v24, v160, v161
    v_cvt_pk_bf16_f32 v25, v162, v163
    v_cvt_pk_bf16_f32 v26, v168, v169
    v_cvt_pk_bf16_f32 v27, v170, v171
    buffer_load_dwordx4 v10, s[52:55], s69 offen offset:1024 lds
    v_mul_f32 v176, v176, v116
    v_mul_f32 v177, v177, v116
    v_mul_f32 v178, v178, v116
    v_mul_f32 v179, v179, v116
    v_mul_f32 v184, v184, v116
    v_mul_f32 v185, v185, v116
    buffer_load_dwordx4 v10, s[52:55], s70 offen offset:2048 lds
    v_mul_f32 v186, v186, v116
    v_mul_f32 v187, v187, v116
    v_cvt_pk_bf16_f32 v28, v176, v177
    v_cvt_pk_bf16_f32 v29, v178, v179
    v_cvt_pk_bf16_f32 v30, v184, v185
    v_cvt_pk_bf16_f32 v31, v186, v187
    buffer_load_dwordx4 v10, s[52:55], s71 offen offset:3072 lds
    v_mul_f32 v192, v192, v116
    v_mul_f32 v193, v193, v116
    v_mul_f32 v194, v194, v116
    v_mul_f32 v195, v195, v116
    v_mul_f32 v200, v200, v116
    v_mul_f32 v201, v201, v116
    s_lshr_b32 s74, s36, 1
    s_add_u32 m0, s74, 32768
    s_nop 0
    buffer_load_dwordx4 v11, s[56:59], s64 offen offset:0 lds
    v_mul_f32 v202, v202, v116
    v_mul_f32 v203, v203, v116
    v_cvt_pk_bf16_f32 v32, v192, v193
    v_cvt_pk_bf16_f32 v33, v194, v195
    v_cvt_pk_bf16_f32 v34, v200, v201
    v_cvt_pk_bf16_f32 v35, v202, v203
    buffer_load_dwordx4 v11, s[56:59], s65 offen offset:1024 lds
    v_mul_f32 v208, v208, v116
    v_mul_f32 v209, v209, v116
    v_mul_f32 v210, v210, v116
    v_mul_f32 v211, v211, v116
    v_mul_f32 v216, v216, v116
    v_mul_f32 v217, v217, v116
    buffer_load_dwordx4 v11, s[56:59], s66 offen offset:2048 lds
    v_mul_f32 v218, v218, v116
    v_mul_f32 v219, v219, v116
    v_cvt_pk_bf16_f32 v36, v208, v209
    v_cvt_pk_bf16_f32 v37, v210, v211
    v_cvt_pk_bf16_f32 v38, v216, v217
    v_cvt_pk_bf16_f32 v39, v218, v219
    buffer_load_dwordx4 v11, s[56:59], s67 offen offset:3072 lds
    v_add_u32 v10, 128, v10
    v_add_u32 v11, 128, v11
    v_mul_f32 v224, v224, v116
    v_mul_f32 v225, v225, v116
    v_mul_f32 v226, v226, v116
    v_mul_f32 v227, v227, v116
    v_mul_f32 v232, v232, v116
    v_mul_f32 v233, v233, v116
    buffer_load_dwordx4 a[132:135], v2, s[16:19], s87 offen offset:0
    v_mul_f32 v234, v234, v116
    v_mul_f32 v235, v235, v116
    v_cvt_pk_bf16_f32 v40, v224, v225
    v_cvt_pk_bf16_f32 v41, v226, v227
    v_cvt_pk_bf16_f32 v42, v232, v233
    v_cvt_pk_bf16_f32 v43, v234, v235
    buffer_load_dwordx4 a[136:139], v2, s[16:19], s88 offen offset:0
    v_mul_f32 v240, v240, v116
    v_mul_f32 v241, v241, v116
    v_mul_f32 v242, v242, v116
    v_mul_f32 v243, v243, v116
    v_mul_f32 v248, v248, v116
    v_mul_f32 v249, v249, v116
    buffer_load_dwordx4 a[140:143], v2, s[16:19], s87 offen offset:1024
    v_mul_f32 v250, v250, v116
    v_mul_f32 v251, v251, v116
    v_cvt_pk_bf16_f32 v44, v240, v241
    v_cvt_pk_bf16_f32 v45, v242, v243
    v_cvt_pk_bf16_f32 v46, v248, v249
    v_cvt_pk_bf16_f32 v47, v250, v251
    buffer_load_dwordx4 a[144:147], v2, s[16:19], s88 offen offset:1024
    v_mul_f32 v132, v132, v117
    v_mul_f32 v133, v133, v117
    v_mul_f32 v134, v134, v117
    v_mul_f32 v135, v135, v117
    v_mul_f32 v140, v140, v117
    v_mul_f32 v141, v141, v117
    buffer_load_dwordx4 a[148:151], v2, s[16:19], s87 offen offset:2048
    v_mul_f32 v142, v142, v117
    v_mul_f32 v143, v143, v117
    v_cvt_pk_bf16_f32 v48, v132, v133
    v_cvt_pk_bf16_f32 v49, v134, v135
    v_cvt_pk_bf16_f32 v50, v140, v141
    v_cvt_pk_bf16_f32 v51, v142, v143
    buffer_load_dwordx4 a[152:155], v2, s[16:19], s88 offen offset:2048
    v_mul_f32 v148, v148, v117
    v_mul_f32 v149, v149, v117
    v_mul_f32 v150, v150, v117
    v_mul_f32 v151, v151, v117
    v_mul_f32 v156, v156, v117
    v_mul_f32 v157, v157, v117
    buffer_load_dwordx4 a[156:159], v2, s[60:63], s87 offen offset:3072
    v_mul_f32 v158, v158, v117
    v_mul_f32 v159, v159, v117
    v_cvt_pk_bf16_f32 v52, v148, v149
    v_cvt_pk_bf16_f32 v53, v150, v151
    v_cvt_pk_bf16_f32 v54, v156, v157
    v_cvt_pk_bf16_f32 v55, v158, v159
    buffer_load_dwordx4 a[160:163], v2, s[60:63], s88 offen offset:3072
    v_mul_f32 v164, v164, v117
    v_mul_f32 v165, v165, v117
    v_mul_f32 v166, v166, v117
    v_mul_f32 v167, v167, v117
    v_mul_f32 v172, v172, v117
    v_mul_f32 v173, v173, v117
    s_add_u32 m0, s36, 65536
    s_nop 0
    buffer_load_dwordx4 v10, s[52:55], s64 offen offset:0 lds
    v_mul_f32 v174, v174, v117
    v_mul_f32 v175, v175, v117
    v_cvt_pk_bf16_f32 v56, v164, v165
    v_cvt_pk_bf16_f32 v57, v166, v167
    v_cvt_pk_bf16_f32 v58, v172, v173
    v_cvt_pk_bf16_f32 v59, v174, v175
    buffer_load_dwordx4 v10, s[52:55], s65 offen offset:1024 lds
    v_mul_f32 v180, v180, v117
    v_mul_f32 v181, v181, v117
    v_mul_f32 v182, v182, v117
    v_mul_f32 v183, v183, v117
    v_mul_f32 v188, v188, v117
    v_mul_f32 v189, v189, v117
    buffer_load_dwordx4 v10, s[52:55], s66 offen offset:2048 lds
    v_mul_f32 v190, v190, v117
    v_mul_f32 v191, v191, v117
    v_cvt_pk_bf16_f32 v60, v180, v181
    v_cvt_pk_bf16_f32 v61, v182, v183
    v_cvt_pk_bf16_f32 v62, v188, v189
    v_cvt_pk_bf16_f32 v63, v190, v191
    buffer_load_dwordx4 v10, s[52:55], s67 offen offset:3072 lds
    v_mul_f32 v196, v196, v117
    v_mul_f32 v197, v197, v117
    v_mul_f32 v198, v198, v117
    v_mul_f32 v199, v199, v117
    v_mul_f32 v204, v204, v117
    v_mul_f32 v205, v205, v117
    s_add_u32 m0, s36, 69632
    s_nop 0
    buffer_load_dwordx4 v10, s[52:55], s68 offen offset:0 lds
    v_mul_f32 v206, v206, v117
    v_mul_f32 v207, v207, v117
    v_cvt_pk_bf16_f32 v64, v196, v197
    v_cvt_pk_bf16_f32 v65, v198, v199
    v_cvt_pk_bf16_f32 v66, v204, v205
    v_cvt_pk_bf16_f32 v67, v206, v207
    buffer_load_dwordx4 v10, s[52:55], s69 offen offset:1024 lds
    v_mul_f32 v212, v212, v117
    v_mul_f32 v213, v213, v117
    v_mul_f32 v214, v214, v117
    v_mul_f32 v215, v215, v117
    v_mul_f32 v220, v220, v117
    v_mul_f32 v221, v221, v117
    buffer_load_dwordx4 v10, s[52:55], s70 offen offset:2048 lds
    v_mul_f32 v222, v222, v117
    v_mul_f32 v223, v223, v117
    v_cvt_pk_bf16_f32 v68, v212, v213
    v_cvt_pk_bf16_f32 v69, v214, v215
    v_cvt_pk_bf16_f32 v70, v220, v221
    v_cvt_pk_bf16_f32 v71, v222, v223
    buffer_load_dwordx4 v10, s[52:55], s71 offen offset:3072 lds
    v_mul_f32 v228, v228, v117
    v_mul_f32 v229, v229, v117
    v_mul_f32 v230, v230, v117
    v_mul_f32 v231, v231, v117
    v_mul_f32 v236, v236, v117
    v_mul_f32 v237, v237, v117
    s_lshr_b32 s74, s36, 1
    s_add_u32 m0, s74, 98304
    s_nop 0
    buffer_load_dwordx4 v11, s[56:59], s64 offen offset:0 lds
    v_mul_f32 v238, v238, v117
    v_mul_f32 v239, v239, v117
    v_cvt_pk_bf16_f32 v72, v228, v229
    v_cvt_pk_bf16_f32 v73, v230, v231
    v_cvt_pk_bf16_f32 v74, v236, v237
    v_cvt_pk_bf16_f32 v75, v238, v239
    buffer_load_dwordx4 v11, s[56:59], s65 offen offset:1024 lds
    v_mul_f32 v244, v244, v117
    v_mul_f32 v245, v245, v117
    v_mul_f32 v246, v246, v117
    v_mul_f32 v247, v247, v117
    v_mul_f32 v252, v252, v117
    v_mul_f32 v253, v253, v117
    buffer_load_dwordx4 v11, s[56:59], s66 offen offset:2048 lds
    v_mul_f32 v254, v254, v117
    v_mul_f32 v255, v255, v117
    v_cvt_pk_bf16_f32 v76, v244, v245
    v_cvt_pk_bf16_f32 v77, v246, v247
    v_cvt_pk_bf16_f32 v78, v252, v253
    v_cvt_pk_bf16_f32 v79, v254, v255
    buffer_load_dwordx4 v11, s[56:59], s67 offen offset:3072 lds
    v_add_u32 v10, 128, v10
    v_add_u32 v11, 128, v11
    s_branch K2_OUTPROJ
K2_EPI_PART:
    s_barrier
    s_mov_b32 s27, s25
    s_mov_b32 s28, 0
    s_lshl_b32 s29, s25, 1
    s_add_u32 s29, s29, 2
    s_mov_b32 s30, 1
    v_rcp_f32 v116, v104
    v_cmp_lt_f32 vcc, 0, v104
    v_sub_f32 v118, 0, v96
    s_nop 1
    v_cndmask_b32 v116, 0, v116, vcc
    v_cndmask_b32 v118, v7, v118, vcc
    v_rcp_f32 v117, v108
    v_cmp_lt_f32 vcc, 0, v108
    v_sub_f32 v119, 0, v100
    s_nop 1
    v_cndmask_b32 v117, 0, v117, vcc
    v_cndmask_b32 v119, v7, v119, vcc
    v_mul_f32 v128, v128, v116
    v_mul_f32 v129, v129, v116
    v_mul_f32 v130, v130, v116
    v_mul_f32 v131, v131, v116
    v_mul_f32 v136, v136, v116
    v_mul_f32 v137, v137, v116
    v_mul_f32 v138, v138, v116
    v_mul_f32 v139, v139, v116
    s_lshl_b32 s89, s24, 5
    s_add_u32 s89, s89, s28
    s_lshl_b32 s89, s89, 15
    s_add_u32 s32, s89, 16777216
    s_add_u32 s34, s89, 33554432
    s_lshl_b32 s90, s29, 15
    s_add_u32 s33, s32, s90
    s_add_u32 s35, s34, s90
    s_mov_b32 s10, s37
    s_mov_b32 s14, s37
    s_cmp_lt_u32 s32, s33
    s_cselect_b32 s10, s37, 0
    s_add_u32 m0, s36, 0
    s_nop 0
    buffer_load_dwordx4 v4, s[8:11], s32 offen offset:0 lds
    v_cvt_pk_bf16_f32 v16, v128, v129
    v_cvt_pk_bf16_f32 v17, v130, v131
    v_cvt_pk_bf16_f32 v18, v136, v137
    v_cvt_pk_bf16_f32 v19, v138, v139
    v_mul_f32 v144, v144, v116
    v_mul_f32 v145, v145, v116
    v_mul_f32 v146, v146, v116
    v_mul_f32 v147, v147, v116
    buffer_load_dwordx4 v4, s[8:11], s32 offen offset:1024 lds
    v_mul_f32 v152, v152, v116
    v_mul_f32 v153, v153, v116
    v_mul_f32 v154, v154, v116
    v_mul_f32 v155, v155, v116
    v_cvt_pk_bf16_f32 v20, v144, v145
    v_cvt_pk_bf16_f32 v21, v146, v147
    v_cvt_pk_bf16_f32 v22, v152, v153
    v_cvt_pk_bf16_f32 v23, v154, v155
    buffer_load_dwordx4 v4, s[8:11], s32 offen offset:2048 lds
    v_mul_f32 v160, v160, v116
    v_mul_f32 v161, v161, v116
    v_mul_f32 v162, v162, v116
    v_mul_f32 v163, v163, v116
    v_mul_f32 v168, v168, v116
    v_mul_f32 v169, v169, v116
    v_mul_f32 v170, v170, v116
    v_mul_f32 v171, v171, v116
    buffer_load_dwordx4 v4, s[8:11], s32 offen offset:3072 lds
    v_cvt_pk_bf16_f32 v24, v160, v161
    v_cvt_pk_bf16_f32 v25, v162, v163
    v_cvt_pk_bf16_f32 v26, v168, v169
    v_cvt_pk_bf16_f32 v27, v170, v171
    v_mul_f32 v176, v176, v116
    v_mul_f32 v177, v177, v116
    v_mul_f32 v178, v178, v116
    v_mul_f32 v179, v179, v116
    s_add_u32 m0, s36, 4096
    s_nop 0
    buffer_load_dwordx4 v5, s[8:11], s32 offen offset:0 lds
    v_mul_f32 v184, v184, v116
    v_mul_f32 v185, v185, v116
    v_mul_f32 v186, v186, v116
    v_mul_f32 v187, v187, v116
    v_cvt_pk_bf16_f32 v28, v176, v177
    v_cvt_pk_bf16_f32 v29, v178, v179
    v_cvt_pk_bf16_f32 v30, v184, v185
    v_cvt_pk_bf16_f32 v31, v186, v187
    buffer_load_dwordx4 v5, s[8:11], s32 offen offset:1024 lds
    v_mul_f32 v192, v192, v116
    v_mul_f32 v193, v193, v116
    v_mul_f32 v194, v194, v116
    v_mul_f32 v195, v195, v116
    v_mul_f32 v200, v200, v116
    v_mul_f32 v201, v201, v116
    v_mul_f32 v202, v202, v116
    v_mul_f32 v203, v203, v116
    buffer_load_dwordx4 v5, s[8:11], s32 offen offset:2048 lds
    v_cvt_pk_bf16_f32 v32, v192, v193
    v_cvt_pk_bf16_f32 v33, v194, v195
    v_cvt_pk_bf16_f32 v34, v200, v201
    v_cvt_pk_bf16_f32 v35, v202, v203
    v_mul_f32 v208, v208, v116
    v_mul_f32 v209, v209, v116
    v_mul_f32 v210, v210, v116
    v_mul_f32 v211, v211, v116
    buffer_load_dwordx4 v5, s[8:11], s32 offen offset:3072 lds
    v_mul_f32 v216, v216, v116
    v_mul_f32 v217, v217, v116
    v_mul_f32 v218, v218, v116
    v_mul_f32 v219, v219, v116
    v_cvt_pk_bf16_f32 v36, v208, v209
    v_cvt_pk_bf16_f32 v37, v210, v211
    v_cvt_pk_bf16_f32 v38, v216, v217
    v_cvt_pk_bf16_f32 v39, v218, v219
    s_add_u32 s32, s32, 0x8000
    s_lshl_b32 s89, s24, 7
    s_lshl_b32 s90, s27, 3
    s_add_u32 s89, s89, s90
    s_add_u32 s89, s89, s3
    s_lshl_b32 s89, s89, 13
    s_add_u32 s89, s89, 0
    s_add_u32 s90, s89, 0
    buffer_load_dwordx4 a[0:3], v2, s[16:19], s90 offen offset:0
    v_mul_f32 v224, v224, v116
    v_mul_f32 v225, v225, v116
    v_mul_f32 v226, v226, v116
    v_mul_f32 v227, v227, v116
    v_mul_f32 v232, v232, v116
    v_mul_f32 v233, v233, v116
    v_mul_f32 v234, v234, v116
    v_mul_f32 v235, v235, v116
    buffer_load_dwordx4 a[8:11], v2, s[16:19], s90 offen offset:1024
    v_cvt_pk_bf16_f32 v40, v224, v225
    v_cvt_pk_bf16_f32 v41, v226, v227
    v_cvt_pk_bf16_f32 v42, v232, v233
    v_cvt_pk_bf16_f32 v43, v234, v235
    v_mul_f32 v240, v240, v116
    v_mul_f32 v241, v241, v116
    v_mul_f32 v242, v242, v116
    v_mul_f32 v243, v243, v116
    buffer_load_dwordx4 a[16:19], v2, s[16:19], s90 offen offset:2048
    v_mul_f32 v248, v248, v116
    v_mul_f32 v249, v249, v116
    v_mul_f32 v250, v250, v116
    v_mul_f32 v251, v251, v116
    v_cvt_pk_bf16_f32 v44, v240, v241
    v_cvt_pk_bf16_f32 v45, v242, v243
    v_cvt_pk_bf16_f32 v46, v248, v249
    v_cvt_pk_bf16_f32 v47, v250, v251
    buffer_load_dwordx4 a[24:27], v2, s[16:19], s90 offen offset:3072
    v_mul_f32 v132, v132, v117
    v_mul_f32 v133, v133, v117
    v_mul_f32 v134, v134, v117
    v_mul_f32 v135, v135, v117
    v_mul_f32 v140, v140, v117
    v_mul_f32 v141, v141, v117
    v_mul_f32 v142, v142, v117
    v_mul_f32 v143, v143, v117
    s_add_u32 s90, s89, 4096
    buffer_load_dwordx4 a[32:35], v2, s[16:19], s90 offen offset:0
    v_cvt_pk_bf16_f32 v48, v132, v133
    v_cvt_pk_bf16_f32 v49, v134, v135
    v_cvt_pk_bf16_f32 v50, v140, v141
    v_cvt_pk_bf16_f32 v51, v142, v143
    v_mul_f32 v148, v148, v117
    v_mul_f32 v149, v149, v117
    v_mul_f32 v150, v150, v117
    v_mul_f32 v151, v151, v117
    buffer_load_dwordx4 a[40:43], v2, s[16:19], s90 offen offset:1024
    v_mul_f32 v156, v156, v117
    v_mul_f32 v157, v157, v117
    v_mul_f32 v158, v158, v117
    v_mul_f32 v159, v159, v117
    v_cvt_pk_bf16_f32 v52, v148, v149
    v_cvt_pk_bf16_f32 v53, v150, v151
    v_cvt_pk_bf16_f32 v54, v156, v157
    v_cvt_pk_bf16_f32 v55, v158, v159
    buffer_load_dwordx4 a[48:51], v2, s[16:19], s90 offen offset:2048
    v_mul_f32 v164, v164, v117
    v_mul_f32 v165, v165, v117
    v_mul_f32 v166, v166, v117
    v_mul_f32 v167, v167, v117
    v_mul_f32 v172, v172, v117
    v_mul_f32 v173, v173, v117
    v_mul_f32 v174, v174, v117
    v_mul_f32 v175, v175, v117
    buffer_load_dwordx4 a[56:59], v2, s[16:19], s90 offen offset:3072
    v_cvt_pk_bf16_f32 v56, v164, v165
    v_cvt_pk_bf16_f32 v57, v166, v167
    v_cvt_pk_bf16_f32 v58, v172, v173
    v_cvt_pk_bf16_f32 v59, v174, v175
    v_mul_f32 v180, v180, v117
    v_mul_f32 v181, v181, v117
    v_mul_f32 v182, v182, v117
    v_mul_f32 v183, v183, v117
    s_add_u32 s90, s89, 32768
    buffer_load_dwordx4 a[4:7], v2, s[16:19], s90 offen offset:0
    v_mul_f32 v188, v188, v117
    v_mul_f32 v189, v189, v117
    v_mul_f32 v190, v190, v117
    v_mul_f32 v191, v191, v117
    v_cvt_pk_bf16_f32 v60, v180, v181
    v_cvt_pk_bf16_f32 v61, v182, v183
    v_cvt_pk_bf16_f32 v62, v188, v189
    v_cvt_pk_bf16_f32 v63, v190, v191
    buffer_load_dwordx4 a[12:15], v2, s[16:19], s90 offen offset:1024
    v_mul_f32 v196, v196, v117
    v_mul_f32 v197, v197, v117
    v_mul_f32 v198, v198, v117
    v_mul_f32 v199, v199, v117
    v_mul_f32 v204, v204, v117
    v_mul_f32 v205, v205, v117
    v_mul_f32 v206, v206, v117
    v_mul_f32 v207, v207, v117
    buffer_load_dwordx4 a[20:23], v2, s[16:19], s90 offen offset:2048
    v_cvt_pk_bf16_f32 v64, v196, v197
    v_cvt_pk_bf16_f32 v65, v198, v199
    v_cvt_pk_bf16_f32 v66, v204, v205
    v_cvt_pk_bf16_f32 v67, v206, v207
    v_mul_f32 v212, v212, v117
    v_mul_f32 v213, v213, v117
    v_mul_f32 v214, v214, v117
    v_mul_f32 v215, v215, v117
    buffer_load_dwordx4 a[28:31], v2, s[16:19], s90 offen offset:3072
    v_mul_f32 v220, v220, v117
    v_mul_f32 v221, v221, v117
    v_mul_f32 v222, v222, v117
    v_mul_f32 v223, v223, v117
    v_cvt_pk_bf16_f32 v68, v212, v213
    v_cvt_pk_bf16_f32 v69, v214, v215
    v_cvt_pk_bf16_f32 v70, v220, v221
    v_cvt_pk_bf16_f32 v71, v222, v223
    s_add_u32 s90, s89, 36864
    buffer_load_dwordx4 a[36:39], v2, s[16:19], s90 offen offset:0
    v_mul_f32 v228, v228, v117
    v_mul_f32 v229, v229, v117
    v_mul_f32 v230, v230, v117
    v_mul_f32 v231, v231, v117
    v_mul_f32 v236, v236, v117
    v_mul_f32 v237, v237, v117
    v_mul_f32 v238, v238, v117
    v_mul_f32 v239, v239, v117
    buffer_load_dwordx4 a[44:47], v2, s[16:19], s90 offen offset:1024
    v_cvt_pk_bf16_f32 v72, v228, v229
    v_cvt_pk_bf16_f32 v73, v230, v231
    v_cvt_pk_bf16_f32 v74, v236, v237
    v_cvt_pk_bf16_f32 v75, v238, v239
    v_mul_f32 v244, v244, v117
    v_mul_f32 v245, v245, v117
    v_mul_f32 v246, v246, v117
    v_mul_f32 v247, v247, v117
    buffer_load_dwordx4 a[52:55], v2, s[16:19], s90 offen offset:2048
    v_mul_f32 v252, v252, v117
    v_mul_f32 v253, v253, v117
    v_mul_f32 v254, v254, v117
    v_mul_f32 v255, v255, v117
    v_cvt_pk_bf16_f32 v76, v244, v245
    v_cvt_pk_bf16_f32 v77, v246, v247
    v_cvt_pk_bf16_f32 v78, v252, v253
    v_cvt_pk_bf16_f32 v79, v254, v255
    buffer_load_dwordx4 a[60:63], v2, s[16:19], s90 offen offset:3072
    s_lshl_b32 s7, s6, 2
    s_add_u32 s7, s7, s3
    s_lshl_b32 s89, s7, 14
    s_add_u32 s89, s89, 83886080
    s_lshl_b32 s5, s7, 10
    s_add_u32 s5, s5, 94371840
    v_lshlrev_b32 v120, 3, v1
    v_mov_b32 v122, v118
    v_mov_b32 v123, v104
    v_mov_b32 v124, v119
    v_mov_b32 v125, v108
    buffer_store_dwordx2 v[122:123], v120, s[16:19], s5 offen sc1
    buffer_store_dwordx2 v[124:125], v120, s[16:19], s5 offen offset:512 sc1
    s_mov_b32 s86, 1
    s_add_u32 s90, s89, 0
    buffer_store_dwordx4 v[16:19], v2, s[16:19], s90 offen offset:0 sc1
    s_lshl_b32 s4, s24, 3
    s_add_u32 s4, s4, s25
    s_lshr_b32 s4, s4, 1
    s_lshl_b32 s4, s4, 2
    v_mov_b32 v13, s4
    v_mov_b32 v14, 0
    s_mov_b32 s91, 0x41400000
    v_add_u32 v3, 0x10000, v2
    v_lshrrev_b32 v6, 4, v1
    v_lshlrev_b32 v6, 2, v6
    v_and_b32 v112, 15, v1
    v_sub_u32 v6, v6, v112
    v_mov_b32 v7, 0xf149f2ca
    buffer_store_dwordx4 v[20:23], v2, s[16:19], s90 offen offset:1024 sc1
    v_mov_b32 v112, 0x3f803f80
    v_accvgpr_write_b32 a64, v112
    v_accvgpr_write_b32 a65, v112
    v_accvgpr_write_b32 a66, v112
    v_accvgpr_write_b32 a67, v112
    s_lshr_b32 s4, s24, 1
    s_mul_i32 s4, s4, 7
    s_and_b32 s5, s24, 1
    s_lshl_b32 s7, s5, 2
    s_add_u32 s4, s4, s7
    s_cmp_eq_u32 s5, 0
    s_cselect_b32 s62, s37, 0
    s_mov_b32 s60, s16
    buffer_store_dwordx4 v[24:27], v2, s[16:19], s90 offen offset:2048 sc1
    s_mov_b32 s61, s17
    s_mov_b32 s63, 0x20000
    s_lshl_b32 s7, s27, 3
    s_add_u32 s7, s7, s3
    s_mul_i32 s7, s7, 184
    s_add_u32 s7, s7, s4
    s_add_u32 s7, s7, 128
    s_lshl_b32 s7, s7, 10
    s_add_u32 s87, s7, 50331648
    s_add_u32 s88, s87, 753664
    v_lshrrev_b32 v10, 3, v1
    v_mul_u32_u24 v10, 896, v10
    v_lshrrev_b32 v11, 4, v1
    buffer_store_dwordx4 v[28:31], v2, s[16:19], s90 offen offset:3072 sc1
    v_lshlrev_b32 v11, 1, v11
    v_and_b32 v112, 7, v1
    v_xor_b32 v11, v11, v112
    v_lshl_add_u32 v10, v11, 4, v10
    s_lshl_b32 s4, s4, 5
    s_lshl_b32 s5, s3, 5
    s_add_u32 s4, s4, s5
    s_mul_i32 s4, s4, 896
    v_add_u32 v11, s4, v10
    s_lshl_b32 s4, s24, 8
    s_lshl_b32 s5, s3, 6
    s_add_u32 s4, s4, s5
    s_mul_i32 s4, s4, 896
    s_add_u32 s90, s89, 4096
    buffer_store_dwordx4 v[32:35], v2, s[16:19], s90 offen offset:0 sc1
    v_add_u32 v10, s4, v10
    s_mov_b32 s52, s78
    s_mov_b32 s53, s79
    s_mov_b32 s54, 3670016
    s_mov_b32 s55, 0x20000
    s_mov_b32 s56, s80
    s_mov_b32 s57, s81
    s_mov_b32 s58, 1605632
    s_mov_b32 s59, 0x20000
    s_mov_b32 s76, 3670016
    s_mov_b32 s77, 1605632
    s_lshl_b32 s4, s27, 7
    s_lshl_b32 s5, s3, 4
    buffer_store_dwordx4 v[36:39], v2, s[16:19], s90 offen offset:1024 sc1
    s_add_u32 s4, s4, s5
    v_and_b32 v112, 15, v1
    v_add_u32 v112, s4, v112
    v_lshlrev_b32 v112, 2, v112
    s_mov_b32 s64, 0
    s_mov_b32 s65, 6144
    s_mov_b32 s66, 12288
    s_mov_b32 s67, 18432
    s_mov_b32 s68, 28672
    s_mov_b32 s69, 34816
    s_mov_b32 s70, 40960
    s_mov_b32 s71, 47104
    v_mov_b32 v128, 0
    buffer_store_dwordx4 v[40:43], v2, s[16:19], s90 offen offset:2048 sc1
    v_mov_b32 v129, 0
    v_mov_b32 v130, 0
    v_mov_b32 v131, 0
    v_mov_b32 v132, 0
    v_mov_b32 v133, 0
    v_mov_b32 v134, 0
    v_mov_b32 v135, 0
    v_mov_b32 v136, 0
    v_mov_b32 v137, 0
    v_mov_b32 v138, 0
    v_mov_b32 v139, 0
    v_mov_b32 v140, 0
    v_mov_b32 v141, 0
    buffer_store_dwordx4 v[44:47], v2, s[16:19], s90 offen offset:3072 sc1
    v_mov_b32 v142, 0
    v_mov_b32 v143, 0
    v_mov_b32 v144, 0
    v_mov_b32 v145, 0
    v_mov_b32 v146, 0
    v_mov_b32 v147, 0
    v_mov_b32 v148, 0
    v_mov_b32 v149, 0
    v_mov_b32 v150, 0
    v_mov_b32 v151, 0
    v_mov_b32 v152, 0
    v_mov_b32 v153, 0
    v_mov_b32 v154, 0
    s_add_u32 s90, s89, 8192
    buffer_store_dwordx4 v[48:51], v2, s[16:19], s90 offen offset:0 sc1
    v_mov_b32 v155, 0
    v_mov_b32 v156, 0
    v_mov_b32 v157, 0
    v_mov_b32 v158, 0
    v_mov_b32 v159, 0
    v_mov_b32 v160, 0
    v_mov_b32 v161, 0
    v_mov_b32 v162, 0
    v_mov_b32 v163, 0
    v_mov_b32 v164, 0
    v_mov_b32 v165, 0
    v_mov_b32 v166, 0
    v_mov_b32 v167, 0
    buffer_store_dwordx4 v[52:55], v2, s[16:19], s90 offen offset:1024 sc1
    v_mov_b32 v168, 0
    v_mov_b32 v169, 0
    v_mov_b32 v170, 0
    v_mov_b32 v171, 0
    v_mov_b32 v172, 0
    v_mov_b32 v173, 0
    v_mov_b32 v174, 0
    v_mov_b32 v175, 0
    v_mov_b32 v176, 0
    v_mov_b32 v177, 0
    v_mov_b32 v178, 0
    v_mov_b32 v179, 0
    v_mov_b32 v180, 0
    buffer_store_dwordx4 v[56:59], v2, s[16:19], s90 offen offset:2048 sc1
    v_mov_b32 v181, 0
    v_mov_b32 v182, 0
    v_mov_b32 v183, 0
    v_mov_b32 v184, 0
    v_mov_b32 v185, 0
    v_mov_b32 v186, 0
    v_mov_b32 v187, 0
    v_mov_b32 v188, 0
    v_mov_b32 v189, 0
    v_mov_b32 v190, 0
    v_mov_b32 v191, 0
    v_mov_b32 v192, 0
    v_mov_b32 v193, 0
    buffer_store_dwordx4 v[60:63], v2, s[16:19], s90 offen offset:3072 sc1
    v_mov_b32 v194, 0
    v_mov_b32 v195, 0
    v_mov_b32 v196, 0
    v_mov_b32 v197, 0
    v_mov_b32 v198, 0
    v_mov_b32 v199, 0
    v_mov_b32 v200, 0
    v_mov_b32 v201, 0
    v_mov_b32 v202, 0
    v_mov_b32 v203, 0
    v_mov_b32 v204, 0
    v_mov_b32 v205, 0
    v_mov_b32 v206, 0
    s_add_u32 s90, s89, 12288
    buffer_store_dwordx4 v[64:67], v2, s[16:19], s90 offen offset:0 sc1
    v_mov_b32 v207, 0
    v_mov_b32 v208, 0
    v_mov_b32 v209, 0
    v_mov_b32 v210, 0
    v_mov_b32 v211, 0
    v_mov_b32 v212, 0
    v_mov_b32 v213, 0
    v_mov_b32 v214, 0
    v_mov_b32 v215, 0
    v_mov_b32 v216, 0
    v_mov_b32 v217, 0
    v_mov_b32 v218, 0
    v_mov_b32 v219, 0
    buffer_store_dwordx4 v[68:71], v2, s[16:19], s90 offen offset:1024 sc1
    v_mov_b32 v220, 0
    v_mov_b32 v221, 0
    v_mov_b32 v222, 0
    v_mov_b32 v223, 0
    v_mov_b32 v224, 0
    v_mov_b32 v225, 0
    v_mov_b32 v226, 0
    v_mov_b32 v227, 0
    v_mov_b32 v228, 0
    v_mov_b32 v229, 0
    v_mov_b32 v230, 0
    v_mov_b32 v231, 0
    v_mov_b32 v232, 0
    buffer_store_dwordx4 v[72:75], v2, s[16:19], s90 offen offset:2048 sc1
    v_mov_b32 v233, 0
    v_mov_b32 v234, 0
    v_mov_b32 v235, 0
    v_mov_b32 v236, 0
    v_mov_b32 v237, 0
    v_mov_b32 v238, 0
    v_mov_b32 v239, 0
    v_mov_b32 v240, 0
    v_mov_b32 v241, 0
    v_mov_b32 v242, 0
    v_mov_b32 v243, 0
    v_mov_b32 v244, 0
    v_mov_b32 v245, 0
    buffer_store_dwordx4 v[76:79], v2, s[16:19], s90 offen offset:3072 sc1
    v_mov_b32 v246, 0
    v_mov_b32 v247, 0
    v_mov_b32 v248, 0
    v_mov_b32 v249, 0
    v_mov_b32 v250, 0
    v_mov_b32 v251, 0
    v_mov_b32 v252, 0
    v_mov_b32 v253, 0
    v_mov_b32 v254, 0
    v_mov_b32 v255, 0
    v_mov_b32 v104, 0
    v_mov_b32 v105, 0
    v_mov_b32 v106, 0
    v_mov_b32 v107, 0
    v_mov_b32 v108, 0
    v_mov_b32 v109, 0
    v_mov_b32 v110, 0
    v_mov_b32 v111, 0
    v_mov_b32 v96, 0
    v_mov_b32 v97, 0
    v_mov_b32 v98, 0
    v_mov_b32 v99, 0
    v_mov_b32 v100, 0
    v_mov_b32 v101, 0
    v_mov_b32 v102, 0
    v_mov_b32 v103, 0
    s_mov_b32 s7, 75497472
    buffer_load_dword v9, v112, s[16:19], s7 offen
    buffer_load_dword v12, v112, s[16:19], s7 offen offset:256
    s_branch K2_SEG_BOOK
K2_SEG2:
    s_mov_b32 s27, s25
    s_mov_b32 s28, 0
    s_lshl_b32 s29, s25, 1
    s_add_u32 s29, s29, 2
    s_mov_b32 s30, 1
    s_branch K2_SEG
K2_EPI_MERGE:
    s_cmp_eq_u32 s83, 1
    s_cbranch_scc1 K2_HAVE
    s_mov_b32 s98, 0x40000
K2_POLL:
    buffer_load_dword v14, v13, s[20:23], 0 offen sc1
    s_waitcnt vmcnt(0)
    v_readfirstlane_b32 s4, v14
    s_lshl_b32 s5, s25, 4
    s_and_b32 s5, s5, 16
    s_nop 1
    s_lshr_b32 s4, s4, s5
    s_and_b32 s4, s4, 0xffff
    s_cmp_lg_u32 s4, 0
    s_cbranch_scc1 K2_POLLED
    s_sleep 4
    s_sub_u32 s98, s98, 1
    s_cmp_lg_u32 s98, 0
    s_cbranch_scc1 K2_POLL
K2_POLLED:
    s_lshl_b32 s6, s24, 3
    s_add_u32 s6, s6, s25
    s_lshl_b32 s7, s6, 2
    s_add_u32 s7, s7, s3
    s_lshl_b32 s4, s7, 14
    s_add_u32 s4, s4, 83886080
    s_lshl_b32 s5, s7, 10
    s_add_u32 s5, s5, 94371840
    v_lshlrev_b32 v120, 3, v1
    buffer_load_dwordx2 v[122:123], v120, s[16:19], s5 offen sc1
    buffer_load_dwordx2 v[124:125], v120, s[16:19], s5 offen offset:512 sc1
    s_add_u32 s5, s4, 0
    buffer_load_dwordx4 a[0:3], v2, s[16:19], s5 offen offset:0 sc1
    buffer_load_dwordx4 a[4:7], v2, s[16:19], s5 offen offset:1024 sc1
    buffer_load_dwordx4 a[8:11], v2, s[16:19], s5 offen offset:2048 sc1
    buffer_load_dwordx4 a[12:15], v2, s[16:19], s5 offen offset:3072 sc1
    s_add_u32 s5, s4, 4096
    buffer_load_dwordx4 a[16:19], v2, s[16:19], s5 offen offset:0 sc1
    buffer_load_dwordx4 a[20:23], v2, s[16:19], s5 offen offset:1024 sc1
    buffer_load_dwordx4 a[24:27], v2, s[16:19], s5 offen offset:2048 sc1
    buffer_load_dwordx4 a[28:31], v2, s[16:19], s5 offen offset:3072 sc1
    s_add_u32 s5, s4, 8192
    buffer_load_dwordx4 a[32:35], v2, s[16:19], s5 offen offset:0 sc1
    buffer_load_dwordx4 a[36:39], v2, s[16:19], s5 offen offset:1024 sc1
    buffer_load_dwordx4 a[40:43], v2, s[16:19], s5 offen offset:2048 sc1
    buffer_load_dwordx4 a[44:47], v2, s[16:19], s5 offen offset:3072 sc1
    s_add_u32 s5, s4, 12288
    buffer_load_dwordx4 a[48:51], v2, s[16:19], s5 offen offset:0 sc1
    buffer_load_dwordx4 a[52:55], v2, s[16:19], s5 offen offset:1024 sc1
    buffer_load_dwordx4 a[56:59], v2, s[16:19], s5 offen offset:2048 sc1
    buffer_load_dwordx4 a[60:63], v2, s[16:19], s5 offen offset:3072 sc1
    s_waitcnt vmcnt(0)
K2_HAVE:
    v_sub_f32 v115, 0, v96
    v_max_f32 v126, v115, v122
    v_sub_f32 v118, v115, v126
    v_sub_f32 v119, v122, v126
    v_exp_f32 v118, v118
    v_exp_f32 v119, v119
    s_nop 0
    v_mul_f32 v119, v119, v123
    v_fma_f32 v126, v118, v104, v119
    v_rcp_f32 v126, v126
    s_nop 0
    v_mul_f32 v126, v126, v9
    v_mul_f32 v116, v118, v126
    v_mul_f32 v122, v119, v126
    v_sub_f32 v115, 0, v100
    v_max_f32 v126, v115, v124
    v_sub_f32 v118, v115, v126
    v_sub_f32 v119, v124, v126
    v_exp_f32 v118, v118
    v_exp_f32 v119, v119
    s_nop 0
    v_mul_f32 v119, v119, v125
    v_fma_f32 v126, v118, v108, v119
    v_rcp_f32 v126, v126
    s_nop 0
    v_mul_f32 v126, v126, v12
    v_mul_f32 v117, v118, v126
    v_mul_f32 v124, v119, v126
    v_accvgpr_read_b32 v16, a0
    v_accvgpr_read_b32 v17, a1
    v_accvgpr_read_b32 v18, a2
    v_accvgpr_read_b32 v19, a3
    v_mul_f32 v128, v128, v116
    v_mul_f32 v129, v129, v116
    v_mul_f32 v130, v130, v116
    v_mul_f32 v131, v131, v116
    v_mul_f32 v136, v136, v116
    v_mul_f32 v137, v137, v116
    v_mul_f32 v138, v138, v116
    v_mul_f32 v139, v139, v116
    v_lshlrev_b32 v80, 16, v16
    v_and_b32 v81, 0xffff0000, v16
    s_add_u32 m0, s36, 0
    s_nop 0
    buffer_load_dwordx4 v10, s[52:55], s64 offen offset:0 lds
    v_lshlrev_b32 v82, 16, v17
    v_and_b32 v83, 0xffff0000, v17
    v_lshlrev_b32 v84, 16, v18
    v_and_b32 v85, 0xffff0000, v18
    v_lshlrev_b32 v86, 16, v19
    v_and_b32 v87, 0xffff0000, v19
    v_fma_f32 v128, v80, v122, v128
    v_fma_f32 v129, v81, v122, v129
    v_fma_f32 v130, v82, v122, v130
    v_fma_f32 v131, v83, v122, v131
    v_fma_f32 v136, v84, v122, v136
    v_fma_f32 v137, v85, v122, v137
    v_fma_f32 v138, v86, v122, v138
    v_fma_f32 v139, v87, v122, v139
    buffer_load_dwordx4 v10, s[52:55], s65 offen offset:1024 lds
    v_cvt_pk_bf16_f32 v16, v128, v129
    v_cvt_pk_bf16_f32 v17, v130, v131
    v_cvt_pk_bf16_f32 v18, v136, v137
    v_cvt_pk_bf16_f32 v19, v138, v139
    v_accvgpr_read_b32 v20, a4
    v_accvgpr_read_b32 v21, a5
    v_accvgpr_read_b32 v22, a6
    v_accvgpr_read_b32 v23, a7
    v_mul_f32 v144, v144, v116
    v_mul_f32 v145, v145, v116
    v_mul_f32 v146, v146, v116
    v_mul_f32 v147, v147, v116
    v_mul_f32 v152, v152, v116
    v_mul_f32 v153, v153, v116
    buffer_load_dwordx4 v10, s[52:55], s66 offen offset:2048 lds
    v_mul_f32 v154, v154, v116
    v_mul_f32 v155, v155, v116
    v_lshlrev_b32 v80, 16, v20
    v_and_b32 v81, 0xffff0000, v20
    v_lshlrev_b32 v82, 16, v21
    v_and_b32 v83, 0xffff0000, v21
    v_lshlrev_b32 v84, 16, v22
    v_and_b32 v85, 0xffff0000, v22
    v_lshlrev_b32 v86, 16, v23
    v_and_b32 v87, 0xffff0000, v23
    v_fma_f32 v144, v80, v122, v144
    v_fma_f32 v145, v81, v122, v145
    v_fma_f32 v146, v82, v122, v146
    v_fma_f32 v147, v83, v122, v147
    buffer_load_dwordx4 v10, s[52:55], s67 offen offset:3072 lds
    v_fma_f32 v152, v84, v122, v152
    v_fma_f32 v153, v85, v122, v153
    v_fma_f32 v154, v86, v122, v154
    v_fma_f32 v155, v87, v122, v155
    v_cvt_pk_bf16_f32 v20, v144, v145
    v_cvt_pk_bf16_f32 v21, v146, v147
    v_cvt_pk_bf16_f32 v22, v152, v153
    v_cvt_pk_bf16_f32 v23, v154, v155
    v_accvgpr_read_b32 v24, a8
    v_accvgpr_read_b32 v25, a9
    v_accvgpr_read_b32 v26, a10
    v_accvgpr_read_b32 v27, a11
    v_mul_f32 v160, v160, v116
    v_mul_f32 v161, v161, v116
    s_add_u32 m0, s36, 4096
    s_nop 0
    buffer_load_dwordx4 v10, s[52:55], s68 offen offset:0 lds
    v_mul_f32 v162, v162, v116
    v_mul_f32 v163, v163, v116
    v_mul_f32 v168, v168, v116
    v_mul_f32 v169, v169, v116
    v_mul_f32 v170, v170, v116
    v_mul_f32 v171, v171, v116
    v_lshlrev_b32 v80, 16, v24
    v_and_b32 v81, 0xffff0000, v24
    v_lshlrev_b32 v82, 16, v25
    v_and_b32 v83, 0xffff0000, v25
    v_lshlrev_b32 v84, 16, v26
    v_and_b32 v85, 0xffff0000, v26
    v_lshlrev_b32 v86, 16, v27
    v_and_b32 v87, 0xffff0000, v27
    buffer_load_dwordx4 v10, s[52:55], s69 offen offset:1024 lds
    v_fma_f32 v160, v80, v122, v160
    v_fma_f32 v161, v81, v122, v161
    v_fma_f32 v162, v82, v122, v162
    v_fma_f32 v163, v83, v122, v163
    v_fma_f32 v168, v84, v122, v168
    v_fma_f32 v169, v85, v122, v169
    v_fma_f32 v170, v86, v122, v170
    v_fma_f32 v171, v87, v122, v171
    v_cvt_pk_bf16_f32 v24, v160, v161
    v_cvt_pk_bf16_f32 v25, v162, v163
    v_cvt_pk_bf16_f32 v26, v168, v169
    v_cvt_pk_bf16_f32 v27, v170, v171
    v_accvgpr_read_b32 v28, a12
    v_accvgpr_read_b32 v29, a13
    buffer_load_dwordx4 v10, s[52:55], s70 offen offset:2048 lds
    v_accvgpr_read_b32 v30, a14
    v_accvgpr_read_b32 v31, a15
    v_mul_f32 v176, v176, v116
    v_mul_f32 v177, v177, v116
    v_mul_f32 v178, v178, v116
    v_mul_f32 v179, v179, v116
    v_mul_f32 v184, v184, v116
    v_mul_f32 v185, v185, v116
    v_mul_f32 v186, v186, v116
    v_mul_f32 v187, v187, v116
    v_lshlrev_b32 v80, 16, v28
    v_and_b32 v81, 0xffff0000, v28
    v_lshlrev_b32 v82, 16, v29
    v_and_b32 v83, 0xffff0000, v29
    buffer_load_dwordx4 v10, s[52:55], s71 offen offset:3072 lds
    v_lshlrev_b32 v84, 16, v30
    v_and_b32 v85, 0xffff0000, v30
    v_lshlrev_b32 v86, 16, v31
    v_and_b32 v87, 0xffff0000, v31
    v_fma_f32 v176, v80, v122, v176
    v_fma_f32 v177, v81, v122, v177
    v_fma_f32 v178, v82, v122, v178
    v_fma_f32 v179, v83, v122, v179
    v_fma_f32 v184, v84, v122, v184
    v_fma_f32 v185, v85, v122, v185
    v_fma_f32 v186, v86, v122, v186
    v_fma_f32 v187, v87, v122, v187
    v_cvt_pk_bf16_f32 v28, v176, v177
    v_cvt_pk_bf16_f32 v29, v178, v179
    s_lshr_b32 s74, s36, 1
    s_add_u32 m0, s74, 32768
    s_nop 0
    buffer_load_dwordx4 v11, s[56:59], s64 offen offset:0 lds
    v_cvt_pk_bf16_f32 v30, v184, v185
    v_cvt_pk_bf16_f32 v31, v186, v187
    v_accvgpr_read_b32 v32, a16
    v_accvgpr_read_b32 v33, a17
    v_accvgpr_read_b32 v34, a18
    v_accvgpr_read_b32 v35, a19
    v_mul_f32 v192, v192, v116
    v_mul_f32 v193, v193, v116
    v_mul_f32 v194, v194, v116
    v_mul_f32 v195, v195, v116
    v_mul_f32 v200, v200, v116
    v_mul_f32 v201, v201, v116
    v_mul_f32 v202, v202, v116
    v_mul_f32 v203, v203, v116
    buffer_load_dwordx4 v11, s[56:59], s65 offen offset:1024 lds
    v_lshlrev_b32 v80, 16, v32
    v_and_b32 v81, 0xffff0000, v32
    v_lshlrev_b32 v82, 16, v33
    v_and_b32 v83, 0xffff0000, v33
    v_lshlrev_b32 v84, 16, v34
    v_and_b32 v85, 0xffff0000, v34
    v_lshlrev_b32 v86, 16, v35
    v_and_b32 v87, 0xffff0000, v35
    v_fma_f32 v192, v80, v122, v192
    v_fma_f32 v193, v81, v122, v193
    v_fma_f32 v194, v82, v122, v194
    v_fma_f32 v195, v83, v122, v195
    v_fma_f32 v200, v84, v122, v200
    v_fma_f32 v201, v85, v122, v201
    buffer_load_dwordx4 v11, s[56:59], s66 offen offset:2048 lds
    v_fma_f32 v202, v86, v122, v202
    v_fma_f32 v203, v87, v122, v203
    v_cvt_pk_bf16_f32 v32, v192, v193
    v_cvt_pk_bf16_f32 v33, v194, v195
    v_cvt_pk_bf16_f32 v34, v200, v201
    v_cvt_pk_bf16_f32 v35, v202, v203
    v_accvgpr_read_b32 v36, a20
    v_accvgpr_read_b32 v37, a21
    v_accvgpr_read_b32 v38, a22
    v_accvgpr_read_b32 v39, a23
    v_mul_f32 v208, v208, v116
    v_mul_f32 v209, v209, v116
    v_mul_f32 v210, v210, v116
    v_mul_f32 v211, v211, v116
    buffer_load_dwordx4 v11, s[56:59], s67 offen offset:3072 lds
    v_add_u32 v10, 128, v10
    v_add_u32 v11, 128, v11
    v_mul_f32 v216, v216, v116
    v_mul_f32 v217, v217, v116
    v_mul_f32 v218, v218, v116
    v_mul_f32 v219, v219, v116
    v_lshlrev_b32 v80, 16, v36
    v_and_b32 v81, 0xffff0000, v36
    v_lshlrev_b32 v82, 16, v37
    v_and_b32 v83, 0xffff0000, v37
    v_lshlrev_b32 v84, 16, v38
    v_and_b32 v85, 0xffff0000, v38
    v_lshlrev_b32 v86, 16, v39
    v_and_b32 v87, 0xffff0000, v39
    v_fma_f32 v208, v80, v122, v208
    v_fma_f32 v209, v81, v122, v209
    buffer_load_dwordx4 a[132:135], v2, s[16:19], s87 offen offset:0
    v_fma_f32 v210, v82, v122, v210
    v_fma_f32 v211, v83, v122, v211
    v_fma_f32 v216, v84, v122, v216
    v_fma_f32 v217, v85, v122, v217
    v_fma_f32 v218, v86, v122, v218
    v_fma_f32 v219, v87, v122, v219
    v_cvt_pk_bf16_f32 v36, v208, v209
    v_cvt_pk_bf16_f32 v37, v210, v211
    v_cvt_pk_bf16_f32 v38, v216, v217
    v_cvt_pk_bf16_f32 v39, v218, v219
    v_accvgpr_read_b32 v40, a24
    v_accvgpr_read_b32 v41, a25
    v_accvgpr_read_b32 v42, a26
    v_accvgpr_read_b32 v43, a27
    buffer_load_dwordx4 a[136:139], v2, s[16:19], s88 offen offset:0
    v_mul_f32 v224, v224, v116
    v_mul_f32 v225, v225, v116
    v_mul_f32 v226, v226, v116
    v_mul_f32 v227, v227, v116
    v_mul_f32 v232, v232, v116
    v_mul_f32 v233, v233, v116
    v_mul_f32 v234, v234, v116
    v_mul_f32 v235, v235, v116
    v_lshlrev_b32 v80, 16, v40
    v_and_b32 v81, 0xffff0000, v40
    v_lshlrev_b32 v82, 16, v41
    v_and_b32 v83, 0xffff0000, v41
    v_lshlrev_b32 v84, 16, v42
    v_and_b32 v85, 0xffff0000, v42
    buffer_load_dwordx4 a[140:143], v2, s[16:19], s87 offen offset:1024
    v_lshlrev_b32 v86, 16, v43
    v_and_b32 v87, 0xffff0000, v43
    v_fma_f32 v224, v80, v122, v224
    v_fma_f32 v225, v81, v122, v225
    v_fma_f32 v226, v82, v122, v226
    v_fma_f32 v227, v83, v122, v227
    v_fma_f32 v232, v84, v122, v232
    v_fma_f32 v233, v85, v122, v233
    v_fma_f32 v234, v86, v122, v234
    v_fma_f32 v235, v87, v122, v235
    v_cvt_pk_bf16_f32 v40, v224, v225
    v_cvt_pk_bf16_f32 v41, v226, v227
    v_cvt_pk_bf16_f32 v42, v232, v233
    v_cvt_pk_bf16_f32 v43, v234, v235
    buffer_load_dwordx4 a[144:147], v2, s[16:19], s88 offen offset:1024
    v_accvgpr_read_b32 v44, a28
    v_accvgpr_read_b32 v45, a29
    v_accvgpr_read_b32 v46, a30
    v_accvgpr_read_b32 v47, a31
    v_mul_f32 v240, v240, v116
    v_mul_f32 v241, v241, v116
    v_mul_f32 v242, v242, v116
    v_mul_f32 v243, v243, v116
    v_mul_f32 v248, v248, v116
    v_mul_f32 v249, v249, v116
    v_mul_f32 v250, v250, v116
    v_mul_f32 v251, v251, v116
    v_lshlrev_b32 v80, 16, v44
    v_and_b32 v81, 0xffff0000, v44
    buffer_load_dwordx4 a[148:151], v2, s[16:19], s87 offen offset:2048
    v_lshlrev_b32 v82, 16, v45
    v_and_b32 v83, 0xffff0000, v45
    v_lshlrev_b32 v84, 16, v46
    v_and_b32 v85, 0xffff0000, v46
    v_lshlrev_b32 v86, 16, v47
    v_and_b32 v87, 0xffff0000, v47
    v_fma_f32 v240, v80, v122, v240
    v_fma_f32 v241, v81, v122, v241
    v_fma_f32 v242, v82, v122, v242
    v_fma_f32 v243, v83, v122, v243
    v_fma_f32 v248, v84, v122, v248
    v_fma_f32 v249, v85, v122, v249
    v_fma_f32 v250, v86, v122, v250
    v_fma_f32 v251, v87, v122, v251
    buffer_load_dwordx4 a[152:155], v2, s[16:19], s88 offen offset:2048
    v_cvt_pk_bf16_f32 v44, v240, v241
    v_cvt_pk_bf16_f32 v45, v242, v243
    v_cvt_pk_bf16_f32 v46, v248, v249
    v_cvt_pk_bf16_f32 v47, v250, v251
    v_accvgpr_read_b32 v48, a32
    v_accvgpr_read_b32 v49, a33
    v_accvgpr_read_b32 v50, a34
    v_accvgpr_read_b32 v51, a35
    v_mul_f32 v132, v132, v117
    v_mul_f32 v133, v133, v117
    v_mul_f32 v134, v134, v117
    v_mul_f32 v135, v135, v117
    v_mul_f32 v140, v140, v117
    v_mul_f32 v141, v141, v117
    buffer_load_dwordx4 a[156:159], v2, s[60:63], s87 offen offset:3072
    v_mul_f32 v142, v142, v117
    v_mul_f32 v143, v143, v117
    v_lshlrev_b32 v80, 16, v48
    v_and_b32 v81, 0xffff0000, v48
    v_lshlrev_b32 v82, 16, v49
    v_and_b32 v83, 0xffff0000, v49
    v_lshlrev_b32 v84, 16, v50
    v_and_b32 v85, 0xffff0000, v50
    v_lshlrev_b32 v86, 16, v51
    v_and_b32 v87, 0xffff0000, v51
    v_fma_f32 v132, v80, v124, v132
    v_fma_f32 v133, v81, v124, v133
    v_fma_f32 v134, v82, v124, v134
    v_fma_f32 v135, v83, v124, v135
    buffer_load_dwordx4 a[160:163], v2, s[60:63], s88 offen offset:3072
    v_fma_f32 v140, v84, v124, v140
    v_fma_f32 v141, v85, v124, v141
    v_fma_f32 v142, v86, v124, v142
    v_fma_f32 v143, v87, v124, v143
    v_cvt_pk_bf16_f32 v48, v132, v133
    v_cvt_pk_bf16_f32 v49, v134, v135
    v_cvt_pk_bf16_f32 v50, v140, v141
    v_cvt_pk_bf16_f32 v51, v142, v143
    v_accvgpr_read_b32 v52, a36
    v_accvgpr_read_b32 v53, a37
    v_accvgpr_read_b32 v54, a38
    v_accvgpr_read_b32 v55, a39
    v_mul_f32 v148, v148, v117
    v_mul_f32 v149, v149, v117
    s_add_u32 m0, s36, 65536
    s_nop 0
    buffer_load_dwordx4 v10, s[52:55], s64 offen offset:0 lds
    v_mul_f32 v150, v150, v117
    v_mul_f32 v151, v151, v117
    v_mul_f32 v156, v156, v117
    v_mul_f32 v157, v157, v117
    v_mul_f32 v158, v158, v117
    v_mul_f32 v159, v159, v117
    v_lshlrev_b32 v80, 16, v52
    v_and_b32 v81, 0xffff0000, v52
    v_lshlrev_b32 v82, 16, v53
    v_and_b32 v83, 0xffff0000, v53
    v_lshlrev_b32 v84, 16, v54
    v_and_b32 v85, 0xffff0000, v54
    v_lshlrev_b32 v86, 16, v55
    v_and_b32 v87, 0xffff0000, v55
    buffer_load_dwordx4 v10, s[52:55], s65 offen offset:1024 lds
    v_fma_f32 v148, v80, v124, v148
    v_fma_f32 v149, v81, v124, v149
    v_fma_f32 v150, v82, v124, v150
    v_fma_f32 v151, v83, v124, v151
    v_fma_f32 v156, v84, v124, v156
    v_fma_f32 v157, v85, v124, v157
    v_fma_f32 v158, v86, v124, v158
    v_fma_f32 v159, v87, v124, v159
    v_cvt_pk_bf16_f32 v52, v148, v149
    v_cvt_pk_bf16_f32 v53, v150, v151
    v_cvt_pk_bf16_f32 v54, v156, v157
    v_cvt_pk_bf16_f32 v55, v158, v159
    v_accvgpr_read_b32 v56, a40
    v_accvgpr_read_b32 v57, a41
    buffer_load_dwordx4 v10, s[52:55], s66 offen offset:2048 lds
    v_accvgpr_read_b32 v58, a42
    v_accvgpr_read_b32 v59, a43
    v_mul_f32 v164, v164, v117
    v_mul_f32 v165, v165, v117
    v_mul_f32 v166, v166, v117
    v_mul_f32 v167, v167, v117
    v_mul_f32 v172, v172, v117
    v_mul_f32 v173, v173, v117
    v_mul_f32 v174, v174, v117
    v_mul_f32 v175, v175, v117
    v_lshlrev_b32 v80, 16, v56
    v_and_b32 v81, 0xffff0000, v56
    v_lshlrev_b32 v82, 16, v57
    v_and_b32 v83, 0xffff0000, v57
    buffer_load_dwordx4 v10, s[52:55], s67 offen offset:3072 lds
    v_lshlrev_b32 v84, 16, v58
    v_and_b32 v85, 0xffff0000, v58
    v_lshlrev_b32 v86, 16, v59
    v_and_b32 v87, 0xffff0000, v59
    v_fma_f32 v164, v80, v124, v164
    v_fma_f32 v165, v81, v124, v165
    v_fma_f32 v166, v82, v124, v166
    v_fma_f32 v167, v83, v124, v167
    v_fma_f32 v172, v84, v124, v172
    v_fma_f32 v173, v85, v124, v173
    v_fma_f32 v174, v86, v124, v174
    v_fma_f32 v175, v87, v124, v175
    v_cvt_pk_bf16_f32 v56, v164, v165
    v_cvt_pk_bf16_f32 v57, v166, v167
    s_add_u32 m0, s36, 69632
    s_nop 0
    buffer_load_dwordx4 v10, s[52:55], s68 offen offset:0 lds
    v_cvt_pk_bf16_f32 v58, v172, v173
    v_cvt_pk_bf16_f32 v59, v174, v175
    v_accvgpr_read_b32 v60, a44
    v_accvgpr_read_b32 v61, a45
    v_accvgpr_read_b32 v62, a46
    v_accvgpr_read_b32 v63, a47
    v_mul_f32 v180, v180, v117
    v_mul_f32 v181, v181, v117
    v_mul_f32 v182, v182, v117
    v_mul_f32 v183, v183, v117
    v_mul_f32 v188, v188, v117
    v_mul_f32 v189, v189, v117
    v_mul_f32 v190, v190, v117
    v_mul_f32 v191, v191, v117
    buffer_load_dwordx4 v10, s[52:55], s69 offen offset:1024 lds
    v_lshlrev_b32 v80, 16, v60
    v_and_b32 v81, 0xffff0000, v60
    v_lshlrev_b32 v82, 16, v61
    v_and_b32 v83, 0xffff0000, v61
    v_lshlrev_b32 v84, 16, v62
    v_and_b32 v85, 0xffff0000, v62
    v_lshlrev_b32 v86, 16, v63
    v_and_b32 v87, 0xffff0000, v63
    v_fma_f32 v180, v80, v124, v180
    v_fma_f32 v181, v81, v124, v181
    v_fma_f32 v182, v82, v124, v182
    v_fma_f32 v183, v83, v124, v183
    v_fma_f32 v188, v84, v124, v188
    v_fma_f32 v189, v85, v124, v189
    buffer_load_dwordx4 v10, s[52:55], s70 offen offset:2048 lds
    v_fma_f32 v190, v86, v124, v190
    v_fma_f32 v191, v87, v124, v191
    v_cvt_pk_bf16_f32 v60, v180, v181
    v_cvt_pk_bf16_f32 v61, v182, v183
    v_cvt_pk_bf16_f32 v62, v188, v189
    v_cvt_pk_bf16_f32 v63, v190, v191
    v_accvgpr_read_b32 v64, a48
    v_accvgpr_read_b32 v65, a49
    v_accvgpr_read_b32 v66, a50
    v_accvgpr_read_b32 v67, a51
    v_mul_f32 v196, v196, v117
    v_mul_f32 v197, v197, v117
    v_mul_f32 v198, v198, v117
    v_mul_f32 v199, v199, v117
    buffer_load_dwordx4 v10, s[52:55], s71 offen offset:3072 lds
    v_mul_f32 v204, v204, v117
    v_mul_f32 v205, v205, v117
    v_mul_f32 v206, v206, v117
    v_mul_f32 v207, v207, v117
    v_lshlrev_b32 v80, 16, v64
    v_and_b32 v81, 0xffff0000, v64
    v_lshlrev_b32 v82, 16, v65
    v_and_b32 v83, 0xffff0000, v65
    v_lshlrev_b32 v84, 16, v66
    v_and_b32 v85, 0xffff0000, v66
    v_lshlrev_b32 v86, 16, v67
    v_and_b32 v87, 0xffff0000, v67
    v_fma_f32 v196, v80, v124, v196
    v_fma_f32 v197, v81, v124, v197
    s_lshr_b32 s74, s36, 1
    s_add_u32 m0, s74, 98304
    s_nop 0
    buffer_load_dwordx4 v11, s[56:59], s64 offen offset:0 lds
    v_fma_f32 v198, v82, v124, v198
    v_fma_f32 v199, v83, v124, v199
    v_fma_f32 v204, v84, v124, v204
    v_fma_f32 v205, v85, v124, v205
    v_fma_f32 v206, v86, v124, v206
    v_fma_f32 v207, v87, v124, v207
    v_cvt_pk_bf16_f32 v64, v196, v197
    v_cvt_pk_bf16_f32 v65, v198, v199
    v_cvt_pk_bf16_f32 v66, v204, v205
    v_cvt_pk_bf16_f32 v67, v206, v207
    v_accvgpr_read_b32 v68, a52
    v_accvgpr_read_b32 v69, a53
    v_accvgpr_read_b32 v70, a54
    v_accvgpr_read_b32 v71, a55
    buffer_load_dwordx4 v11, s[56:59], s65 offen offset:1024 lds
    v_mul_f32 v212, v212, v117
    v_mul_f32 v213, v213, v117
    v_mul_f32 v214, v214, v117
    v_mul_f32 v215, v215, v117
    v_mul_f32 v220, v220, v117
    v_mul_f32 v221, v221, v117
    v_mul_f32 v222, v222, v117
    v_mul_f32 v223, v223, v117
    v_lshlrev_b32 v80, 16, v68
    v_and_b32 v81, 0xffff0000, v68
    v_lshlrev_b32 v82, 16, v69
    v_and_b32 v83, 0xffff0000, v69
    v_lshlrev_b32 v84, 16, v70
    v_and_b32 v85, 0xffff0000, v70
    buffer_load_dwordx4 v11, s[56:59], s66 offen offset:2048 lds
    v_lshlrev_b32 v86, 16, v71
    v_and_b32 v87, 0xffff0000, v71
    v_fma_f32 v212, v80, v124, v212
    v_fma_f32 v213, v81, v124, v213
    v_fma_f32 v214, v82, v124, v214
    v_fma_f32 v215, v83, v124, v215
    v_fma_f32 v220, v84, v124, v220
    v_fma_f32 v221, v85, v124, v221
    v_fma_f32 v222, v86, v124, v222
    v_fma_f32 v223, v87, v124, v223
    v_cvt_pk_bf16_f32 v68, v212, v213
    v_cvt_pk_bf16_f32 v69, v214, v215
    v_cvt_pk_bf16_f32 v70, v220, v221
    v_cvt_pk_bf16_f32 v71, v222, v223
    buffer_load_dwordx4 v11, s[56:59], s67 offen offset:3072 lds
    v_add_u32 v10, 128, v10
    v_add_u32 v11, 128, v11
    v_accvgpr_read_b32 v72, a56
    v_accvgpr_read_b32 v73, a57
    v_accvgpr_read_b32 v74, a58
    v_accvgpr_read_b32 v75, a59
    v_mul_f32 v228, v228, v117
    v_mul_f32 v229, v229, v117
    v_mul_f32 v230, v230, v117
    v_mul_f32 v231, v231, v117
    v_mul_f32 v236, v236, v117
    v_mul_f32 v237, v237, v117
    v_mul_f32 v238, v238, v117
    v_mul_f32 v239, v239, v117
    v_lshlrev_b32 v80, 16, v72
    v_and_b32 v81, 0xffff0000, v72
    v_lshlrev_b32 v82, 16, v73
    v_and_b32 v83, 0xffff0000, v73
    v_lshlrev_b32 v84, 16, v74
    v_and_b32 v85, 0xffff0000, v74
    v_lshlrev_b32 v86, 16, v75
    v_and_b32 v87, 0xffff0000, v75
    v_fma_f32 v228, v80, v124, v228
    v_fma_f32 v229, v81, v124, v229
    v_fma_f32 v230, v82, v124, v230
    v_fma_f32 v231, v83, v124, v231
    v_fma_f32 v236, v84, v124, v236
    v_fma_f32 v237, v85, v124, v237
    v_fma_f32 v238, v86, v124, v238
    v_fma_f32 v239, v87, v124, v239
    v_cvt_pk_bf16_f32 v72, v228, v229
    v_cvt_pk_bf16_f32 v73, v230, v231
    v_cvt_pk_bf16_f32 v74, v236, v237
    v_cvt_pk_bf16_f32 v75, v238, v239
    v_accvgpr_read_b32 v76, a60
    v_accvgpr_read_b32 v77, a61
    v_accvgpr_read_b32 v78, a62
    v_accvgpr_read_b32 v79, a63
    v_mul_f32 v244, v244, v117
    v_mul_f32 v245, v245, v117
    v_mul_f32 v246, v246, v117
    v_mul_f32 v247, v247, v117
    v_mul_f32 v252, v252, v117
    v_mul_f32 v253, v253, v117
    v_mul_f32 v254, v254, v117
    v_mul_f32 v255, v255, v117
    v_lshlrev_b32 v80, 16, v76
    v_and_b32 v81, 0xffff0000, v76
    v_lshlrev_b32 v82, 16, v77
    v_and_b32 v83, 0xffff0000, v77
    v_lshlrev_b32 v84, 16, v78
    v_and_b32 v85, 0xffff0000, v78
    v_lshlrev_b32 v86, 16, v79
    v_and_b32 v87, 0xffff0000, v79
    v_fma_f32 v244, v80, v124, v244
    v_fma_f32 v245, v81, v124, v245
    v_fma_f32 v246, v82, v124, v246
    v_fma_f32 v247, v83, v124, v247
    v_fma_f32 v252, v84, v124, v252
    v_fma_f32 v253, v85, v124, v253
    v_fma_f32 v254, v86, v124, v254
    v_fma_f32 v255, v87, v124, v255
    v_cvt_pk_bf16_f32 v76, v244, v245
    v_cvt_pk_bf16_f32 v77, v246, v247
    v_cvt_pk_bf16_f32 v78, v252, v253
    v_cvt_pk_bf16_f32 v79, v254, v255
K2_OUTPROJ:
    s_waitcnt vmcnt(12)
    v_sub_f32 v116, 1.0, v9
    v_sub_f32 v117, 1.0, v12
    v_accvgpr_read_b32 v120, a132
    v_lshlrev_b32 v121, 16, v120
    v_and_b32 v120, 0xffff0000, v120
    v_mul_f32 v121, v121, v116
    v_mul_f32 v120, v120, v116
    v_cvt_pk_bf16_f32 v80, v121, v120
    v_accvgpr_read_b32 v120, a133
    v_lshlrev_b32 v121, 16, v120
    v_and_b32 v120, 0xffff0000, v120
    v_mul_f32 v121, v121, v116
    v_mul_f32 v120, v120, v116
    v_cvt_pk_bf16_f32 v81, v121, v120
    v_accvgpr_read_b32 v120, a134
    v_lshlrev_b32 v121, 16, v120
    v_and_b32 v120, 0xffff0000, v120
    v_mul_f32 v121, v121, v116
    v_mul_f32 v120, v120, v116
    v_cvt_pk_bf16_f32 v82, v121, v120
    v_accvgpr_read_b32 v120, a135
    v_lshlrev_b32 v121, 16, v120
    v_and_b32 v120, 0xffff0000, v120
    v_mul_f32 v121, v121, v116
    v_mul_f32 v120, v120, v116
    v_cvt_pk_bf16_f32 v83, v121, v120
    v_accvgpr_read_b32 v120, a136
    v_lshlrev_b32 v121, 16, v120
    v_and_b32 v120, 0xffff0000, v120
    v_mul_f32 v121, v121, v117
    v_mul_f32 v120, v120, v117
    v_cvt_pk_bf16_f32 v84, v121, v120
    v_accvgpr_read_b32 v120, a137
    v_lshlrev_b32 v121, 16, v120
    v_and_b32 v120, 0xffff0000, v120
    v_mul_f32 v121, v121, v117
    v_mul_f32 v120, v120, v117
    v_cvt_pk_bf16_f32 v85, v121, v120
    v_accvgpr_read_b32 v120, a138
    v_lshlrev_b32 v121, 16, v120
    v_and_b32 v120, 0xffff0000, v120
    v_mul_f32 v121, v121, v117
    v_mul_f32 v120, v120, v117
    v_cvt_pk_bf16_f32 v86, v121, v120
    v_accvgpr_read_b32 v120, a139
    v_lshlrev_b32 v121, 16, v120
    v_and_b32 v120, 0xffff0000, v120
    v_mul_f32 v121, v121, v117
    v_mul_f32 v120, v120, v117
    v_cvt_pk_bf16_f32 v87, v121, v120
    v_accvgpr_read_b32 v120, a140
    v_lshlrev_b32 v121, 16, v120
    v_and_b32 v120, 0xffff0000, v120
    v_mul_f32 v121, v121, v116
    v_mul_f32 v120, v120, v116
    v_cvt_pk_bf16_f32 v88, v121, v120
    v_accvgpr_read_b32 v120, a141
    v_lshlrev_b32 v121, 16, v120
    v_and_b32 v120, 0xffff0000, v120
    v_mul_f32 v121, v121, v116
    v_mul_f32 v120, v120, v116
    v_cvt_pk_bf16_f32 v89, v121, v120
    v_accvgpr_read_b32 v120, a142
    v_lshlrev_b32 v121, 16, v120
    v_and_b32 v120, 0xffff0000, v120
    v_mul_f32 v121, v121, v116
    v_mul_f32 v120, v120, v116
    v_cvt_pk_bf16_f32 v90, v121, v120
    v_accvgpr_read_b32 v120, a143
    v_lshlrev_b32 v121, 16, v120
    v_and_b32 v120, 0xffff0000, v120
    v_mul_f32 v121, v121, v116
    v_mul_f32 v120, v120, v116
    v_cvt_pk_bf16_f32 v91, v121, v120
    v_accvgpr_read_b32 v120, a144
    v_lshlrev_b32 v121, 16, v120
    v_and_b32 v120, 0xffff0000, v120
    v_mul_f32 v121, v121, v117
    v_mul_f32 v120, v120, v117
    v_cvt_pk_bf16_f32 v92, v121, v120
    v_accvgpr_read_b32 v120, a145
    v_lshlrev_b32 v121, 16, v120
    v_and_b32 v120, 0xffff0000, v120
    v_mul_f32 v121, v121, v117
    v_mul_f32 v120, v120, v117
    v_cvt_pk_bf16_f32 v93, v121, v120
    v_accvgpr_read_b32 v120, a146
    v_lshlrev_b32 v121, 16, v120
    v_and_b32 v120, 0xffff0000, v120
    v_mul_f32 v121, v121, v117
    v_mul_f32 v120, v120, v117
    v_cvt_pk_bf16_f32 v94, v121, v120
    v_accvgpr_read_b32 v120, a147
    v_lshlrev_b32 v121, 16, v120
    v_and_b32 v120, 0xffff0000, v120
    v_mul_f32 v121, v121, v117
    v_mul_f32 v120, v120, v117
    v_cvt_pk_bf16_f32 v95, v121, v120
    v_accvgpr_read_b32 v120, a148
    v_lshlrev_b32 v121, 16, v120
    v_and_b32 v120, 0xffff0000, v120
    v_mul_f32 v121, v121, v116
    v_mul_f32 v120, v120, v116
    v_cvt_pk_bf16_f32 v96, v121, v120
    v_accvgpr_read_b32 v120, a149
    v_lshlrev_b32 v121, 16, v120
    v_and_b32 v120, 0xffff0000, v120
    v_mul_f32 v121, v121, v116
    v_mul_f32 v120, v120, v116
    v_cvt_pk_bf16_f32 v97, v121, v120
    v_accvgpr_read_b32 v120, a150
    v_lshlrev_b32 v121, 16, v120
    v_and_b32 v120, 0xffff0000, v120
    v_mul_f32 v121, v121, v116
    v_mul_f32 v120, v120, v116
    v_cvt_pk_bf16_f32 v98, v121, v120
    v_accvgpr_read_b32 v120, a151
    v_lshlrev_b32 v121, 16, v120
    v_and_b32 v120, 0xffff0000, v120
    v_mul_f32 v121, v121, v116
    v_mul_f32 v120, v120, v116
    v_cvt_pk_bf16_f32 v99, v121, v120
    v_accvgpr_read_b32 v120, a152
    v_lshlrev_b32 v121, 16, v120
    v_and_b32 v120, 0xffff0000, v120
    v_mul_f32 v121, v121, v117
    v_mul_f32 v120, v120, v117
    v_cvt_pk_bf16_f32 v100, v121, v120
    v_accvgpr_read_b32 v120, a153
    v_lshlrev_b32 v121, 16, v120
    v_and_b32 v120, 0xffff0000, v120
    v_mul_f32 v121, v121, v117
    v_mul_f32 v120, v120, v117
    v_cvt_pk_bf16_f32 v101, v121, v120
    v_accvgpr_read_b32 v120, a154
    v_lshlrev_b32 v121, 16, v120
    v_and_b32 v120, 0xffff0000, v120
    v_mul_f32 v121, v121, v117
    v_mul_f32 v120, v120, v117
    v_cvt_pk_bf16_f32 v102, v121, v120
    v_accvgpr_read_b32 v120, a155
    v_lshlrev_b32 v121, 16, v120
    v_and_b32 v120, 0xffff0000, v120
    v_mul_f32 v121, v121, v117
    v_mul_f32 v120, v120, v117
    v_cvt_pk_bf16_f32 v103, v121, v120
    v_accvgpr_read_b32 v120, a156
    v_lshlrev_b32 v121, 16, v120
    v_and_b32 v120, 0xffff0000, v120
    v_mul_f32 v121, v121, v116
    v_mul_f32 v120, v120, v116
    v_cvt_pk_bf16_f32 v104, v121, v120
    v_accvgpr_read_b32 v120, a157
    v_lshlrev_b32 v121, 16, v120
    v_and_b32 v120, 0xffff0000, v120
    v_mul_f32 v121, v121, v116
    v_mul_f32 v120, v120, v116
    v_cvt_pk_bf16_f32 v105, v121, v120
    v_accvgpr_read_b32 v120, a158
    v_lshlrev_b32 v121, 16, v120
    v_and_b32 v120, 0xffff0000, v120
    v_mul_f32 v121, v121, v116
    v_mul_f32 v120, v120, v116
    v_cvt_pk_bf16_f32 v106, v121, v120
    v_accvgpr_read_b32 v120, a159
    v_lshlrev_b32 v121, 16, v120
    v_and_b32 v120, 0xffff0000, v120
    v_mul_f32 v121, v121, v116
    v_mul_f32 v120, v120, v116
    v_cvt_pk_bf16_f32 v107, v121, v120
    v_accvgpr_read_b32 v120, a160
    v_lshlrev_b32 v121, 16, v120
    v_and_b32 v120, 0xffff0000, v120
    v_mul_f32 v121, v121, v117
    v_mul_f32 v120, v120, v117
    v_cvt_pk_bf16_f32 v108, v121, v120
    v_accvgpr_read_b32 v120, a161
    v_lshlrev_b32 v121, 16, v120
    v_and_b32 v120, 0xffff0000, v120
    v_mul_f32 v121, v121, v117
    v_mul_f32 v120, v120, v117
    v_cvt_pk_bf16_f32 v109, v121, v120
    v_accvgpr_read_b32 v120, a162
    v_lshlrev_b32 v121, 16, v120
    v_and_b32 v120, 0xffff0000, v120
    v_mul_f32 v121, v121, v117
    v_mul_f32 v120, v120, v117
    v_cvt_pk_bf16_f32 v110, v121, v120
    v_accvgpr_read_b32 v120, a163
    v_lshlrev_b32 v121, 16, v120
    v_and_b32 v120, 0xffff0000, v120
    v_mul_f32 v121, v121, v117
    v_mul_f32 v120, v120, v117
    v_cvt_pk_bf16_f32 v111, v121, v120
    v_lshrrev_b32 v112, 2, v1
    v_lshlrev_b32 v113, 7, v112
    v_and_b32 v114, 3, v1
    v_lshl_add_u32 v113, v114, 3, v113
    v_lshrrev_b32 v112, 1, v112
    v_and_b32 v112, 3, v112
    v_xor_b32 v114, 0, v112
    v_lshl_add_u32 v208, v114, 5, v113
    v_add_u32 v212, 0x10000, v208
    v_xor_b32 v114, 1, v112
    v_lshl_add_u32 v209, v114, 5, v113
    v_add_u32 v213, 0x10000, v209
    v_xor_b32 v114, 2, v112
    v_lshl_add_u32 v210, v114, 5, v113
    v_add_u32 v214, 0x10000, v210
    v_xor_b32 v114, 3, v112
    v_lshl_add_u32 v211, v114, 5, v113
    v_add_u32 v215, 0x10000, v211
    s_lshl_b32 s4, s27, 2
    s_add_u32 s4, s4, s3
    s_mul_i32 s4, s4, 448
    s_add_u32 s4, s4, s24
    s_lshl_b32 s4, s4, 10
    s_add_u32 s72, s4, 100663296
    s_mov_b32 s73, 0
    s_waitcnt vmcnt(12)
    s_barrier
    ds_read_b64_tr_b16 a[68:69], v208 offset:32768
    ds_read_b64_tr_b16 a[70:71], v208 offset:34816
    ds_read_b64_tr_b16 a[72:73], v208 offset:36864
    ds_read_b64_tr_b16 a[74:75], v208 offset:38912
    ds_read_b64_tr_b16 a[76:77], v208 offset:40960
    ds_read_b64_tr_b16 a[78:79], v208 offset:43008
    ds_read_b64_tr_b16 a[80:81], v208 offset:45056
    ds_read_b64_tr_b16 a[82:83], v208 offset:47104
    ds_read_b64_tr_b16 a[84:85], v208 offset:0
    ds_read_b64_tr_b16 a[86:87], v208 offset:2048
    ds_read_b64_tr_b16 a[88:89], v208 offset:4096
    ds_read_b64_tr_b16 a[90:91], v208 offset:6144
    ds_read_b64_tr_b16 a[92:93], v208 offset:8192
    ds_read_b64_tr_b16 a[94:95], v208 offset:10240
    ds_read_b64_tr_b16 a[96:97], v208 offset:12288
    ds_read_b64_tr_b16 a[98:99], v208 offset:14336
    s_waitcnt lgkmcnt(0)
    v_mfma_f32_16x16x32_bf16 v[128:131], a[68:71], v[80:83], 0
    ds_read_b64_tr_b16 a[100:101], v208 offset:16384
    ds_read_b64_tr_b16 a[102:103], v208 offset:18432
    v_mfma_f32_16x16x32_bf16 v[132:135], a[68:71], v[84:87], 0
    ds_read_b64_tr_b16 a[104:105], v208 offset:20480
    ds_read_b64_tr_b16 a[106:107], v208 offset:22528
    v_mfma_f32_16x16x32_bf16 v[128:131], a[72:75], v[88:91], v[128:131]
    v_mfma_f32_16x16x32_bf16 v[132:135], a[72:75], v[92:95], v[132:135]
    ds_read_b64_tr_b16 a[108:109], v208 offset:24576
    ds_read_b64_tr_b16 a[110:111], v208 offset:26624
    v_mfma_f32_16x16x32_bf16 v[128:131], a[76:79], v[96:99], v[128:131]
    v_mfma_f32_16x16x32_bf16 v[132:135], a[76:79], v[100:103], v[132:135]
    ds_read_b64_tr_b16 a[112:113], v208 offset:28672
    ds_read_b64_tr_b16 a[114:115], v208 offset:30720
    v_mfma_f32_16x16x32_bf16 v[128:131], a[80:83], v[104:107], v[128:131]
    v_mfma_f32_16x16x32_bf16 v[132:135], a[80:83], v[108:111], v[132:135]
    ds_read_b64_tr_b16 a[116:117], v209 offset:32768
    ds_read_b64_tr_b16 a[118:119], v209 offset:34816
    v_mfma_f32_16x16x32_bf16 v[128:131], a[84:87], v[16:19], v[128:131]
    v_mfma_f32_16x16x32_bf16 v[132:135], a[84:87], v[48:51], v[132:135]
    ds_read_b64_tr_b16 a[120:121], v209 offset:36864
    ds_read_b64_tr_b16 a[122:123], v209 offset:38912
    v_mfma_f32_16x16x32_bf16 v[128:131], a[88:91], v[20:23], v[128:131]
    v_mfma_f32_16x16x32_bf16 v[132:135], a[88:91], v[52:55], v[132:135]
    ds_read_b64_tr_b16 a[124:125], v209 offset:40960
    ds_read_b64_tr_b16 a[126:127], v209 offset:43008
    v_mfma_f32_16x16x32_bf16 v[128:131], a[92:95], v[24:27], v[128:131]
    ds_read_b64_tr_b16 a[128:129], v209 offset:45056
    ds_read_b64_tr_b16 a[130:131], v209 offset:47104
    v_mfma_f32_16x16x32_bf16 v[132:135], a[92:95], v[56:59], v[132:135]
    v_mfma_f32_16x16x32_bf16 v[128:131], a[96:99], v[28:31], v[128:131]
    ds_read_b64_tr_b16 a[68:69], v209 offset:0
    ds_read_b64_tr_b16 a[70:71], v209 offset:2048
    v_mfma_f32_16x16x32_bf16 v[132:135], a[96:99], v[60:63], v[132:135]
    s_waitcnt lgkmcnt(4)
    v_mfma_f32_16x16x32_bf16 v[128:131], a[100:103], v[32:35], v[128:131]
    ds_read_b64_tr_b16 a[72:73], v209 offset:4096
    ds_read_b64_tr_b16 a[74:75], v209 offset:6144
    v_mfma_f32_16x16x32_bf16 v[132:135], a[100:103], v[64:67], v[132:135]
    v_mfma_f32_16x16x32_bf16 v[128:131], a[104:107], v[36:39], v[128:131]
    ds_read_b64_tr_b16 a[76:77], v209 offset:8192
    ds_read_b64_tr_b16 a[78:79], v209 offset:10240
    v_mfma_f32_16x16x32_bf16 v[132:135], a[104:107], v[68:71], v[132:135]
    v_mfma_f32_16x16x32_bf16 v[128:131], a[108:111], v[40:43], v[128:131]
    ds_read_b64_tr_b16 a[80:81], v209 offset:12288
    ds_read_b64_tr_b16 a[82:83], v209 offset:14336
    v_mfma_f32_16x16x32_bf16 v[132:135], a[108:111], v[72:75], v[132:135]
    v_mfma_f32_16x16x32_bf16 v[128:131], a[112:115], v[44:47], v[128:131]
    ds_read_b64_tr_b16 a[84:85], v209 offset:16384
    ds_read_b64_tr_b16 a[86:87], v209 offset:18432
    v_mfma_f32_16x16x32_bf16 v[132:135], a[112:115], v[76:79], v[132:135]
    v_mfma_f32_16x16x32_bf16 v[136:139], a[116:119], v[80:83], 0
    ds_read_b64_tr_b16 a[88:89], v209 offset:20480
    ds_read_b64_tr_b16 a[90:91], v209 offset:22528
    v_mfma_f32_16x16x32_bf16 v[140:143], a[116:119], v[84:87], 0
    ds_read_b64_tr_b16 a[92:93], v209 offset:24576
    ds_read_b64_tr_b16 a[94:95], v209 offset:26624
    v_mfma_f32_16x16x32_bf16 v[136:139], a[120:123], v[88:91], v[136:139]
    v_mfma_f32_16x16x32_bf16 v[140:143], a[120:123], v[92:95], v[140:143]
    ds_read_b64_tr_b16 a[96:97], v209 offset:28672
    ds_read_b64_tr_b16 a[98:99], v209 offset:30720
    v_mfma_f32_16x16x32_bf16 v[136:139], a[124:127], v[96:99], v[136:139]
    v_mfma_f32_16x16x32_bf16 v[140:143], a[124:127], v[100:103], v[140:143]
    ds_read_b64_tr_b16 a[100:101], v210 offset:32768
    ds_read_b64_tr_b16 a[102:103], v210 offset:34816
    s_waitcnt lgkmcnt(4)
    v_mfma_f32_16x16x32_bf16 v[136:139], a[128:131], v[104:107], v[136:139]
    v_mfma_f32_16x16x32_bf16 v[140:143], a[128:131], v[108:111], v[140:143]
    ds_read_b64_tr_b16 a[104:105], v210 offset:36864
    ds_read_b64_tr_b16 a[106:107], v210 offset:38912
    v_mfma_f32_16x16x32_bf16 v[136:139], a[68:71], v[16:19], v[136:139]
    v_mfma_f32_16x16x32_bf16 v[140:143], a[68:71], v[48:51], v[140:143]
    ds_read_b64_tr_b16 a[108:109], v210 offset:40960
    ds_read_b64_tr_b16 a[110:111], v210 offset:43008
    v_mfma_f32_16x16x32_bf16 v[136:139], a[72:75], v[20:23], v[136:139]
    v_mfma_f32_16x16x32_bf16 v[140:143], a[72:75], v[52:55], v[140:143]
    ds_read_b64_tr_b16 a[112:113], v210 offset:45056
    ds_read_b64_tr_b16 a[114:115], v210 offset:47104
    v_mfma_f32_16x16x32_bf16 v[136:139], a[76:79], v[24:27], v[136:139]
    v_mfma_f32_16x16x32_bf16 v[140:143], a[76:79], v[56:59], v[140:143]
    ds_read_b64_tr_b16 a[116:117], v210 offset:0
    ds_read_b64_tr_b16 a[118:119], v210 offset:2048
    v_mfma_f32_16x16x32_bf16 v[136:139], a[80:83], v[28:31], v[136:139]
    ds_read_b64_tr_b16 a[120:121], v210 offset:4096
    ds_read_b64_tr_b16 a[122:123], v210 offset:6144
    v_mfma_f32_16x16x32_bf16 v[140:143], a[80:83], v[60:63], v[140:143]
    v_mfma_f32_16x16x32_bf16 v[136:139], a[84:87], v[32:35], v[136:139]
    ds_read_b64_tr_b16 a[124:125], v210 offset:8192
    ds_read_b64_tr_b16 a[126:127], v210 offset:10240
    v_mfma_f32_16x16x32_bf16 v[140:143], a[84:87], v[64:67], v[140:143]
    v_mfma_f32_16x16x32_bf16 v[136:139], a[88:91], v[36:39], v[136:139]
    ds_read_b64_tr_b16 a[128:129], v210 offset:12288
    ds_read_b64_tr_b16 a[130:131], v210 offset:14336
    v_mfma_f32_16x16x32_bf16 v[140:143], a[88:91], v[68:71], v[140:143]
    v_mfma_f32_16x16x32_bf16 v[136:139], a[92:95], v[40:43], v[136:139]
    ds_read_b64_tr_b16 a[68:69], v210 offset:16384
    ds_read_b64_tr_b16 a[70:71], v210 offset:18432
    v_mfma_f32_16x16x32_bf16 v[140:143], a[92:95], v[72:75], v[140:143]
    s_waitcnt lgkmcnt(4)
    v_mfma_f32_16x16x32_bf16 v[136:139], a[96:99], v[44:47], v[136:139]
    ds_read_b64_tr_b16 a[72:73], v210 offset:20480
    ds_read_b64_tr_b16 a[74:75], v210 offset:22528
    v_mfma_f32_16x16x32_bf16 v[140:143], a[96:99], v[76:79], v[140:143]
    v_mfma_f32_16x16x32_bf16 v[144:147], a[100:103], v[80:83], 0
    ds_read_b64_tr_b16 a[76:77], v210 offset:24576
    ds_read_b64_tr_b16 a[78:79], v210 offset:26624
    v_mfma_f32_16x16x32_bf16 v[148:151], a[100:103], v[84:87], 0
    ds_read_b64_tr_b16 a[80:81], v210 offset:28672
    ds_read_b64_tr_b16 a[82:83], v210 offset:30720
    v_mfma_f32_16x16x32_bf16 v[144:147], a[104:107], v[88:91], v[144:147]
    v_mfma_f32_16x16x32_bf16 v[148:151], a[104:107], v[92:95], v[148:151]
    ds_read_b64_tr_b16 a[84:85], v211 offset:32768
    ds_read_b64_tr_b16 a[86:87], v211 offset:34816
    v_mfma_f32_16x16x32_bf16 v[144:147], a[108:111], v[96:99], v[144:147]
    v_mfma_f32_16x16x32_bf16 v[148:151], a[108:111], v[100:103], v[148:151]
    ds_read_b64_tr_b16 a[88:89], v211 offset:36864
    ds_read_b64_tr_b16 a[90:91], v211 offset:38912
    v_mfma_f32_16x16x32_bf16 v[144:147], a[112:115], v[104:107], v[144:147]
    v_mfma_f32_16x16x32_bf16 v[148:151], a[112:115], v[108:111], v[148:151]
    ds_read_b64_tr_b16 a[92:93], v211 offset:40960
    ds_read_b64_tr_b16 a[94:95], v211 offset:43008
    v_mfma_f32_16x16x32_bf16 v[144:147], a[116:119], v[16:19], v[144:147]
    v_mfma_f32_16x16x32_bf16 v[148:151], a[116:119], v[48:51], v[148:151]
    ds_read_b64_tr_b16 a[96:97], v211 offset:45056
    ds_read_b64_tr_b16 a[98:99], v211 offset:47104
    v_mfma_f32_16x16x32_bf16 v[144:147], a[120:123], v[20:23], v[144:147]
    v_mfma_f32_16x16x32_bf16 v[148:151], a[120:123], v[52:55], v[148:151]
    ds_read_b64_tr_b16 a[100:101], v211 offset:0
    ds_read_b64_tr_b16 a[102:103], v211 offset:2048
    v_mfma_f32_16x16x32_bf16 v[144:147], a[124:127], v[24:27], v[144:147]
    v_mfma_f32_16x16x32_bf16 v[148:151], a[124:127], v[56:59], v[148:151]
    ds_read_b64_tr_b16 a[104:105], v211 offset:4096
    ds_read_b64_tr_b16 a[106:107], v211 offset:6144
    s_waitcnt lgkmcnt(4)
    v_mfma_f32_16x16x32_bf16 v[144:147], a[128:131], v[28:31], v[144:147]
    ds_read_b64_tr_b16 a[108:109], v211 offset:8192
    ds_read_b64_tr_b16 a[110:111], v211 offset:10240
    v_mfma_f32_16x16x32_bf16 v[148:151], a[128:131], v[60:63], v[148:151]
    v_mfma_f32_16x16x32_bf16 v[144:147], a[68:71], v[32:35], v[144:147]
    ds_read_b64_tr_b16 a[112:113], v211 offset:12288
    ds_read_b64_tr_b16 a[114:115], v211 offset:14336
    v_mfma_f32_16x16x32_bf16 v[148:151], a[68:71], v[64:67], v[148:151]
    v_mfma_f32_16x16x32_bf16 v[144:147], a[72:75], v[36:39], v[144:147]
    ds_read_b64_tr_b16 a[116:117], v211 offset:16384
    ds_read_b64_tr_b16 a[118:119], v211 offset:18432
    v_mfma_f32_16x16x32_bf16 v[148:151], a[72:75], v[68:71], v[148:151]
    v_mfma_f32_16x16x32_bf16 v[144:147], a[76:79], v[40:43], v[144:147]
    ds_read_b64_tr_b16 a[120:121], v211 offset:20480
    ds_read_b64_tr_b16 a[122:123], v211 offset:22528
    v_mfma_f32_16x16x32_bf16 v[148:151], a[76:79], v[72:75], v[148:151]
    v_mfma_f32_16x16x32_bf16 v[144:147], a[80:83], v[44:47], v[144:147]
    ds_read_b64_tr_b16 a[124:125], v211 offset:24576
    ds_read_b64_tr_b16 a[126:127], v211 offset:26624
    v_mfma_f32_16x16x32_bf16 v[148:151], a[80:83], v[76:79], v[148:151]
    v_mfma_f32_16x16x32_bf16 v[152:155], a[84:87], v[80:83], 0
    ds_read_b64_tr_b16 a[128:129], v211 offset:28672
    ds_read_b64_tr_b16 a[130:131], v211 offset:30720
    v_mfma_f32_16x16x32_bf16 v[156:159], a[84:87], v[84:87], 0
    v_mfma_f32_16x16x32_bf16 v[152:155], a[88:91], v[88:91], v[152:155]
    v_mfma_f32_16x16x32_bf16 v[156:159], a[88:91], v[92:95], v[156:159]
    v_mfma_f32_16x16x32_bf16 v[152:155], a[92:95], v[96:99], v[152:155]
    v_mfma_f32_16x16x32_bf16 v[156:159], a[92:95], v[100:103], v[156:159]
    v_mfma_f32_16x16x32_bf16 v[152:155], a[96:99], v[104:107], v[152:155]
    v_mfma_f32_16x16x32_bf16 v[156:159], a[96:99], v[108:111], v[156:159]
    s_waitcnt lgkmcnt(0)
    v_mfma_f32_16x16x32_bf16 v[152:155], a[100:103], v[16:19], v[152:155]
    s_waitcnt vmcnt(0) lgkmcnt(0)
    s_barrier
    v_mfma_f32_16x16x32_bf16 v[156:159], a[100:103], v[48:51], v[156:159]
    ds_read_b64_tr_b16 a[68:69], v212 offset:32768
    ds_read_b64_tr_b16 a[70:71], v212 offset:34816
    v_mfma_f32_16x16x32_bf16 v[152:155], a[104:107], v[20:23], v[152:155]
    ds_read_b64_tr_b16 a[72:73], v212 offset:36864
    v_mfma_f32_16x16x32_bf16 v[156:159], a[104:107], v[52:55], v[156:159]
    ds_read_b64_tr_b16 a[74:75], v212 offset:38912
    v_mfma_f32_16x16x32_bf16 v[152:155], a[108:111], v[24:27], v[152:155]
    ds_read_b64_tr_b16 a[76:77], v212 offset:40960
    v_mfma_f32_16x16x32_bf16 v[156:159], a[108:111], v[56:59], v[156:159]
    ds_read_b64_tr_b16 a[78:79], v212 offset:43008
    v_mfma_f32_16x16x32_bf16 v[152:155], a[112:115], v[28:31], v[152:155]
    ds_read_b64_tr_b16 a[80:81], v212 offset:45056
    v_mfma_f32_16x16x32_bf16 v[156:159], a[112:115], v[60:63], v[156:159]
    ds_read_b64_tr_b16 a[82:83], v212 offset:47104
    v_mfma_f32_16x16x32_bf16 v[152:155], a[116:119], v[32:35], v[152:155]
    ds_read_b64_tr_b16 a[84:85], v212 offset:0
    ds_read_b64_tr_b16 a[86:87], v212 offset:2048
    v_mfma_f32_16x16x32_bf16 v[156:159], a[116:119], v[64:67], v[156:159]
    ds_read_b64_tr_b16 a[88:89], v212 offset:4096
    v_mfma_f32_16x16x32_bf16 v[152:155], a[120:123], v[36:39], v[152:155]
    ds_read_b64_tr_b16 a[90:91], v212 offset:6144
    v_mfma_f32_16x16x32_bf16 v[156:159], a[120:123], v[68:71], v[156:159]
    ds_read_b64_tr_b16 a[92:93], v212 offset:8192
    v_mfma_f32_16x16x32_bf16 v[152:155], a[124:127], v[40:43], v[152:155]
    ds_read_b64_tr_b16 a[94:95], v212 offset:10240
    v_mfma_f32_16x16x32_bf16 v[156:159], a[124:127], v[72:75], v[156:159]
    ds_read_b64_tr_b16 a[96:97], v212 offset:12288
    v_mfma_f32_16x16x32_bf16 v[152:155], a[128:131], v[44:47], v[152:155]
    ds_read_b64_tr_b16 a[98:99], v212 offset:14336
    v_mfma_f32_16x16x32_bf16 v[156:159], a[128:131], v[76:79], v[156:159]
    s_add_u32 s73, s73, 1
K2_OLOOP:
    s_waitcnt lgkmcnt(0)
    v_mfma_f32_16x16x32_bf16 v[160:163], a[68:71], v[80:83], 0
    ds_read_b64_tr_b16 a[100:101], v212 offset:16384
    ds_read_b64_tr_b16 a[102:103], v212 offset:18432
    v_mfma_f32_16x16x32_bf16 v[164:167], a[68:71], v[84:87], 0
    ds_read_b64_tr_b16 a[104:105], v212 offset:20480
    ds_read_b64_tr_b16 a[106:107], v212 offset:22528
    s_cmp_lt_u32 s73, 6
    s_cselect_b32 s54, s76, 0
    s_cselect_b32 s58, s77, 0
    v_mfma_f32_16x16x32_bf16 v[160:163], a[72:75], v[88:91], v[160:163]
    s_add_u32 m0, s36, 0
    v_mfma_f32_16x16x32_bf16 v[164:167], a[72:75], v[92:95], v[164:167]
    ds_read_b64_tr_b16 a[108:109], v212 offset:24576
    ds_read_b64_tr_b16 a[110:111], v212 offset:26624
    v_mfma_f32_16x16x32_bf16 v[160:163], a[76:79], v[96:99], v[160:163]
    buffer_load_dwordx4 v10, s[52:55], s64 offen offset:0 lds
    v_mfma_f32_16x16x32_bf16 v[164:167], a[76:79], v[100:103], v[164:167]
    ds_read_b64_tr_b16 a[112:113], v212 offset:28672
    ds_read_b64_tr_b16 a[114:115], v212 offset:30720
    v_mfma_f32_16x16x32_bf16 v[160:163], a[80:83], v[104:107], v[160:163]
    buffer_load_dwordx4 v10, s[52:55], s65 offen offset:1024 lds
    v_mfma_f32_16x16x32_bf16 v[164:167], a[80:83], v[108:111], v[164:167]
    ds_read_b64_tr_b16 a[116:117], v213 offset:32768
    ds_read_b64_tr_b16 a[118:119], v213 offset:34816
    v_mfma_f32_16x16x32_bf16 v[160:163], a[84:87], v[16:19], v[160:163]
    buffer_load_dwordx4 v10, s[52:55], s66 offen offset:2048 lds
    v_mfma_f32_16x16x32_bf16 v[164:167], a[84:87], v[48:51], v[164:167]
    ds_read_b64_tr_b16 a[120:121], v213 offset:36864
    ds_read_b64_tr_b16 a[122:123], v213 offset:38912
    v_mfma_f32_16x16x32_bf16 v[160:163], a[88:91], v[20:23], v[160:163]
    buffer_load_dwordx4 v10, s[52:55], s67 offen offset:3072 lds
    v_mfma_f32_16x16x32_bf16 v[164:167], a[88:91], v[52:55], v[164:167]
    ds_read_b64_tr_b16 a[124:125], v213 offset:40960
    ds_read_b64_tr_b16 a[126:127], v213 offset:43008
    v_mfma_f32_16x16x32_bf16 v[160:163], a[92:95], v[24:27], v[160:163]
    ds_read_b64_tr_b16 a[128:129], v213 offset:45056
    ds_read_b64_tr_b16 a[130:131], v213 offset:47104
    v_mfma_f32_16x16x32_bf16 v[164:167], a[92:95], v[56:59], v[164:167]
    s_add_u32 m0, s36, 4096
    v_cvt_pk_bf16_f32 v192, v128, v129
    v_mfma_f32_16x16x32_bf16 v[160:163], a[96:99], v[28:31], v[160:163]
    ds_read_b64_tr_b16 a[68:69], v213 offset:0
    ds_read_b64_tr_b16 a[70:71], v213 offset:2048
    v_mfma_f32_16x16x32_bf16 v[164:167], a[96:99], v[60:63], v[164:167]
    buffer_load_dwordx4 v10, s[52:55], s68 offen offset:0 lds
    s_waitcnt lgkmcnt(4)
    v_mfma_f32_16x16x32_bf16 v[160:163], a[100:103], v[32:35], v[160:163]
    ds_read_b64_tr_b16 a[72:73], v213 offset:4096
    ds_read_b64_tr_b16 a[74:75], v213 offset:6144
    v_mfma_f32_16x16x32_bf16 v[164:167], a[100:103], v[64:67], v[164:167]
    buffer_load_dwordx4 v10, s[52:55], s69 offen offset:1024 lds
    v_mfma_f32_16x16x32_bf16 v[160:163], a[104:107], v[36:39], v[160:163]
    ds_read_b64_tr_b16 a[76:77], v213 offset:8192
    ds_read_b64_tr_b16 a[78:79], v213 offset:10240
    v_mfma_f32_16x16x32_bf16 v[164:167], a[104:107], v[68:71], v[164:167]
    buffer_load_dwordx4 v10, s[52:55], s70 offen offset:2048 lds
    v_mfma_f32_16x16x32_bf16 v[160:163], a[108:111], v[40:43], v[160:163]
    ds_read_b64_tr_b16 a[80:81], v213 offset:12288
    ds_read_b64_tr_b16 a[82:83], v213 offset:14336
    v_mfma_f32_16x16x32_bf16 v[164:167], a[108:111], v[72:75], v[164:167]
    buffer_load_dwordx4 v10, s[52:55], s71 offen offset:3072 lds
    v_mfma_f32_16x16x32_bf16 v[160:163], a[112:115], v[44:47], v[160:163]
    ds_read_b64_tr_b16 a[84:85], v213 offset:16384
    ds_read_b64_tr_b16 a[86:87], v213 offset:18432
    v_mfma_f32_16x16x32_bf16 v[164:167], a[112:115], v[76:79], v[164:167]
    s_lshr_b32 s74, s36, 1
    s_add_u32 m0, s74, 32768
    v_mfma_f32_16x16x32_bf16 v[168:171], a[116:119], v[80:83], 0
    ds_read_b64_tr_b16 a[88:89], v213 offset:20480
    ds_read_b64_tr_b16 a[90:91], v213 offset:22528
    v_mfma_f32_16x16x32_bf16 v[172:175], a[116:119], v[84:87], 0
    ds_read_b64_tr_b16 a[92:93], v213 offset:24576
    ds_read_b64_tr_b16 a[94:95], v213 offset:26624
    v_mfma_f32_16x16x32_bf16 v[168:171], a[120:123], v[88:91], v[168:171]
    buffer_load_dwordx4 v11, s[56:59], s64 offen offset:0 lds
    v_mfma_f32_16x16x32_bf16 v[172:175], a[120:123], v[92:95], v[172:175]
    ds_read_b64_tr_b16 a[96:97], v213 offset:28672
    ds_read_b64_tr_b16 a[98:99], v213 offset:30720
    v_mfma_f32_16x16x32_bf16 v[168:171], a[124:127], v[96:99], v[168:171]
    buffer_load_dwordx4 v11, s[56:59], s65 offen offset:1024 lds
    v_mfma_f32_16x16x32_bf16 v[172:175], a[124:127], v[100:103], v[172:175]
    ds_read_b64_tr_b16 a[100:101], v214 offset:32768
    ds_read_b64_tr_b16 a[102:103], v214 offset:34816
    s_waitcnt lgkmcnt(4)
    v_mfma_f32_16x16x32_bf16 v[168:171], a[128:131], v[104:107], v[168:171]
    buffer_load_dwordx4 v11, s[56:59], s66 offen offset:2048 lds
    v_mfma_f32_16x16x32_bf16 v[172:175], a[128:131], v[108:111], v[172:175]
    ds_read_b64_tr_b16 a[104:105], v214 offset:36864
    ds_read_b64_tr_b16 a[106:107], v214 offset:38912
    v_mfma_f32_16x16x32_bf16 v[168:171], a[68:71], v[16:19], v[168:171]
    buffer_load_dwordx4 v11, s[56:59], s67 offen offset:3072 lds
    v_mfma_f32_16x16x32_bf16 v[172:175], a[68:71], v[48:51], v[172:175]
    ds_read_b64_tr_b16 a[108:109], v214 offset:40960
    ds_read_b64_tr_b16 a[110:111], v214 offset:43008
    v_mfma_f32_16x16x32_bf16 v[168:171], a[72:75], v[20:23], v[168:171]
    v_add_u32 v10, 128, v10
    v_add_u32 v11, 128, v11
    v_mfma_f32_16x16x32_bf16 v[172:175], a[72:75], v[52:55], v[172:175]
    ds_read_b64_tr_b16 a[112:113], v214 offset:45056
    ds_read_b64_tr_b16 a[114:115], v214 offset:47104
    v_mfma_f32_16x16x32_bf16 v[168:171], a[76:79], v[24:27], v[168:171]
    v_cvt_pk_bf16_f32 v193, v130, v131
    v_cvt_pk_bf16_f32 v194, v132, v133
    v_mfma_f32_16x16x32_bf16 v[172:175], a[76:79], v[56:59], v[172:175]
    ds_read_b64_tr_b16 a[116:117], v214 offset:0
    ds_read_b64_tr_b16 a[118:119], v214 offset:2048
    v_mfma_f32_16x16x32_bf16 v[168:171], a[80:83], v[28:31], v[168:171]
    ds_read_b64_tr_b16 a[120:121], v214 offset:4096
    ds_read_b64_tr_b16 a[122:123], v214 offset:6144
    v_mfma_f32_16x16x32_bf16 v[172:175], a[80:83], v[60:63], v[172:175]
    v_cvt_pk_bf16_f32 v195, v134, v135
    v_cvt_pk_bf16_f32 v196, v136, v137
    v_mfma_f32_16x16x32_bf16 v[168:171], a[84:87], v[32:35], v[168:171]
    ds_read_b64_tr_b16 a[124:125], v214 offset:8192
    ds_read_b64_tr_b16 a[126:127], v214 offset:10240
    v_mfma_f32_16x16x32_bf16 v[172:175], a[84:87], v[64:67], v[172:175]
    v_cvt_pk_bf16_f32 v197, v138, v139
    v_cvt_pk_bf16_f32 v198, v140, v141
    v_mfma_f32_16x16x32_bf16 v[168:171], a[88:91], v[36:39], v[168:171]
    ds_read_b64_tr_b16 a[128:129], v214 offset:12288
    ds_read_b64_tr_b16 a[130:131], v214 offset:14336
    v_mfma_f32_16x16x32_bf16 v[172:175], a[88:91], v[68:71], v[172:175]
    v_cvt_pk_bf16_f32 v199, v142, v143
    v_cvt_pk_bf16_f32 v200, v144, v145
    v_mfma_f32_16x16x32_bf16 v[168:171], a[92:95], v[40:43], v[168:171]
    ds_read_b64_tr_b16 a[68:69], v214 offset:16384
    ds_read_b64_tr_b16 a[70:71], v214 offset:18432
    v_mfma_f32_16x16x32_bf16 v[172:175], a[92:95], v[72:75], v[172:175]
    v_cvt_pk_bf16_f32 v201, v146, v147
    v_cvt_pk_bf16_f32 v202, v148, v149
    s_waitcnt lgkmcnt(4)
    v_mfma_f32_16x16x32_bf16 v[168:171], a[96:99], v[44:47], v[168:171]
    ds_read_b64_tr_b16 a[72:73], v214 offset:20480
    ds_read_b64_tr_b16 a[74:75], v214 offset:22528
    v_mfma_f32_16x16x32_bf16 v[172:175], a[96:99], v[76:79], v[172:175]
    v_cvt_pk_bf16_f32 v203, v150, v151
    v_cvt_pk_bf16_f32 v204, v152, v153
    v_mfma_f32_16x16x32_bf16 v[176:179], a[100:103], v[80:83], 0
    ds_read_b64_tr_b16 a[76:77], v214 offset:24576
    ds_read_b64_tr_b16 a[78:79], v214 offset:26624
    v_mfma_f32_16x16x32_bf16 v[180:183], a[100:103], v[84:87], 0
    ds_read_b64_tr_b16 a[80:81], v214 offset:28672
    ds_read_b64_tr_b16 a[82:83], v214 offset:30720
    v_mfma_f32_16x16x32_bf16 v[176:179], a[104:107], v[88:91], v[176:179]
    v_cvt_pk_bf16_f32 v205, v154, v155
    v_cvt_pk_bf16_f32 v206, v156, v157
    v_mfma_f32_16x16x32_bf16 v[180:183], a[104:107], v[92:95], v[180:183]
    ds_read_b64_tr_b16 a[84:85], v215 offset:32768
    ds_read_b64_tr_b16 a[86:87], v215 offset:34816
    v_mfma_f32_16x16x32_bf16 v[176:179], a[108:111], v[96:99], v[176:179]
    v_cvt_pk_bf16_f32 v207, v158, v159
    v_mfma_f32_16x16x32_bf16 v[180:183], a[108:111], v[100:103], v[180:183]
    ds_read_b64_tr_b16 a[88:89], v215 offset:36864
    ds_read_b64_tr_b16 a[90:91], v215 offset:38912
    v_mfma_f32_16x16x32_bf16 v[176:179], a[112:115], v[104:107], v[176:179]
    s_add_u32 s75, s72, 0
    v_mfma_f32_16x16x32_bf16 v[180:183], a[112:115], v[108:111], v[180:183]
    ds_read_b64_tr_b16 a[92:93], v215 offset:40960
    ds_read_b64_tr_b16 a[94:95], v215 offset:43008
    v_mfma_f32_16x16x32_bf16 v[176:179], a[116:119], v[16:19], v[176:179]
    buffer_store_dwordx4 v[192:195], v2, s[16:19], s75 offen sc1
    v_mfma_f32_16x16x32_bf16 v[180:183], a[116:119], v[48:51], v[180:183]
    ds_read_b64_tr_b16 a[96:97], v215 offset:45056
    ds_read_b64_tr_b16 a[98:99], v215 offset:47104
    v_mfma_f32_16x16x32_bf16 v[176:179], a[120:123], v[20:23], v[176:179]
    s_add_u32 s75, s72, 16384
    v_mfma_f32_16x16x32_bf16 v[180:183], a[120:123], v[52:55], v[180:183]
    ds_read_b64_tr_b16 a[100:101], v215 offset:0
    ds_read_b64_tr_b16 a[102:103], v215 offset:2048
    v_mfma_f32_16x16x32_bf16 v[176:179], a[124:127], v[24:27], v[176:179]
    buffer_store_dwordx4 v[196:199], v2, s[16:19], s75 offen sc1
    v_mfma_f32_16x16x32_bf16 v[180:183], a[124:127], v[56:59], v[180:183]
    ds_read_b64_tr_b16 a[104:105], v215 offset:4096
    ds_read_b64_tr_b16 a[106:107], v215 offset:6144
    s_waitcnt lgkmcnt(4)
    v_mfma_f32_16x16x32_bf16 v[176:179], a[128:131], v[28:31], v[176:179]
    ds_read_b64_tr_b16 a[108:109], v215 offset:8192
    ds_read_b64_tr_b16 a[110:111], v215 offset:10240
    v_mfma_f32_16x16x32_bf16 v[180:183], a[128:131], v[60:63], v[180:183]
    s_add_u32 s75, s72, 32768
    v_mfma_f32_16x16x32_bf16 v[176:179], a[68:71], v[32:35], v[176:179]
    ds_read_b64_tr_b16 a[112:113], v215 offset:12288
    ds_read_b64_tr_b16 a[114:115], v215 offset:14336
    v_mfma_f32_16x16x32_bf16 v[180:183], a[68:71], v[64:67], v[180:183]
    buffer_store_dwordx4 v[200:203], v2, s[16:19], s75 offen sc1
    v_mfma_f32_16x16x32_bf16 v[176:179], a[72:75], v[36:39], v[176:179]
    ds_read_b64_tr_b16 a[116:117], v215 offset:16384
    ds_read_b64_tr_b16 a[118:119], v215 offset:18432
    v_mfma_f32_16x16x32_bf16 v[180:183], a[72:75], v[68:71], v[180:183]
    s_add_u32 s75, s72, 49152
    v_mfma_f32_16x16x32_bf16 v[176:179], a[76:79], v[40:43], v[176:179]
    ds_read_b64_tr_b16 a[120:121], v215 offset:20480
    ds_read_b64_tr_b16 a[122:123], v215 offset:22528
    v_mfma_f32_16x16x32_bf16 v[180:183], a[76:79], v[72:75], v[180:183]
    buffer_store_dwordx4 v[204:207], v2, s[16:19], s75 offen sc1
    v_mfma_f32_16x16x32_bf16 v[176:179], a[80:83], v[44:47], v[176:179]
    ds_read_b64_tr_b16 a[124:125], v215 offset:24576
    ds_read_b64_tr_b16 a[126:127], v215 offset:26624
    v_mfma_f32_16x16x32_bf16 v[180:183], a[80:83], v[76:79], v[180:183]
    s_add_u32 s72, s72, 65536
    v_mfma_f32_16x16x32_bf16 v[184:187], a[84:87], v[80:83], 0
    ds_read_b64_tr_b16 a[128:129], v215 offset:28672
    ds_read_b64_tr_b16 a[130:131], v215 offset:30720
    v_mfma_f32_16x16x32_bf16 v[188:191], a[84:87], v[84:87], 0
    v_mfma_f32_16x16x32_bf16 v[184:187], a[88:91], v[88:91], v[184:187]
    v_mfma_f32_16x16x32_bf16 v[188:191], a[88:91], v[92:95], v[188:191]
    v_mfma_f32_16x16x32_bf16 v[184:187], a[92:95], v[96:99], v[184:187]
    v_mfma_f32_16x16x32_bf16 v[188:191], a[92:95], v[100:103], v[188:191]
    v_mfma_f32_16x16x32_bf16 v[184:187], a[96:99], v[104:107], v[184:187]
    v_mfma_f32_16x16x32_bf16 v[188:191], a[96:99], v[108:111], v[188:191]
    s_waitcnt lgkmcnt(0)
    v_mfma_f32_16x16x32_bf16 v[184:187], a[100:103], v[16:19], v[184:187]
    s_waitcnt vmcnt(4) lgkmcnt(0)
    s_barrier
    v_mfma_f32_16x16x32_bf16 v[188:191], a[100:103], v[48:51], v[188:191]
    ds_read_b64_tr_b16 a[68:69], v208 offset:32768
    ds_read_b64_tr_b16 a[70:71], v208 offset:34816
    v_mfma_f32_16x16x32_bf16 v[184:187], a[104:107], v[20:23], v[184:187]
    ds_read_b64_tr_b16 a[72:73], v208 offset:36864
    v_mfma_f32_16x16x32_bf16 v[188:191], a[104:107], v[52:55], v[188:191]
    ds_read_b64_tr_b16 a[74:75], v208 offset:38912
    v_mfma_f32_16x16x32_bf16 v[184:187], a[108:111], v[24:27], v[184:187]
    ds_read_b64_tr_b16 a[76:77], v208 offset:40960
    v_mfma_f32_16x16x32_bf16 v[188:191], a[108:111], v[56:59], v[188:191]
    ds_read_b64_tr_b16 a[78:79], v208 offset:43008
    v_mfma_f32_16x16x32_bf16 v[184:187], a[112:115], v[28:31], v[184:187]
    ds_read_b64_tr_b16 a[80:81], v208 offset:45056
    v_mfma_f32_16x16x32_bf16 v[188:191], a[112:115], v[60:63], v[188:191]
    ds_read_b64_tr_b16 a[82:83], v208 offset:47104
    v_mfma_f32_16x16x32_bf16 v[184:187], a[116:119], v[32:35], v[184:187]
    ds_read_b64_tr_b16 a[84:85], v208 offset:0
    ds_read_b64_tr_b16 a[86:87], v208 offset:2048
    v_mfma_f32_16x16x32_bf16 v[188:191], a[116:119], v[64:67], v[188:191]
    ds_read_b64_tr_b16 a[88:89], v208 offset:4096
    v_mfma_f32_16x16x32_bf16 v[184:187], a[120:123], v[36:39], v[184:187]
    ds_read_b64_tr_b16 a[90:91], v208 offset:6144
    v_mfma_f32_16x16x32_bf16 v[188:191], a[120:123], v[68:71], v[188:191]
    ds_read_b64_tr_b16 a[92:93], v208 offset:8192
    v_mfma_f32_16x16x32_bf16 v[184:187], a[124:127], v[40:43], v[184:187]
    ds_read_b64_tr_b16 a[94:95], v208 offset:10240
    v_mfma_f32_16x16x32_bf16 v[188:191], a[124:127], v[72:75], v[188:191]
    ds_read_b64_tr_b16 a[96:97], v208 offset:12288
    v_mfma_f32_16x16x32_bf16 v[184:187], a[128:131], v[44:47], v[184:187]
    ds_read_b64_tr_b16 a[98:99], v208 offset:14336
    v_mfma_f32_16x16x32_bf16 v[188:191], a[128:131], v[76:79], v[188:191]
    s_add_u32 s73, s73, 1
    s_waitcnt lgkmcnt(0)
    v_mfma_f32_16x16x32_bf16 v[128:131], a[68:71], v[80:83], 0
    ds_read_b64_tr_b16 a[100:101], v208 offset:16384
    ds_read_b64_tr_b16 a[102:103], v208 offset:18432
    v_mfma_f32_16x16x32_bf16 v[132:135], a[68:71], v[84:87], 0
    ds_read_b64_tr_b16 a[104:105], v208 offset:20480
    ds_read_b64_tr_b16 a[106:107], v208 offset:22528
    s_cmp_lt_u32 s73, 6
    s_cselect_b32 s54, s76, 0
    s_cselect_b32 s58, s77, 0
    v_mfma_f32_16x16x32_bf16 v[128:131], a[72:75], v[88:91], v[128:131]
    s_add_u32 m0, s36, 65536
    v_mfma_f32_16x16x32_bf16 v[132:135], a[72:75], v[92:95], v[132:135]
    ds_read_b64_tr_b16 a[108:109], v208 offset:24576
    ds_read_b64_tr_b16 a[110:111], v208 offset:26624
    v_mfma_f32_16x16x32_bf16 v[128:131], a[76:79], v[96:99], v[128:131]
    buffer_load_dwordx4 v10, s[52:55], s64 offen offset:0 lds
    v_mfma_f32_16x16x32_bf16 v[132:135], a[76:79], v[100:103], v[132:135]
    ds_read_b64_tr_b16 a[112:113], v208 offset:28672
    ds_read_b64_tr_b16 a[114:115], v208 offset:30720
    v_mfma_f32_16x16x32_bf16 v[128:131], a[80:83], v[104:107], v[128:131]
    buffer_load_dwordx4 v10, s[52:55], s65 offen offset:1024 lds
    v_mfma_f32_16x16x32_bf16 v[132:135], a[80:83], v[108:111], v[132:135]
    ds_read_b64_tr_b16 a[116:117], v209 offset:32768
    ds_read_b64_tr_b16 a[118:119], v209 offset:34816
    v_mfma_f32_16x16x32_bf16 v[128:131], a[84:87], v[16:19], v[128:131]
    buffer_load_dwordx4 v10, s[52:55], s66 offen offset:2048 lds
    v_mfma_f32_16x16x32_bf16 v[132:135], a[84:87], v[48:51], v[132:135]
    ds_read_b64_tr_b16 a[120:121], v209 offset:36864
    ds_read_b64_tr_b16 a[122:123], v209 offset:38912
    v_mfma_f32_16x16x32_bf16 v[128:131], a[88:91], v[20:23], v[128:131]
    buffer_load_dwordx4 v10, s[52:55], s67 offen offset:3072 lds
    v_mfma_f32_16x16x32_bf16 v[132:135], a[88:91], v[52:55], v[132:135]
    ds_read_b64_tr_b16 a[124:125], v209 offset:40960
    ds_read_b64_tr_b16 a[126:127], v209 offset:43008
    v_mfma_f32_16x16x32_bf16 v[128:131], a[92:95], v[24:27], v[128:131]
    ds_read_b64_tr_b16 a[128:129], v209 offset:45056
    ds_read_b64_tr_b16 a[130:131], v209 offset:47104
    v_mfma_f32_16x16x32_bf16 v[132:135], a[92:95], v[56:59], v[132:135]
    s_add_u32 m0, s36, 69632
    v_cvt_pk_bf16_f32 v192, v160, v161
    v_mfma_f32_16x16x32_bf16 v[128:131], a[96:99], v[28:31], v[128:131]
    ds_read_b64_tr_b16 a[68:69], v209 offset:0
    ds_read_b64_tr_b16 a[70:71], v209 offset:2048
    v_mfma_f32_16x16x32_bf16 v[132:135], a[96:99], v[60:63], v[132:135]
    buffer_load_dwordx4 v10, s[52:55], s68 offen offset:0 lds
    s_waitcnt lgkmcnt(4)
    v_mfma_f32_16x16x32_bf16 v[128:131], a[100:103], v[32:35], v[128:131]
    ds_read_b64_tr_b16 a[72:73], v209 offset:4096
    ds_read_b64_tr_b16 a[74:75], v209 offset:6144
    v_mfma_f32_16x16x32_bf16 v[132:135], a[100:103], v[64:67], v[132:135]
    buffer_load_dwordx4 v10, s[52:55], s69 offen offset:1024 lds
    v_mfma_f32_16x16x32_bf16 v[128:131], a[104:107], v[36:39], v[128:131]
    ds_read_b64_tr_b16 a[76:77], v209 offset:8192
    ds_read_b64_tr_b16 a[78:79], v209 offset:10240
    v_mfma_f32_16x16x32_bf16 v[132:135], a[104:107], v[68:71], v[132:135]
    buffer_load_dwordx4 v10, s[52:55], s70 offen offset:2048 lds
    v_mfma_f32_16x16x32_bf16 v[128:131], a[108:111], v[40:43], v[128:131]
    ds_read_b64_tr_b16 a[80:81], v209 offset:12288
    ds_read_b64_tr_b16 a[82:83], v209 offset:14336
    v_mfma_f32_16x16x32_bf16 v[132:135], a[108:111], v[72:75], v[132:135]
    buffer_load_dwordx4 v10, s[52:55], s71 offen offset:3072 lds
    v_mfma_f32_16x16x32_bf16 v[128:131], a[112:115], v[44:47], v[128:131]
    ds_read_b64_tr_b16 a[84:85], v209 offset:16384
    ds_read_b64_tr_b16 a[86:87], v209 offset:18432
    v_mfma_f32_16x16x32_bf16 v[132:135], a[112:115], v[76:79], v[132:135]
    s_lshr_b32 s74, s36, 1
    s_add_u32 m0, s74, 98304
    v_mfma_f32_16x16x32_bf16 v[136:139], a[116:119], v[80:83], 0
    ds_read_b64_tr_b16 a[88:89], v209 offset:20480
    ds_read_b64_tr_b16 a[90:91], v209 offset:22528
    v_mfma_f32_16x16x32_bf16 v[140:143], a[116:119], v[84:87], 0
    ds_read_b64_tr_b16 a[92:93], v209 offset:24576
    ds_read_b64_tr_b16 a[94:95], v209 offset:26624
    v_mfma_f32_16x16x32_bf16 v[136:139], a[120:123], v[88:91], v[136:139]
    buffer_load_dwordx4 v11, s[56:59], s64 offen offset:0 lds
    v_mfma_f32_16x16x32_bf16 v[140:143], a[120:123], v[92:95], v[140:143]
    ds_read_b64_tr_b16 a[96:97], v209 offset:28672
    ds_read_b64_tr_b16 a[98:99], v209 offset:30720
    v_mfma_f32_16x16x32_bf16 v[136:139], a[124:127], v[96:99], v[136:139]
    buffer_load_dwordx4 v11, s[56:59], s65 offen offset:1024 lds
    v_mfma_f32_16x16x32_bf16 v[140:143], a[124:127], v[100:103], v[140:143]
    ds_read_b64_tr_b16 a[100:101], v210 offset:32768
    ds_read_b64_tr_b16 a[102:103], v210 offset:34816
    s_waitcnt lgkmcnt(4)
    v_mfma_f32_16x16x32_bf16 v[136:139], a[128:131], v[104:107], v[136:139]
    buffer_load_dwordx4 v11, s[56:59], s66 offen offset:2048 lds
    v_mfma_f32_16x16x32_bf16 v[140:143], a[128:131], v[108:111], v[140:143]
    ds_read_b64_tr_b16 a[104:105], v210 offset:36864
    ds_read_b64_tr_b16 a[106:107], v210 offset:38912
    v_mfma_f32_16x16x32_bf16 v[136:139], a[68:71], v[16:19], v[136:139]
    buffer_load_dwordx4 v11, s[56:59], s67 offen offset:3072 lds
    v_mfma_f32_16x16x32_bf16 v[140:143], a[68:71], v[48:51], v[140:143]
    ds_read_b64_tr_b16 a[108:109], v210 offset:40960
    ds_read_b64_tr_b16 a[110:111], v210 offset:43008
    v_mfma_f32_16x16x32_bf16 v[136:139], a[72:75], v[20:23], v[136:139]
    v_add_u32 v10, 128, v10
    v_add_u32 v11, 128, v11
    v_mfma_f32_16x16x32_bf16 v[140:143], a[72:75], v[52:55], v[140:143]
    ds_read_b64_tr_b16 a[112:113], v210 offset:45056
    ds_read_b64_tr_b16 a[114:115], v210 offset:47104
    v_mfma_f32_16x16x32_bf16 v[136:139], a[76:79], v[24:27], v[136:139]
    v_cvt_pk_bf16_f32 v193, v162, v163
    v_cvt_pk_bf16_f32 v194, v164, v165
    v_mfma_f32_16x16x32_bf16 v[140:143], a[76:79], v[56:59], v[140:143]
    ds_read_b64_tr_b16 a[116:117], v210 offset:0
    ds_read_b64_tr_b16 a[118:119], v210 offset:2048
    v_mfma_f32_16x16x32_bf16 v[136:139], a[80:83], v[28:31], v[136:139]
    ds_read_b64_tr_b16 a[120:121], v210 offset:4096
    ds_read_b64_tr_b16 a[122:123], v210 offset:6144
    v_mfma_f32_16x16x32_bf16 v[140:143], a[80:83], v[60:63], v[140:143]
    v_cvt_pk_bf16_f32 v195, v166, v167
    v_cvt_pk_bf16_f32 v196, v168, v169
    v_mfma_f32_16x16x32_bf16 v[136:139], a[84:87], v[32:35], v[136:139]
    ds_read_b64_tr_b16 a[124:125], v210 offset:8192
    ds_read_b64_tr_b16 a[126:127], v210 offset:10240
    v_mfma_f32_16x16x32_bf16 v[140:143], a[84:87], v[64:67], v[140:143]
    v_cvt_pk_bf16_f32 v197, v170, v171
    v_cvt_pk_bf16_f32 v198, v172, v173
    v_mfma_f32_16x16x32_bf16 v[136:139], a[88:91], v[36:39], v[136:139]
    ds_read_b64_tr_b16 a[128:129], v210 offset:12288
    ds_read_b64_tr_b16 a[130:131], v210 offset:14336
    v_mfma_f32_16x16x32_bf16 v[140:143], a[88:91], v[68:71], v[140:143]
    v_cvt_pk_bf16_f32 v199, v174, v175
    v_cvt_pk_bf16_f32 v200, v176, v177
    v_mfma_f32_16x16x32_bf16 v[136:139], a[92:95], v[40:43], v[136:139]
    ds_read_b64_tr_b16 a[68:69], v210 offset:16384
    ds_read_b64_tr_b16 a[70:71], v210 offset:18432
    v_mfma_f32_16x16x32_bf16 v[140:143], a[92:95], v[72:75], v[140:143]
    v_cvt_pk_bf16_f32 v201, v178, v179
    v_cvt_pk_bf16_f32 v202, v180, v181
    s_waitcnt lgkmcnt(4)
    v_mfma_f32_16x16x32_bf16 v[136:139], a[96:99], v[44:47], v[136:139]
    ds_read_b64_tr_b16 a[72:73], v210 offset:20480
    ds_read_b64_tr_b16 a[74:75], v210 offset:22528
    v_mfma_f32_16x16x32_bf16 v[140:143], a[96:99], v[76:79], v[140:143]
    v_cvt_pk_bf16_f32 v203, v182, v183
    v_cvt_pk_bf16_f32 v204, v184, v185
    v_mfma_f32_16x16x32_bf16 v[144:147], a[100:103], v[80:83], 0
    ds_read_b64_tr_b16 a[76:77], v210 offset:24576
    ds_read_b64_tr_b16 a[78:79], v210 offset:26624
    v_mfma_f32_16x16x32_bf16 v[148:151], a[100:103], v[84:87], 0
    ds_read_b64_tr_b16 a[80:81], v210 offset:28672
    ds_read_b64_tr_b16 a[82:83], v210 offset:30720
    v_mfma_f32_16x16x32_bf16 v[144:147], a[104:107], v[88:91], v[144:147]
    v_cvt_pk_bf16_f32 v205, v186, v187
    v_cvt_pk_bf16_f32 v206, v188, v189
    v_mfma_f32_16x16x32_bf16 v[148:151], a[104:107], v[92:95], v[148:151]
    ds_read_b64_tr_b16 a[84:85], v211 offset:32768
    ds_read_b64_tr_b16 a[86:87], v211 offset:34816
    v_mfma_f32_16x16x32_bf16 v[144:147], a[108:111], v[96:99], v[144:147]
    v_cvt_pk_bf16_f32 v207, v190, v191
    v_mfma_f32_16x16x32_bf16 v[148:151], a[108:111], v[100:103], v[148:151]
    ds_read_b64_tr_b16 a[88:89], v211 offset:36864
    ds_read_b64_tr_b16 a[90:91], v211 offset:38912
    v_mfma_f32_16x16x32_bf16 v[144:147], a[112:115], v[104:107], v[144:147]
    s_add_u32 s75, s72, 0
    v_mfma_f32_16x16x32_bf16 v[148:151], a[112:115], v[108:111], v[148:151]
    ds_read_b64_tr_b16 a[92:93], v211 offset:40960
    ds_read_b64_tr_b16 a[94:95], v211 offset:43008
    v_mfma_f32_16x16x32_bf16 v[144:147], a[116:119], v[16:19], v[144:147]
    buffer_store_dwordx4 v[192:195], v2, s[16:19], s75 offen sc1
    v_mfma_f32_16x16x32_bf16 v[148:151], a[116:119], v[48:51], v[148:151]
    ds_read_b64_tr_b16 a[96:97], v211 offset:45056
    ds_read_b64_tr_b16 a[98:99], v211 offset:47104
    v_mfma_f32_16x16x32_bf16 v[144:147], a[120:123], v[20:23], v[144:147]
    s_add_u32 s75, s72, 16384
    v_mfma_f32_16x16x32_bf16 v[148:151], a[120:123], v[52:55], v[148:151]
    ds_read_b64_tr_b16 a[100:101], v211 offset:0
    ds_read_b64_tr_b16 a[102:103], v211 offset:2048
    v_mfma_f32_16x16x32_bf16 v[144:147], a[124:127], v[24:27], v[144:147]
    buffer_store_dwordx4 v[196:199], v2, s[16:19], s75 offen sc1
    v_mfma_f32_16x16x32_bf16 v[148:151], a[124:127], v[56:59], v[148:151]
    ds_read_b64_tr_b16 a[104:105], v211 offset:4096
    ds_read_b64_tr_b16 a[106:107], v211 offset:6144
    s_waitcnt lgkmcnt(4)
    v_mfma_f32_16x16x32_bf16 v[144:147], a[128:131], v[28:31], v[144:147]
    ds_read_b64_tr_b16 a[108:109], v211 offset:8192
    ds_read_b64_tr_b16 a[110:111], v211 offset:10240
    v_mfma_f32_16x16x32_bf16 v[148:151], a[128:131], v[60:63], v[148:151]
    s_add_u32 s75, s72, 32768
    v_mfma_f32_16x16x32_bf16 v[144:147], a[68:71], v[32:35], v[144:147]
    ds_read_b64_tr_b16 a[112:113], v211 offset:12288
    ds_read_b64_tr_b16 a[114:115], v211 offset:14336
    v_mfma_f32_16x16x32_bf16 v[148:151], a[68:71], v[64:67], v[148:151]
    buffer_store_dwordx4 v[200:203], v2, s[16:19], s75 offen sc1
    v_mfma_f32_16x16x32_bf16 v[144:147], a[72:75], v[36:39], v[144:147]
    ds_read_b64_tr_b16 a[116:117], v211 offset:16384
    ds_read_b64_tr_b16 a[118:119], v211 offset:18432
    v_mfma_f32_16x16x32_bf16 v[148:151], a[72:75], v[68:71], v[148:151]
    s_add_u32 s75, s72, 49152
    v_mfma_f32_16x16x32_bf16 v[144:147], a[76:79], v[40:43], v[144:147]
    ds_read_b64_tr_b16 a[120:121], v211 offset:20480
    ds_read_b64_tr_b16 a[122:123], v211 offset:22528
    v_mfma_f32_16x16x32_bf16 v[148:151], a[76:79], v[72:75], v[148:151]
    buffer_store_dwordx4 v[204:207], v2, s[16:19], s75 offen sc1
    v_mfma_f32_16x16x32_bf16 v[144:147], a[80:83], v[44:47], v[144:147]
    ds_read_b64_tr_b16 a[124:125], v211 offset:24576
    ds_read_b64_tr_b16 a[126:127], v211 offset:26624
    v_mfma_f32_16x16x32_bf16 v[148:151], a[80:83], v[76:79], v[148:151]
    s_add_u32 s72, s72, 65536
    v_mfma_f32_16x16x32_bf16 v[152:155], a[84:87], v[80:83], 0
    ds_read_b64_tr_b16 a[128:129], v211 offset:28672
    ds_read_b64_tr_b16 a[130:131], v211 offset:30720
    v_mfma_f32_16x16x32_bf16 v[156:159], a[84:87], v[84:87], 0
    v_mfma_f32_16x16x32_bf16 v[152:155], a[88:91], v[88:91], v[152:155]
    v_mfma_f32_16x16x32_bf16 v[156:159], a[88:91], v[92:95], v[156:159]
    v_mfma_f32_16x16x32_bf16 v[152:155], a[92:95], v[96:99], v[152:155]
    v_mfma_f32_16x16x32_bf16 v[156:159], a[92:95], v[100:103], v[156:159]
    v_mfma_f32_16x16x32_bf16 v[152:155], a[96:99], v[104:107], v[152:155]
    v_mfma_f32_16x16x32_bf16 v[156:159], a[96:99], v[108:111], v[156:159]
    s_waitcnt lgkmcnt(0)
    v_mfma_f32_16x16x32_bf16 v[152:155], a[100:103], v[16:19], v[152:155]
    s_waitcnt vmcnt(4) lgkmcnt(0)
    s_barrier
    v_mfma_f32_16x16x32_bf16 v[156:159], a[100:103], v[48:51], v[156:159]
    ds_read_b64_tr_b16 a[68:69], v212 offset:32768
    ds_read_b64_tr_b16 a[70:71], v212 offset:34816
    v_mfma_f32_16x16x32_bf16 v[152:155], a[104:107], v[20:23], v[152:155]
    ds_read_b64_tr_b16 a[72:73], v212 offset:36864
    v_mfma_f32_16x16x32_bf16 v[156:159], a[104:107], v[52:55], v[156:159]
    ds_read_b64_tr_b16 a[74:75], v212 offset:38912
    v_mfma_f32_16x16x32_bf16 v[152:155], a[108:111], v[24:27], v[152:155]
    ds_read_b64_tr_b16 a[76:77], v212 offset:40960
    v_mfma_f32_16x16x32_bf16 v[156:159], a[108:111], v[56:59], v[156:159]
    ds_read_b64_tr_b16 a[78:79], v212 offset:43008
    v_mfma_f32_16x16x32_bf16 v[152:155], a[112:115], v[28:31], v[152:155]
    ds_read_b64_tr_b16 a[80:81], v212 offset:45056
    v_mfma_f32_16x16x32_bf16 v[156:159], a[112:115], v[60:63], v[156:159]
    ds_read_b64_tr_b16 a[82:83], v212 offset:47104
    v_mfma_f32_16x16x32_bf16 v[152:155], a[116:119], v[32:35], v[152:155]
    ds_read_b64_tr_b16 a[84:85], v212 offset:0
    ds_read_b64_tr_b16 a[86:87], v212 offset:2048
    v_mfma_f32_16x16x32_bf16 v[156:159], a[116:119], v[64:67], v[156:159]
    ds_read_b64_tr_b16 a[88:89], v212 offset:4096
    v_mfma_f32_16x16x32_bf16 v[152:155], a[120:123], v[36:39], v[152:155]
    ds_read_b64_tr_b16 a[90:91], v212 offset:6144
    v_mfma_f32_16x16x32_bf16 v[156:159], a[120:123], v[68:71], v[156:159]
    ds_read_b64_tr_b16 a[92:93], v212 offset:8192
    v_mfma_f32_16x16x32_bf16 v[152:155], a[124:127], v[40:43], v[152:155]
    ds_read_b64_tr_b16 a[94:95], v212 offset:10240
    v_mfma_f32_16x16x32_bf16 v[156:159], a[124:127], v[72:75], v[156:159]
    ds_read_b64_tr_b16 a[96:97], v212 offset:12288
    v_mfma_f32_16x16x32_bf16 v[152:155], a[128:131], v[44:47], v[152:155]
    ds_read_b64_tr_b16 a[98:99], v212 offset:14336
    v_mfma_f32_16x16x32_bf16 v[156:159], a[128:131], v[76:79], v[156:159]
    s_add_u32 s73, s73, 1
    s_cmp_lt_u32 s73, 7
    s_cbranch_scc1 K2_OLOOP
    s_nop 7
    v_cvt_pk_bf16_f32 v192, v128, v129
    v_cvt_pk_bf16_f32 v193, v130, v131
    v_cvt_pk_bf16_f32 v194, v132, v133
    v_cvt_pk_bf16_f32 v195, v134, v135
    s_add_u32 s75, s72, 0
    buffer_store_dwordx4 v[192:195], v2, s[16:19], s75 offen sc1
    v_cvt_pk_bf16_f32 v196, v136, v137
    v_cvt_pk_bf16_f32 v197, v138, v139
    v_cvt_pk_bf16_f32 v198, v140, v141
    v_cvt_pk_bf16_f32 v199, v142, v143
    s_add_u32 s75, s72, 16384
    buffer_store_dwordx4 v[196:199], v2, s[16:19], s75 offen sc1
    v_cvt_pk_bf16_f32 v200, v144, v145
    v_cvt_pk_bf16_f32 v201, v146, v147
    v_cvt_pk_bf16_f32 v202, v148, v149
    v_cvt_pk_bf16_f32 v203, v150, v151
    s_add_u32 s75, s72, 32768
    buffer_store_dwordx4 v[200:203], v2, s[16:19], s75 offen sc1
    v_cvt_pk_bf16_f32 v204, v152, v153
    v_cvt_pk_bf16_f32 v205, v154, v155
    v_cvt_pk_bf16_f32 v206, v156, v157
    v_cvt_pk_bf16_f32 v207, v158, v159
    s_add_u32 s75, s72, 49152
    buffer_store_dwordx4 v[204:207], v2, s[16:19], s75 offen sc1
K2_DONE:
K2_END:
    s_endpgm
.globl k4_red_kernel
.p2align 8
.type k4_red_kernel,@function
k4_red_kernel:
    s_cmp_ge_u32 s2, 224
    s_cbranch_scc1 K4_END
    s_load_dwordx2 s[4:5], s[0:1], 88
    s_load_dwordx2 s[6:7], s[0:1], 104
    v_lshrrev_b32 v2, 6, v0
    v_and_b32 v1, 63, v0
    s_nop 0
    v_readfirstlane_b32 s3, v2
    v_lshlrev_b32 v3, 4, v1
    s_mul_i32 s16, s2, 8
    s_add_u32 s16, s16, s3
    s_lshl_b32 s18, s16, 14
    s_add_u32 s18, s18, 100663296
    s_mov_b32 s14, 268435456
    s_mov_b32 s15, 0x20000
    s_waitcnt lgkmcnt(0)
    s_mov_b32 s12, s6
    s_mov_b32 s13, s7
    buffer_load_dwordx4 v[16:19], v3, s[12:15], s18 offen offset:0
    buffer_load_dwordx4 v[20:23], v3, s[12:15], s18 offen offset:1024
    buffer_load_dwordx4 v[24:27], v3, s[12:15], s18 offen offset:2048
    buffer_load_dwordx4 v[28:31], v3, s[12:15], s18 offen offset:3072
    s_add_u32 s18, s18, 4096
    buffer_load_dwordx4 v[32:35], v3, s[12:15], s18 offen offset:0
    buffer_load_dwordx4 v[36:39], v3, s[12:15], s18 offen offset:1024
    buffer_load_dwordx4 v[40:43], v3, s[12:15], s18 offen offset:2048
    buffer_load_dwordx4 v[44:47], v3, s[12:15], s18 offen offset:3072
    s_add_u32 s18, s18, 4096
    buffer_load_dwordx4 v[48:51], v3, s[12:15], s18 offen offset:0
    buffer_load_dwordx4 v[52:55], v3, s[12:15], s18 offen offset:1024
    buffer_load_dwordx4 v[56:59], v3, s[12:15], s18 offen offset:2048
    buffer_load_dwordx4 v[60:63], v3, s[12:15], s18 offen offset:3072
    s_add_u32 s18, s18, 4096
    buffer_load_dwordx4 v[64:67], v3, s[12:15], s18 offen offset:0
    buffer_load_dwordx4 v[68:71], v3, s[12:15], s18 offen offset:1024
    buffer_load_dwordx4 v[72:75], v3, s[12:15], s18 offen offset:2048
    buffer_load_dwordx4 v[76:79], v3, s[12:15], s18 offen offset:3072
    s_mov_b32 s8, s4
    s_mov_b32 s9, s5
    s_mov_b32 s10, 1835008
    s_mov_b32 s11, 0x20000
    s_mul_hi_u32 s17, s16, 153391690
    s_mul_i32 s19, s17, 28
    s_sub_u32 s19, s16, s19
    s_lshr_b32 s20, s17, 2
    s_lshl_b32 s20, s20, 7
    s_and_b32 s21, s17, 3
    s_lshl_b32 s21, s21, 4
    s_add_u32 s20, s20, s21
    v_and_b32 v4, 15, v1
    v_bfe_u32 v5, v1, 4, 1
    v_lshl_add_u32 v4, v5, 6, v4
    v_add_u32 v4, s20, v4
    v_mul_u32_u24 v4, 896, v4
    v_lshrrev_b32 v5, 5, v1
    v_lshl_add_u32 v4, v5, 4, v4
    s_lshl_b32 s22, s19, 5
    v_add_u32 v4, s22, v4
    v_mov_b32 v8, 0
    v_mov_b32 v9, 0
    v_mov_b32 v10, 0
    v_mov_b32 v11, 0
    v_mov_b32 v12, 0
    v_mov_b32 v13, 0
    v_mov_b32 v14, 0
    v_mov_b32 v15, 0
    s_waitcnt vmcnt(15)
    v_lshlrev_b32 v6, 16, v16
    v_and_b32 v7, 0xffff0000, v16
    v_add_f32 v8, v8, v6
    v_add_f32 v9, v9, v7
    v_lshlrev_b32 v6, 16, v17
    v_and_b32 v7, 0xffff0000, v17
    v_add_f32 v10, v10, v6
    v_add_f32 v11, v11, v7
    v_lshlrev_b32 v6, 16, v18
    v_and_b32 v7, 0xffff0000, v18
    v_add_f32 v12, v12, v6
    v_add_f32 v13, v13, v7
    v_lshlrev_b32 v6, 16, v19
    v_and_b32 v7, 0xffff0000, v19
    v_add_f32 v14, v14, v6
    v_add_f32 v15, v15, v7
    s_waitcnt vmcnt(14)
    v_lshlrev_b32 v6, 16, v20
    v_and_b32 v7, 0xffff0000, v20
    v_add_f32 v8, v8, v6
    v_add_f32 v9, v9, v7
    v_lshlrev_b32 v6, 16, v21
    v_and_b32 v7, 0xffff0000, v21
    v_add_f32 v10, v10, v6
    v_add_f32 v11, v11, v7
    v_lshlrev_b32 v6, 16, v22
    v_and_b32 v7, 0xffff0000, v22
    v_add_f32 v12, v12, v6
    v_add_f32 v13, v13, v7
    v_lshlrev_b32 v6, 16, v23
    v_and_b32 v7, 0xffff0000, v23
    v_add_f32 v14, v14, v6
    v_add_f32 v15, v15, v7
    s_waitcnt vmcnt(13)
    v_lshlrev_b32 v6, 16, v24
    v_and_b32 v7, 0xffff0000, v24
    v_add_f32 v8, v8, v6
    v_add_f32 v9, v9, v7
    v_lshlrev_b32 v6, 16, v25
    v_and_b32 v7, 0xffff0000, v25
    v_add_f32 v10, v10, v6
    v_add_f32 v11, v11, v7
    v_lshlrev_b32 v6, 16, v26
    v_and_b32 v7, 0xffff0000, v26
    v_add_f32 v12, v12, v6
    v_add_f32 v13, v13, v7
    v_lshlrev_b32 v6, 16, v27
    v_and_b32 v7, 0xffff0000, v27
    v_add_f32 v14, v14, v6
    v_add_f32 v15, v15, v7
    s_waitcnt vmcnt(12)
    v_lshlrev_b32 v6, 16, v28
    v_and_b32 v7, 0xffff0000, v28
    v_add_f32 v8, v8, v6
    v_add_f32 v9, v9, v7
    v_lshlrev_b32 v6, 16, v29
    v_and_b32 v7, 0xffff0000, v29
    v_add_f32 v10, v10, v6
    v_add_f32 v11, v11, v7
    v_lshlrev_b32 v6, 16, v30
    v_and_b32 v7, 0xffff0000, v30
    v_add_f32 v12, v12, v6
    v_add_f32 v13, v13, v7
    v_lshlrev_b32 v6, 16, v31
    v_and_b32 v7, 0xffff0000, v31
    v_add_f32 v14, v14, v6
    v_add_f32 v15, v15, v7
    s_waitcnt vmcnt(11)
    v_lshlrev_b32 v6, 16, v32
    v_and_b32 v7, 0xffff0000, v32
    v_add_f32 v8, v8, v6
    v_add_f32 v9, v9, v7
    v_lshlrev_b32 v6, 16, v33
    v_and_b32 v7, 0xffff0000, v33
    v_add_f32 v10, v10, v6
    v_add_f32 v11, v11, v7
    v_lshlrev_b32 v6, 16, v34
    v_and_b32 v7, 0xffff0000, v34
    v_add_f32 v12, v12, v6
    v_add_f32 v13, v13, v7
    v_lshlrev_b32 v6, 16, v35
    v_and_b32 v7, 0xffff0000, v35
    v_add_f32 v14, v14, v6
    v_add_f32 v15, v15, v7
    s_waitcnt vmcnt(10)
    v_lshlrev_b32 v6, 16, v36
    v_and_b32 v7, 0xffff0000, v36
    v_add_f32 v8, v8, v6
    v_add_f32 v9, v9, v7
    v_lshlrev_b32 v6, 16, v37
    v_and_b32 v7, 0xffff0000, v37
    v_add_f32 v10, v10, v6
    v_add_f32 v11, v11, v7
    v_lshlrev_b32 v6, 16, v38
    v_and_b32 v7, 0xffff0000, v38
    v_add_f32 v12, v12, v6
    v_add_f32 v13, v13, v7
    v_lshlrev_b32 v6, 16, v39
    v_and_b32 v7, 0xffff0000, v39
    v_add_f32 v14, v14, v6
    v_add_f32 v15, v15, v7
    s_waitcnt vmcnt(9)
    v_lshlrev_b32 v6, 16, v40
    v_and_b32 v7, 0xffff0000, v40
    v_add_f32 v8, v8, v6
    v_add_f32 v9, v9, v7
    v_lshlrev_b32 v6, 16, v41
    v_and_b32 v7, 0xffff0000, v41
    v_add_f32 v10, v10, v6
    v_add_f32 v11, v11, v7
    v_lshlrev_b32 v6, 16, v42
    v_and_b32 v7, 0xffff0000, v42
    v_add_f32 v12, v12, v6
    v_add_f32 v13, v13, v7
    v_lshlrev_b32 v6, 16, v43
    v_and_b32 v7, 0xffff0000, v43
    v_add_f32 v14, v14, v6
    v_add_f32 v15, v15, v7
    s_waitcnt vmcnt(8)
    v_lshlrev_b32 v6, 16, v44
    v_and_b32 v7, 0xffff0000, v44
    v_add_f32 v8, v8, v6
    v_add_f32 v9, v9, v7
    v_lshlrev_b32 v6, 16, v45
    v_and_b32 v7, 0xffff0000, v45
    v_add_f32 v10, v10, v6
    v_add_f32 v11, v11, v7
    v_lshlrev_b32 v6, 16, v46
    v_and_b32 v7, 0xffff0000, v46
    v_add_f32 v12, v12, v6
    v_add_f32 v13, v13, v7
    v_lshlrev_b32 v6, 16, v47
    v_and_b32 v7, 0xffff0000, v47
    v_add_f32 v14, v14, v6
    v_add_f32 v15, v15, v7
    s_waitcnt vmcnt(7)
    v_lshlrev_b32 v6, 16, v48
    v_and_b32 v7, 0xffff0000, v48
    v_add_f32 v8, v8, v6
    v_add_f32 v9, v9, v7
    v_lshlrev_b32 v6, 16, v49
    v_and_b32 v7, 0xffff0000, v49
    v_add_f32 v10, v10, v6
    v_add_f32 v11, v11, v7
    v_lshlrev_b32 v6, 16, v50
    v_and_b32 v7, 0xffff0000, v50
    v_add_f32 v12, v12, v6
    v_add_f32 v13, v13, v7
    v_lshlrev_b32 v6, 16, v51
    v_and_b32 v7, 0xffff0000, v51
    v_add_f32 v14, v14, v6
    v_add_f32 v15, v15, v7
    s_waitcnt vmcnt(6)
    v_lshlrev_b32 v6, 16, v52
    v_and_b32 v7, 0xffff0000, v52
    v_add_f32 v8, v8, v6
    v_add_f32 v9, v9, v7
    v_lshlrev_b32 v6, 16, v53
    v_and_b32 v7, 0xffff0000, v53
    v_add_f32 v10, v10, v6
    v_add_f32 v11, v11, v7
    v_lshlrev_b32 v6, 16, v54
    v_and_b32 v7, 0xffff0000, v54
    v_add_f32 v12, v12, v6
    v_add_f32 v13, v13, v7
    v_lshlrev_b32 v6, 16, v55
    v_and_b32 v7, 0xffff0000, v55
    v_add_f32 v14, v14, v6
    v_add_f32 v15, v15, v7
    s_waitcnt vmcnt(5)
    v_lshlrev_b32 v6, 16, v56
    v_and_b32 v7, 0xffff0000, v56
    v_add_f32 v8, v8, v6
    v_add_f32 v9, v9, v7
    v_lshlrev_b32 v6, 16, v57
    v_and_b32 v7, 0xffff0000, v57
    v_add_f32 v10, v10, v6
    v_add_f32 v11, v11, v7
    v_lshlrev_b32 v6, 16, v58
    v_and_b32 v7, 0xffff0000, v58
    v_add_f32 v12, v12, v6
    v_add_f32 v13, v13, v7
    v_lshlrev_b32 v6, 16, v59
    v_and_b32 v7, 0xffff0000, v59
    v_add_f32 v14, v14, v6
    v_add_f32 v15, v15, v7
    s_waitcnt vmcnt(4)
    v_lshlrev_b32 v6, 16, v60
    v_and_b32 v7, 0xffff0000, v60
    v_add_f32 v8, v8, v6
    v_add_f32 v9, v9, v7
    v_lshlrev_b32 v6, 16, v61
    v_and_b32 v7, 0xffff0000, v61
    v_add_f32 v10, v10, v6
    v_add_f32 v11, v11, v7
    v_lshlrev_b32 v6, 16, v62
    v_and_b32 v7, 0xffff0000, v62
    v_add_f32 v12, v12, v6
    v_add_f32 v13, v13, v7
    v_lshlrev_b32 v6, 16, v63
    v_and_b32 v7, 0xffff0000, v63
    v_add_f32 v14, v14, v6
    v_add_f32 v15, v15, v7
    s_waitcnt vmcnt(3)
    v_lshlrev_b32 v6, 16, v64
    v_and_b32 v7, 0xffff0000, v64
    v_add_f32 v8, v8, v6
    v_add_f32 v9, v9, v7
    v_lshlrev_b32 v6, 16, v65
    v_and_b32 v7, 0xffff0000, v65
    v_add_f32 v10, v10, v6
    v_add_f32 v11, v11, v7
    v_lshlrev_b32 v6, 16, v66
    v_and_b32 v7, 0xffff0000, v66
    v_add_f32 v12, v12, v6
    v_add_f32 v13, v13, v7
    v_lshlrev_b32 v6, 16, v67
    v_and_b32 v7, 0xffff0000, v67
    v_add_f32 v14, v14, v6
    v_add_f32 v15, v15, v7
    s_waitcnt vmcnt(2)
    v_lshlrev_b32 v6, 16, v68
    v_and_b32 v7, 0xffff0000, v68
    v_add_f32 v8, v8, v6
    v_add_f32 v9, v9, v7
    v_lshlrev_b32 v6, 16, v69
    v_and_b32 v7, 0xffff0000, v69
    v_add_f32 v10, v10, v6
    v_add_f32 v11, v11, v7
    v_lshlrev_b32 v6, 16, v70
    v_and_b32 v7, 0xffff0000, v70
    v_add_f32 v12, v12, v6
    v_add_f32 v13, v13, v7
    v_lshlrev_b32 v6, 16, v71
    v_and_b32 v7, 0xffff0000, v71
    v_add_f32 v14, v14, v6
    v_add_f32 v15, v15, v7
    s_waitcnt vmcnt(1)
    v_lshlrev_b32 v6, 16, v72
    v_and_b32 v7, 0xffff0000, v72
    v_add_f32 v8, v8, v6
    v_add_f32 v9, v9, v7
    v_lshlrev_b32 v6, 16, v73
    v_and_b32 v7, 0xffff0000, v73
    v_add_f32 v10, v10, v6
    v_add_f32 v11, v11, v7
    v_lshlrev_b32 v6, 16, v74
    v_and_b32 v7, 0xffff0000, v74
    v_add_f32 v12, v12, v6
    v_add_f32 v13, v13, v7
    v_lshlrev_b32 v6, 16, v75
    v_and_b32 v7, 0xffff0000, v75
    v_add_f32 v14, v14, v6
    v_add_f32 v15, v15, v7
    s_waitcnt vmcnt(0)
    v_lshlrev_b32 v6, 16, v76
    v_and_b32 v7, 0xffff0000, v76
    v_add_f32 v8, v8, v6
    v_add_f32 v9, v9, v7
    v_lshlrev_b32 v6, 16, v77
    v_and_b32 v7, 0xffff0000, v77
    v_add_f32 v10, v10, v6
    v_add_f32 v11, v11, v7
    v_lshlrev_b32 v6, 16, v78
    v_and_b32 v7, 0xffff0000, v78
    v_add_f32 v12, v12, v6
    v_add_f32 v13, v13, v7
    v_lshlrev_b32 v6, 16, v79
    v_and_b32 v7, 0xffff0000, v79
    v_add_f32 v14, v14, v6
    v_add_f32 v15, v15, v7
    v_cvt_pk_bf16_f32 v80, v8, v9
    v_cvt_pk_bf16_f32 v81, v10, v11
    v_cvt_pk_bf16_f32 v82, v12, v13
    v_cvt_pk_bf16_f32 v83, v14, v15
    s_nop 1
    v_permlane16_swap_b32 v80, v82
    v_permlane16_swap_b32 v81, v83
    buffer_store_dwordx4 v[80:83], v4, s[8:11], 0 offen
K4_END:
    s_endpgm
.section .rodata,"a"
.p2align 6
.amdhsa_kernel k1_proj_kernel
  .amdhsa_next_free_vgpr 512
  .amdhsa_next_free_sgpr 102
  .amdhsa_accum_offset 256
  .amdhsa_group_segment_fixed_size 0
  .amdhsa_kernarg_size 112
  .amdhsa_user_sgpr_count 2
  .amdhsa_user_sgpr_kernarg_segment_ptr 1
  .amdhsa_system_sgpr_workgroup_id_x 1
.end_amdhsa_kernel
.p2align 6
.amdhsa_kernel k2_attn_kernel
  .amdhsa_next_free_vgpr 512
  .amdhsa_next_free_sgpr 102
  .amdhsa_accum_offset 256
  .amdhsa_group_segment_fixed_size 0
  .amdhsa_kernarg_size 112
  .amdhsa_user_sgpr_count 2
  .amdhsa_user_sgpr_kernarg_segment_ptr 1
  .amdhsa_system_sgpr_workgroup_id_x 1
.end_amdhsa_kernel
.p2align 6
.amdhsa_kernel k4_red_kernel
  .amdhsa_next_free_vgpr 88
  .amdhsa_next_free_sgpr 32
  .amdhsa_accum_offset 88
  .amdhsa_group_segment_fixed_size 0
  .amdhsa_kernarg_size 112
  .amdhsa_user_sgpr_count 2
  .amdhsa_user_sgpr_kernarg_segment_ptr 1
  .amdhsa_system_sgpr_workgroup_id_x 1
.end_amdhsa_kernel
```
